```python
import torch

def _softmax(x, axis=-1):
    return torch.softmax(x, dim=axis)

def _gelu(x):
    return torch.nn.functional.gelu(x, approximate='tanh')

def _silu(x):
    return torch.nn.functional.silu(x)

def _sigmoid(x):
    return torch.sigmoid(x)

def _layernorm(x, axis=-1, eps=1e-05):
    m = x.mean(dim=axis, keepdim=True)
    v = x.var(dim=axis, keepdim=True, unbiased=False)
    return (x - m) / torch.sqrt(v + eps)

def _scatter_add(tgt, idx, src, axis=0):
    return tgt.clone().index_add_(axis, idx, src)

def _segment_sum(src, seg, n):
    out = torch.zeros((n,) + src.shape[1:], dtype=src.dtype)
    return out.index_add_(0, seg, src)

def _pad(x, pw):
    flat = tuple((v for pair in reversed(pw) for v in pair))
    return torch.nn.functional.pad(x, flat)
kernel_name = 'adaLN_cond__memory_aug_recurrent_mem_tr__dense_activation_gelu__prompt'

def setup_inputs():

    _w = lambda a: (lambda t: t.to(torch.bfloat16) if t.is_floating_point() else t)(torch.as_tensor(a))

    def _A_setup():
        B, S, Dm = (1, 2048, 512)
        H, Dh = (32, 128)
        M, seg = (8, 32)
        seg = min(seg, S)
        S = S // seg * seg
        return {'x': _w((lambda *s: torch.randn(*s, dtype=torch.bfloat16) * 0.05)(B, S, Dm)), 'mem0': _w((lambda *s: torch.randn(*s, dtype=torch.bfloat16) * 0.8)(B, M, Dm)), 'Wq': _w((lambda *s: torch.randn(*s, dtype=torch.bfloat16) * 1.6)(Dm, H, Dh) * Dm ** (-0.5)), 'Wk': _w((lambda *s: torch.randn(*s, dtype=torch.bfloat16) * 1.6)(Dm, H, Dh) * Dm ** (-0.5)), 'Wv': _w((lambda *s: torch.randn(*s, dtype=torch.bfloat16) * 0.8)(Dm, H, Dh) * Dm ** (-0.5)), 'Wo': _w((lambda *s: torch.randn(*s, dtype=torch.bfloat16) * 0.8)(H, Dh, Dm) * (H * Dh) ** (-0.5)), 'seg_len': seg}
    _A_in = _A_setup()

    def _B_setup():
        B, S, D, F = (1, 2048, 512, 1376)
        return {'x': _w((lambda *s: torch.randn(*s, dtype=torch.bfloat16) * 0.05)(B, S, D)), 'w1': _w((lambda *s: torch.randn(*s, dtype=torch.bfloat16) * 1.6)(D, F) * D ** (-0.5)), 'b1': _w((lambda *s: torch.randn(*s, dtype=torch.bfloat16) * 1.6)(F) * 0.01), 'w2': _w((lambda *s: torch.randn(*s, dtype=torch.bfloat16) * 0.2)(F, D) * F ** (-0.5)), 'b2': _w((lambda *s: torch.randn(*s, dtype=torch.bfloat16) * 0.2)(D) * 0.01)}
    _B_in = _B_setup()
    return {'A_x': _A_in['x'], 'A_mem0': _A_in['mem0'], 'A_Wq': _A_in['Wq'], 'A_Wk': _A_in['Wk'], 'A_Wv': _A_in['Wv'], 'A_Wo': _A_in['Wo'], 'A_seg_len': _A_in['seg_len'], 'B_x': _B_in['x'], 'B_w1': _B_in['w1'], 'B_b1': _B_in['b1'], 'B_w2': _B_in['w2'], 'B_b2': _B_in['b2'], 'c': _w((lambda *s: torch.randn(*s, dtype=torch.bfloat16) * 0.05)(1, 512) * 8.0), 'w_mod': _w((lambda *s: torch.randn(*s, dtype=torch.bfloat16) * 0.05)(512, 6 * 512) * 512 ** (-0.5) * 8.0)}

def reference(A_x, A_mem0, A_Wq, A_Wk, A_Wv, A_Wo, A_seg_len, B_x, B_w1, B_b1, B_w2, B_b2, c, w_mod):

    def _A_ref(x, mem0, Wq, Wk, Wv, Wo, seg_len):
        B, S, Dm = x.shape
        H, Dh = (Wq.shape[1], Wq.shape[2])
        M = mem0.shape[1]
        scale = Dh ** (-0.5)
        n_seg = S // seg_len
        L = M + seg_len
        idx = torch.arange(L)
        mask = (idx[:, None] < M) | (idx[:, None] >= idx[None, :])
        mem = mem0
        outs = []
        for s in range(n_seg):
            xs = x[:, s * seg_len:(s + 1) * seg_len, :].clone()
            h = torch.concatenate([mem, xs], axis=1)
            q = torch.einsum('btd,dhe->bhte', h, Wq)
            k = torch.einsum('btd,dhe->bhte', h, Wk)
            v = torch.einsum('btd,dhe->bhte', h, Wv)
            scores = torch.einsum('bhqe,bhke->bhqk', q, k) * scale
            scores = torch.where(mask[None, None], scores, -1000000000.0)
            p = _softmax(scores, axis=-1)
            o = torch.einsum('bhqk,bhke->bhqe', p, v)
            o = torch.einsum('bhte,hed->btd', o, Wo)
            mem = o[:, :M, :].clone()
            outs.append(o[:, M:, :])
        return torch.concatenate(outs, axis=1)

    def _B_ref(x, w1, b1, w2, b2):
        h = torch.einsum('bsd,df->bsf', x, w1) + b1
        h = _gelu(h)
        return torch.einsum('bsf,fd->bsd', h, w2) + b2
    x = A_x
    mod = (_silu(c) @ w_mod).reshape(c.shape[0], 6, 1, -1)
    sa, ca, ga, sb, cb, gb = (mod[:, 0].clone(), mod[:, 1].clone(), mod[:, 2].clone(), mod[:, 3].clone(), mod[:, 4].clone(), mod[:, 5].clone())
    h = _layernorm(x, axis=-1) * (1 + ca) + sa
    x = x + ga * _A_ref(h, A_mem0, A_Wq, A_Wk, A_Wv, A_Wo, A_seg_len)
    h = _layernorm(x, axis=-1) * (1 + cb) + sb
    x = x + gb * _B_ref(h, B_w1, B_b1, B_w2, B_b2)
    return x
```

```asm
; @launch grid=(256,1,1) block=(256,1,1) lds=155648
.amdgcn_target "amdgcn-amd-amdhsa--gfx950"
.text
.globl adaLN_cond__memory_aug_recurrent_mem_tr__dense_activation_gelu__prompt_kernel
.p2align 8
.type adaLN_cond__memory_aug_recurrent_mem_tr__dense_activation_gelu__prompt_kernel,@function
adaLN_cond__memory_aug_recurrent_mem_tr__dense_activation_gelu__prompt_kernel:
    s_cmp_ge_u32 s2, 256
    s_cbranch_scc1 L_adaLN_cond__memory_aug_recurrent_mem_tr__dense_activation_gelu__prompt_kernel_exit
    s_load_dwordx2 s[90:91], s[0:1], 120
    s_load_dwordx2 s[4:5], s[0:1], 128
    s_getreg_b32 s3, hwreg(HW_REG_XCC_ID)
    s_and_b32 s3, s3, 15
    v_lshrrev_b32 v1, 6, v0
    s_nop 0
    v_readfirstlane_b32 s92, v1
    s_waitcnt lgkmcnt(0)
    s_mov_b32 s6, 268435456
    s_mov_b32 s7, 0x00020000
    s_nop 0
    s_cmp_lg_u32 s92, 0
    s_cbranch_scc1 L_adaLN_cond__memory_aug_recurrent_mem_tr__dense_activation_gelu__prompt_kernel_el_wait
    s_mov_b64 exec, 1
    v_mov_b32 v2, 1
    s_lshl_b32 s10, s3, 2
    v_mov_b32 v3, s10
    global_atomic_add v4, v3, v2, s[90:91] sc0
    s_waitcnt vmcnt(0)
    v_mov_b32 v3, 64
    global_atomic_add v3, v2, s[90:91]
    v_readfirstlane_b32 s10, v4
    s_lshl_b32 s14, s3, 8
    s_nop 2
    s_or_b32 s14, s14, s10
    s_cmp_lg_u32 s3, 0
    s_cbranch_scc1 L_adaLN_cond__memory_aug_recurrent_mem_tr__dense_activation_gelu__prompt_kernel_el_other
    s_cmp_lt_u32 s10, 32
    s_cbranch_scc1 L_adaLN_cond__memory_aug_recurrent_mem_tr__dense_activation_gelu__prompt_kernel_el_pub
L_adaLN_cond__memory_aug_recurrent_mem_tr__dense_activation_gelu__prompt_kernel_el_other:
    v_mov_b32 v3, 80
    global_atomic_add v4, v3, v2, s[90:91] sc0
    s_waitcnt vmcnt(0)
    v_readfirstlane_b32 s10, v4
    s_nop 3
    s_add_u32 s10, s10, 0x100
L_adaLN_cond__memory_aug_recurrent_mem_tr__dense_activation_gelu__prompt_kernel_el_pub:
    v_mov_b32 v4, s10
    v_mov_b32 v5, s14
    v_mov_b32 v3, 0
    ds_write_b64 v3, v[4:5]
    s_mov_b64 exec, -1
L_adaLN_cond__memory_aug_recurrent_mem_tr__dense_activation_gelu__prompt_kernel_el_wait:
    s_waitcnt lgkmcnt(0)
    s_barrier
    v_mov_b32 v3, 0
    ds_read_b64 v[4:5], v3
    s_waitcnt lgkmcnt(0)
    v_readfirstlane_b32 s8, v4
    v_readfirstlane_b32 s89, v5
    s_barrier
    s_nop 1
    s_cmp_lt_u32 s8, 32
    s_cbranch_scc1 L_adaLN_cond__memory_aug_recurrent_mem_tr__dense_activation_gelu__prompt_kernel_rec
    s_cmp_ge_u32 s8, 0x1000
    s_cbranch_scc1 L_adaLN_cond__memory_aug_recurrent_mem_tr__dense_activation_gelu__prompt_kernel_exit
    s_sub_u32 s95, s8, 0x100
    v_accvgpr_write_b32 a255, v0
    s_cmp_lt_u32 s95, 48
    s_cbranch_scc1 L_adaLN_cond__memory_aug_recurrent_mem_tr__dense_activation_gelu__prompt_kernel_t_mod
    s_cmp_lt_u32 s95, 176
    s_cbranch_scc1 L_adaLN_cond__memory_aug_recurrent_mem_tr__dense_activation_gelu__prompt_kernel_t_ln1
    s_branch L_adaLN_cond__memory_aug_recurrent_mem_tr__dense_activation_gelu__prompt_kernel_ph2
L_adaLN_cond__memory_aug_recurrent_mem_tr__dense_activation_gelu__prompt_kernel_t_mod:
    s_mov_b32 s2, s95
    s_load_dwordx2 s[12:13], s[0:1], 96
    s_load_dwordx2 s[14:15], s[0:1], 104
    s_waitcnt lgkmcnt(0)
    s_mov_b32 s16, s12
    s_and_b32 s17, s13, 0xffff
    s_mov_b32 s18, 1024
    s_mov_b32 s19, 0x00020000
    s_mov_b32 s20, s14
    s_and_b32 s21, s15, 0xffff
    s_mov_b32 s22, 3145728
    s_mov_b32 s23, 0x00020000
    v_lshrrev_b32 v3, 3, v0
    v_and_b32 v4, 7, v0
    v_mul_u32_u24 v5, 98304, v3
    v_lshl_add_u32 v5, v4, 4, v5
    s_lshl_b32 s3, s2, 7
    s_add_u32 s24, s3, 0
    buffer_load_dwordx4 v[32:35], v5, s[20:23], s24 offen
    s_add_u32 s24, s3, 6144
    buffer_load_dwordx4 v[36:39], v5, s[20:23], s24 offen
    s_add_u32 s24, s3, 12288
    buffer_load_dwordx4 v[40:43], v5, s[20:23], s24 offen
    s_add_u32 s24, s3, 18432
    buffer_load_dwordx4 v[44:47], v5, s[20:23], s24 offen
    s_add_u32 s24, s3, 24576
    buffer_load_dwordx4 v[48:51], v5, s[20:23], s24 offen
    s_add_u32 s24, s3, 30720
    buffer_load_dwordx4 v[52:55], v5, s[20:23], s24 offen
    s_add_u32 s24, s3, 36864
    buffer_load_dwordx4 v[56:59], v5, s[20:23], s24 offen
    s_add_u32 s24, s3, 43008
    buffer_load_dwordx4 v[60:63], v5, s[20:23], s24 offen
    s_add_u32 s24, s3, 49152
    buffer_load_dwordx4 v[64:67], v5, s[20:23], s24 offen
    s_add_u32 s24, s3, 55296
    buffer_load_dwordx4 v[68:71], v5, s[20:23], s24 offen
    s_add_u32 s24, s3, 61440
    buffer_load_dwordx4 v[72:75], v5, s[20:23], s24 offen
    s_add_u32 s24, s3, 67584
    buffer_load_dwordx4 v[76:79], v5, s[20:23], s24 offen
    s_add_u32 s24, s3, 73728
    buffer_load_dwordx4 v[80:83], v5, s[20:23], s24 offen
    s_add_u32 s24, s3, 79872
    buffer_load_dwordx4 v[84:87], v5, s[20:23], s24 offen
    s_add_u32 s24, s3, 86016
    buffer_load_dwordx4 v[88:91], v5, s[20:23], s24 offen
    s_add_u32 s24, s3, 92160
    buffer_load_dwordx4 v[92:95], v5, s[20:23], s24 offen
    v_lshlrev_b32 v6, 5, v3
    buffer_load_dwordx4 v[8:11], v6, s[16:19], 0 offen
    buffer_load_dwordx4 v[12:15], v6, s[16:19], 0 offen offset:16
    s_waitcnt vmcnt(1)
    v_lshlrev_b32 v16, 16, v8
    v_and_b32 v17, 0xffff0000, v8
    v_lshlrev_b32 v18, 16, v9
    v_and_b32 v19, 0xffff0000, v9
    v_lshlrev_b32 v20, 16, v10
    v_and_b32 v21, 0xffff0000, v10
    v_lshlrev_b32 v22, 16, v11
    v_and_b32 v23, 0xffff0000, v11
    s_waitcnt vmcnt(0)
    v_lshlrev_b32 v24, 16, v12
    v_and_b32 v25, 0xffff0000, v12
    v_lshlrev_b32 v26, 16, v13
    v_and_b32 v27, 0xffff0000, v13
    v_lshlrev_b32 v28, 16, v14
    v_and_b32 v29, 0xffff0000, v14
    v_lshlrev_b32 v30, 16, v15
    v_and_b32 v31, 0xffff0000, v15
    v_mul_f32 v7, 0xbfb8aa3b, v16
    v_exp_f32 v7, v7
    s_nop 0
    v_add_f32 v7, 1.0, v7
    v_rcp_f32 v7, v7
    s_nop 0
    v_mul_f32 v16, v16, v7
    v_mul_f32 v7, 0xbfb8aa3b, v17
    v_exp_f32 v7, v7
    s_nop 0
    v_add_f32 v7, 1.0, v7
    v_rcp_f32 v7, v7
    s_nop 0
    v_mul_f32 v17, v17, v7
    v_mul_f32 v7, 0xbfb8aa3b, v18
    v_exp_f32 v7, v7
    s_nop 0
    v_add_f32 v7, 1.0, v7
    v_rcp_f32 v7, v7
    s_nop 0
    v_mul_f32 v18, v18, v7
    v_mul_f32 v7, 0xbfb8aa3b, v19
    v_exp_f32 v7, v7
    s_nop 0
    v_add_f32 v7, 1.0, v7
    v_rcp_f32 v7, v7
    s_nop 0
    v_mul_f32 v19, v19, v7
    v_mul_f32 v7, 0xbfb8aa3b, v20
    v_exp_f32 v7, v7
    s_nop 0
    v_add_f32 v7, 1.0, v7
    v_rcp_f32 v7, v7
    s_nop 0
    v_mul_f32 v20, v20, v7
    v_mul_f32 v7, 0xbfb8aa3b, v21
    v_exp_f32 v7, v7
    s_nop 0
    v_add_f32 v7, 1.0, v7
    v_rcp_f32 v7, v7
    s_nop 0
    v_mul_f32 v21, v21, v7
    v_mul_f32 v7, 0xbfb8aa3b, v22
    v_exp_f32 v7, v7
    s_nop 0
    v_add_f32 v7, 1.0, v7
    v_rcp_f32 v7, v7
    s_nop 0
    v_mul_f32 v22, v22, v7
    v_mul_f32 v7, 0xbfb8aa3b, v23
    v_exp_f32 v7, v7
    s_nop 0
    v_add_f32 v7, 1.0, v7
    v_rcp_f32 v7, v7
    s_nop 0
    v_mul_f32 v23, v23, v7
    v_mul_f32 v7, 0xbfb8aa3b, v24
    v_exp_f32 v7, v7
    s_nop 0
    v_add_f32 v7, 1.0, v7
    v_rcp_f32 v7, v7
    s_nop 0
    v_mul_f32 v24, v24, v7
    v_mul_f32 v7, 0xbfb8aa3b, v25
    v_exp_f32 v7, v7
    s_nop 0
    v_add_f32 v7, 1.0, v7
    v_rcp_f32 v7, v7
    s_nop 0
    v_mul_f32 v25, v25, v7
    v_mul_f32 v7, 0xbfb8aa3b, v26
    v_exp_f32 v7, v7
    s_nop 0
    v_add_f32 v7, 1.0, v7
    v_rcp_f32 v7, v7
    s_nop 0
    v_mul_f32 v26, v26, v7
    v_mul_f32 v7, 0xbfb8aa3b, v27
    v_exp_f32 v7, v7
    s_nop 0
    v_add_f32 v7, 1.0, v7
    v_rcp_f32 v7, v7
    s_nop 0
    v_mul_f32 v27, v27, v7
    v_mul_f32 v7, 0xbfb8aa3b, v28
    v_exp_f32 v7, v7
    s_nop 0
    v_add_f32 v7, 1.0, v7
    v_rcp_f32 v7, v7
    s_nop 0
    v_mul_f32 v28, v28, v7
    v_mul_f32 v7, 0xbfb8aa3b, v29
    v_exp_f32 v7, v7
    s_nop 0
    v_add_f32 v7, 1.0, v7
    v_rcp_f32 v7, v7
    s_nop 0
    v_mul_f32 v29, v29, v7
    v_mul_f32 v7, 0xbfb8aa3b, v30
    v_exp_f32 v7, v7
    s_nop 0
    v_add_f32 v7, 1.0, v7
    v_rcp_f32 v7, v7
    s_nop 0
    v_mul_f32 v30, v30, v7
    v_mul_f32 v7, 0xbfb8aa3b, v31
    v_exp_f32 v7, v7
    s_nop 0
    v_add_f32 v7, 1.0, v7
    v_rcp_f32 v7, v7
    s_nop 0
    v_mul_f32 v31, v31, v7
    v_cvt_pk_bf16_f32 v7, v16, v17
    v_lshlrev_b32 v16, 16, v7
    v_and_b32 v17, 0xffff0000, v7
    v_cvt_pk_bf16_f32 v7, v18, v19
    v_lshlrev_b32 v18, 16, v7
    v_and_b32 v19, 0xffff0000, v7
    v_cvt_pk_bf16_f32 v7, v20, v21
    v_lshlrev_b32 v20, 16, v7
    v_and_b32 v21, 0xffff0000, v7
    v_cvt_pk_bf16_f32 v7, v22, v23
    v_lshlrev_b32 v22, 16, v7
    v_and_b32 v23, 0xffff0000, v7
    v_cvt_pk_bf16_f32 v7, v24, v25
    v_lshlrev_b32 v24, 16, v7
    v_and_b32 v25, 0xffff0000, v7
    v_cvt_pk_bf16_f32 v7, v26, v27
    v_lshlrev_b32 v26, 16, v7
    v_and_b32 v27, 0xffff0000, v7
    v_cvt_pk_bf16_f32 v7, v28, v29
    v_lshlrev_b32 v28, 16, v7
    v_and_b32 v29, 0xffff0000, v7
    v_cvt_pk_bf16_f32 v7, v30, v31
    v_lshlrev_b32 v30, 16, v7
    v_and_b32 v31, 0xffff0000, v7
    v_mov_b32 v100, 0
    v_mov_b32 v101, 0
    v_mov_b32 v102, 0
    v_mov_b32 v103, 0
    v_mov_b32 v104, 0
    v_mov_b32 v105, 0
    v_mov_b32 v106, 0
    v_mov_b32 v107, 0
    v_lshlrev_b32 v6, 16, v32
    v_and_b32 v7, 0xffff0000, v32
    v_fmac_f32 v100, v16, v6
    v_fmac_f32 v101, v16, v7
    v_lshlrev_b32 v6, 16, v33
    v_and_b32 v7, 0xffff0000, v33
    v_fmac_f32 v102, v16, v6
    v_fmac_f32 v103, v16, v7
    v_lshlrev_b32 v6, 16, v34
    v_and_b32 v7, 0xffff0000, v34
    v_fmac_f32 v104, v16, v6
    v_fmac_f32 v105, v16, v7
    v_lshlrev_b32 v6, 16, v35
    v_and_b32 v7, 0xffff0000, v35
    v_fmac_f32 v106, v16, v6
    v_fmac_f32 v107, v16, v7
    v_lshlrev_b32 v6, 16, v36
    v_and_b32 v7, 0xffff0000, v36
    v_fmac_f32 v100, v17, v6
    v_fmac_f32 v101, v17, v7
    v_lshlrev_b32 v6, 16, v37
    v_and_b32 v7, 0xffff0000, v37
    v_fmac_f32 v102, v17, v6
    v_fmac_f32 v103, v17, v7
    v_lshlrev_b32 v6, 16, v38
    v_and_b32 v7, 0xffff0000, v38
    v_fmac_f32 v104, v17, v6
    v_fmac_f32 v105, v17, v7
    v_lshlrev_b32 v6, 16, v39
    v_and_b32 v7, 0xffff0000, v39
    v_fmac_f32 v106, v17, v6
    v_fmac_f32 v107, v17, v7
    v_lshlrev_b32 v6, 16, v40
    v_and_b32 v7, 0xffff0000, v40
    v_fmac_f32 v100, v18, v6
    v_fmac_f32 v101, v18, v7
    v_lshlrev_b32 v6, 16, v41
    v_and_b32 v7, 0xffff0000, v41
    v_fmac_f32 v102, v18, v6
    v_fmac_f32 v103, v18, v7
    v_lshlrev_b32 v6, 16, v42
    v_and_b32 v7, 0xffff0000, v42
    v_fmac_f32 v104, v18, v6
    v_fmac_f32 v105, v18, v7
    v_lshlrev_b32 v6, 16, v43
    v_and_b32 v7, 0xffff0000, v43
    v_fmac_f32 v106, v18, v6
    v_fmac_f32 v107, v18, v7
    v_lshlrev_b32 v6, 16, v44
    v_and_b32 v7, 0xffff0000, v44
    v_fmac_f32 v100, v19, v6
    v_fmac_f32 v101, v19, v7
    v_lshlrev_b32 v6, 16, v45
    v_and_b32 v7, 0xffff0000, v45
    v_fmac_f32 v102, v19, v6
    v_fmac_f32 v103, v19, v7
    v_lshlrev_b32 v6, 16, v46
    v_and_b32 v7, 0xffff0000, v46
    v_fmac_f32 v104, v19, v6
    v_fmac_f32 v105, v19, v7
    v_lshlrev_b32 v6, 16, v47
    v_and_b32 v7, 0xffff0000, v47
    v_fmac_f32 v106, v19, v6
    v_fmac_f32 v107, v19, v7
    v_lshlrev_b32 v6, 16, v48
    v_and_b32 v7, 0xffff0000, v48
    v_fmac_f32 v100, v20, v6
    v_fmac_f32 v101, v20, v7
    v_lshlrev_b32 v6, 16, v49
    v_and_b32 v7, 0xffff0000, v49
    v_fmac_f32 v102, v20, v6
    v_fmac_f32 v103, v20, v7
    v_lshlrev_b32 v6, 16, v50
    v_and_b32 v7, 0xffff0000, v50
    v_fmac_f32 v104, v20, v6
    v_fmac_f32 v105, v20, v7
    v_lshlrev_b32 v6, 16, v51
    v_and_b32 v7, 0xffff0000, v51
    v_fmac_f32 v106, v20, v6
    v_fmac_f32 v107, v20, v7
    v_lshlrev_b32 v6, 16, v52
    v_and_b32 v7, 0xffff0000, v52
    v_fmac_f32 v100, v21, v6
    v_fmac_f32 v101, v21, v7
    v_lshlrev_b32 v6, 16, v53
    v_and_b32 v7, 0xffff0000, v53
    v_fmac_f32 v102, v21, v6
    v_fmac_f32 v103, v21, v7
    v_lshlrev_b32 v6, 16, v54
    v_and_b32 v7, 0xffff0000, v54
    v_fmac_f32 v104, v21, v6
    v_fmac_f32 v105, v21, v7
    v_lshlrev_b32 v6, 16, v55
    v_and_b32 v7, 0xffff0000, v55
    v_fmac_f32 v106, v21, v6
    v_fmac_f32 v107, v21, v7
    v_lshlrev_b32 v6, 16, v56
    v_and_b32 v7, 0xffff0000, v56
    v_fmac_f32 v100, v22, v6
    v_fmac_f32 v101, v22, v7
    v_lshlrev_b32 v6, 16, v57
    v_and_b32 v7, 0xffff0000, v57
    v_fmac_f32 v102, v22, v6
    v_fmac_f32 v103, v22, v7
    v_lshlrev_b32 v6, 16, v58
    v_and_b32 v7, 0xffff0000, v58
    v_fmac_f32 v104, v22, v6
    v_fmac_f32 v105, v22, v7
    v_lshlrev_b32 v6, 16, v59
    v_and_b32 v7, 0xffff0000, v59
    v_fmac_f32 v106, v22, v6
    v_fmac_f32 v107, v22, v7
    v_lshlrev_b32 v6, 16, v60
    v_and_b32 v7, 0xffff0000, v60
    v_fmac_f32 v100, v23, v6
    v_fmac_f32 v101, v23, v7
    v_lshlrev_b32 v6, 16, v61
    v_and_b32 v7, 0xffff0000, v61
    v_fmac_f32 v102, v23, v6
    v_fmac_f32 v103, v23, v7
    v_lshlrev_b32 v6, 16, v62
    v_and_b32 v7, 0xffff0000, v62
    v_fmac_f32 v104, v23, v6
    v_fmac_f32 v105, v23, v7
    v_lshlrev_b32 v6, 16, v63
    v_and_b32 v7, 0xffff0000, v63
    v_fmac_f32 v106, v23, v6
    v_fmac_f32 v107, v23, v7
    v_lshlrev_b32 v6, 16, v64
    v_and_b32 v7, 0xffff0000, v64
    v_fmac_f32 v100, v24, v6
    v_fmac_f32 v101, v24, v7
    v_lshlrev_b32 v6, 16, v65
    v_and_b32 v7, 0xffff0000, v65
    v_fmac_f32 v102, v24, v6
    v_fmac_f32 v103, v24, v7
    v_lshlrev_b32 v6, 16, v66
    v_and_b32 v7, 0xffff0000, v66
    v_fmac_f32 v104, v24, v6
    v_fmac_f32 v105, v24, v7
    v_lshlrev_b32 v6, 16, v67
    v_and_b32 v7, 0xffff0000, v67
    v_fmac_f32 v106, v24, v6
    v_fmac_f32 v107, v24, v7
    v_lshlrev_b32 v6, 16, v68
    v_and_b32 v7, 0xffff0000, v68
    v_fmac_f32 v100, v25, v6
    v_fmac_f32 v101, v25, v7
    v_lshlrev_b32 v6, 16, v69
    v_and_b32 v7, 0xffff0000, v69
    v_fmac_f32 v102, v25, v6
    v_fmac_f32 v103, v25, v7
    v_lshlrev_b32 v6, 16, v70
    v_and_b32 v7, 0xffff0000, v70
    v_fmac_f32 v104, v25, v6
    v_fmac_f32 v105, v25, v7
    v_lshlrev_b32 v6, 16, v71
    v_and_b32 v7, 0xffff0000, v71
    v_fmac_f32 v106, v25, v6
    v_fmac_f32 v107, v25, v7
    v_lshlrev_b32 v6, 16, v72
    v_and_b32 v7, 0xffff0000, v72
    v_fmac_f32 v100, v26, v6
    v_fmac_f32 v101, v26, v7
    v_lshlrev_b32 v6, 16, v73
    v_and_b32 v7, 0xffff0000, v73
    v_fmac_f32 v102, v26, v6
    v_fmac_f32 v103, v26, v7
    v_lshlrev_b32 v6, 16, v74
    v_and_b32 v7, 0xffff0000, v74
    v_fmac_f32 v104, v26, v6
    v_fmac_f32 v105, v26, v7
    v_lshlrev_b32 v6, 16, v75
    v_and_b32 v7, 0xffff0000, v75
    v_fmac_f32 v106, v26, v6
    v_fmac_f32 v107, v26, v7
    v_lshlrev_b32 v6, 16, v76
    v_and_b32 v7, 0xffff0000, v76
    v_fmac_f32 v100, v27, v6
    v_fmac_f32 v101, v27, v7
    v_lshlrev_b32 v6, 16, v77
    v_and_b32 v7, 0xffff0000, v77
    v_fmac_f32 v102, v27, v6
    v_fmac_f32 v103, v27, v7
    v_lshlrev_b32 v6, 16, v78
    v_and_b32 v7, 0xffff0000, v78
    v_fmac_f32 v104, v27, v6
    v_fmac_f32 v105, v27, v7
    v_lshlrev_b32 v6, 16, v79
    v_and_b32 v7, 0xffff0000, v79
    v_fmac_f32 v106, v27, v6
    v_fmac_f32 v107, v27, v7
    v_lshlrev_b32 v6, 16, v80
    v_and_b32 v7, 0xffff0000, v80
    v_fmac_f32 v100, v28, v6
    v_fmac_f32 v101, v28, v7
    v_lshlrev_b32 v6, 16, v81
    v_and_b32 v7, 0xffff0000, v81
    v_fmac_f32 v102, v28, v6
    v_fmac_f32 v103, v28, v7
    v_lshlrev_b32 v6, 16, v82
    v_and_b32 v7, 0xffff0000, v82
    v_fmac_f32 v104, v28, v6
    v_fmac_f32 v105, v28, v7
    v_lshlrev_b32 v6, 16, v83
    v_and_b32 v7, 0xffff0000, v83
    v_fmac_f32 v106, v28, v6
    v_fmac_f32 v107, v28, v7
    v_lshlrev_b32 v6, 16, v84
    v_and_b32 v7, 0xffff0000, v84
    v_fmac_f32 v100, v29, v6
    v_fmac_f32 v101, v29, v7
    v_lshlrev_b32 v6, 16, v85
    v_and_b32 v7, 0xffff0000, v85
    v_fmac_f32 v102, v29, v6
    v_fmac_f32 v103, v29, v7
    v_lshlrev_b32 v6, 16, v86
    v_and_b32 v7, 0xffff0000, v86
    v_fmac_f32 v104, v29, v6
    v_fmac_f32 v105, v29, v7
    v_lshlrev_b32 v6, 16, v87
    v_and_b32 v7, 0xffff0000, v87
    v_fmac_f32 v106, v29, v6
    v_fmac_f32 v107, v29, v7
    v_lshlrev_b32 v6, 16, v88
    v_and_b32 v7, 0xffff0000, v88
    v_fmac_f32 v100, v30, v6
    v_fmac_f32 v101, v30, v7
    v_lshlrev_b32 v6, 16, v89
    v_and_b32 v7, 0xffff0000, v89
    v_fmac_f32 v102, v30, v6
    v_fmac_f32 v103, v30, v7
    v_lshlrev_b32 v6, 16, v90
    v_and_b32 v7, 0xffff0000, v90
    v_fmac_f32 v104, v30, v6
    v_fmac_f32 v105, v30, v7
    v_lshlrev_b32 v6, 16, v91
    v_and_b32 v7, 0xffff0000, v91
    v_fmac_f32 v106, v30, v6
    v_fmac_f32 v107, v30, v7
    v_lshlrev_b32 v6, 16, v92
    v_and_b32 v7, 0xffff0000, v92
    v_fmac_f32 v100, v31, v6
    v_fmac_f32 v101, v31, v7
    v_lshlrev_b32 v6, 16, v93
    v_and_b32 v7, 0xffff0000, v93
    v_fmac_f32 v102, v31, v6
    v_fmac_f32 v103, v31, v7
    v_lshlrev_b32 v6, 16, v94
    v_and_b32 v7, 0xffff0000, v94
    v_fmac_f32 v104, v31, v6
    v_fmac_f32 v105, v31, v7
    v_lshlrev_b32 v6, 16, v95
    v_and_b32 v7, 0xffff0000, v95
    v_fmac_f32 v106, v31, v6
    v_fmac_f32 v107, v31, v7
    v_lshlrev_b32 v6, 8, v3
    v_lshl_add_u32 v6, v4, 5, v6
    ds_write_b128 v6, v[100:103]
    ds_write_b128 v6, v[104:107] offset:16
    s_waitcnt lgkmcnt(0)
    s_barrier
    s_cmp_lg_u32 s92, 0
    s_cbranch_scc1 L_adaLN_cond__memory_aug_recurrent_mem_tr__dense_activation_gelu__prompt_kernel_mod_sig
    v_lshlrev_b32 v10, 2, v0
    ds_read_b32 v32, v10 offset:0
    ds_read_b32 v33, v10 offset:256
    ds_read_b32 v34, v10 offset:512
    ds_read_b32 v35, v10 offset:768
    ds_read_b32 v36, v10 offset:1024
    ds_read_b32 v37, v10 offset:1280
    ds_read_b32 v38, v10 offset:1536
    ds_read_b32 v39, v10 offset:1792
    ds_read_b32 v40, v10 offset:2048
    ds_read_b32 v41, v10 offset:2304
    ds_read_b32 v42, v10 offset:2560
    ds_read_b32 v43, v10 offset:2816
    ds_read_b32 v44, v10 offset:3072
    ds_read_b32 v45, v10 offset:3328
    ds_read_b32 v46, v10 offset:3584
    ds_read_b32 v47, v10 offset:3840
    ds_read_b32 v48, v10 offset:4096
    ds_read_b32 v49, v10 offset:4352
    ds_read_b32 v50, v10 offset:4608
    ds_read_b32 v51, v10 offset:4864
    ds_read_b32 v52, v10 offset:5120
    ds_read_b32 v53, v10 offset:5376
    ds_read_b32 v54, v10 offset:5632
    ds_read_b32 v55, v10 offset:5888
    ds_read_b32 v56, v10 offset:6144
    ds_read_b32 v57, v10 offset:6400
    ds_read_b32 v58, v10 offset:6656
    ds_read_b32 v59, v10 offset:6912
    ds_read_b32 v60, v10 offset:7168
    ds_read_b32 v61, v10 offset:7424
    ds_read_b32 v62, v10 offset:7680
    ds_read_b32 v63, v10 offset:7936
    s_waitcnt lgkmcnt(15)
    v_add_f32 v32, v32, v48
    s_waitcnt lgkmcnt(14)
    v_add_f32 v33, v33, v49
    s_waitcnt lgkmcnt(13)
    v_add_f32 v34, v34, v50
    s_waitcnt lgkmcnt(12)
    v_add_f32 v35, v35, v51
    s_waitcnt lgkmcnt(11)
    v_add_f32 v36, v36, v52
    s_waitcnt lgkmcnt(10)
    v_add_f32 v37, v37, v53
    s_waitcnt lgkmcnt(9)
    v_add_f32 v38, v38, v54
    s_waitcnt lgkmcnt(8)
    v_add_f32 v39, v39, v55
    s_waitcnt lgkmcnt(7)
    v_add_f32 v40, v40, v56
    s_waitcnt lgkmcnt(6)
    v_add_f32 v41, v41, v57
    s_waitcnt lgkmcnt(5)
    v_add_f32 v42, v42, v58
    s_waitcnt lgkmcnt(4)
    v_add_f32 v43, v43, v59
    s_waitcnt lgkmcnt(3)
    v_add_f32 v44, v44, v60
    s_waitcnt lgkmcnt(2)
    v_add_f32 v45, v45, v61
    s_waitcnt lgkmcnt(1)
    v_add_f32 v46, v46, v62
    s_waitcnt lgkmcnt(0)
    v_add_f32 v47, v47, v63
    v_add_f32 v32, v32, v40
    v_add_f32 v33, v33, v41
    v_add_f32 v34, v34, v42
    v_add_f32 v35, v35, v43
    v_add_f32 v36, v36, v44
    v_add_f32 v37, v37, v45
    v_add_f32 v38, v38, v46
    v_add_f32 v39, v39, v47
    v_add_f32 v32, v32, v36
    v_add_f32 v33, v33, v37
    v_add_f32 v34, v34, v38
    v_add_f32 v35, v35, v39
    v_add_f32 v32, v32, v34
    v_add_f32 v33, v33, v35
    v_add_f32 v32, v32, v33
    v_mov_b32 v16, v32
    v_cvt_pk_bf16_f32 v16, v16, v16
    v_lshlrev_b32 v16, 16, v16
    s_lshr_b32 s24, s2, 3
    s_cmp_eq_u32 s24, 1
    s_cselect_b32 s25, 1, 0
    s_cmp_eq_u32 s24, 4
    s_cselect_b32 s25, 1, s25
    s_cmp_eq_u32 s25, 0
    s_cbranch_scc1 L_adaLN_cond__memory_aug_recurrent_mem_tr__dense_activation_gelu__prompt_kernel_mod_st
    v_add_f32 v16, 1.0, v16
    v_cvt_pk_bf16_f32 v16, v16, v16
    v_lshlrev_b32 v16, 16, v16
L_adaLN_cond__memory_aug_recurrent_mem_tr__dense_activation_gelu__prompt_kernel_mod_st:
    s_lshl_b32 s3, s2, 8
    s_add_u32 s3, s3, 2097152
    buffer_store_dword v16, v10, s[4:7], s3 offen sc1
L_adaLN_cond__memory_aug_recurrent_mem_tr__dense_activation_gelu__prompt_kernel_mod_sig:
    s_cmp_ge_u32 s2, 20
    s_cbranch_scc1 L_adaLN_cond__memory_aug_recurrent_mem_tr__dense_activation_gelu__prompt_kernel_mod_nz
    v_lshlrev_b32 v1, 2, v0
    v_mov_b32 v2, 0
    s_lshl_b32 s3, s2, 10
    s_add_u32 s3, s3, 3932160
    buffer_store_dword v2, v1, s[4:7], s3 offen sc1
L_adaLN_cond__memory_aug_recurrent_mem_tr__dense_activation_gelu__prompt_kernel_mod_nz:
    s_cmp_ge_u32 s2, 20
    s_cbranch_scc1 L_adaLN_cond__memory_aug_recurrent_mem_tr__dense_activation_gelu__prompt_kernel_mod_late
    s_waitcnt vmcnt(0)
    s_barrier
    s_cmp_lg_u32 s92, 0
    s_cbranch_scc1 L_adaLN_cond__memory_aug_recurrent_mem_tr__dense_activation_gelu__prompt_kernel_mod_sd
    s_lshl_b32 s3, s2, 2
    s_add_u32 s3, s3, 128
    v_mov_b32 v1, s3
    v_mov_b32 v2, 1
    s_mov_b64 exec, 1
    global_store_dword v1, v2, s[90:91] sc1
    s_mov_b64 exec, -1
    s_branch L_adaLN_cond__memory_aug_recurrent_mem_tr__dense_activation_gelu__prompt_kernel_mod_sd
L_adaLN_cond__memory_aug_recurrent_mem_tr__dense_activation_gelu__prompt_kernel_mod_late:
    s_waitcnt vmcnt(0)
    s_barrier
    s_cmp_lg_u32 s92, 0
    s_cbranch_scc1 L_s69_done
    v_mov_b32 v250, 224
    v_mov_b32 v251, 1
    s_mov_b64 exec, 1
    global_atomic_add v250, v251, s[90:91]
    s_mov_b64 exec, -1
L_s69_done:
L_adaLN_cond__memory_aug_recurrent_mem_tr__dense_activation_gelu__prompt_kernel_mod_sd:
    s_waitcnt vmcnt(0) lgkmcnt(0)
    s_barrier
    v_accvgpr_read_b32 v0, a255
    s_branch L_adaLN_cond__memory_aug_recurrent_mem_tr__dense_activation_gelu__prompt_kernel_ph2
L_adaLN_cond__memory_aug_recurrent_mem_tr__dense_activation_gelu__prompt_kernel_t_ln1:
    s_sub_u32 s2, s95, 48
    s_load_dwordx2 s[12:13], s[0:1], 0
    v_and_b32 v2, 63, v0
    v_and_b32 v3, 15, v2
    v_lshrrev_b32 v4, 4, v2
    s_waitcnt lgkmcnt(0)
    s_mov_b32 s16, s12
    s_and_b32 s17, s13, 0xffff
    s_mov_b32 s18, 2097152
    s_mov_b32 s19, 0x00020000
    s_lshr_b32 s11, s2, 3
    v_lshlrev_b32 v5, 10, v3
    v_lshl_add_u32 v5, v4, 4, v5
    s_lshl_b32 s10, s2, 14
    s_lshl_b32 s9, s92, 8
    s_add_u32 s10, s10, s9
    buffer_load_dwordx4 v[8:11], v5, s[16:19], s10 offen offset:0
    buffer_load_dwordx4 v[12:15], v5, s[16:19], s10 offen offset:64
    buffer_load_dwordx4 v[16:19], v5, s[16:19], s10 offen offset:128
    buffer_load_dwordx4 v[20:23], v5, s[16:19], s10 offen offset:192
    s_waitcnt vmcnt(3)
    v_lshlrev_b32 v32, 16, v8
    v_and_b32 v33, 0xffff0000, v8
    v_lshlrev_b32 v34, 16, v9
    v_and_b32 v35, 0xffff0000, v9
    v_lshlrev_b32 v36, 16, v10
    v_and_b32 v37, 0xffff0000, v10
    v_lshlrev_b32 v38, 16, v11
    v_and_b32 v39, 0xffff0000, v11
    s_waitcnt vmcnt(2)
    v_lshlrev_b32 v40, 16, v12
    v_and_b32 v41, 0xffff0000, v12
    v_lshlrev_b32 v42, 16, v13
    v_and_b32 v43, 0xffff0000, v13
    v_lshlrev_b32 v44, 16, v14
    v_and_b32 v45, 0xffff0000, v14
    v_lshlrev_b32 v46, 16, v15
    v_and_b32 v47, 0xffff0000, v15
    s_waitcnt vmcnt(1)
    v_lshlrev_b32 v48, 16, v16
    v_and_b32 v49, 0xffff0000, v16
    v_lshlrev_b32 v50, 16, v17
    v_and_b32 v51, 0xffff0000, v17
    v_lshlrev_b32 v52, 16, v18
    v_and_b32 v53, 0xffff0000, v18
    v_lshlrev_b32 v54, 16, v19
    v_and_b32 v55, 0xffff0000, v19
    s_waitcnt vmcnt(0)
    v_lshlrev_b32 v56, 16, v20
    v_and_b32 v57, 0xffff0000, v20
    v_lshlrev_b32 v58, 16, v21
    v_and_b32 v59, 0xffff0000, v21
    v_lshlrev_b32 v60, 16, v22
    v_and_b32 v61, 0xffff0000, v22
    v_lshlrev_b32 v62, 16, v23
    v_and_b32 v63, 0xffff0000, v23
    v_add_f32 v8, v32, v33
    v_add_f32 v9, v34, v35
    v_add_f32 v8, v8, v36
    v_add_f32 v9, v9, v37
    v_add_f32 v8, v8, v38
    v_add_f32 v9, v9, v39
    v_add_f32 v8, v8, v40
    v_add_f32 v9, v9, v41
    v_add_f32 v8, v8, v42
    v_add_f32 v9, v9, v43
    v_add_f32 v8, v8, v44
    v_add_f32 v9, v9, v45
    v_add_f32 v8, v8, v46
    v_add_f32 v9, v9, v47
    v_add_f32 v8, v8, v48
    v_add_f32 v9, v9, v49
    v_add_f32 v8, v8, v50
    v_add_f32 v9, v9, v51
    v_add_f32 v8, v8, v52
    v_add_f32 v9, v9, v53
    v_add_f32 v8, v8, v54
    v_add_f32 v9, v9, v55
    v_add_f32 v8, v8, v56
    v_add_f32 v9, v9, v57
    v_add_f32 v8, v8, v58
    v_add_f32 v9, v9, v59
    v_add_f32 v8, v8, v60
    v_add_f32 v9, v9, v61
    v_add_f32 v8, v8, v62
    v_add_f32 v9, v9, v63
    v_add_f32 v8, v8, v9
    v_mov_b32 v10, v8
    s_nop 1
    v_permlane32_swap_b32 v8, v10
    v_add_f32 v8, v8, v10
    v_mov_b32 v10, v8
    s_nop 1
    v_permlane16_swap_b32 v8, v10
    v_add_f32 v8, v8, v10
    v_lshlrev_b32 v11, 2, v3
    s_lshl_b32 s24, s92, 6
    v_add_u32 v12, s24, v11
    ds_write_b32 v12, v8 offset:0
    s_waitcnt lgkmcnt(0)
    s_barrier
    ds_read_b32 v12, v11 offset:0
    ds_read_b32 v13, v11 offset:64
    ds_read_b32 v14, v11 offset:128
    ds_read_b32 v15, v11 offset:192
    s_waitcnt lgkmcnt(2)
    v_add_f32 v12, v12, v13
    s_waitcnt lgkmcnt(0)
    v_add_f32 v14, v14, v15
    v_add_f32 v8, v12, v14
    v_mul_f32 v8, 0x3b000000, v8
    v_sub_f32 v32, v32, v8
    v_sub_f32 v33, v33, v8
    v_sub_f32 v34, v34, v8
    v_sub_f32 v35, v35, v8
    v_sub_f32 v36, v36, v8
    v_sub_f32 v37, v37, v8
    v_sub_f32 v38, v38, v8
    v_sub_f32 v39, v39, v8
    v_sub_f32 v40, v40, v8
    v_sub_f32 v41, v41, v8
    v_sub_f32 v42, v42, v8
    v_sub_f32 v43, v43, v8
    v_sub_f32 v44, v44, v8
    v_sub_f32 v45, v45, v8
    v_sub_f32 v46, v46, v8
    v_sub_f32 v47, v47, v8
    v_sub_f32 v48, v48, v8
    v_sub_f32 v49, v49, v8
    v_sub_f32 v50, v50, v8
    v_sub_f32 v51, v51, v8
    v_sub_f32 v52, v52, v8
    v_sub_f32 v53, v53, v8
    v_sub_f32 v54, v54, v8
    v_sub_f32 v55, v55, v8
    v_sub_f32 v56, v56, v8
    v_sub_f32 v57, v57, v8
    v_sub_f32 v58, v58, v8
    v_sub_f32 v59, v59, v8
    v_sub_f32 v60, v60, v8
    v_sub_f32 v61, v61, v8
    v_sub_f32 v62, v62, v8
    v_sub_f32 v63, v63, v8
    v_mul_f32 v9, v32, v32
    v_mul_f32 v16, v33, v33
    v_fmac_f32 v9, v34, v34
    v_fmac_f32 v16, v35, v35
    v_fmac_f32 v9, v36, v36
    v_fmac_f32 v16, v37, v37
    v_fmac_f32 v9, v38, v38
    v_fmac_f32 v16, v39, v39
    v_fmac_f32 v9, v40, v40
    v_fmac_f32 v16, v41, v41
    v_fmac_f32 v9, v42, v42
    v_fmac_f32 v16, v43, v43
    v_fmac_f32 v9, v44, v44
    v_fmac_f32 v16, v45, v45
    v_fmac_f32 v9, v46, v46
    v_fmac_f32 v16, v47, v47
    v_fmac_f32 v9, v48, v48
    v_fmac_f32 v16, v49, v49
    v_fmac_f32 v9, v50, v50
    v_fmac_f32 v16, v51, v51
    v_fmac_f32 v9, v52, v52
    v_fmac_f32 v16, v53, v53
    v_fmac_f32 v9, v54, v54
    v_fmac_f32 v16, v55, v55
    v_fmac_f32 v9, v56, v56
    v_fmac_f32 v16, v57, v57
    v_fmac_f32 v9, v58, v58
    v_fmac_f32 v16, v59, v59
    v_fmac_f32 v9, v60, v60
    v_fmac_f32 v16, v61, v61
    v_fmac_f32 v9, v62, v62
    v_fmac_f32 v16, v63, v63
    v_add_f32 v9, v9, v16
    v_mov_b32 v10, v9
    s_nop 1
    v_permlane32_swap_b32 v9, v10
    v_add_f32 v9, v9, v10
    v_mov_b32 v10, v9
    s_nop 1
    v_permlane16_swap_b32 v9, v10
    v_add_f32 v9, v9, v10
    v_lshlrev_b32 v11, 2, v3
    s_lshl_b32 s24, s92, 6
    v_add_u32 v12, s24, v11
    ds_write_b32 v12, v9 offset:256
    s_waitcnt lgkmcnt(0)
    s_barrier
    ds_read_b32 v12, v11 offset:256
    ds_read_b32 v13, v11 offset:320
    ds_read_b32 v14, v11 offset:384
    ds_read_b32 v15, v11 offset:448
    s_waitcnt lgkmcnt(2)
    v_add_f32 v12, v12, v13
    s_waitcnt lgkmcnt(0)
    v_add_f32 v14, v14, v15
    v_add_f32 v9, v12, v14
    v_mov_b32 v11, 0x3727c5ac
    v_fmac_f32 v11, 0x3b000000, v9
    v_rsq_f32 v11, v11
    s_cmp_lg_u32 s92, 0
    s_cbranch_scc1 L_w70_done
    v_mbcnt_lo_u32_b32 v250, -1, 0
    v_mbcnt_hi_u32_b32 v250, -1, v250
    v_min_u32 v250, 19, v250
    v_lshlrev_b32 v250, 2, v250
    s_mov_b32 s94, 400000
L_w70_spin:
    global_load_dword v251, v250, s[90:91] offset:128 sc1
    s_waitcnt vmcnt(0)
    v_cmp_eq_u32 vcc, 0, v251
    s_cbranch_vccz L_w70_done
    s_sleep 3
    s_sub_u32 s94, s94, 1
    s_cbranch_scc0 L_w70_spin
L_w70_done:
    s_barrier
    v_lshlrev_b32 v6, 5, v4
    s_lshl_b32 s13, s92, 9
    s_add_u32 s20, s13, 2097152
    s_add_u32 s21, s13, 2099200
    buffer_load_dwordx4 v[64:67], v6, s[4:7], s20 offen offset:0 sc1
    buffer_load_dwordx4 v[96:99], v6, s[4:7], s21 offen offset:0 sc1
    buffer_load_dwordx4 v[68:71], v6, s[4:7], s20 offen offset:16 sc1
    buffer_load_dwordx4 v[100:103], v6, s[4:7], s21 offen offset:16 sc1
    buffer_load_dwordx4 v[72:75], v6, s[4:7], s20 offen offset:128 sc1
    buffer_load_dwordx4 v[104:107], v6, s[4:7], s21 offen offset:128 sc1
    buffer_load_dwordx4 v[76:79], v6, s[4:7], s20 offen offset:144 sc1
    buffer_load_dwordx4 v[108:111], v6, s[4:7], s21 offen offset:144 sc1
    buffer_load_dwordx4 v[80:83], v6, s[4:7], s20 offen offset:256 sc1
    buffer_load_dwordx4 v[112:115], v6, s[4:7], s21 offen offset:256 sc1
    buffer_load_dwordx4 v[84:87], v6, s[4:7], s20 offen offset:272 sc1
    buffer_load_dwordx4 v[116:119], v6, s[4:7], s21 offen offset:272 sc1
    buffer_load_dwordx4 v[88:91], v6, s[4:7], s20 offen offset:384 sc1
    buffer_load_dwordx4 v[120:123], v6, s[4:7], s21 offen offset:384 sc1
    buffer_load_dwordx4 v[92:95], v6, s[4:7], s20 offen offset:400 sc1
    buffer_load_dwordx4 v[124:127], v6, s[4:7], s21 offen offset:400 sc1
    s_lshl_b32 s22, s2, 14
    s_lshl_b32 s24, s92, 12
    s_add_u32 s22, s22, s24
    s_add_u32 s22, s22, 0
    v_lshlrev_b32 v7, 4, v2
    v_mul_f32 v32, v32, v11
    s_waitcnt vmcnt(14)
    v_fma_f32 v32, v32, v96, v64
    v_mul_f32 v33, v33, v11
    v_fma_f32 v33, v33, v97, v65
    v_mul_f32 v34, v34, v11
    v_fma_f32 v34, v34, v98, v66
    v_mul_f32 v35, v35, v11
    v_fma_f32 v35, v35, v99, v67
    v_mul_f32 v36, v36, v11
    s_waitcnt vmcnt(12)
    v_fma_f32 v36, v36, v100, v68
    v_mul_f32 v37, v37, v11
    v_fma_f32 v37, v37, v101, v69
    v_mul_f32 v38, v38, v11
    v_fma_f32 v38, v38, v102, v70
    v_mul_f32 v39, v39, v11
    v_fma_f32 v39, v39, v103, v71
    v_cvt_pk_bf16_f32 v16, v32, v33
    v_cvt_pk_bf16_f32 v17, v34, v35
    v_cvt_pk_bf16_f32 v18, v36, v37
    v_cvt_pk_bf16_f32 v19, v38, v39
    buffer_store_dwordx4 v[16:19], v7, s[4:7], s22 offen offset:0 sc1
    v_mul_f32 v40, v40, v11
    s_waitcnt vmcnt(11)
    v_fma_f32 v40, v40, v104, v72
    v_mul_f32 v41, v41, v11
    v_fma_f32 v41, v41, v105, v73
    v_mul_f32 v42, v42, v11
    v_fma_f32 v42, v42, v106, v74
    v_mul_f32 v43, v43, v11
    v_fma_f32 v43, v43, v107, v75
    v_mul_f32 v44, v44, v11
    s_waitcnt vmcnt(9)
    v_fma_f32 v44, v44, v108, v76
    v_mul_f32 v45, v45, v11
    v_fma_f32 v45, v45, v109, v77
    v_mul_f32 v46, v46, v11
    v_fma_f32 v46, v46, v110, v78
    v_mul_f32 v47, v47, v11
    v_fma_f32 v47, v47, v111, v79
    v_cvt_pk_bf16_f32 v20, v40, v41
    v_cvt_pk_bf16_f32 v21, v42, v43
    v_cvt_pk_bf16_f32 v22, v44, v45
    v_cvt_pk_bf16_f32 v23, v46, v47
    buffer_store_dwordx4 v[20:23], v7, s[4:7], s22 offen offset:1024 sc1
    v_mul_f32 v48, v48, v11
    s_waitcnt vmcnt(8)
    v_fma_f32 v48, v48, v112, v80
    v_mul_f32 v49, v49, v11
    v_fma_f32 v49, v49, v113, v81
    v_mul_f32 v50, v50, v11
    v_fma_f32 v50, v50, v114, v82
    v_mul_f32 v51, v51, v11
    v_fma_f32 v51, v51, v115, v83
    v_mul_f32 v52, v52, v11
    s_waitcnt vmcnt(6)
    v_fma_f32 v52, v52, v116, v84
    v_mul_f32 v53, v53, v11
    v_fma_f32 v53, v53, v117, v85
    v_mul_f32 v54, v54, v11
    v_fma_f32 v54, v54, v118, v86
    v_mul_f32 v55, v55, v11
    v_fma_f32 v55, v55, v119, v87
    v_cvt_pk_bf16_f32 v16, v48, v49
    v_cvt_pk_bf16_f32 v17, v50, v51
    v_cvt_pk_bf16_f32 v18, v52, v53
    v_cvt_pk_bf16_f32 v19, v54, v55
    buffer_store_dwordx4 v[16:19], v7, s[4:7], s22 offen offset:2048 sc1
    v_mul_f32 v56, v56, v11
    s_waitcnt vmcnt(5)
    v_fma_f32 v56, v56, v120, v88
    v_mul_f32 v57, v57, v11
    v_fma_f32 v57, v57, v121, v89
    v_mul_f32 v58, v58, v11
    v_fma_f32 v58, v58, v122, v90
    v_mul_f32 v59, v59, v11
    v_fma_f32 v59, v59, v123, v91
    v_mul_f32 v60, v60, v11
    s_waitcnt vmcnt(3)
    v_fma_f32 v60, v60, v124, v92
    v_mul_f32 v61, v61, v11
    v_fma_f32 v61, v61, v125, v93
    v_mul_f32 v62, v62, v11
    v_fma_f32 v62, v62, v126, v94
    v_mul_f32 v63, v63, v11
    v_fma_f32 v63, v63, v127, v95
    v_cvt_pk_bf16_f32 v20, v56, v57
    v_cvt_pk_bf16_f32 v21, v58, v59
    v_cvt_pk_bf16_f32 v22, v60, v61
    v_cvt_pk_bf16_f32 v23, v62, v63
    buffer_store_dwordx4 v[20:23], v7, s[4:7], s22 offen offset:3072 sc1
    s_waitcnt vmcnt(0)
    s_barrier
    s_cmp_lg_u32 s92, 0
    s_cbranch_scc1 L_s71_done
    s_lshl_b32 s79, s11, 7
    s_add_u32 s79, s79, 3932160
    v_mov_b32 v250, 0
    v_mov_b32 v251, 1
    s_mov_b64 exec, 1
    buffer_atomic_add v251, v250, s[4:7], s79 offen
    s_mov_b64 exec, -1
L_s71_done:
    s_waitcnt vmcnt(0) lgkmcnt(0)
    s_barrier
    v_accvgpr_read_b32 v0, a255
L_adaLN_cond__memory_aug_recurrent_mem_tr__dense_activation_gelu__prompt_kernel_ph2:
    s_waitcnt vmcnt(0)
    s_cmp_lg_u32 s92, 0
    s_cbranch_scc1 L_w72_done
    v_mov_b32 v250, 64
    s_mov_b32 s94, 400000
L_w72_spin:
    global_load_dword v251, v250, s[90:91] sc1
    s_waitcnt vmcnt(0)
    v_readfirstlane_b32 s93, v251
    s_nop 3
    s_cmp_ge_u32 s93, 256
    s_cbranch_scc1 L_w72_done
    s_sleep 1
    s_sub_u32 s94, s94, 1
    s_cbranch_scc0 L_w72_spin
L_w72_done:
    s_barrier
    s_cmp_lg_u32 s92, 0
    s_cbranch_scc1 L_w73_done
    v_mbcnt_lo_u32_b32 v250, -1, 0
    v_mbcnt_hi_u32_b32 v250, -1, v250
    v_min_u32 v250, 19, v250
    v_lshlrev_b32 v250, 2, v250
    s_mov_b32 s94, 400000
L_w73_spin:
    global_load_dword v251, v250, s[90:91] offset:128 sc1
    s_waitcnt vmcnt(0)
    v_cmp_eq_u32 vcc, 0, v251
    s_cbranch_vccz L_w73_done
    s_sleep 3
    s_sub_u32 s94, s94, 1
    s_cbranch_scc0 L_w73_spin
L_w73_done:
    s_barrier
    v_and_b32 v2, 63, v0
    v_lshlrev_b32 v3, 2, v2
    v_min_u32 v3, 28, v3
    global_load_dword v4, v3, s[90:91] sc1
    s_waitcnt vmcnt(0)
    v_readfirstlane_b32 s12, v4
    v_cmp_ne_u32 vcc, 32, v4
    s_nop 4
    s_lshr_b32 s8, s89, 8
    s_and_b32 s9, s89, 0xff
    s_sub_u32 s8, s8, 1
    s_lshl_b32 s8, s8, 5
    s_add_u32 s8, s8, s9
    s_mov_b32 s95, s8
    s_mov_b32 s80, 1
    s_cmp_eq_u64 vcc, 0
    s_cbranch_scc1 L_adaLN_cond__memory_aug_recurrent_mem_tr__dense_activation_gelu__prompt_kernel_reg
    s_mov_b32 s80, 0
    s_cmp_lg_u32 s92, 0
    s_cbranch_scc1 L_adaLN_cond__memory_aug_recurrent_mem_tr__dense_activation_gelu__prompt_kernel_ir_wait
    s_mov_b64 exec, 1
    v_mov_b32 v2, 1
    s_cmp_ge_u32 s12, 32
    s_cbranch_scc1 L_adaLN_cond__memory_aug_recurrent_mem_tr__dense_activation_gelu__prompt_kernel_ir_work
    v_mov_b32 v3, 68
    global_atomic_add v4, v3, v2, s[90:91] sc0
    s_waitcnt vmcnt(0)
    v_readfirstlane_b32 s10, v4
    s_nop 3
    s_add_u32 s10, s10, s12
    s_cmp_lt_u32 s10, 32
    s_cbranch_scc1 L_adaLN_cond__memory_aug_recurrent_mem_tr__dense_activation_gelu__prompt_kernel_ir_pub
L_adaLN_cond__memory_aug_recurrent_mem_tr__dense_activation_gelu__prompt_kernel_ir_work:
    v_mov_b32 v3, 72
    global_atomic_add v4, v3, v2, s[90:91] sc0
    s_waitcnt vmcnt(0)
    v_readfirstlane_b32 s10, v4
    s_nop 3
    s_add_u32 s10, s10, 0x100
L_adaLN_cond__memory_aug_recurrent_mem_tr__dense_activation_gelu__prompt_kernel_ir_pub:
    v_mov_b32 v4, s10
    v_mov_b32 v3, 0
    ds_write_b32 v3, v4
    s_mov_b64 exec, -1
L_adaLN_cond__memory_aug_recurrent_mem_tr__dense_activation_gelu__prompt_kernel_ir_wait:
    s_waitcnt vmcnt(0) lgkmcnt(0)
    s_barrier
    v_mov_b32 v3, 0
    ds_read_b32 v4, v3
    s_waitcnt lgkmcnt(0)
    v_readfirstlane_b32 s8, v4
    s_barrier
    s_nop 2
    s_cmp_lt_u32 s8, 32
    s_cbranch_scc1 L_adaLN_cond__memory_aug_recurrent_mem_tr__dense_activation_gelu__prompt_kernel_rec
    s_sub_u32 s95, s8, 0x100
L_adaLN_cond__memory_aug_recurrent_mem_tr__dense_activation_gelu__prompt_kernel_reg:
    s_lshr_b32 s84, s95, 5
    s_and_b32 s85, s95, 31
    s_cmp_lt_u32 s84, 4
    s_cselect_b32 s86, 5, 4
L_adaLN_cond__memory_aug_recurrent_mem_tr__dense_activation_gelu__prompt_kernel_qloop:
    s_mul_i32 s8, s86, 18
    s_cmp_ge_u32 s85, s8
    s_cbranch_scc1 L_adaLN_cond__memory_aug_recurrent_mem_tr__dense_activation_gelu__prompt_kernel_ph3
    s_mov_b32 s9, 0x40000000
    s_cmp_eq_u32 s86, 5
    s_cselect_b32 s9, 0x33333334, s9
    s_mul_hi_u32 s10, s85, s9
    s_mul_i32 s11, s10, s86
    s_sub_u32 s11, s85, s11
    s_mul_i32 s11, s11, 7
    s_add_u32 s11, s11, s84
    s_cmp_ge_u32 s10, 3
    s_cbranch_scc1 L_adaLN_cond__memory_aug_recurrent_mem_tr__dense_activation_gelu__prompt_kernel_q_full
    s_cmp_ge_u32 s10, 2
    s_cbranch_scc1 L_adaLN_cond__memory_aug_recurrent_mem_tr__dense_activation_gelu__prompt_kernel_q_q
    s_lshr_b32 s12, s10, 1
    s_lshl_b32 s2, s12, 5
    s_add_u32 s2, s2, s11
    s_mov_b32 s87, s2
    s_bitcmp1_b32 s10, 0
    s_cbranch_scc1 L_adaLN_cond__memory_aug_recurrent_mem_tr__dense_activation_gelu__prompt_kernel_q_v
    s_mov_b32 s88, 0
    s_branch L_adaLN_cond__memory_aug_recurrent_mem_tr__dense_activation_gelu__prompt_kernel_q_kq
L_adaLN_cond__memory_aug_recurrent_mem_tr__dense_activation_gelu__prompt_kernel_q_q:
    s_sub_u32 s12, s10, 2
    s_lshl_b32 s2, s12, 5
    s_add_u32 s2, s2, s11
    s_mov_b32 s87, s2
    s_mov_b32 s88, 1
L_adaLN_cond__memory_aug_recurrent_mem_tr__dense_activation_gelu__prompt_kernel_q_kq:
    s_load_dwordx2 s[60:61], s[0:1], 24
    s_load_dwordx2 s[62:63], s[0:1], 32
    s_load_dwordx2 s[64:65], s[0:1], 16
    s_waitcnt lgkmcnt(0)
    s_cmp_eq_u32 s88, 0
    s_cselect_b32 s60, s60, s64
    s_cselect_b32 s61, s61, s65
    s_mov_b32 s38, 50331648
    s_cselect_b32 s38, 16777216, s38
    v_and_b32 v2, 63, v0
    s_lshr_b32 s16, s2, 5
    s_and_b32 s17, s2, 31
    s_lshl_b32 s9, s16, 3
    s_lshl_b32 s18, s92, 1
    s_add_u32 s9, s9, s18
    s_lshl_b32 s10, s17, 7
    v_lshlrev_b32 v3, 4, v2
    v_and_b32 v4, 15, v2
    v_lshrrev_b32 v5, 4, v2
    v_lshrrev_b32 v6, 4, v2
    v_and_b32 v7, 15, v2
    s_mov_b32 s20, 8192
    v_add_u32 v8, 0, v6
    v_and_b32 v20, 3, v8
    v_bfe_u32 v21, v8, 3, 1
    v_lshl_or_b32 v20, v21, 2, v20
    v_lshrrev_b32 v21, 1, v7
    v_xor_b32 v21, v21, v20
    v_and_b32 v22, 1, v7
    v_lshl_or_b32 v21, v21, 1, v22
    v_mul_lo_u32 v8, v8, s20
    v_lshl_add_u32 v8, v21, 4, v8
    v_add_u32 v9, 4, v6
    v_and_b32 v20, 3, v9
    v_bfe_u32 v21, v9, 3, 1
    v_lshl_or_b32 v20, v21, 2, v20
    v_lshrrev_b32 v21, 1, v7
    v_xor_b32 v21, v21, v20
    v_and_b32 v22, 1, v7
    v_lshl_or_b32 v21, v21, 1, v22
    v_mul_lo_u32 v9, v9, s20
    v_lshl_add_u32 v9, v21, 4, v9
    v_add_u32 v10, 8, v6
    v_and_b32 v20, 3, v10
    v_bfe_u32 v21, v10, 3, 1
    v_lshl_or_b32 v20, v21, 2, v20
    v_lshrrev_b32 v21, 1, v7
    v_xor_b32 v21, v21, v20
    v_and_b32 v22, 1, v7
    v_lshl_or_b32 v21, v21, 1, v22
    v_mul_lo_u32 v10, v10, s20
    v_lshl_add_u32 v10, v21, 4, v10
    v_add_u32 v11, 12, v6
    v_and_b32 v20, 3, v11
    v_bfe_u32 v21, v11, 3, 1
    v_lshl_or_b32 v20, v21, 2, v20
    v_lshrrev_b32 v21, 1, v7
    v_xor_b32 v21, v21, v20
    v_and_b32 v22, 1, v7
    v_lshl_or_b32 v21, v21, 1, v22
    v_mul_lo_u32 v11, v11, s20
    v_lshl_add_u32 v11, v21, 4, v11
    v_lshrrev_b32 v20, 2, v4
    v_lshl_add_u32 v21, v5, 3, v20
    v_and_b32 v22, 1, v5
    v_lshl_or_b32 v22, v22, 2, v20
    v_mul_u32_u24 v21, 256, v21
    v_and_b32 v23, 3, v2
    v_lshl_add_u32 v21, v23, 3, v21
    v_xor_b32 v23, 0, v22
    v_lshl_add_u32 v12, v23, 5, v21
    v_add_u32 v24, 0x10000, v12
    v_xor_b32 v23, 1, v22
    v_lshl_add_u32 v13, v23, 5, v21
    v_add_u32 v25, 0x10000, v13
    v_xor_b32 v23, 2, v22
    v_lshl_add_u32 v14, v23, 5, v21
    v_add_u32 v26, 0x10000, v14
    v_xor_b32 v23, 3, v22
    v_lshl_add_u32 v15, v23, 5, v21
    v_add_u32 v27, 0x10000, v15
    v_xor_b32 v23, 4, v22
    v_lshl_add_u32 v16, v23, 5, v21
    v_add_u32 v28, 0x10000, v16
    v_xor_b32 v23, 5, v22
    v_lshl_add_u32 v17, v23, 5, v21
    v_add_u32 v29, 0x10000, v17
    v_xor_b32 v23, 6, v22
    v_lshl_add_u32 v18, v23, 5, v21
    v_add_u32 v30, 0x10000, v18
    v_xor_b32 v23, 7, v22
    v_lshl_add_u32 v19, v23, 5, v21
    v_add_u32 v31, 0x10000, v19
    v_and_b32 v32, 1, v4
    v_lshlrev_b32 v32, 10, v32
    v_lshl_add_u32 v32, v5, 8, v32
    v_lshrrev_b32 v21, 1, v4
    v_lshl_add_u32 v32, v21, 4, v32
    s_waitcnt lgkmcnt(0)
    s_mov_b32 s12, s60
    s_and_b32 s13, s61, 0xffff
    s_mov_b32 s14, 4194304
    s_mov_b32 s15, 0x00020000
    s_mul_i32 s28, s92, 262144
    s_lshl_b32 s29, s10, 1
    s_add_u32 s28, s28, s29
    s_mul_i32 s30, s92, 8192
    s_lshr_b32 s36, s9, 1
    s_lshl_b32 s36, s36, 5
    s_add_u32 s36, s36, s17
    s_lshl_b32 s36, s36, 13
    s_barrier
    s_add_u32 s31, s28, 0
    s_add_u32 m0, s30, 0
    s_nop 0
    buffer_load_dwordx4 v8, s[12:15], s31 offen lds
    s_add_u32 m0, m0, 1024
    s_nop 0
    buffer_load_dwordx4 v9, s[12:15], s31 offen lds
    s_add_u32 m0, m0, 1024
    s_nop 0
    buffer_load_dwordx4 v10, s[12:15], s31 offen lds
    s_add_u32 m0, m0, 1024
    s_nop 0
    buffer_load_dwordx4 v11, s[12:15], s31 offen lds
    s_add_u32 m0, m0, 1024
    s_add_u32 s31, s31, 131072
    buffer_load_dwordx4 v8, s[12:15], s31 offen lds
    s_add_u32 m0, m0, 1024
    s_nop 0
    buffer_load_dwordx4 v9, s[12:15], s31 offen lds
    s_add_u32 m0, m0, 1024
    s_nop 0
    buffer_load_dwordx4 v10, s[12:15], s31 offen lds
    s_add_u32 m0, m0, 1024
    s_nop 0
    buffer_load_dwordx4 v11, s[12:15], s31 offen lds
    s_add_u32 s31, s28, 1048576
    s_add_u32 m0, s30, 32768
    s_nop 0
    buffer_load_dwordx4 v8, s[12:15], s31 offen lds
    s_add_u32 m0, m0, 1024
    s_nop 0
    buffer_load_dwordx4 v9, s[12:15], s31 offen lds
    s_add_u32 m0, m0, 1024
    s_nop 0
    buffer_load_dwordx4 v10, s[12:15], s31 offen lds
    s_add_u32 m0, m0, 1024
    s_nop 0
    buffer_load_dwordx4 v11, s[12:15], s31 offen lds
    s_add_u32 m0, m0, 1024
    s_add_u32 s31, s31, 131072
    buffer_load_dwordx4 v8, s[12:15], s31 offen lds
    s_add_u32 m0, m0, 1024
    s_nop 0
    buffer_load_dwordx4 v9, s[12:15], s31 offen lds
    s_add_u32 m0, m0, 1024
    s_nop 0
    buffer_load_dwordx4 v10, s[12:15], s31 offen lds
    s_add_u32 m0, m0, 1024
    s_nop 0
    buffer_load_dwordx4 v11, s[12:15], s31 offen lds
    s_add_u32 s31, s28, 2097152
    s_add_u32 m0, s30, 65536
    s_nop 0
    buffer_load_dwordx4 v8, s[12:15], s31 offen lds
    s_add_u32 m0, m0, 1024
    s_nop 0
    buffer_load_dwordx4 v9, s[12:15], s31 offen lds
    s_add_u32 m0, m0, 1024
    s_nop 0
    buffer_load_dwordx4 v10, s[12:15], s31 offen lds
    s_add_u32 m0, m0, 1024
    s_nop 0
    buffer_load_dwordx4 v11, s[12:15], s31 offen lds
    s_add_u32 m0, m0, 1024
    s_add_u32 s31, s31, 131072
    buffer_load_dwordx4 v8, s[12:15], s31 offen lds
    s_add_u32 m0, m0, 1024
    s_nop 0
    buffer_load_dwordx4 v9, s[12:15], s31 offen lds
    s_add_u32 m0, m0, 1024
    s_nop 0
    buffer_load_dwordx4 v10, s[12:15], s31 offen lds
    s_add_u32 m0, m0, 1024
    s_nop 0
    buffer_load_dwordx4 v11, s[12:15], s31 offen lds
    s_cmp_lg_u32 s92, 0
    s_cbranch_scc1 L_w74_done
    s_lshl_b32 s79, s16, 7
    s_add_u32 s79, s79, 3932160
    v_mov_b32 v250, 0
    s_mov_b32 s94, 400000
L_w74_spin:
    buffer_load_dword v251, v250, s[4:7], s79 offen sc1
    s_waitcnt vmcnt(0)
    v_readfirstlane_b32 s93, v251
    s_nop 3
    s_cmp_ge_u32 s93, 8
    s_cbranch_scc1 L_w74_done
    s_sleep 1
    s_sub_u32 s94, s94, 1
    s_cbranch_scc0 L_w74_spin
L_w74_done:
    s_barrier
    s_mul_i32 s23, s9, 16384
    s_add_u32 s23, s23, 0
    s_add_u32 s24, s23, 16384
    buffer_load_dwordx4 a[0:3], v3, s[4:7], s23 offen offset:0 sc1
    buffer_load_dwordx4 a[64:67], v3, s[4:7], s24 offen offset:0 sc1
    buffer_load_dwordx4 a[4:7], v3, s[4:7], s23 offen offset:1024 sc1
    buffer_load_dwordx4 a[68:71], v3, s[4:7], s24 offen offset:1024 sc1
    buffer_load_dwordx4 a[8:11], v3, s[4:7], s23 offen offset:2048 sc1
    buffer_load_dwordx4 a[72:75], v3, s[4:7], s24 offen offset:2048 sc1
    buffer_load_dwordx4 a[12:15], v3, s[4:7], s23 offen offset:3072 sc1
    buffer_load_dwordx4 a[76:79], v3, s[4:7], s24 offen offset:3072 sc1
    s_add_u32 s23, s23, 4096
    buffer_load_dwordx4 a[16:19], v3, s[4:7], s23 offen offset:0 sc1
    s_add_u32 s24, s24, 4096
    buffer_load_dwordx4 a[80:83], v3, s[4:7], s24 offen offset:0 sc1
    buffer_load_dwordx4 a[20:23], v3, s[4:7], s23 offen offset:1024 sc1
    buffer_load_dwordx4 a[84:87], v3, s[4:7], s24 offen offset:1024 sc1
    buffer_load_dwordx4 a[24:27], v3, s[4:7], s23 offen offset:2048 sc1
    buffer_load_dwordx4 a[88:91], v3, s[4:7], s24 offen offset:2048 sc1
    buffer_load_dwordx4 a[28:31], v3, s[4:7], s23 offen offset:3072 sc1
    buffer_load_dwordx4 a[92:95], v3, s[4:7], s24 offen offset:3072 sc1
    s_add_u32 s23, s23, 4096
    buffer_load_dwordx4 a[32:35], v3, s[4:7], s23 offen offset:0 sc1
    s_add_u32 s24, s24, 4096
    buffer_load_dwordx4 a[96:99], v3, s[4:7], s24 offen offset:0 sc1
    buffer_load_dwordx4 a[36:39], v3, s[4:7], s23 offen offset:1024 sc1
    buffer_load_dwordx4 a[100:103], v3, s[4:7], s24 offen offset:1024 sc1
    buffer_load_dwordx4 a[40:43], v3, s[4:7], s23 offen offset:2048 sc1
    buffer_load_dwordx4 a[104:107], v3, s[4:7], s24 offen offset:2048 sc1
    buffer_load_dwordx4 a[44:47], v3, s[4:7], s23 offen offset:3072 sc1
    buffer_load_dwordx4 a[108:111], v3, s[4:7], s24 offen offset:3072 sc1
    s_add_u32 s23, s23, 4096
    buffer_load_dwordx4 a[48:51], v3, s[4:7], s23 offen offset:0 sc1
    s_add_u32 s24, s24, 4096
    buffer_load_dwordx4 a[112:115], v3, s[4:7], s24 offen offset:0 sc1
    buffer_load_dwordx4 a[52:55], v3, s[4:7], s23 offen offset:1024 sc1
    buffer_load_dwordx4 a[116:119], v3, s[4:7], s24 offen offset:1024 sc1
    buffer_load_dwordx4 a[56:59], v3, s[4:7], s23 offen offset:2048 sc1
    buffer_load_dwordx4 a[120:123], v3, s[4:7], s24 offen offset:2048 sc1
    buffer_load_dwordx4 a[60:63], v3, s[4:7], s23 offen offset:3072 sc1
    buffer_load_dwordx4 a[124:127], v3, s[4:7], s24 offen offset:3072 sc1
    s_waitcnt vmcnt(48)
    s_barrier
    ds_read_b64_tr_b16 v[164:165], v12 offset:0
    ds_read_b64_tr_b16 v[166:167], v12 offset:1024
    ds_read_b64_tr_b16 v[168:169], v13 offset:0
    ds_read_b64_tr_b16 v[170:171], v13 offset:1024
    ds_read_b64_tr_b16 v[172:173], v14 offset:0
    ds_read_b64_tr_b16 v[174:175], v14 offset:1024
    ds_read_b64_tr_b16 v[176:177], v15 offset:0
    ds_read_b64_tr_b16 v[178:179], v15 offset:1024
    ds_read_b64_tr_b16 v[180:181], v16 offset:0
    ds_read_b64_tr_b16 v[182:183], v16 offset:1024
    ds_read_b64_tr_b16 v[184:185], v17 offset:0
    ds_read_b64_tr_b16 v[186:187], v17 offset:1024
    s_waitcnt vmcnt(31) lgkmcnt(10)
    v_mfma_f32_16x16x32_bf16 v[36:39], v[164:167], a[0:3], 0
    ds_read_b64_tr_b16 v[188:189], v18 offset:0
    ds_read_b64_tr_b16 v[190:191], v18 offset:1024
    s_waitcnt vmcnt(30)
    v_mfma_f32_16x16x32_bf16 v[40:43], v[164:167], a[64:67], 0
    s_waitcnt lgkmcnt(10)
    v_mfma_f32_16x16x32_bf16 v[44:47], v[168:171], a[0:3], 0
    ds_read_b64_tr_b16 v[192:193], v19 offset:0
    ds_read_b64_tr_b16 v[194:195], v19 offset:1024
    v_mfma_f32_16x16x32_bf16 v[48:51], v[168:171], a[64:67], 0
    s_waitcnt lgkmcnt(10)
    v_mfma_f32_16x16x32_bf16 v[52:55], v[172:175], a[0:3], 0
    ds_read_b64_tr_b16 v[164:165], v12 offset:8192
    ds_read_b64_tr_b16 v[166:167], v12 offset:9216
    v_mfma_f32_16x16x32_bf16 v[56:59], v[172:175], a[64:67], 0
    s_waitcnt lgkmcnt(10)
    v_mfma_f32_16x16x32_bf16 v[60:63], v[176:179], a[0:3], 0
    ds_read_b64_tr_b16 v[168:169], v13 offset:8192
    ds_read_b64_tr_b16 v[170:171], v13 offset:9216
    v_mfma_f32_16x16x32_bf16 v[64:67], v[176:179], a[64:67], 0
    s_waitcnt lgkmcnt(10)
    v_mfma_f32_16x16x32_bf16 v[68:71], v[180:183], a[0:3], 0
    ds_read_b64_tr_b16 v[172:173], v14 offset:8192
    ds_read_b64_tr_b16 v[174:175], v14 offset:9216
    v_mfma_f32_16x16x32_bf16 v[72:75], v[180:183], a[64:67], 0
    s_waitcnt lgkmcnt(10)
    v_mfma_f32_16x16x32_bf16 v[76:79], v[184:187], a[0:3], 0
    ds_read_b64_tr_b16 v[176:177], v15 offset:8192
    ds_read_b64_tr_b16 v[178:179], v15 offset:9216
    v_mfma_f32_16x16x32_bf16 v[80:83], v[184:187], a[64:67], 0
    s_waitcnt lgkmcnt(10)
    v_mfma_f32_16x16x32_bf16 v[84:87], v[188:191], a[0:3], 0
    ds_read_b64_tr_b16 v[180:181], v16 offset:8192
    ds_read_b64_tr_b16 v[182:183], v16 offset:9216
    v_mfma_f32_16x16x32_bf16 v[88:91], v[188:191], a[64:67], 0
    s_waitcnt lgkmcnt(10)
    v_mfma_f32_16x16x32_bf16 v[92:95], v[192:195], a[0:3], 0
    ds_read_b64_tr_b16 v[184:185], v17 offset:8192
    ds_read_b64_tr_b16 v[186:187], v17 offset:9216
    v_mfma_f32_16x16x32_bf16 v[96:99], v[192:195], a[64:67], 0
    s_waitcnt vmcnt(29) lgkmcnt(10)
    v_mfma_f32_16x16x32_bf16 v[36:39], v[164:167], a[4:7], v[36:39]
    ds_read_b64_tr_b16 v[188:189], v18 offset:8192
    ds_read_b64_tr_b16 v[190:191], v18 offset:9216
    s_waitcnt vmcnt(28)
    v_mfma_f32_16x16x32_bf16 v[40:43], v[164:167], a[68:71], v[40:43]
    s_waitcnt lgkmcnt(10)
    v_mfma_f32_16x16x32_bf16 v[44:47], v[168:171], a[4:7], v[44:47]
    ds_read_b64_tr_b16 v[192:193], v19 offset:8192
    ds_read_b64_tr_b16 v[194:195], v19 offset:9216
    v_mfma_f32_16x16x32_bf16 v[48:51], v[168:171], a[68:71], v[48:51]
    s_waitcnt lgkmcnt(10)
    v_mfma_f32_16x16x32_bf16 v[52:55], v[172:175], a[4:7], v[52:55]
    ds_read_b64_tr_b16 v[164:165], v12 offset:16384
    ds_read_b64_tr_b16 v[166:167], v12 offset:17408
    v_mfma_f32_16x16x32_bf16 v[56:59], v[172:175], a[68:71], v[56:59]
    s_waitcnt lgkmcnt(10)
    v_mfma_f32_16x16x32_bf16 v[60:63], v[176:179], a[4:7], v[60:63]
    ds_read_b64_tr_b16 v[168:169], v13 offset:16384
    ds_read_b64_tr_b16 v[170:171], v13 offset:17408
    v_mfma_f32_16x16x32_bf16 v[64:67], v[176:179], a[68:71], v[64:67]
    s_waitcnt lgkmcnt(10)
    v_mfma_f32_16x16x32_bf16 v[68:71], v[180:183], a[4:7], v[68:71]
    ds_read_b64_tr_b16 v[172:173], v14 offset:16384
    ds_read_b64_tr_b16 v[174:175], v14 offset:17408
    v_mfma_f32_16x16x32_bf16 v[72:75], v[180:183], a[68:71], v[72:75]
    s_waitcnt lgkmcnt(10)
    v_mfma_f32_16x16x32_bf16 v[76:79], v[184:187], a[4:7], v[76:79]
    ds_read_b64_tr_b16 v[176:177], v15 offset:16384
    ds_read_b64_tr_b16 v[178:179], v15 offset:17408
    v_mfma_f32_16x16x32_bf16 v[80:83], v[184:187], a[68:71], v[80:83]
    s_waitcnt lgkmcnt(10)
    v_mfma_f32_16x16x32_bf16 v[84:87], v[188:191], a[4:7], v[84:87]
    ds_read_b64_tr_b16 v[180:181], v16 offset:16384
    ds_read_b64_tr_b16 v[182:183], v16 offset:17408
    v_mfma_f32_16x16x32_bf16 v[88:91], v[188:191], a[68:71], v[88:91]
    s_waitcnt lgkmcnt(10)
    v_mfma_f32_16x16x32_bf16 v[92:95], v[192:195], a[4:7], v[92:95]
    ds_read_b64_tr_b16 v[184:185], v17 offset:16384
    ds_read_b64_tr_b16 v[186:187], v17 offset:17408
    v_mfma_f32_16x16x32_bf16 v[96:99], v[192:195], a[68:71], v[96:99]
    s_waitcnt vmcnt(27) lgkmcnt(10)
    v_mfma_f32_16x16x32_bf16 v[36:39], v[164:167], a[8:11], v[36:39]
    ds_read_b64_tr_b16 v[188:189], v18 offset:16384
    ds_read_b64_tr_b16 v[190:191], v18 offset:17408
    s_waitcnt vmcnt(26)
    v_mfma_f32_16x16x32_bf16 v[40:43], v[164:167], a[72:75], v[40:43]
    s_waitcnt lgkmcnt(10)
    v_mfma_f32_16x16x32_bf16 v[44:47], v[168:171], a[8:11], v[44:47]
    ds_read_b64_tr_b16 v[192:193], v19 offset:16384
    ds_read_b64_tr_b16 v[194:195], v19 offset:17408
    v_mfma_f32_16x16x32_bf16 v[48:51], v[168:171], a[72:75], v[48:51]
    s_waitcnt lgkmcnt(10)
    v_mfma_f32_16x16x32_bf16 v[52:55], v[172:175], a[8:11], v[52:55]
    ds_read_b64_tr_b16 v[164:165], v12 offset:24576
    ds_read_b64_tr_b16 v[166:167], v12 offset:25600
    v_mfma_f32_16x16x32_bf16 v[56:59], v[172:175], a[72:75], v[56:59]
    s_waitcnt lgkmcnt(10)
    v_mfma_f32_16x16x32_bf16 v[60:63], v[176:179], a[8:11], v[60:63]
    ds_read_b64_tr_b16 v[168:169], v13 offset:24576
    ds_read_b64_tr_b16 v[170:171], v13 offset:25600
    v_mfma_f32_16x16x32_bf16 v[64:67], v[176:179], a[72:75], v[64:67]
    s_waitcnt lgkmcnt(10)
    v_mfma_f32_16x16x32_bf16 v[68:71], v[180:183], a[8:11], v[68:71]
    ds_read_b64_tr_b16 v[172:173], v14 offset:24576
    ds_read_b64_tr_b16 v[174:175], v14 offset:25600
    v_mfma_f32_16x16x32_bf16 v[72:75], v[180:183], a[72:75], v[72:75]
    s_waitcnt lgkmcnt(10)
    v_mfma_f32_16x16x32_bf16 v[76:79], v[184:187], a[8:11], v[76:79]
    ds_read_b64_tr_b16 v[176:177], v15 offset:24576
    ds_read_b64_tr_b16 v[178:179], v15 offset:25600
    v_mfma_f32_16x16x32_bf16 v[80:83], v[184:187], a[72:75], v[80:83]
    s_waitcnt lgkmcnt(10)
    v_mfma_f32_16x16x32_bf16 v[84:87], v[188:191], a[8:11], v[84:87]
    ds_read_b64_tr_b16 v[180:181], v16 offset:24576
    ds_read_b64_tr_b16 v[182:183], v16 offset:25600
    v_mfma_f32_16x16x32_bf16 v[88:91], v[188:191], a[72:75], v[88:91]
    s_waitcnt lgkmcnt(10)
    v_mfma_f32_16x16x32_bf16 v[92:95], v[192:195], a[8:11], v[92:95]
    ds_read_b64_tr_b16 v[184:185], v17 offset:24576
    ds_read_b64_tr_b16 v[186:187], v17 offset:25600
    v_mfma_f32_16x16x32_bf16 v[96:99], v[192:195], a[72:75], v[96:99]
    s_waitcnt vmcnt(25) lgkmcnt(10)
    v_mfma_f32_16x16x32_bf16 v[36:39], v[164:167], a[12:15], v[36:39]
    ds_read_b64_tr_b16 v[188:189], v18 offset:24576
    ds_read_b64_tr_b16 v[190:191], v18 offset:25600
    s_waitcnt vmcnt(24)
    v_mfma_f32_16x16x32_bf16 v[40:43], v[164:167], a[76:79], v[40:43]
    s_waitcnt lgkmcnt(10)
    v_mfma_f32_16x16x32_bf16 v[44:47], v[168:171], a[12:15], v[44:47]
    ds_read_b64_tr_b16 v[192:193], v19 offset:24576
    ds_read_b64_tr_b16 v[194:195], v19 offset:25600
    v_mfma_f32_16x16x32_bf16 v[48:51], v[168:171], a[76:79], v[48:51]
    s_waitcnt lgkmcnt(10)
    v_mfma_f32_16x16x32_bf16 v[52:55], v[172:175], a[12:15], v[52:55]
    s_waitcnt vmcnt(40)
    s_barrier
    s_add_u32 s31, s28, 3145728
    s_add_u32 m0, s30, 98304
    s_nop 0
    buffer_load_dwordx4 v8, s[12:15], s31 offen lds
    s_add_u32 m0, m0, 1024
    s_nop 0
    buffer_load_dwordx4 v9, s[12:15], s31 offen lds
    s_add_u32 m0, m0, 1024
    s_nop 0
    buffer_load_dwordx4 v10, s[12:15], s31 offen lds
    s_add_u32 m0, m0, 1024
    s_nop 0
    buffer_load_dwordx4 v11, s[12:15], s31 offen lds
    s_add_u32 m0, m0, 1024
    s_add_u32 s31, s31, 131072
    buffer_load_dwordx4 v8, s[12:15], s31 offen lds
    s_add_u32 m0, m0, 1024
    s_nop 0
    buffer_load_dwordx4 v9, s[12:15], s31 offen lds
    s_add_u32 m0, m0, 1024
    s_nop 0
    buffer_load_dwordx4 v10, s[12:15], s31 offen lds
    s_add_u32 m0, m0, 1024
    s_nop 0
    buffer_load_dwordx4 v11, s[12:15], s31 offen lds
    ds_read_b64_tr_b16 v[164:165], v12 offset:32768
    ds_read_b64_tr_b16 v[166:167], v12 offset:33792
    v_mfma_f32_16x16x32_bf16 v[56:59], v[172:175], a[76:79], v[56:59]
    s_waitcnt lgkmcnt(10)
    v_mfma_f32_16x16x32_bf16 v[60:63], v[176:179], a[12:15], v[60:63]
    ds_read_b64_tr_b16 v[168:169], v13 offset:32768
    ds_read_b64_tr_b16 v[170:171], v13 offset:33792
    v_mfma_f32_16x16x32_bf16 v[64:67], v[176:179], a[76:79], v[64:67]
    s_waitcnt lgkmcnt(10)
    v_mfma_f32_16x16x32_bf16 v[68:71], v[180:183], a[12:15], v[68:71]
    ds_read_b64_tr_b16 v[172:173], v14 offset:32768
    ds_read_b64_tr_b16 v[174:175], v14 offset:33792
    v_mfma_f32_16x16x32_bf16 v[72:75], v[180:183], a[76:79], v[72:75]
    s_waitcnt lgkmcnt(10)
    v_mfma_f32_16x16x32_bf16 v[76:79], v[184:187], a[12:15], v[76:79]
    ds_read_b64_tr_b16 v[176:177], v15 offset:32768
    ds_read_b64_tr_b16 v[178:179], v15 offset:33792
    v_mfma_f32_16x16x32_bf16 v[80:83], v[184:187], a[76:79], v[80:83]
    s_waitcnt lgkmcnt(10)
    v_mfma_f32_16x16x32_bf16 v[84:87], v[188:191], a[12:15], v[84:87]
    ds_read_b64_tr_b16 v[180:181], v16 offset:32768
    ds_read_b64_tr_b16 v[182:183], v16 offset:33792
    v_mfma_f32_16x16x32_bf16 v[88:91], v[188:191], a[76:79], v[88:91]
    s_waitcnt lgkmcnt(10)
    v_mfma_f32_16x16x32_bf16 v[92:95], v[192:195], a[12:15], v[92:95]
    ds_read_b64_tr_b16 v[184:185], v17 offset:32768
    ds_read_b64_tr_b16 v[186:187], v17 offset:33792
    v_mfma_f32_16x16x32_bf16 v[96:99], v[192:195], a[76:79], v[96:99]
    s_waitcnt vmcnt(31) lgkmcnt(10)
    v_mfma_f32_16x16x32_bf16 v[36:39], v[164:167], a[16:19], v[36:39]
    ds_read_b64_tr_b16 v[188:189], v18 offset:32768
    ds_read_b64_tr_b16 v[190:191], v18 offset:33792
    s_waitcnt vmcnt(30)
    v_mfma_f32_16x16x32_bf16 v[40:43], v[164:167], a[80:83], v[40:43]
    s_waitcnt lgkmcnt(10)
    v_mfma_f32_16x16x32_bf16 v[44:47], v[168:171], a[16:19], v[44:47]
    ds_read_b64_tr_b16 v[192:193], v19 offset:32768
    ds_read_b64_tr_b16 v[194:195], v19 offset:33792
    v_mfma_f32_16x16x32_bf16 v[48:51], v[168:171], a[80:83], v[48:51]
    s_waitcnt lgkmcnt(10)
    v_mfma_f32_16x16x32_bf16 v[52:55], v[172:175], a[16:19], v[52:55]
    ds_read_b64_tr_b16 v[164:165], v12 offset:40960
    ds_read_b64_tr_b16 v[166:167], v12 offset:41984
    v_mfma_f32_16x16x32_bf16 v[56:59], v[172:175], a[80:83], v[56:59]
    s_waitcnt lgkmcnt(10)
    v_mfma_f32_16x16x32_bf16 v[60:63], v[176:179], a[16:19], v[60:63]
    ds_read_b64_tr_b16 v[168:169], v13 offset:40960
    ds_read_b64_tr_b16 v[170:171], v13 offset:41984
    v_mfma_f32_16x16x32_bf16 v[64:67], v[176:179], a[80:83], v[64:67]
    s_waitcnt lgkmcnt(10)
    v_mfma_f32_16x16x32_bf16 v[68:71], v[180:183], a[16:19], v[68:71]
    ds_read_b64_tr_b16 v[172:173], v14 offset:40960
    ds_read_b64_tr_b16 v[174:175], v14 offset:41984
    v_mfma_f32_16x16x32_bf16 v[72:75], v[180:183], a[80:83], v[72:75]
    s_waitcnt lgkmcnt(10)
    v_mfma_f32_16x16x32_bf16 v[76:79], v[184:187], a[16:19], v[76:79]
    ds_read_b64_tr_b16 v[176:177], v15 offset:40960
    ds_read_b64_tr_b16 v[178:179], v15 offset:41984
    v_mfma_f32_16x16x32_bf16 v[80:83], v[184:187], a[80:83], v[80:83]
    s_waitcnt lgkmcnt(10)
    v_mfma_f32_16x16x32_bf16 v[84:87], v[188:191], a[16:19], v[84:87]
    ds_read_b64_tr_b16 v[180:181], v16 offset:40960
    ds_read_b64_tr_b16 v[182:183], v16 offset:41984
    v_mfma_f32_16x16x32_bf16 v[88:91], v[188:191], a[80:83], v[88:91]
    s_waitcnt lgkmcnt(10)
    v_mfma_f32_16x16x32_bf16 v[92:95], v[192:195], a[16:19], v[92:95]
    ds_read_b64_tr_b16 v[184:185], v17 offset:40960
    ds_read_b64_tr_b16 v[186:187], v17 offset:41984
    v_mfma_f32_16x16x32_bf16 v[96:99], v[192:195], a[80:83], v[96:99]
    s_waitcnt vmcnt(29) lgkmcnt(10)
    v_mfma_f32_16x16x32_bf16 v[36:39], v[164:167], a[20:23], v[36:39]
    ds_read_b64_tr_b16 v[188:189], v18 offset:40960
    ds_read_b64_tr_b16 v[190:191], v18 offset:41984
    s_waitcnt vmcnt(28)
    v_mfma_f32_16x16x32_bf16 v[40:43], v[164:167], a[84:87], v[40:43]
    s_waitcnt lgkmcnt(10)
    v_mfma_f32_16x16x32_bf16 v[44:47], v[168:171], a[20:23], v[44:47]
    ds_read_b64_tr_b16 v[192:193], v19 offset:40960
    ds_read_b64_tr_b16 v[194:195], v19 offset:41984
    v_mfma_f32_16x16x32_bf16 v[48:51], v[168:171], a[84:87], v[48:51]
    s_waitcnt lgkmcnt(10)
    v_mfma_f32_16x16x32_bf16 v[52:55], v[172:175], a[20:23], v[52:55]
    ds_read_b64_tr_b16 v[164:165], v12 offset:49152
    ds_read_b64_tr_b16 v[166:167], v12 offset:50176
    v_mfma_f32_16x16x32_bf16 v[56:59], v[172:175], a[84:87], v[56:59]
    s_waitcnt lgkmcnt(10)
    v_mfma_f32_16x16x32_bf16 v[60:63], v[176:179], a[20:23], v[60:63]
    ds_read_b64_tr_b16 v[168:169], v13 offset:49152
    ds_read_b64_tr_b16 v[170:171], v13 offset:50176
    v_mfma_f32_16x16x32_bf16 v[64:67], v[176:179], a[84:87], v[64:67]
    s_waitcnt lgkmcnt(10)
    v_mfma_f32_16x16x32_bf16 v[68:71], v[180:183], a[20:23], v[68:71]
    ds_read_b64_tr_b16 v[172:173], v14 offset:49152
    ds_read_b64_tr_b16 v[174:175], v14 offset:50176
    v_mfma_f32_16x16x32_bf16 v[72:75], v[180:183], a[84:87], v[72:75]
    s_waitcnt lgkmcnt(10)
    v_mfma_f32_16x16x32_bf16 v[76:79], v[184:187], a[20:23], v[76:79]
    ds_read_b64_tr_b16 v[176:177], v15 offset:49152
    ds_read_b64_tr_b16 v[178:179], v15 offset:50176
    v_mfma_f32_16x16x32_bf16 v[80:83], v[184:187], a[84:87], v[80:83]
    s_waitcnt lgkmcnt(10)
    v_mfma_f32_16x16x32_bf16 v[84:87], v[188:191], a[20:23], v[84:87]
    ds_read_b64_tr_b16 v[180:181], v16 offset:49152
    ds_read_b64_tr_b16 v[182:183], v16 offset:50176
    v_mfma_f32_16x16x32_bf16 v[88:91], v[188:191], a[84:87], v[88:91]
    s_waitcnt lgkmcnt(10)
    v_mfma_f32_16x16x32_bf16 v[92:95], v[192:195], a[20:23], v[92:95]
    ds_read_b64_tr_b16 v[184:185], v17 offset:49152
    ds_read_b64_tr_b16 v[186:187], v17 offset:50176
    v_mfma_f32_16x16x32_bf16 v[96:99], v[192:195], a[84:87], v[96:99]
    s_waitcnt vmcnt(27) lgkmcnt(10)
    v_mfma_f32_16x16x32_bf16 v[36:39], v[164:167], a[24:27], v[36:39]
    ds_read_b64_tr_b16 v[188:189], v18 offset:49152
    ds_read_b64_tr_b16 v[190:191], v18 offset:50176
    s_waitcnt vmcnt(26)
    v_mfma_f32_16x16x32_bf16 v[40:43], v[164:167], a[88:91], v[40:43]
    s_waitcnt lgkmcnt(10)
    v_mfma_f32_16x16x32_bf16 v[44:47], v[168:171], a[24:27], v[44:47]
    ds_read_b64_tr_b16 v[192:193], v19 offset:49152
    ds_read_b64_tr_b16 v[194:195], v19 offset:50176
    v_mfma_f32_16x16x32_bf16 v[48:51], v[168:171], a[88:91], v[48:51]
    s_waitcnt lgkmcnt(10)
    v_mfma_f32_16x16x32_bf16 v[52:55], v[172:175], a[24:27], v[52:55]
    ds_read_b64_tr_b16 v[164:165], v12 offset:57344
    ds_read_b64_tr_b16 v[166:167], v12 offset:58368
    v_mfma_f32_16x16x32_bf16 v[56:59], v[172:175], a[88:91], v[56:59]
    s_waitcnt lgkmcnt(10)
    v_mfma_f32_16x16x32_bf16 v[60:63], v[176:179], a[24:27], v[60:63]
    ds_read_b64_tr_b16 v[168:169], v13 offset:57344
    ds_read_b64_tr_b16 v[170:171], v13 offset:58368
    v_mfma_f32_16x16x32_bf16 v[64:67], v[176:179], a[88:91], v[64:67]
    s_waitcnt lgkmcnt(10)
    v_mfma_f32_16x16x32_bf16 v[68:71], v[180:183], a[24:27], v[68:71]
    ds_read_b64_tr_b16 v[172:173], v14 offset:57344
    ds_read_b64_tr_b16 v[174:175], v14 offset:58368
    v_mfma_f32_16x16x32_bf16 v[72:75], v[180:183], a[88:91], v[72:75]
    s_waitcnt lgkmcnt(10)
    v_mfma_f32_16x16x32_bf16 v[76:79], v[184:187], a[24:27], v[76:79]
    ds_read_b64_tr_b16 v[176:177], v15 offset:57344
    ds_read_b64_tr_b16 v[178:179], v15 offset:58368
    v_mfma_f32_16x16x32_bf16 v[80:83], v[184:187], a[88:91], v[80:83]
    s_waitcnt lgkmcnt(10)
    v_mfma_f32_16x16x32_bf16 v[84:87], v[188:191], a[24:27], v[84:87]
    ds_read_b64_tr_b16 v[180:181], v16 offset:57344
    ds_read_b64_tr_b16 v[182:183], v16 offset:58368
    v_mfma_f32_16x16x32_bf16 v[88:91], v[188:191], a[88:91], v[88:91]
    s_waitcnt lgkmcnt(10)
    v_mfma_f32_16x16x32_bf16 v[92:95], v[192:195], a[24:27], v[92:95]
    ds_read_b64_tr_b16 v[184:185], v17 offset:57344
    ds_read_b64_tr_b16 v[186:187], v17 offset:58368
    v_mfma_f32_16x16x32_bf16 v[96:99], v[192:195], a[88:91], v[96:99]
    s_waitcnt vmcnt(25) lgkmcnt(10)
    v_mfma_f32_16x16x32_bf16 v[36:39], v[164:167], a[28:31], v[36:39]
    ds_read_b64_tr_b16 v[188:189], v18 offset:57344
    ds_read_b64_tr_b16 v[190:191], v18 offset:58368
    s_waitcnt vmcnt(24)
    v_mfma_f32_16x16x32_bf16 v[40:43], v[164:167], a[92:95], v[40:43]
    s_waitcnt lgkmcnt(10)
    v_mfma_f32_16x16x32_bf16 v[44:47], v[168:171], a[28:31], v[44:47]
    ds_read_b64_tr_b16 v[192:193], v19 offset:57344
    ds_read_b64_tr_b16 v[194:195], v19 offset:58368
    v_mfma_f32_16x16x32_bf16 v[48:51], v[168:171], a[92:95], v[48:51]
    s_waitcnt lgkmcnt(10)
    v_mfma_f32_16x16x32_bf16 v[52:55], v[172:175], a[28:31], v[52:55]
    s_waitcnt vmcnt(40)
    s_barrier
    ds_read_b64_tr_b16 v[164:165], v24 offset:0
    ds_read_b64_tr_b16 v[166:167], v24 offset:1024
    v_mfma_f32_16x16x32_bf16 v[56:59], v[172:175], a[92:95], v[56:59]
    s_waitcnt lgkmcnt(10)
    v_mfma_f32_16x16x32_bf16 v[60:63], v[176:179], a[28:31], v[60:63]
    ds_read_b64_tr_b16 v[168:169], v25 offset:0
    ds_read_b64_tr_b16 v[170:171], v25 offset:1024
    v_mfma_f32_16x16x32_bf16 v[64:67], v[176:179], a[92:95], v[64:67]
    s_waitcnt lgkmcnt(10)
    v_mfma_f32_16x16x32_bf16 v[68:71], v[180:183], a[28:31], v[68:71]
    ds_read_b64_tr_b16 v[172:173], v26 offset:0
    ds_read_b64_tr_b16 v[174:175], v26 offset:1024
    v_mfma_f32_16x16x32_bf16 v[72:75], v[180:183], a[92:95], v[72:75]
    s_waitcnt lgkmcnt(10)
    v_mfma_f32_16x16x32_bf16 v[76:79], v[184:187], a[28:31], v[76:79]
    ds_read_b64_tr_b16 v[176:177], v27 offset:0
    ds_read_b64_tr_b16 v[178:179], v27 offset:1024
    v_mfma_f32_16x16x32_bf16 v[80:83], v[184:187], a[92:95], v[80:83]
    s_waitcnt lgkmcnt(10)
    v_mfma_f32_16x16x32_bf16 v[84:87], v[188:191], a[28:31], v[84:87]
    ds_read_b64_tr_b16 v[180:181], v28 offset:0
    ds_read_b64_tr_b16 v[182:183], v28 offset:1024
    v_mfma_f32_16x16x32_bf16 v[88:91], v[188:191], a[92:95], v[88:91]
    s_waitcnt lgkmcnt(10)
    v_mfma_f32_16x16x32_bf16 v[92:95], v[192:195], a[28:31], v[92:95]
    ds_read_b64_tr_b16 v[184:185], v29 offset:0
    ds_read_b64_tr_b16 v[186:187], v29 offset:1024
    v_mfma_f32_16x16x32_bf16 v[96:99], v[192:195], a[92:95], v[96:99]
    s_waitcnt vmcnt(23) lgkmcnt(10)
    v_mfma_f32_16x16x32_bf16 v[36:39], v[164:167], a[32:35], v[36:39]
    ds_read_b64_tr_b16 v[188:189], v30 offset:0
    ds_read_b64_tr_b16 v[190:191], v30 offset:1024
    s_waitcnt vmcnt(22)
    v_mfma_f32_16x16x32_bf16 v[40:43], v[164:167], a[96:99], v[40:43]
    s_waitcnt lgkmcnt(10)
    v_mfma_f32_16x16x32_bf16 v[44:47], v[168:171], a[32:35], v[44:47]
    ds_read_b64_tr_b16 v[192:193], v31 offset:0
    ds_read_b64_tr_b16 v[194:195], v31 offset:1024
    v_mfma_f32_16x16x32_bf16 v[48:51], v[168:171], a[96:99], v[48:51]
    s_waitcnt lgkmcnt(10)
    v_mfma_f32_16x16x32_bf16 v[52:55], v[172:175], a[32:35], v[52:55]
    ds_read_b64_tr_b16 v[164:165], v24 offset:8192
    ds_read_b64_tr_b16 v[166:167], v24 offset:9216
    v_mfma_f32_16x16x32_bf16 v[56:59], v[172:175], a[96:99], v[56:59]
    s_waitcnt lgkmcnt(10)
    v_mfma_f32_16x16x32_bf16 v[60:63], v[176:179], a[32:35], v[60:63]
    ds_read_b64_tr_b16 v[168:169], v25 offset:8192
    ds_read_b64_tr_b16 v[170:171], v25 offset:9216
    v_mfma_f32_16x16x32_bf16 v[64:67], v[176:179], a[96:99], v[64:67]
    s_waitcnt lgkmcnt(10)
    v_mfma_f32_16x16x32_bf16 v[68:71], v[180:183], a[32:35], v[68:71]
    ds_read_b64_tr_b16 v[172:173], v26 offset:8192
    ds_read_b64_tr_b16 v[174:175], v26 offset:9216
    v_mfma_f32_16x16x32_bf16 v[72:75], v[180:183], a[96:99], v[72:75]
    s_waitcnt lgkmcnt(10)
    v_mfma_f32_16x16x32_bf16 v[76:79], v[184:187], a[32:35], v[76:79]
    ds_read_b64_tr_b16 v[176:177], v27 offset:8192
    ds_read_b64_tr_b16 v[178:179], v27 offset:9216
    v_mfma_f32_16x16x32_bf16 v[80:83], v[184:187], a[96:99], v[80:83]
    s_waitcnt lgkmcnt(10)
    v_mfma_f32_16x16x32_bf16 v[84:87], v[188:191], a[32:35], v[84:87]
    ds_read_b64_tr_b16 v[180:181], v28 offset:8192
    ds_read_b64_tr_b16 v[182:183], v28 offset:9216
    v_mfma_f32_16x16x32_bf16 v[88:91], v[188:191], a[96:99], v[88:91]
    s_waitcnt lgkmcnt(10)
    v_mfma_f32_16x16x32_bf16 v[92:95], v[192:195], a[32:35], v[92:95]
    ds_read_b64_tr_b16 v[184:185], v29 offset:8192
    ds_read_b64_tr_b16 v[186:187], v29 offset:9216
    v_mfma_f32_16x16x32_bf16 v[96:99], v[192:195], a[96:99], v[96:99]
    s_waitcnt vmcnt(21) lgkmcnt(10)
    v_mfma_f32_16x16x32_bf16 v[36:39], v[164:167], a[36:39], v[36:39]
    ds_read_b64_tr_b16 v[188:189], v30 offset:8192
    ds_read_b64_tr_b16 v[190:191], v30 offset:9216
    s_waitcnt vmcnt(20)
    v_mfma_f32_16x16x32_bf16 v[40:43], v[164:167], a[100:103], v[40:43]
    s_waitcnt lgkmcnt(10)
    v_mfma_f32_16x16x32_bf16 v[44:47], v[168:171], a[36:39], v[44:47]
    ds_read_b64_tr_b16 v[192:193], v31 offset:8192
    ds_read_b64_tr_b16 v[194:195], v31 offset:9216
    v_mfma_f32_16x16x32_bf16 v[48:51], v[168:171], a[100:103], v[48:51]
    s_waitcnt lgkmcnt(10)
    v_mfma_f32_16x16x32_bf16 v[52:55], v[172:175], a[36:39], v[52:55]
    ds_read_b64_tr_b16 v[164:165], v24 offset:16384
    ds_read_b64_tr_b16 v[166:167], v24 offset:17408
    v_mfma_f32_16x16x32_bf16 v[56:59], v[172:175], a[100:103], v[56:59]
    s_waitcnt lgkmcnt(10)
    v_mfma_f32_16x16x32_bf16 v[60:63], v[176:179], a[36:39], v[60:63]
    ds_read_b64_tr_b16 v[168:169], v25 offset:16384
    ds_read_b64_tr_b16 v[170:171], v25 offset:17408
    v_mfma_f32_16x16x32_bf16 v[64:67], v[176:179], a[100:103], v[64:67]
    s_waitcnt lgkmcnt(10)
    v_mfma_f32_16x16x32_bf16 v[68:71], v[180:183], a[36:39], v[68:71]
    ds_read_b64_tr_b16 v[172:173], v26 offset:16384
    ds_read_b64_tr_b16 v[174:175], v26 offset:17408
    v_mfma_f32_16x16x32_bf16 v[72:75], v[180:183], a[100:103], v[72:75]
    s_waitcnt lgkmcnt(10)
    v_mfma_f32_16x16x32_bf16 v[76:79], v[184:187], a[36:39], v[76:79]
    ds_read_b64_tr_b16 v[176:177], v27 offset:16384
    ds_read_b64_tr_b16 v[178:179], v27 offset:17408
    v_mfma_f32_16x16x32_bf16 v[80:83], v[184:187], a[100:103], v[80:83]
    s_waitcnt lgkmcnt(10)
    v_mfma_f32_16x16x32_bf16 v[84:87], v[188:191], a[36:39], v[84:87]
    ds_read_b64_tr_b16 v[180:181], v28 offset:16384
    ds_read_b64_tr_b16 v[182:183], v28 offset:17408
    v_mfma_f32_16x16x32_bf16 v[88:91], v[188:191], a[100:103], v[88:91]
    s_waitcnt lgkmcnt(10)
    v_mfma_f32_16x16x32_bf16 v[92:95], v[192:195], a[36:39], v[92:95]
    ds_read_b64_tr_b16 v[184:185], v29 offset:16384
    ds_read_b64_tr_b16 v[186:187], v29 offset:17408
    v_mfma_f32_16x16x32_bf16 v[96:99], v[192:195], a[100:103], v[96:99]
    s_waitcnt vmcnt(19) lgkmcnt(10)
    v_mfma_f32_16x16x32_bf16 v[36:39], v[164:167], a[40:43], v[36:39]
    ds_read_b64_tr_b16 v[188:189], v30 offset:16384
    ds_read_b64_tr_b16 v[190:191], v30 offset:17408
    s_waitcnt vmcnt(18)
    v_mfma_f32_16x16x32_bf16 v[40:43], v[164:167], a[104:107], v[40:43]
    s_waitcnt lgkmcnt(10)
    v_mfma_f32_16x16x32_bf16 v[44:47], v[168:171], a[40:43], v[44:47]
    ds_read_b64_tr_b16 v[192:193], v31 offset:16384
    ds_read_b64_tr_b16 v[194:195], v31 offset:17408
    v_mfma_f32_16x16x32_bf16 v[48:51], v[168:171], a[104:107], v[48:51]
    s_waitcnt lgkmcnt(10)
    v_mfma_f32_16x16x32_bf16 v[52:55], v[172:175], a[40:43], v[52:55]
    ds_read_b64_tr_b16 v[164:165], v24 offset:24576
    ds_read_b64_tr_b16 v[166:167], v24 offset:25600
    v_mfma_f32_16x16x32_bf16 v[56:59], v[172:175], a[104:107], v[56:59]
    s_waitcnt lgkmcnt(10)
    v_mfma_f32_16x16x32_bf16 v[60:63], v[176:179], a[40:43], v[60:63]
    ds_read_b64_tr_b16 v[168:169], v25 offset:24576
    ds_read_b64_tr_b16 v[170:171], v25 offset:25600
    v_mfma_f32_16x16x32_bf16 v[64:67], v[176:179], a[104:107], v[64:67]
    s_waitcnt lgkmcnt(10)
    v_mfma_f32_16x16x32_bf16 v[68:71], v[180:183], a[40:43], v[68:71]
    ds_read_b64_tr_b16 v[172:173], v26 offset:24576
    ds_read_b64_tr_b16 v[174:175], v26 offset:25600
    v_mfma_f32_16x16x32_bf16 v[72:75], v[180:183], a[104:107], v[72:75]
    s_waitcnt lgkmcnt(10)
    v_mfma_f32_16x16x32_bf16 v[76:79], v[184:187], a[40:43], v[76:79]
    ds_read_b64_tr_b16 v[176:177], v27 offset:24576
    ds_read_b64_tr_b16 v[178:179], v27 offset:25600
    v_mfma_f32_16x16x32_bf16 v[80:83], v[184:187], a[104:107], v[80:83]
    s_waitcnt lgkmcnt(10)
    v_mfma_f32_16x16x32_bf16 v[84:87], v[188:191], a[40:43], v[84:87]
    ds_read_b64_tr_b16 v[180:181], v28 offset:24576
    ds_read_b64_tr_b16 v[182:183], v28 offset:25600
    v_mfma_f32_16x16x32_bf16 v[88:91], v[188:191], a[104:107], v[88:91]
    s_waitcnt lgkmcnt(10)
    v_mfma_f32_16x16x32_bf16 v[92:95], v[192:195], a[40:43], v[92:95]
    ds_read_b64_tr_b16 v[184:185], v29 offset:24576
    ds_read_b64_tr_b16 v[186:187], v29 offset:25600
    v_mfma_f32_16x16x32_bf16 v[96:99], v[192:195], a[104:107], v[96:99]
    s_waitcnt vmcnt(17) lgkmcnt(10)
    v_mfma_f32_16x16x32_bf16 v[36:39], v[164:167], a[44:47], v[36:39]
    ds_read_b64_tr_b16 v[188:189], v30 offset:24576
    ds_read_b64_tr_b16 v[190:191], v30 offset:25600
    s_waitcnt vmcnt(16)
    v_mfma_f32_16x16x32_bf16 v[40:43], v[164:167], a[108:111], v[40:43]
    s_waitcnt lgkmcnt(10)
    v_mfma_f32_16x16x32_bf16 v[44:47], v[168:171], a[44:47], v[44:47]
    ds_read_b64_tr_b16 v[192:193], v31 offset:24576
    ds_read_b64_tr_b16 v[194:195], v31 offset:25600
    v_mfma_f32_16x16x32_bf16 v[48:51], v[168:171], a[108:111], v[48:51]
    s_waitcnt lgkmcnt(10)
    v_mfma_f32_16x16x32_bf16 v[52:55], v[172:175], a[44:47], v[52:55]
    s_waitcnt vmcnt(0)
    s_barrier
    ds_read_b64_tr_b16 v[164:165], v24 offset:32768
    ds_read_b64_tr_b16 v[166:167], v24 offset:33792
    v_mfma_f32_16x16x32_bf16 v[56:59], v[172:175], a[108:111], v[56:59]
    s_waitcnt lgkmcnt(10)
    v_mfma_f32_16x16x32_bf16 v[60:63], v[176:179], a[44:47], v[60:63]
    ds_read_b64_tr_b16 v[168:169], v25 offset:32768
    ds_read_b64_tr_b16 v[170:171], v25 offset:33792
    v_mfma_f32_16x16x32_bf16 v[64:67], v[176:179], a[108:111], v[64:67]
    s_waitcnt lgkmcnt(10)
    v_mfma_f32_16x16x32_bf16 v[68:71], v[180:183], a[44:47], v[68:71]
    ds_read_b64_tr_b16 v[172:173], v26 offset:32768
    ds_read_b64_tr_b16 v[174:175], v26 offset:33792
    v_mfma_f32_16x16x32_bf16 v[72:75], v[180:183], a[108:111], v[72:75]
    s_waitcnt lgkmcnt(10)
    v_mfma_f32_16x16x32_bf16 v[76:79], v[184:187], a[44:47], v[76:79]
    ds_read_b64_tr_b16 v[176:177], v27 offset:32768
    ds_read_b64_tr_b16 v[178:179], v27 offset:33792
    v_mfma_f32_16x16x32_bf16 v[80:83], v[184:187], a[108:111], v[80:83]
    s_waitcnt lgkmcnt(10)
    v_mfma_f32_16x16x32_bf16 v[84:87], v[188:191], a[44:47], v[84:87]
    ds_read_b64_tr_b16 v[180:181], v28 offset:32768
    ds_read_b64_tr_b16 v[182:183], v28 offset:33792
    v_mfma_f32_16x16x32_bf16 v[88:91], v[188:191], a[108:111], v[88:91]
    s_waitcnt lgkmcnt(10)
    v_mfma_f32_16x16x32_bf16 v[92:95], v[192:195], a[44:47], v[92:95]
    ds_read_b64_tr_b16 v[184:185], v29 offset:32768
    ds_read_b64_tr_b16 v[186:187], v29 offset:33792
    v_mfma_f32_16x16x32_bf16 v[96:99], v[192:195], a[108:111], v[96:99]
    s_waitcnt lgkmcnt(10)
    v_mfma_f32_16x16x32_bf16 v[36:39], v[164:167], a[48:51], v[36:39]
    ds_read_b64_tr_b16 v[188:189], v30 offset:32768
    ds_read_b64_tr_b16 v[190:191], v30 offset:33792
    v_mfma_f32_16x16x32_bf16 v[40:43], v[164:167], a[112:115], v[40:43]
    s_waitcnt lgkmcnt(10)
    v_mfma_f32_16x16x32_bf16 v[44:47], v[168:171], a[48:51], v[44:47]
    ds_read_b64_tr_b16 v[192:193], v31 offset:32768
    ds_read_b64_tr_b16 v[194:195], v31 offset:33792
    v_mfma_f32_16x16x32_bf16 v[48:51], v[168:171], a[112:115], v[48:51]
    s_waitcnt lgkmcnt(10)
    v_mfma_f32_16x16x32_bf16 v[52:55], v[172:175], a[48:51], v[52:55]
    ds_read_b64_tr_b16 v[164:165], v24 offset:40960
    ds_read_b64_tr_b16 v[166:167], v24 offset:41984
    v_mfma_f32_16x16x32_bf16 v[56:59], v[172:175], a[112:115], v[56:59]
    s_waitcnt lgkmcnt(10)
    v_mfma_f32_16x16x32_bf16 v[60:63], v[176:179], a[48:51], v[60:63]
    ds_read_b64_tr_b16 v[168:169], v25 offset:40960
    ds_read_b64_tr_b16 v[170:171], v25 offset:41984
    v_mfma_f32_16x16x32_bf16 v[64:67], v[176:179], a[112:115], v[64:67]
    s_waitcnt lgkmcnt(10)
    v_mfma_f32_16x16x32_bf16 v[68:71], v[180:183], a[48:51], v[68:71]
    ds_read_b64_tr_b16 v[172:173], v26 offset:40960
    ds_read_b64_tr_b16 v[174:175], v26 offset:41984
    v_mfma_f32_16x16x32_bf16 v[72:75], v[180:183], a[112:115], v[72:75]
    s_waitcnt lgkmcnt(10)
    v_mfma_f32_16x16x32_bf16 v[76:79], v[184:187], a[48:51], v[76:79]
    ds_read_b64_tr_b16 v[176:177], v27 offset:40960
    ds_read_b64_tr_b16 v[178:179], v27 offset:41984
    v_mfma_f32_16x16x32_bf16 v[80:83], v[184:187], a[112:115], v[80:83]
    s_waitcnt lgkmcnt(10)
    v_mfma_f32_16x16x32_bf16 v[84:87], v[188:191], a[48:51], v[84:87]
    ds_read_b64_tr_b16 v[180:181], v28 offset:40960
    ds_read_b64_tr_b16 v[182:183], v28 offset:41984
    v_mfma_f32_16x16x32_bf16 v[88:91], v[188:191], a[112:115], v[88:91]
    s_waitcnt lgkmcnt(10)
    v_mfma_f32_16x16x32_bf16 v[92:95], v[192:195], a[48:51], v[92:95]
    ds_read_b64_tr_b16 v[184:185], v29 offset:40960
    ds_read_b64_tr_b16 v[186:187], v29 offset:41984
    v_mfma_f32_16x16x32_bf16 v[96:99], v[192:195], a[112:115], v[96:99]
    s_waitcnt lgkmcnt(10)
    v_mfma_f32_16x16x32_bf16 v[36:39], v[164:167], a[52:55], v[36:39]
    ds_read_b64_tr_b16 v[188:189], v30 offset:40960
    ds_read_b64_tr_b16 v[190:191], v30 offset:41984
    v_mfma_f32_16x16x32_bf16 v[40:43], v[164:167], a[116:119], v[40:43]
    s_waitcnt lgkmcnt(10)
    v_mfma_f32_16x16x32_bf16 v[44:47], v[168:171], a[52:55], v[44:47]
    ds_read_b64_tr_b16 v[192:193], v31 offset:40960
    ds_read_b64_tr_b16 v[194:195], v31 offset:41984
    v_mfma_f32_16x16x32_bf16 v[48:51], v[168:171], a[116:119], v[48:51]
    s_waitcnt lgkmcnt(10)
    v_mfma_f32_16x16x32_bf16 v[52:55], v[172:175], a[52:55], v[52:55]
    ds_read_b64_tr_b16 v[164:165], v24 offset:49152
    ds_read_b64_tr_b16 v[166:167], v24 offset:50176
    v_mfma_f32_16x16x32_bf16 v[56:59], v[172:175], a[116:119], v[56:59]
    s_waitcnt lgkmcnt(10)
    v_mfma_f32_16x16x32_bf16 v[60:63], v[176:179], a[52:55], v[60:63]
    ds_read_b64_tr_b16 v[168:169], v25 offset:49152
    ds_read_b64_tr_b16 v[170:171], v25 offset:50176
    v_mfma_f32_16x16x32_bf16 v[64:67], v[176:179], a[116:119], v[64:67]
    s_waitcnt lgkmcnt(10)
    v_mfma_f32_16x16x32_bf16 v[68:71], v[180:183], a[52:55], v[68:71]
    ds_read_b64_tr_b16 v[172:173], v26 offset:49152
    ds_read_b64_tr_b16 v[174:175], v26 offset:50176
    v_mfma_f32_16x16x32_bf16 v[72:75], v[180:183], a[116:119], v[72:75]
    s_waitcnt lgkmcnt(10)
    v_mfma_f32_16x16x32_bf16 v[76:79], v[184:187], a[52:55], v[76:79]
    ds_read_b64_tr_b16 v[176:177], v27 offset:49152
    ds_read_b64_tr_b16 v[178:179], v27 offset:50176
    v_mfma_f32_16x16x32_bf16 v[80:83], v[184:187], a[116:119], v[80:83]
    s_waitcnt lgkmcnt(10)
    v_mfma_f32_16x16x32_bf16 v[84:87], v[188:191], a[52:55], v[84:87]
    ds_read_b64_tr_b16 v[180:181], v28 offset:49152
    ds_read_b64_tr_b16 v[182:183], v28 offset:50176
    v_mfma_f32_16x16x32_bf16 v[88:91], v[188:191], a[116:119], v[88:91]
    s_waitcnt lgkmcnt(10)
    v_mfma_f32_16x16x32_bf16 v[92:95], v[192:195], a[52:55], v[92:95]
    ds_read_b64_tr_b16 v[184:185], v29 offset:49152
    ds_read_b64_tr_b16 v[186:187], v29 offset:50176
    v_mfma_f32_16x16x32_bf16 v[96:99], v[192:195], a[116:119], v[96:99]
    s_waitcnt lgkmcnt(10)
    v_mfma_f32_16x16x32_bf16 v[36:39], v[164:167], a[56:59], v[36:39]
    ds_read_b64_tr_b16 v[188:189], v30 offset:49152
    ds_read_b64_tr_b16 v[190:191], v30 offset:50176
    v_mfma_f32_16x16x32_bf16 v[40:43], v[164:167], a[120:123], v[40:43]
    s_waitcnt lgkmcnt(10)
    v_mfma_f32_16x16x32_bf16 v[44:47], v[168:171], a[56:59], v[44:47]
    ds_read_b64_tr_b16 v[192:193], v31 offset:49152
    ds_read_b64_tr_b16 v[194:195], v31 offset:50176
    v_mfma_f32_16x16x32_bf16 v[48:51], v[168:171], a[120:123], v[48:51]
    s_waitcnt lgkmcnt(10)
    v_mfma_f32_16x16x32_bf16 v[52:55], v[172:175], a[56:59], v[52:55]
    ds_read_b64_tr_b16 v[164:165], v24 offset:57344
    ds_read_b64_tr_b16 v[166:167], v24 offset:58368
    v_mfma_f32_16x16x32_bf16 v[56:59], v[172:175], a[120:123], v[56:59]
    s_waitcnt lgkmcnt(10)
    v_mfma_f32_16x16x32_bf16 v[60:63], v[176:179], a[56:59], v[60:63]
    ds_read_b64_tr_b16 v[168:169], v25 offset:57344
    ds_read_b64_tr_b16 v[170:171], v25 offset:58368
    v_mfma_f32_16x16x32_bf16 v[64:67], v[176:179], a[120:123], v[64:67]
    s_waitcnt lgkmcnt(10)
    v_mfma_f32_16x16x32_bf16 v[68:71], v[180:183], a[56:59], v[68:71]
    ds_read_b64_tr_b16 v[172:173], v26 offset:57344
    ds_read_b64_tr_b16 v[174:175], v26 offset:58368
    v_mfma_f32_16x16x32_bf16 v[72:75], v[180:183], a[120:123], v[72:75]
    s_waitcnt lgkmcnt(10)
    v_mfma_f32_16x16x32_bf16 v[76:79], v[184:187], a[56:59], v[76:79]
    ds_read_b64_tr_b16 v[176:177], v27 offset:57344
    ds_read_b64_tr_b16 v[178:179], v27 offset:58368
    v_mfma_f32_16x16x32_bf16 v[80:83], v[184:187], a[120:123], v[80:83]
    s_waitcnt lgkmcnt(10)
    v_mfma_f32_16x16x32_bf16 v[84:87], v[188:191], a[56:59], v[84:87]
    ds_read_b64_tr_b16 v[180:181], v28 offset:57344
    ds_read_b64_tr_b16 v[182:183], v28 offset:58368
    v_mfma_f32_16x16x32_bf16 v[88:91], v[188:191], a[120:123], v[88:91]
    s_waitcnt lgkmcnt(10)
    v_mfma_f32_16x16x32_bf16 v[92:95], v[192:195], a[56:59], v[92:95]
    ds_read_b64_tr_b16 v[184:185], v29 offset:57344
    ds_read_b64_tr_b16 v[186:187], v29 offset:58368
    v_mfma_f32_16x16x32_bf16 v[96:99], v[192:195], a[120:123], v[96:99]
    s_waitcnt lgkmcnt(10)
    v_mfma_f32_16x16x32_bf16 v[36:39], v[164:167], a[60:63], v[36:39]
    ds_read_b64_tr_b16 v[188:189], v30 offset:57344
    ds_read_b64_tr_b16 v[190:191], v30 offset:58368
    v_mfma_f32_16x16x32_bf16 v[40:43], v[164:167], a[124:127], v[40:43]
    s_waitcnt lgkmcnt(10)
    v_mfma_f32_16x16x32_bf16 v[44:47], v[168:171], a[60:63], v[44:47]
    ds_read_b64_tr_b16 v[192:193], v31 offset:57344
    ds_read_b64_tr_b16 v[194:195], v31 offset:58368
    v_mfma_f32_16x16x32_bf16 v[48:51], v[168:171], a[124:127], v[48:51]
    s_waitcnt lgkmcnt(10)
    v_mfma_f32_16x16x32_bf16 v[52:55], v[172:175], a[60:63], v[52:55]
    v_mfma_f32_16x16x32_bf16 v[56:59], v[172:175], a[124:127], v[56:59]
    s_waitcnt lgkmcnt(8)
    v_mfma_f32_16x16x32_bf16 v[60:63], v[176:179], a[60:63], v[60:63]
    v_mfma_f32_16x16x32_bf16 v[64:67], v[176:179], a[124:127], v[64:67]
    s_waitcnt lgkmcnt(6)
    v_mfma_f32_16x16x32_bf16 v[68:71], v[180:183], a[60:63], v[68:71]
    v_mfma_f32_16x16x32_bf16 v[72:75], v[180:183], a[124:127], v[72:75]
    s_waitcnt lgkmcnt(4)
    v_mfma_f32_16x16x32_bf16 v[76:79], v[184:187], a[60:63], v[76:79]
    v_mfma_f32_16x16x32_bf16 v[80:83], v[184:187], a[124:127], v[80:83]
    s_waitcnt lgkmcnt(2)
    v_mfma_f32_16x16x32_bf16 v[84:87], v[188:191], a[60:63], v[84:87]
    v_mfma_f32_16x16x32_bf16 v[88:91], v[188:191], a[124:127], v[88:91]
    s_waitcnt lgkmcnt(0)
    v_mfma_f32_16x16x32_bf16 v[92:95], v[192:195], a[60:63], v[92:95]
    v_mfma_f32_16x16x32_bf16 v[96:99], v[192:195], a[124:127], v[96:99]
    s_add_u32 s37, s36, s38
    v_cvt_pk_bf16_f32 v196, v36, v37
    v_cvt_pk_bf16_f32 v197, v38, v39
    v_cvt_pk_bf16_f32 v198, v44, v45
    v_cvt_pk_bf16_f32 v199, v46, v47
    buffer_store_dwordx4 v[196:199], v3, s[4:7], s37 offen offset:0 sc1
    v_cvt_pk_bf16_f32 v200, v52, v53
    v_cvt_pk_bf16_f32 v201, v54, v55
    v_cvt_pk_bf16_f32 v202, v60, v61
    v_cvt_pk_bf16_f32 v203, v62, v63
    buffer_store_dwordx4 v[200:203], v3, s[4:7], s37 offen offset:1024 sc1
    v_cvt_pk_bf16_f32 v204, v68, v69
    v_cvt_pk_bf16_f32 v205, v70, v71
    v_cvt_pk_bf16_f32 v206, v76, v77
    v_cvt_pk_bf16_f32 v207, v78, v79
    buffer_store_dwordx4 v[204:207], v3, s[4:7], s37 offen offset:2048 sc1
    v_cvt_pk_bf16_f32 v208, v84, v85
    v_cvt_pk_bf16_f32 v209, v86, v87
    v_cvt_pk_bf16_f32 v210, v92, v93
    v_cvt_pk_bf16_f32 v211, v94, v95
    buffer_store_dwordx4 v[208:211], v3, s[4:7], s37 offen offset:3072 sc1
    s_add_u32 s37, s37, 4096
    v_cvt_pk_bf16_f32 v196, v40, v41
    v_cvt_pk_bf16_f32 v197, v42, v43
    v_cvt_pk_bf16_f32 v198, v48, v49
    v_cvt_pk_bf16_f32 v199, v50, v51
    buffer_store_dwordx4 v[196:199], v3, s[4:7], s37 offen offset:0 sc1
    v_cvt_pk_bf16_f32 v200, v56, v57
    v_cvt_pk_bf16_f32 v201, v58, v59
    v_cvt_pk_bf16_f32 v202, v64, v65
    v_cvt_pk_bf16_f32 v203, v66, v67
    buffer_store_dwordx4 v[200:203], v3, s[4:7], s37 offen offset:1024 sc1
    v_cvt_pk_bf16_f32 v204, v72, v73
    v_cvt_pk_bf16_f32 v205, v74, v75
    v_cvt_pk_bf16_f32 v206, v80, v81
    v_cvt_pk_bf16_f32 v207, v82, v83
    buffer_store_dwordx4 v[204:207], v3, s[4:7], s37 offen offset:2048 sc1
    v_cvt_pk_bf16_f32 v208, v88, v89
    v_cvt_pk_bf16_f32 v209, v90, v91
    v_cvt_pk_bf16_f32 v210, v96, v97
    v_cvt_pk_bf16_f32 v211, v98, v99
    buffer_store_dwordx4 v[208:211], v3, s[4:7], s37 offen offset:3072 sc1
    s_cmp_eq_u32 s88, 0
    s_cselect_b32 s39, 16, 32
    s_add_u32 s39, s39, s16
    s_waitcnt vmcnt(0)
    s_barrier
    s_cmp_lg_u32 s92, 0
    s_cbranch_scc1 L_s75_done
    s_lshl_b32 s79, s39, 7
    s_add_u32 s79, s79, 3932160
    v_mov_b32 v250, 0
    v_mov_b32 v251, 1
    s_mov_b64 exec, 1
    buffer_atomic_add v251, v250, s[4:7], s79 offen
    s_mov_b64 exec, -1
L_s75_done:
    s_waitcnt vmcnt(0) lgkmcnt(0)
    s_barrier
    v_accvgpr_read_b32 v0, a255
    s_branch L_adaLN_cond__memory_aug_recurrent_mem_tr__dense_activation_gelu__prompt_kernel_q_next
L_adaLN_cond__memory_aug_recurrent_mem_tr__dense_activation_gelu__prompt_kernel_q_v:
    s_load_dwordx2 s[60:61], s[0:1], 24
    s_load_dwordx2 s[62:63], s[0:1], 32
    s_load_dwordx2 s[64:65], s[0:1], 16
    v_and_b32 v2, 63, v0
    s_lshr_b32 s16, s2, 5
    s_and_b32 s17, s2, 31
    s_lshl_b32 s9, s16, 3
    s_lshl_b32 s18, s92, 1
    s_add_u32 s9, s9, s18
    s_lshl_b32 s10, s17, 7
    v_lshlrev_b32 v3, 4, v2
    v_and_b32 v4, 15, v2
    v_lshrrev_b32 v5, 4, v2
    v_lshrrev_b32 v6, 4, v2
    v_and_b32 v7, 15, v2
    s_mov_b32 s20, 8192
    v_add_u32 v8, 0, v6
    v_and_b32 v20, 3, v8
    v_bfe_u32 v21, v8, 3, 1
    v_lshl_or_b32 v20, v21, 2, v20
    v_lshrrev_b32 v21, 1, v7
    v_xor_b32 v21, v21, v20
    v_and_b32 v22, 1, v7
    v_lshl_or_b32 v21, v21, 1, v22
    v_mul_lo_u32 v8, v8, s20
    v_lshl_add_u32 v8, v21, 4, v8
    v_add_u32 v9, 4, v6
    v_and_b32 v20, 3, v9
    v_bfe_u32 v21, v9, 3, 1
    v_lshl_or_b32 v20, v21, 2, v20
    v_lshrrev_b32 v21, 1, v7
    v_xor_b32 v21, v21, v20
    v_and_b32 v22, 1, v7
    v_lshl_or_b32 v21, v21, 1, v22
    v_mul_lo_u32 v9, v9, s20
    v_lshl_add_u32 v9, v21, 4, v9
    v_add_u32 v10, 8, v6
    v_and_b32 v20, 3, v10
    v_bfe_u32 v21, v10, 3, 1
    v_lshl_or_b32 v20, v21, 2, v20
    v_lshrrev_b32 v21, 1, v7
    v_xor_b32 v21, v21, v20
    v_and_b32 v22, 1, v7
    v_lshl_or_b32 v21, v21, 1, v22
    v_mul_lo_u32 v10, v10, s20
    v_lshl_add_u32 v10, v21, 4, v10
    v_add_u32 v11, 12, v6
    v_and_b32 v20, 3, v11
    v_bfe_u32 v21, v11, 3, 1
    v_lshl_or_b32 v20, v21, 2, v20
    v_lshrrev_b32 v21, 1, v7
    v_xor_b32 v21, v21, v20
    v_and_b32 v22, 1, v7
    v_lshl_or_b32 v21, v21, 1, v22
    v_mul_lo_u32 v11, v11, s20
    v_lshl_add_u32 v11, v21, 4, v11
    v_lshrrev_b32 v20, 2, v4
    v_lshl_add_u32 v21, v5, 3, v20
    v_and_b32 v22, 1, v5
    v_lshl_or_b32 v22, v22, 2, v20
    v_mul_u32_u24 v21, 256, v21
    v_and_b32 v23, 3, v2
    v_lshl_add_u32 v21, v23, 3, v21
    v_xor_b32 v23, 0, v22
    v_lshl_add_u32 v12, v23, 5, v21
    v_add_u32 v24, 0x10000, v12
    v_xor_b32 v23, 1, v22
    v_lshl_add_u32 v13, v23, 5, v21
    v_add_u32 v25, 0x10000, v13
    v_xor_b32 v23, 2, v22
    v_lshl_add_u32 v14, v23, 5, v21
    v_add_u32 v26, 0x10000, v14
    v_xor_b32 v23, 3, v22
    v_lshl_add_u32 v15, v23, 5, v21
    v_add_u32 v27, 0x10000, v15
    v_xor_b32 v23, 4, v22
    v_lshl_add_u32 v16, v23, 5, v21
    v_add_u32 v28, 0x10000, v16
    v_xor_b32 v23, 5, v22
    v_lshl_add_u32 v17, v23, 5, v21
    v_add_u32 v29, 0x10000, v17
    v_xor_b32 v23, 6, v22
    v_lshl_add_u32 v18, v23, 5, v21
    v_add_u32 v30, 0x10000, v18
    v_xor_b32 v23, 7, v22
    v_lshl_add_u32 v19, v23, 5, v21
    v_add_u32 v31, 0x10000, v19
    v_and_b32 v32, 1, v4
    v_lshlrev_b32 v32, 10, v32
    v_lshl_add_u32 v32, v5, 8, v32
    v_lshrrev_b32 v21, 1, v4
    v_lshl_add_u32 v32, v21, 4, v32
    s_waitcnt lgkmcnt(0)
    s_mov_b32 s40, s62
    s_and_b32 s41, s63, 0xffff
    s_mov_b32 s42, 4194304
    s_mov_b32 s43, 0x00020000
    s_mul_i32 s28, s92, 262144
    s_lshl_b32 s29, s10, 1
    s_add_u32 s28, s28, s29
    s_mul_i32 s30, s92, 8192
    s_lshr_b32 s36, s9, 1
    s_lshl_b32 s36, s36, 5
    s_add_u32 s36, s36, s17
    s_lshl_b32 s36, s36, 13
    s_barrier
    s_add_u32 s31, s28, 0
    s_add_u32 m0, s30, 0
    s_nop 0
    buffer_load_dwordx4 v8, s[40:43], s31 offen lds
    s_add_u32 m0, m0, 1024
    s_nop 0
    buffer_load_dwordx4 v9, s[40:43], s31 offen lds
    s_add_u32 m0, m0, 1024
    s_nop 0
    buffer_load_dwordx4 v10, s[40:43], s31 offen lds
    s_add_u32 m0, m0, 1024
    s_nop 0
    buffer_load_dwordx4 v11, s[40:43], s31 offen lds
    s_add_u32 m0, m0, 1024
    s_add_u32 s31, s31, 131072
    buffer_load_dwordx4 v8, s[40:43], s31 offen lds
    s_add_u32 m0, m0, 1024
    s_nop 0
    buffer_load_dwordx4 v9, s[40:43], s31 offen lds
    s_add_u32 m0, m0, 1024
    s_nop 0
    buffer_load_dwordx4 v10, s[40:43], s31 offen lds
    s_add_u32 m0, m0, 1024
    s_nop 0
    buffer_load_dwordx4 v11, s[40:43], s31 offen lds
    s_add_u32 s31, s28, 1048576
    s_add_u32 m0, s30, 32768
    s_nop 0
    buffer_load_dwordx4 v8, s[40:43], s31 offen lds
    s_add_u32 m0, m0, 1024
    s_nop 0
    buffer_load_dwordx4 v9, s[40:43], s31 offen lds
    s_add_u32 m0, m0, 1024
    s_nop 0
    buffer_load_dwordx4 v10, s[40:43], s31 offen lds
    s_add_u32 m0, m0, 1024
    s_nop 0
    buffer_load_dwordx4 v11, s[40:43], s31 offen lds
    s_add_u32 m0, m0, 1024
    s_add_u32 s31, s31, 131072
    buffer_load_dwordx4 v8, s[40:43], s31 offen lds
    s_add_u32 m0, m0, 1024
    s_nop 0
    buffer_load_dwordx4 v9, s[40:43], s31 offen lds
    s_add_u32 m0, m0, 1024
    s_nop 0
    buffer_load_dwordx4 v10, s[40:43], s31 offen lds
    s_add_u32 m0, m0, 1024
    s_nop 0
    buffer_load_dwordx4 v11, s[40:43], s31 offen lds
    s_add_u32 s31, s28, 2097152
    s_add_u32 m0, s30, 65536
    s_nop 0
    buffer_load_dwordx4 v8, s[40:43], s31 offen lds
    s_add_u32 m0, m0, 1024
    s_nop 0
    buffer_load_dwordx4 v9, s[40:43], s31 offen lds
    s_add_u32 m0, m0, 1024
    s_nop 0
    buffer_load_dwordx4 v10, s[40:43], s31 offen lds
    s_add_u32 m0, m0, 1024
    s_nop 0
    buffer_load_dwordx4 v11, s[40:43], s31 offen lds
    s_add_u32 m0, m0, 1024
    s_add_u32 s31, s31, 131072
    buffer_load_dwordx4 v8, s[40:43], s31 offen lds
    s_add_u32 m0, m0, 1024
    s_nop 0
    buffer_load_dwordx4 v9, s[40:43], s31 offen lds
    s_add_u32 m0, m0, 1024
    s_nop 0
    buffer_load_dwordx4 v10, s[40:43], s31 offen lds
    s_add_u32 m0, m0, 1024
    s_nop 0
    buffer_load_dwordx4 v11, s[40:43], s31 offen lds
    s_cmp_lg_u32 s92, 0
    s_cbranch_scc1 L_w76_done
    s_lshl_b32 s79, s16, 7
    s_add_u32 s79, s79, 3932160
    v_mov_b32 v250, 0
    s_mov_b32 s94, 400000
L_w76_spin:
    buffer_load_dword v251, v250, s[4:7], s79 offen sc1
    s_waitcnt vmcnt(0)
    v_readfirstlane_b32 s93, v251
    s_nop 3
    s_cmp_ge_u32 s93, 8
    s_cbranch_scc1 L_w76_done
    s_sleep 1
    s_sub_u32 s94, s94, 1
    s_cbranch_scc0 L_w76_spin
L_w76_done:
    s_barrier
    s_mul_i32 s23, s9, 16384
    s_add_u32 s23, s23, 0
    s_add_u32 s24, s23, 16384
    buffer_load_dwordx4 a[0:3], v3, s[4:7], s23 offen offset:0 sc1
    buffer_load_dwordx4 a[64:67], v3, s[4:7], s24 offen offset:0 sc1
    buffer_load_dwordx4 a[4:7], v3, s[4:7], s23 offen offset:1024 sc1
    buffer_load_dwordx4 a[68:71], v3, s[4:7], s24 offen offset:1024 sc1
    buffer_load_dwordx4 a[8:11], v3, s[4:7], s23 offen offset:2048 sc1
    buffer_load_dwordx4 a[72:75], v3, s[4:7], s24 offen offset:2048 sc1
    buffer_load_dwordx4 a[12:15], v3, s[4:7], s23 offen offset:3072 sc1
    buffer_load_dwordx4 a[76:79], v3, s[4:7], s24 offen offset:3072 sc1
    s_add_u32 s23, s23, 4096
    buffer_load_dwordx4 a[16:19], v3, s[4:7], s23 offen offset:0 sc1
    s_add_u32 s24, s24, 4096
    buffer_load_dwordx4 a[80:83], v3, s[4:7], s24 offen offset:0 sc1
    buffer_load_dwordx4 a[20:23], v3, s[4:7], s23 offen offset:1024 sc1
    buffer_load_dwordx4 a[84:87], v3, s[4:7], s24 offen offset:1024 sc1
    buffer_load_dwordx4 a[24:27], v3, s[4:7], s23 offen offset:2048 sc1
    buffer_load_dwordx4 a[88:91], v3, s[4:7], s24 offen offset:2048 sc1
    buffer_load_dwordx4 a[28:31], v3, s[4:7], s23 offen offset:3072 sc1
    buffer_load_dwordx4 a[92:95], v3, s[4:7], s24 offen offset:3072 sc1
    s_add_u32 s23, s23, 4096
    buffer_load_dwordx4 a[32:35], v3, s[4:7], s23 offen offset:0 sc1
    s_add_u32 s24, s24, 4096
    buffer_load_dwordx4 a[96:99], v3, s[4:7], s24 offen offset:0 sc1
    buffer_load_dwordx4 a[36:39], v3, s[4:7], s23 offen offset:1024 sc1
    buffer_load_dwordx4 a[100:103], v3, s[4:7], s24 offen offset:1024 sc1
    buffer_load_dwordx4 a[40:43], v3, s[4:7], s23 offen offset:2048 sc1
    buffer_load_dwordx4 a[104:107], v3, s[4:7], s24 offen offset:2048 sc1
    buffer_load_dwordx4 a[44:47], v3, s[4:7], s23 offen offset:3072 sc1
    buffer_load_dwordx4 a[108:111], v3, s[4:7], s24 offen offset:3072 sc1
    s_add_u32 s23, s23, 4096
    buffer_load_dwordx4 a[48:51], v3, s[4:7], s23 offen offset:0 sc1
    s_add_u32 s24, s24, 4096
    buffer_load_dwordx4 a[112:115], v3, s[4:7], s24 offen offset:0 sc1
    buffer_load_dwordx4 a[52:55], v3, s[4:7], s23 offen offset:1024 sc1
    buffer_load_dwordx4 a[116:119], v3, s[4:7], s24 offen offset:1024 sc1
    buffer_load_dwordx4 a[56:59], v3, s[4:7], s23 offen offset:2048 sc1
    buffer_load_dwordx4 a[120:123], v3, s[4:7], s24 offen offset:2048 sc1
    buffer_load_dwordx4 a[60:63], v3, s[4:7], s23 offen offset:3072 sc1
    buffer_load_dwordx4 a[124:127], v3, s[4:7], s24 offen offset:3072 sc1
    s_waitcnt vmcnt(48)
    s_barrier
    ds_read_b64_tr_b16 v[164:165], v12 offset:0
    ds_read_b64_tr_b16 v[166:167], v12 offset:1024
    ds_read_b64_tr_b16 v[168:169], v13 offset:0
    ds_read_b64_tr_b16 v[170:171], v13 offset:1024
    ds_read_b64_tr_b16 v[172:173], v14 offset:0
    ds_read_b64_tr_b16 v[174:175], v14 offset:1024
    ds_read_b64_tr_b16 v[176:177], v15 offset:0
    ds_read_b64_tr_b16 v[178:179], v15 offset:1024
    ds_read_b64_tr_b16 v[180:181], v16 offset:0
    ds_read_b64_tr_b16 v[182:183], v16 offset:1024
    ds_read_b64_tr_b16 v[184:185], v17 offset:0
    ds_read_b64_tr_b16 v[186:187], v17 offset:1024
    s_waitcnt vmcnt(31) lgkmcnt(10)
    v_mfma_f32_16x16x32_bf16 v[100:103], a[0:3], v[164:167], 0
    ds_read_b64_tr_b16 v[188:189], v18 offset:0
    ds_read_b64_tr_b16 v[190:191], v18 offset:1024
    s_waitcnt vmcnt(30)
    v_mfma_f32_16x16x32_bf16 v[104:107], a[64:67], v[164:167], 0
    s_waitcnt lgkmcnt(10)
    v_mfma_f32_16x16x32_bf16 v[108:111], a[0:3], v[168:171], 0
    ds_read_b64_tr_b16 v[192:193], v19 offset:0
    ds_read_b64_tr_b16 v[194:195], v19 offset:1024
    v_mfma_f32_16x16x32_bf16 v[112:115], a[64:67], v[168:171], 0
    s_waitcnt lgkmcnt(10)
    v_mfma_f32_16x16x32_bf16 v[116:119], a[0:3], v[172:175], 0
    ds_read_b64_tr_b16 v[164:165], v12 offset:8192
    ds_read_b64_tr_b16 v[166:167], v12 offset:9216
    v_mfma_f32_16x16x32_bf16 v[120:123], a[64:67], v[172:175], 0
    s_waitcnt lgkmcnt(10)
    v_mfma_f32_16x16x32_bf16 v[124:127], a[0:3], v[176:179], 0
    ds_read_b64_tr_b16 v[168:169], v13 offset:8192
    ds_read_b64_tr_b16 v[170:171], v13 offset:9216
    v_mfma_f32_16x16x32_bf16 v[128:131], a[64:67], v[176:179], 0
    s_waitcnt lgkmcnt(10)
    v_mfma_f32_16x16x32_bf16 v[132:135], a[0:3], v[180:183], 0
    ds_read_b64_tr_b16 v[172:173], v14 offset:8192
    ds_read_b64_tr_b16 v[174:175], v14 offset:9216
    v_mfma_f32_16x16x32_bf16 v[136:139], a[64:67], v[180:183], 0
    s_waitcnt lgkmcnt(10)
    v_mfma_f32_16x16x32_bf16 v[140:143], a[0:3], v[184:187], 0
    ds_read_b64_tr_b16 v[176:177], v15 offset:8192
    ds_read_b64_tr_b16 v[178:179], v15 offset:9216
    v_mfma_f32_16x16x32_bf16 v[144:147], a[64:67], v[184:187], 0
    s_waitcnt lgkmcnt(10)
    v_mfma_f32_16x16x32_bf16 v[148:151], a[0:3], v[188:191], 0
    ds_read_b64_tr_b16 v[180:181], v16 offset:8192
    ds_read_b64_tr_b16 v[182:183], v16 offset:9216
    v_mfma_f32_16x16x32_bf16 v[152:155], a[64:67], v[188:191], 0
    s_waitcnt lgkmcnt(10)
    v_mfma_f32_16x16x32_bf16 v[156:159], a[0:3], v[192:195], 0
    ds_read_b64_tr_b16 v[184:185], v17 offset:8192
    ds_read_b64_tr_b16 v[186:187], v17 offset:9216
    v_mfma_f32_16x16x32_bf16 v[160:163], a[64:67], v[192:195], 0
    s_waitcnt vmcnt(29) lgkmcnt(10)
    v_mfma_f32_16x16x32_bf16 v[100:103], a[4:7], v[164:167], v[100:103]
    ds_read_b64_tr_b16 v[188:189], v18 offset:8192
    ds_read_b64_tr_b16 v[190:191], v18 offset:9216
    s_waitcnt vmcnt(28)
    v_mfma_f32_16x16x32_bf16 v[104:107], a[68:71], v[164:167], v[104:107]
    s_waitcnt lgkmcnt(10)
    v_mfma_f32_16x16x32_bf16 v[108:111], a[4:7], v[168:171], v[108:111]
    ds_read_b64_tr_b16 v[192:193], v19 offset:8192
    ds_read_b64_tr_b16 v[194:195], v19 offset:9216
    v_mfma_f32_16x16x32_bf16 v[112:115], a[68:71], v[168:171], v[112:115]
    s_waitcnt lgkmcnt(10)
    v_mfma_f32_16x16x32_bf16 v[116:119], a[4:7], v[172:175], v[116:119]
    ds_read_b64_tr_b16 v[164:165], v12 offset:16384
    ds_read_b64_tr_b16 v[166:167], v12 offset:17408
    v_mfma_f32_16x16x32_bf16 v[120:123], a[68:71], v[172:175], v[120:123]
    s_waitcnt lgkmcnt(10)
    v_mfma_f32_16x16x32_bf16 v[124:127], a[4:7], v[176:179], v[124:127]
    ds_read_b64_tr_b16 v[168:169], v13 offset:16384
    ds_read_b64_tr_b16 v[170:171], v13 offset:17408
    v_mfma_f32_16x16x32_bf16 v[128:131], a[68:71], v[176:179], v[128:131]
    s_waitcnt lgkmcnt(10)
    v_mfma_f32_16x16x32_bf16 v[132:135], a[4:7], v[180:183], v[132:135]
    ds_read_b64_tr_b16 v[172:173], v14 offset:16384
    ds_read_b64_tr_b16 v[174:175], v14 offset:17408
    v_mfma_f32_16x16x32_bf16 v[136:139], a[68:71], v[180:183], v[136:139]
    s_waitcnt lgkmcnt(10)
    v_mfma_f32_16x16x32_bf16 v[140:143], a[4:7], v[184:187], v[140:143]
    ds_read_b64_tr_b16 v[176:177], v15 offset:16384
    ds_read_b64_tr_b16 v[178:179], v15 offset:17408
    v_mfma_f32_16x16x32_bf16 v[144:147], a[68:71], v[184:187], v[144:147]
    s_waitcnt lgkmcnt(10)
    v_mfma_f32_16x16x32_bf16 v[148:151], a[4:7], v[188:191], v[148:151]
    ds_read_b64_tr_b16 v[180:181], v16 offset:16384
    ds_read_b64_tr_b16 v[182:183], v16 offset:17408
    v_mfma_f32_16x16x32_bf16 v[152:155], a[68:71], v[188:191], v[152:155]
    s_waitcnt lgkmcnt(10)
    v_mfma_f32_16x16x32_bf16 v[156:159], a[4:7], v[192:195], v[156:159]
    ds_read_b64_tr_b16 v[184:185], v17 offset:16384
    ds_read_b64_tr_b16 v[186:187], v17 offset:17408
    v_mfma_f32_16x16x32_bf16 v[160:163], a[68:71], v[192:195], v[160:163]
    s_waitcnt vmcnt(27) lgkmcnt(10)
    v_mfma_f32_16x16x32_bf16 v[100:103], a[8:11], v[164:167], v[100:103]
    ds_read_b64_tr_b16 v[188:189], v18 offset:16384
    ds_read_b64_tr_b16 v[190:191], v18 offset:17408
    s_waitcnt vmcnt(26)
    v_mfma_f32_16x16x32_bf16 v[104:107], a[72:75], v[164:167], v[104:107]
    s_waitcnt lgkmcnt(10)
    v_mfma_f32_16x16x32_bf16 v[108:111], a[8:11], v[168:171], v[108:111]
    ds_read_b64_tr_b16 v[192:193], v19 offset:16384
    ds_read_b64_tr_b16 v[194:195], v19 offset:17408
    v_mfma_f32_16x16x32_bf16 v[112:115], a[72:75], v[168:171], v[112:115]
    s_waitcnt lgkmcnt(10)
    v_mfma_f32_16x16x32_bf16 v[116:119], a[8:11], v[172:175], v[116:119]
    ds_read_b64_tr_b16 v[164:165], v12 offset:24576
    ds_read_b64_tr_b16 v[166:167], v12 offset:25600
    v_mfma_f32_16x16x32_bf16 v[120:123], a[72:75], v[172:175], v[120:123]
    s_waitcnt lgkmcnt(10)
    v_mfma_f32_16x16x32_bf16 v[124:127], a[8:11], v[176:179], v[124:127]
    ds_read_b64_tr_b16 v[168:169], v13 offset:24576
    ds_read_b64_tr_b16 v[170:171], v13 offset:25600
    v_mfma_f32_16x16x32_bf16 v[128:131], a[72:75], v[176:179], v[128:131]
    s_waitcnt lgkmcnt(10)
    v_mfma_f32_16x16x32_bf16 v[132:135], a[8:11], v[180:183], v[132:135]
    ds_read_b64_tr_b16 v[172:173], v14 offset:24576
    ds_read_b64_tr_b16 v[174:175], v14 offset:25600
    v_mfma_f32_16x16x32_bf16 v[136:139], a[72:75], v[180:183], v[136:139]
    s_waitcnt lgkmcnt(10)
    v_mfma_f32_16x16x32_bf16 v[140:143], a[8:11], v[184:187], v[140:143]
    ds_read_b64_tr_b16 v[176:177], v15 offset:24576
    ds_read_b64_tr_b16 v[178:179], v15 offset:25600
    v_mfma_f32_16x16x32_bf16 v[144:147], a[72:75], v[184:187], v[144:147]
    s_waitcnt lgkmcnt(10)
    v_mfma_f32_16x16x32_bf16 v[148:151], a[8:11], v[188:191], v[148:151]
    ds_read_b64_tr_b16 v[180:181], v16 offset:24576
    ds_read_b64_tr_b16 v[182:183], v16 offset:25600
    v_mfma_f32_16x16x32_bf16 v[152:155], a[72:75], v[188:191], v[152:155]
    s_waitcnt lgkmcnt(10)
    v_mfma_f32_16x16x32_bf16 v[156:159], a[8:11], v[192:195], v[156:159]
    ds_read_b64_tr_b16 v[184:185], v17 offset:24576
    ds_read_b64_tr_b16 v[186:187], v17 offset:25600
    v_mfma_f32_16x16x32_bf16 v[160:163], a[72:75], v[192:195], v[160:163]
    s_waitcnt vmcnt(25) lgkmcnt(10)
    v_mfma_f32_16x16x32_bf16 v[100:103], a[12:15], v[164:167], v[100:103]
    ds_read_b64_tr_b16 v[188:189], v18 offset:24576
    ds_read_b64_tr_b16 v[190:191], v18 offset:25600
    s_waitcnt vmcnt(24)
    v_mfma_f32_16x16x32_bf16 v[104:107], a[76:79], v[164:167], v[104:107]
    s_waitcnt lgkmcnt(10)
    v_mfma_f32_16x16x32_bf16 v[108:111], a[12:15], v[168:171], v[108:111]
    ds_read_b64_tr_b16 v[192:193], v19 offset:24576
    ds_read_b64_tr_b16 v[194:195], v19 offset:25600
    v_mfma_f32_16x16x32_bf16 v[112:115], a[76:79], v[168:171], v[112:115]
    s_waitcnt lgkmcnt(10)
    v_mfma_f32_16x16x32_bf16 v[116:119], a[12:15], v[172:175], v[116:119]
    s_waitcnt vmcnt(40)
    s_barrier
    s_add_u32 s31, s28, 3145728
    s_add_u32 m0, s30, 98304
    s_nop 0
    buffer_load_dwordx4 v8, s[40:43], s31 offen lds
    s_add_u32 m0, m0, 1024
    s_nop 0
    buffer_load_dwordx4 v9, s[40:43], s31 offen lds
    s_add_u32 m0, m0, 1024
    s_nop 0
    buffer_load_dwordx4 v10, s[40:43], s31 offen lds
    s_add_u32 m0, m0, 1024
    s_nop 0
    buffer_load_dwordx4 v11, s[40:43], s31 offen lds
    s_add_u32 m0, m0, 1024
    s_add_u32 s31, s31, 131072
    buffer_load_dwordx4 v8, s[40:43], s31 offen lds
    s_add_u32 m0, m0, 1024
    s_nop 0
    buffer_load_dwordx4 v9, s[40:43], s31 offen lds
    s_add_u32 m0, m0, 1024
    s_nop 0
    buffer_load_dwordx4 v10, s[40:43], s31 offen lds
    s_add_u32 m0, m0, 1024
    s_nop 0
    buffer_load_dwordx4 v11, s[40:43], s31 offen lds
    ds_read_b64_tr_b16 v[164:165], v12 offset:32768
    ds_read_b64_tr_b16 v[166:167], v12 offset:33792
    v_mfma_f32_16x16x32_bf16 v[120:123], a[76:79], v[172:175], v[120:123]
    s_waitcnt lgkmcnt(10)
    v_mfma_f32_16x16x32_bf16 v[124:127], a[12:15], v[176:179], v[124:127]
    ds_read_b64_tr_b16 v[168:169], v13 offset:32768
    ds_read_b64_tr_b16 v[170:171], v13 offset:33792
    v_mfma_f32_16x16x32_bf16 v[128:131], a[76:79], v[176:179], v[128:131]
    s_waitcnt lgkmcnt(10)
    v_mfma_f32_16x16x32_bf16 v[132:135], a[12:15], v[180:183], v[132:135]
    ds_read_b64_tr_b16 v[172:173], v14 offset:32768
    ds_read_b64_tr_b16 v[174:175], v14 offset:33792
    v_mfma_f32_16x16x32_bf16 v[136:139], a[76:79], v[180:183], v[136:139]
    s_waitcnt lgkmcnt(10)
    v_mfma_f32_16x16x32_bf16 v[140:143], a[12:15], v[184:187], v[140:143]
    ds_read_b64_tr_b16 v[176:177], v15 offset:32768
    ds_read_b64_tr_b16 v[178:179], v15 offset:33792
    v_mfma_f32_16x16x32_bf16 v[144:147], a[76:79], v[184:187], v[144:147]
    s_waitcnt lgkmcnt(10)
    v_mfma_f32_16x16x32_bf16 v[148:151], a[12:15], v[188:191], v[148:151]
    ds_read_b64_tr_b16 v[180:181], v16 offset:32768
    ds_read_b64_tr_b16 v[182:183], v16 offset:33792
    v_mfma_f32_16x16x32_bf16 v[152:155], a[76:79], v[188:191], v[152:155]
    s_waitcnt lgkmcnt(10)
    v_mfma_f32_16x16x32_bf16 v[156:159], a[12:15], v[192:195], v[156:159]
    ds_read_b64_tr_b16 v[184:185], v17 offset:32768
    ds_read_b64_tr_b16 v[186:187], v17 offset:33792
    v_mfma_f32_16x16x32_bf16 v[160:163], a[76:79], v[192:195], v[160:163]
    s_waitcnt vmcnt(31) lgkmcnt(10)
    v_mfma_f32_16x16x32_bf16 v[100:103], a[16:19], v[164:167], v[100:103]
    ds_read_b64_tr_b16 v[188:189], v18 offset:32768
    ds_read_b64_tr_b16 v[190:191], v18 offset:33792
    s_waitcnt vmcnt(30)
    v_mfma_f32_16x16x32_bf16 v[104:107], a[80:83], v[164:167], v[104:107]
    s_waitcnt lgkmcnt(10)
    v_mfma_f32_16x16x32_bf16 v[108:111], a[16:19], v[168:171], v[108:111]
    ds_read_b64_tr_b16 v[192:193], v19 offset:32768
    ds_read_b64_tr_b16 v[194:195], v19 offset:33792
    v_mfma_f32_16x16x32_bf16 v[112:115], a[80:83], v[168:171], v[112:115]
    s_waitcnt lgkmcnt(10)
    v_mfma_f32_16x16x32_bf16 v[116:119], a[16:19], v[172:175], v[116:119]
    ds_read_b64_tr_b16 v[164:165], v12 offset:40960
    ds_read_b64_tr_b16 v[166:167], v12 offset:41984
    v_mfma_f32_16x16x32_bf16 v[120:123], a[80:83], v[172:175], v[120:123]
    s_waitcnt lgkmcnt(10)
    v_mfma_f32_16x16x32_bf16 v[124:127], a[16:19], v[176:179], v[124:127]
    ds_read_b64_tr_b16 v[168:169], v13 offset:40960
    ds_read_b64_tr_b16 v[170:171], v13 offset:41984
    v_mfma_f32_16x16x32_bf16 v[128:131], a[80:83], v[176:179], v[128:131]
    s_waitcnt lgkmcnt(10)
    v_mfma_f32_16x16x32_bf16 v[132:135], a[16:19], v[180:183], v[132:135]
    ds_read_b64_tr_b16 v[172:173], v14 offset:40960
    ds_read_b64_tr_b16 v[174:175], v14 offset:41984
    v_mfma_f32_16x16x32_bf16 v[136:139], a[80:83], v[180:183], v[136:139]
    s_waitcnt lgkmcnt(10)
    v_mfma_f32_16x16x32_bf16 v[140:143], a[16:19], v[184:187], v[140:143]
    ds_read_b64_tr_b16 v[176:177], v15 offset:40960
    ds_read_b64_tr_b16 v[178:179], v15 offset:41984
    v_mfma_f32_16x16x32_bf16 v[144:147], a[80:83], v[184:187], v[144:147]
    s_waitcnt lgkmcnt(10)
    v_mfma_f32_16x16x32_bf16 v[148:151], a[16:19], v[188:191], v[148:151]
    ds_read_b64_tr_b16 v[180:181], v16 offset:40960
    ds_read_b64_tr_b16 v[182:183], v16 offset:41984
    v_mfma_f32_16x16x32_bf16 v[152:155], a[80:83], v[188:191], v[152:155]
    s_waitcnt lgkmcnt(10)
    v_mfma_f32_16x16x32_bf16 v[156:159], a[16:19], v[192:195], v[156:159]
    ds_read_b64_tr_b16 v[184:185], v17 offset:40960
    ds_read_b64_tr_b16 v[186:187], v17 offset:41984
    v_mfma_f32_16x16x32_bf16 v[160:163], a[80:83], v[192:195], v[160:163]
    s_waitcnt vmcnt(29) lgkmcnt(10)
    v_mfma_f32_16x16x32_bf16 v[100:103], a[20:23], v[164:167], v[100:103]
    ds_read_b64_tr_b16 v[188:189], v18 offset:40960
    ds_read_b64_tr_b16 v[190:191], v18 offset:41984
    s_waitcnt vmcnt(28)
    v_mfma_f32_16x16x32_bf16 v[104:107], a[84:87], v[164:167], v[104:107]
    s_waitcnt lgkmcnt(10)
    v_mfma_f32_16x16x32_bf16 v[108:111], a[20:23], v[168:171], v[108:111]
    ds_read_b64_tr_b16 v[192:193], v19 offset:40960
    ds_read_b64_tr_b16 v[194:195], v19 offset:41984
    v_mfma_f32_16x16x32_bf16 v[112:115], a[84:87], v[168:171], v[112:115]
    s_waitcnt lgkmcnt(10)
    v_mfma_f32_16x16x32_bf16 v[116:119], a[20:23], v[172:175], v[116:119]
    ds_read_b64_tr_b16 v[164:165], v12 offset:49152
    ds_read_b64_tr_b16 v[166:167], v12 offset:50176
    v_mfma_f32_16x16x32_bf16 v[120:123], a[84:87], v[172:175], v[120:123]
    s_waitcnt lgkmcnt(10)
    v_mfma_f32_16x16x32_bf16 v[124:127], a[20:23], v[176:179], v[124:127]
    ds_read_b64_tr_b16 v[168:169], v13 offset:49152
    ds_read_b64_tr_b16 v[170:171], v13 offset:50176
    v_mfma_f32_16x16x32_bf16 v[128:131], a[84:87], v[176:179], v[128:131]
    s_waitcnt lgkmcnt(10)
    v_mfma_f32_16x16x32_bf16 v[132:135], a[20:23], v[180:183], v[132:135]
    ds_read_b64_tr_b16 v[172:173], v14 offset:49152
    ds_read_b64_tr_b16 v[174:175], v14 offset:50176
    v_mfma_f32_16x16x32_bf16 v[136:139], a[84:87], v[180:183], v[136:139]
    s_waitcnt lgkmcnt(10)
    v_mfma_f32_16x16x32_bf16 v[140:143], a[20:23], v[184:187], v[140:143]
    ds_read_b64_tr_b16 v[176:177], v15 offset:49152
    ds_read_b64_tr_b16 v[178:179], v15 offset:50176
    v_mfma_f32_16x16x32_bf16 v[144:147], a[84:87], v[184:187], v[144:147]
    s_waitcnt lgkmcnt(10)
    v_mfma_f32_16x16x32_bf16 v[148:151], a[20:23], v[188:191], v[148:151]
    ds_read_b64_tr_b16 v[180:181], v16 offset:49152
    ds_read_b64_tr_b16 v[182:183], v16 offset:50176
    v_mfma_f32_16x16x32_bf16 v[152:155], a[84:87], v[188:191], v[152:155]
    s_waitcnt lgkmcnt(10)
    v_mfma_f32_16x16x32_bf16 v[156:159], a[20:23], v[192:195], v[156:159]
    ds_read_b64_tr_b16 v[184:185], v17 offset:49152
    ds_read_b64_tr_b16 v[186:187], v17 offset:50176
    v_mfma_f32_16x16x32_bf16 v[160:163], a[84:87], v[192:195], v[160:163]
    s_waitcnt vmcnt(27) lgkmcnt(10)
    v_mfma_f32_16x16x32_bf16 v[100:103], a[24:27], v[164:167], v[100:103]
    ds_read_b64_tr_b16 v[188:189], v18 offset:49152
    ds_read_b64_tr_b16 v[190:191], v18 offset:50176
    s_waitcnt vmcnt(26)
    v_mfma_f32_16x16x32_bf16 v[104:107], a[88:91], v[164:167], v[104:107]
    s_waitcnt lgkmcnt(10)
    v_mfma_f32_16x16x32_bf16 v[108:111], a[24:27], v[168:171], v[108:111]
    ds_read_b64_tr_b16 v[192:193], v19 offset:49152
    ds_read_b64_tr_b16 v[194:195], v19 offset:50176
    v_mfma_f32_16x16x32_bf16 v[112:115], a[88:91], v[168:171], v[112:115]
    s_waitcnt lgkmcnt(10)
    v_mfma_f32_16x16x32_bf16 v[116:119], a[24:27], v[172:175], v[116:119]
    ds_read_b64_tr_b16 v[164:165], v12 offset:57344
    ds_read_b64_tr_b16 v[166:167], v12 offset:58368
    v_mfma_f32_16x16x32_bf16 v[120:123], a[88:91], v[172:175], v[120:123]
    s_waitcnt lgkmcnt(10)
    v_mfma_f32_16x16x32_bf16 v[124:127], a[24:27], v[176:179], v[124:127]
    ds_read_b64_tr_b16 v[168:169], v13 offset:57344
    ds_read_b64_tr_b16 v[170:171], v13 offset:58368
    v_mfma_f32_16x16x32_bf16 v[128:131], a[88:91], v[176:179], v[128:131]
    s_waitcnt lgkmcnt(10)
    v_mfma_f32_16x16x32_bf16 v[132:135], a[24:27], v[180:183], v[132:135]
    ds_read_b64_tr_b16 v[172:173], v14 offset:57344
    ds_read_b64_tr_b16 v[174:175], v14 offset:58368
    v_mfma_f32_16x16x32_bf16 v[136:139], a[88:91], v[180:183], v[136:139]
    s_waitcnt lgkmcnt(10)
    v_mfma_f32_16x16x32_bf16 v[140:143], a[24:27], v[184:187], v[140:143]
    ds_read_b64_tr_b16 v[176:177], v15 offset:57344
    ds_read_b64_tr_b16 v[178:179], v15 offset:58368
    v_mfma_f32_16x16x32_bf16 v[144:147], a[88:91], v[184:187], v[144:147]
    s_waitcnt lgkmcnt(10)
    v_mfma_f32_16x16x32_bf16 v[148:151], a[24:27], v[188:191], v[148:151]
    ds_read_b64_tr_b16 v[180:181], v16 offset:57344
    ds_read_b64_tr_b16 v[182:183], v16 offset:58368
    v_mfma_f32_16x16x32_bf16 v[152:155], a[88:91], v[188:191], v[152:155]
    s_waitcnt lgkmcnt(10)
    v_mfma_f32_16x16x32_bf16 v[156:159], a[24:27], v[192:195], v[156:159]
    ds_read_b64_tr_b16 v[184:185], v17 offset:57344
    ds_read_b64_tr_b16 v[186:187], v17 offset:58368
    v_mfma_f32_16x16x32_bf16 v[160:163], a[88:91], v[192:195], v[160:163]
    s_waitcnt vmcnt(25) lgkmcnt(10)
    v_mfma_f32_16x16x32_bf16 v[100:103], a[28:31], v[164:167], v[100:103]
    ds_read_b64_tr_b16 v[188:189], v18 offset:57344
    ds_read_b64_tr_b16 v[190:191], v18 offset:58368
    s_waitcnt vmcnt(24)
    v_mfma_f32_16x16x32_bf16 v[104:107], a[92:95], v[164:167], v[104:107]
    s_waitcnt lgkmcnt(10)
    v_mfma_f32_16x16x32_bf16 v[108:111], a[28:31], v[168:171], v[108:111]
    ds_read_b64_tr_b16 v[192:193], v19 offset:57344
    ds_read_b64_tr_b16 v[194:195], v19 offset:58368
    v_mfma_f32_16x16x32_bf16 v[112:115], a[92:95], v[168:171], v[112:115]
    s_waitcnt lgkmcnt(10)
    v_mfma_f32_16x16x32_bf16 v[116:119], a[28:31], v[172:175], v[116:119]
    s_waitcnt vmcnt(40)
    s_barrier
    ds_read_b64_tr_b16 v[164:165], v24 offset:0
    ds_read_b64_tr_b16 v[166:167], v24 offset:1024
    v_mfma_f32_16x16x32_bf16 v[120:123], a[92:95], v[172:175], v[120:123]
    s_waitcnt lgkmcnt(10)
    v_mfma_f32_16x16x32_bf16 v[124:127], a[28:31], v[176:179], v[124:127]
    ds_read_b64_tr_b16 v[168:169], v25 offset:0
    ds_read_b64_tr_b16 v[170:171], v25 offset:1024
    v_mfma_f32_16x16x32_bf16 v[128:131], a[92:95], v[176:179], v[128:131]
    s_waitcnt lgkmcnt(10)
    v_mfma_f32_16x16x32_bf16 v[132:135], a[28:31], v[180:183], v[132:135]
    ds_read_b64_tr_b16 v[172:173], v26 offset:0
    ds_read_b64_tr_b16 v[174:175], v26 offset:1024
    v_mfma_f32_16x16x32_bf16 v[136:139], a[92:95], v[180:183], v[136:139]
    s_waitcnt lgkmcnt(10)
    v_mfma_f32_16x16x32_bf16 v[140:143], a[28:31], v[184:187], v[140:143]
    ds_read_b64_tr_b16 v[176:177], v27 offset:0
    ds_read_b64_tr_b16 v[178:179], v27 offset:1024
    v_mfma_f32_16x16x32_bf16 v[144:147], a[92:95], v[184:187], v[144:147]
    s_waitcnt lgkmcnt(10)
    v_mfma_f32_16x16x32_bf16 v[148:151], a[28:31], v[188:191], v[148:151]
    ds_read_b64_tr_b16 v[180:181], v28 offset:0
    ds_read_b64_tr_b16 v[182:183], v28 offset:1024
    v_mfma_f32_16x16x32_bf16 v[152:155], a[92:95], v[188:191], v[152:155]
    s_waitcnt lgkmcnt(10)
    v_mfma_f32_16x16x32_bf16 v[156:159], a[28:31], v[192:195], v[156:159]
    ds_read_b64_tr_b16 v[184:185], v29 offset:0
    ds_read_b64_tr_b16 v[186:187], v29 offset:1024
    v_mfma_f32_16x16x32_bf16 v[160:163], a[92:95], v[192:195], v[160:163]
    s_waitcnt vmcnt(23) lgkmcnt(10)
    v_mfma_f32_16x16x32_bf16 v[100:103], a[32:35], v[164:167], v[100:103]
    ds_read_b64_tr_b16 v[188:189], v30 offset:0
    ds_read_b64_tr_b16 v[190:191], v30 offset:1024
    s_waitcnt vmcnt(22)
    v_mfma_f32_16x16x32_bf16 v[104:107], a[96:99], v[164:167], v[104:107]
    s_waitcnt lgkmcnt(10)
    v_mfma_f32_16x16x32_bf16 v[108:111], a[32:35], v[168:171], v[108:111]
    ds_read_b64_tr_b16 v[192:193], v31 offset:0
    ds_read_b64_tr_b16 v[194:195], v31 offset:1024
    v_mfma_f32_16x16x32_bf16 v[112:115], a[96:99], v[168:171], v[112:115]
    s_waitcnt lgkmcnt(10)
    v_mfma_f32_16x16x32_bf16 v[116:119], a[32:35], v[172:175], v[116:119]
    ds_read_b64_tr_b16 v[164:165], v24 offset:8192
    ds_read_b64_tr_b16 v[166:167], v24 offset:9216
    v_mfma_f32_16x16x32_bf16 v[120:123], a[96:99], v[172:175], v[120:123]
    s_waitcnt lgkmcnt(10)
    v_mfma_f32_16x16x32_bf16 v[124:127], a[32:35], v[176:179], v[124:127]
    ds_read_b64_tr_b16 v[168:169], v25 offset:8192
    ds_read_b64_tr_b16 v[170:171], v25 offset:9216
    v_mfma_f32_16x16x32_bf16 v[128:131], a[96:99], v[176:179], v[128:131]
    s_waitcnt lgkmcnt(10)
    v_mfma_f32_16x16x32_bf16 v[132:135], a[32:35], v[180:183], v[132:135]
    ds_read_b64_tr_b16 v[172:173], v26 offset:8192
    ds_read_b64_tr_b16 v[174:175], v26 offset:9216
    v_mfma_f32_16x16x32_bf16 v[136:139], a[96:99], v[180:183], v[136:139]
    s_waitcnt lgkmcnt(10)
    v_mfma_f32_16x16x32_bf16 v[140:143], a[32:35], v[184:187], v[140:143]
    ds_read_b64_tr_b16 v[176:177], v27 offset:8192
    ds_read_b64_tr_b16 v[178:179], v27 offset:9216
    v_mfma_f32_16x16x32_bf16 v[144:147], a[96:99], v[184:187], v[144:147]
    s_waitcnt lgkmcnt(10)
    v_mfma_f32_16x16x32_bf16 v[148:151], a[32:35], v[188:191], v[148:151]
    ds_read_b64_tr_b16 v[180:181], v28 offset:8192
    ds_read_b64_tr_b16 v[182:183], v28 offset:9216
    v_mfma_f32_16x16x32_bf16 v[152:155], a[96:99], v[188:191], v[152:155]
    s_waitcnt lgkmcnt(10)
    v_mfma_f32_16x16x32_bf16 v[156:159], a[32:35], v[192:195], v[156:159]
    ds_read_b64_tr_b16 v[184:185], v29 offset:8192
    ds_read_b64_tr_b16 v[186:187], v29 offset:9216
    v_mfma_f32_16x16x32_bf16 v[160:163], a[96:99], v[192:195], v[160:163]
    s_waitcnt vmcnt(21) lgkmcnt(10)
    v_mfma_f32_16x16x32_bf16 v[100:103], a[36:39], v[164:167], v[100:103]
    ds_read_b64_tr_b16 v[188:189], v30 offset:8192
    ds_read_b64_tr_b16 v[190:191], v30 offset:9216
    s_waitcnt vmcnt(20)
    v_mfma_f32_16x16x32_bf16 v[104:107], a[100:103], v[164:167], v[104:107]
    s_waitcnt lgkmcnt(10)
    v_mfma_f32_16x16x32_bf16 v[108:111], a[36:39], v[168:171], v[108:111]
    ds_read_b64_tr_b16 v[192:193], v31 offset:8192
    ds_read_b64_tr_b16 v[194:195], v31 offset:9216
    v_mfma_f32_16x16x32_bf16 v[112:115], a[100:103], v[168:171], v[112:115]
    s_waitcnt lgkmcnt(10)
    v_mfma_f32_16x16x32_bf16 v[116:119], a[36:39], v[172:175], v[116:119]
    ds_read_b64_tr_b16 v[164:165], v24 offset:16384
    ds_read_b64_tr_b16 v[166:167], v24 offset:17408
    v_mfma_f32_16x16x32_bf16 v[120:123], a[100:103], v[172:175], v[120:123]
    s_waitcnt lgkmcnt(10)
    v_mfma_f32_16x16x32_bf16 v[124:127], a[36:39], v[176:179], v[124:127]
    ds_read_b64_tr_b16 v[168:169], v25 offset:16384
    ds_read_b64_tr_b16 v[170:171], v25 offset:17408
    v_mfma_f32_16x16x32_bf16 v[128:131], a[100:103], v[176:179], v[128:131]
    s_waitcnt lgkmcnt(10)
    v_mfma_f32_16x16x32_bf16 v[132:135], a[36:39], v[180:183], v[132:135]
    ds_read_b64_tr_b16 v[172:173], v26 offset:16384
    ds_read_b64_tr_b16 v[174:175], v26 offset:17408
    v_mfma_f32_16x16x32_bf16 v[136:139], a[100:103], v[180:183], v[136:139]
    s_waitcnt lgkmcnt(10)
    v_mfma_f32_16x16x32_bf16 v[140:143], a[36:39], v[184:187], v[140:143]
    ds_read_b64_tr_b16 v[176:177], v27 offset:16384
    ds_read_b64_tr_b16 v[178:179], v27 offset:17408
    v_mfma_f32_16x16x32_bf16 v[144:147], a[100:103], v[184:187], v[144:147]
    s_waitcnt lgkmcnt(10)
    v_mfma_f32_16x16x32_bf16 v[148:151], a[36:39], v[188:191], v[148:151]
    ds_read_b64_tr_b16 v[180:181], v28 offset:16384
    ds_read_b64_tr_b16 v[182:183], v28 offset:17408
    v_mfma_f32_16x16x32_bf16 v[152:155], a[100:103], v[188:191], v[152:155]
    s_waitcnt lgkmcnt(10)
    v_mfma_f32_16x16x32_bf16 v[156:159], a[36:39], v[192:195], v[156:159]
    ds_read_b64_tr_b16 v[184:185], v29 offset:16384
    ds_read_b64_tr_b16 v[186:187], v29 offset:17408
    v_mfma_f32_16x16x32_bf16 v[160:163], a[100:103], v[192:195], v[160:163]
    s_waitcnt vmcnt(19) lgkmcnt(10)
    v_mfma_f32_16x16x32_bf16 v[100:103], a[40:43], v[164:167], v[100:103]
    ds_read_b64_tr_b16 v[188:189], v30 offset:16384
    ds_read_b64_tr_b16 v[190:191], v30 offset:17408
    s_waitcnt vmcnt(18)
    v_mfma_f32_16x16x32_bf16 v[104:107], a[104:107], v[164:167], v[104:107]
    s_waitcnt lgkmcnt(10)
    v_mfma_f32_16x16x32_bf16 v[108:111], a[40:43], v[168:171], v[108:111]
    ds_read_b64_tr_b16 v[192:193], v31 offset:16384
    ds_read_b64_tr_b16 v[194:195], v31 offset:17408
    v_mfma_f32_16x16x32_bf16 v[112:115], a[104:107], v[168:171], v[112:115]
    s_waitcnt lgkmcnt(10)
    v_mfma_f32_16x16x32_bf16 v[116:119], a[40:43], v[172:175], v[116:119]
    ds_read_b64_tr_b16 v[164:165], v24 offset:24576
    ds_read_b64_tr_b16 v[166:167], v24 offset:25600
    v_mfma_f32_16x16x32_bf16 v[120:123], a[104:107], v[172:175], v[120:123]
    s_waitcnt lgkmcnt(10)
    v_mfma_f32_16x16x32_bf16 v[124:127], a[40:43], v[176:179], v[124:127]
    ds_read_b64_tr_b16 v[168:169], v25 offset:24576
    ds_read_b64_tr_b16 v[170:171], v25 offset:25600
    v_mfma_f32_16x16x32_bf16 v[128:131], a[104:107], v[176:179], v[128:131]
    s_waitcnt lgkmcnt(10)
    v_mfma_f32_16x16x32_bf16 v[132:135], a[40:43], v[180:183], v[132:135]
    ds_read_b64_tr_b16 v[172:173], v26 offset:24576
    ds_read_b64_tr_b16 v[174:175], v26 offset:25600
    v_mfma_f32_16x16x32_bf16 v[136:139], a[104:107], v[180:183], v[136:139]
    s_waitcnt lgkmcnt(10)
    v_mfma_f32_16x16x32_bf16 v[140:143], a[40:43], v[184:187], v[140:143]
    ds_read_b64_tr_b16 v[176:177], v27 offset:24576
    ds_read_b64_tr_b16 v[178:179], v27 offset:25600
    v_mfma_f32_16x16x32_bf16 v[144:147], a[104:107], v[184:187], v[144:147]
    s_waitcnt lgkmcnt(10)
    v_mfma_f32_16x16x32_bf16 v[148:151], a[40:43], v[188:191], v[148:151]
    ds_read_b64_tr_b16 v[180:181], v28 offset:24576
    ds_read_b64_tr_b16 v[182:183], v28 offset:25600
    v_mfma_f32_16x16x32_bf16 v[152:155], a[104:107], v[188:191], v[152:155]
    s_waitcnt lgkmcnt(10)
    v_mfma_f32_16x16x32_bf16 v[156:159], a[40:43], v[192:195], v[156:159]
    ds_read_b64_tr_b16 v[184:185], v29 offset:24576
    ds_read_b64_tr_b16 v[186:187], v29 offset:25600
    v_mfma_f32_16x16x32_bf16 v[160:163], a[104:107], v[192:195], v[160:163]
    s_waitcnt vmcnt(17) lgkmcnt(10)
    v_mfma_f32_16x16x32_bf16 v[100:103], a[44:47], v[164:167], v[100:103]
    ds_read_b64_tr_b16 v[188:189], v30 offset:24576
    ds_read_b64_tr_b16 v[190:191], v30 offset:25600
    s_waitcnt vmcnt(16)
    v_mfma_f32_16x16x32_bf16 v[104:107], a[108:111], v[164:167], v[104:107]
    s_waitcnt lgkmcnt(10)
    v_mfma_f32_16x16x32_bf16 v[108:111], a[44:47], v[168:171], v[108:111]
    ds_read_b64_tr_b16 v[192:193], v31 offset:24576
    ds_read_b64_tr_b16 v[194:195], v31 offset:25600
    v_mfma_f32_16x16x32_bf16 v[112:115], a[108:111], v[168:171], v[112:115]
    s_waitcnt lgkmcnt(10)
    v_mfma_f32_16x16x32_bf16 v[116:119], a[44:47], v[172:175], v[116:119]
    s_waitcnt vmcnt(0)
    s_barrier
    ds_read_b64_tr_b16 v[164:165], v24 offset:32768
    ds_read_b64_tr_b16 v[166:167], v24 offset:33792
    v_mfma_f32_16x16x32_bf16 v[120:123], a[108:111], v[172:175], v[120:123]
    s_waitcnt lgkmcnt(10)
    v_mfma_f32_16x16x32_bf16 v[124:127], a[44:47], v[176:179], v[124:127]
    ds_read_b64_tr_b16 v[168:169], v25 offset:32768
    ds_read_b64_tr_b16 v[170:171], v25 offset:33792
    v_mfma_f32_16x16x32_bf16 v[128:131], a[108:111], v[176:179], v[128:131]
    s_waitcnt lgkmcnt(10)
    v_mfma_f32_16x16x32_bf16 v[132:135], a[44:47], v[180:183], v[132:135]
    ds_read_b64_tr_b16 v[172:173], v26 offset:32768
    ds_read_b64_tr_b16 v[174:175], v26 offset:33792
    v_mfma_f32_16x16x32_bf16 v[136:139], a[108:111], v[180:183], v[136:139]
    s_waitcnt lgkmcnt(10)
    v_mfma_f32_16x16x32_bf16 v[140:143], a[44:47], v[184:187], v[140:143]
    ds_read_b64_tr_b16 v[176:177], v27 offset:32768
    ds_read_b64_tr_b16 v[178:179], v27 offset:33792
    v_mfma_f32_16x16x32_bf16 v[144:147], a[108:111], v[184:187], v[144:147]
    s_waitcnt lgkmcnt(10)
    v_mfma_f32_16x16x32_bf16 v[148:151], a[44:47], v[188:191], v[148:151]
    ds_read_b64_tr_b16 v[180:181], v28 offset:32768
    ds_read_b64_tr_b16 v[182:183], v28 offset:33792
    v_mfma_f32_16x16x32_bf16 v[152:155], a[108:111], v[188:191], v[152:155]
    s_waitcnt lgkmcnt(10)
    v_mfma_f32_16x16x32_bf16 v[156:159], a[44:47], v[192:195], v[156:159]
    ds_read_b64_tr_b16 v[184:185], v29 offset:32768
    ds_read_b64_tr_b16 v[186:187], v29 offset:33792
    v_mfma_f32_16x16x32_bf16 v[160:163], a[108:111], v[192:195], v[160:163]
    s_waitcnt lgkmcnt(10)
    v_mfma_f32_16x16x32_bf16 v[100:103], a[48:51], v[164:167], v[100:103]
    ds_read_b64_tr_b16 v[188:189], v30 offset:32768
    ds_read_b64_tr_b16 v[190:191], v30 offset:33792
    v_mfma_f32_16x16x32_bf16 v[104:107], a[112:115], v[164:167], v[104:107]
    s_waitcnt lgkmcnt(10)
    v_mfma_f32_16x16x32_bf16 v[108:111], a[48:51], v[168:171], v[108:111]
    ds_read_b64_tr_b16 v[192:193], v31 offset:32768
    ds_read_b64_tr_b16 v[194:195], v31 offset:33792
    v_mfma_f32_16x16x32_bf16 v[112:115], a[112:115], v[168:171], v[112:115]
    s_waitcnt lgkmcnt(10)
    v_mfma_f32_16x16x32_bf16 v[116:119], a[48:51], v[172:175], v[116:119]
    ds_read_b64_tr_b16 v[164:165], v24 offset:40960
    ds_read_b64_tr_b16 v[166:167], v24 offset:41984
    v_mfma_f32_16x16x32_bf16 v[120:123], a[112:115], v[172:175], v[120:123]
    s_waitcnt lgkmcnt(10)
    v_mfma_f32_16x16x32_bf16 v[124:127], a[48:51], v[176:179], v[124:127]
    ds_read_b64_tr_b16 v[168:169], v25 offset:40960
    ds_read_b64_tr_b16 v[170:171], v25 offset:41984
    v_mfma_f32_16x16x32_bf16 v[128:131], a[112:115], v[176:179], v[128:131]
    s_waitcnt lgkmcnt(10)
    v_mfma_f32_16x16x32_bf16 v[132:135], a[48:51], v[180:183], v[132:135]
    ds_read_b64_tr_b16 v[172:173], v26 offset:40960
    ds_read_b64_tr_b16 v[174:175], v26 offset:41984
    v_mfma_f32_16x16x32_bf16 v[136:139], a[112:115], v[180:183], v[136:139]
    s_waitcnt lgkmcnt(10)
    v_mfma_f32_16x16x32_bf16 v[140:143], a[48:51], v[184:187], v[140:143]
    ds_read_b64_tr_b16 v[176:177], v27 offset:40960
    ds_read_b64_tr_b16 v[178:179], v27 offset:41984
    v_mfma_f32_16x16x32_bf16 v[144:147], a[112:115], v[184:187], v[144:147]
    s_waitcnt lgkmcnt(10)
    v_mfma_f32_16x16x32_bf16 v[148:151], a[48:51], v[188:191], v[148:151]
    ds_read_b64_tr_b16 v[180:181], v28 offset:40960
    ds_read_b64_tr_b16 v[182:183], v28 offset:41984
    v_mfma_f32_16x16x32_bf16 v[152:155], a[112:115], v[188:191], v[152:155]
    s_waitcnt lgkmcnt(10)
    v_mfma_f32_16x16x32_bf16 v[156:159], a[48:51], v[192:195], v[156:159]
    ds_read_b64_tr_b16 v[184:185], v29 offset:40960
    ds_read_b64_tr_b16 v[186:187], v29 offset:41984
    v_mfma_f32_16x16x32_bf16 v[160:163], a[112:115], v[192:195], v[160:163]
    s_waitcnt lgkmcnt(10)
    v_mfma_f32_16x16x32_bf16 v[100:103], a[52:55], v[164:167], v[100:103]
    ds_read_b64_tr_b16 v[188:189], v30 offset:40960
    ds_read_b64_tr_b16 v[190:191], v30 offset:41984
    v_mfma_f32_16x16x32_bf16 v[104:107], a[116:119], v[164:167], v[104:107]
    s_waitcnt lgkmcnt(10)
    v_mfma_f32_16x16x32_bf16 v[108:111], a[52:55], v[168:171], v[108:111]
    ds_read_b64_tr_b16 v[192:193], v31 offset:40960
    ds_read_b64_tr_b16 v[194:195], v31 offset:41984
    v_mfma_f32_16x16x32_bf16 v[112:115], a[116:119], v[168:171], v[112:115]
    s_waitcnt lgkmcnt(10)
    v_mfma_f32_16x16x32_bf16 v[116:119], a[52:55], v[172:175], v[116:119]
    ds_read_b64_tr_b16 v[164:165], v24 offset:49152
    ds_read_b64_tr_b16 v[166:167], v24 offset:50176
    v_mfma_f32_16x16x32_bf16 v[120:123], a[116:119], v[172:175], v[120:123]
    s_waitcnt lgkmcnt(10)
    v_mfma_f32_16x16x32_bf16 v[124:127], a[52:55], v[176:179], v[124:127]
    ds_read_b64_tr_b16 v[168:169], v25 offset:49152
    ds_read_b64_tr_b16 v[170:171], v25 offset:50176
    v_mfma_f32_16x16x32_bf16 v[128:131], a[116:119], v[176:179], v[128:131]
    s_waitcnt lgkmcnt(10)
    v_mfma_f32_16x16x32_bf16 v[132:135], a[52:55], v[180:183], v[132:135]
    ds_read_b64_tr_b16 v[172:173], v26 offset:49152
    ds_read_b64_tr_b16 v[174:175], v26 offset:50176
    v_mfma_f32_16x16x32_bf16 v[136:139], a[116:119], v[180:183], v[136:139]
    s_waitcnt lgkmcnt(10)
    v_mfma_f32_16x16x32_bf16 v[140:143], a[52:55], v[184:187], v[140:143]
    ds_read_b64_tr_b16 v[176:177], v27 offset:49152
    ds_read_b64_tr_b16 v[178:179], v27 offset:50176
    v_mfma_f32_16x16x32_bf16 v[144:147], a[116:119], v[184:187], v[144:147]
    s_waitcnt lgkmcnt(10)
    v_mfma_f32_16x16x32_bf16 v[148:151], a[52:55], v[188:191], v[148:151]
    ds_read_b64_tr_b16 v[180:181], v28 offset:49152
    ds_read_b64_tr_b16 v[182:183], v28 offset:50176
    v_mfma_f32_16x16x32_bf16 v[152:155], a[116:119], v[188:191], v[152:155]
    s_waitcnt lgkmcnt(10)
    v_mfma_f32_16x16x32_bf16 v[156:159], a[52:55], v[192:195], v[156:159]
    ds_read_b64_tr_b16 v[184:185], v29 offset:49152
    ds_read_b64_tr_b16 v[186:187], v29 offset:50176
    v_mfma_f32_16x16x32_bf16 v[160:163], a[116:119], v[192:195], v[160:163]
    s_waitcnt lgkmcnt(10)
    v_mfma_f32_16x16x32_bf16 v[100:103], a[56:59], v[164:167], v[100:103]
    ds_read_b64_tr_b16 v[188:189], v30 offset:49152
    ds_read_b64_tr_b16 v[190:191], v30 offset:50176
    v_mfma_f32_16x16x32_bf16 v[104:107], a[120:123], v[164:167], v[104:107]
    s_waitcnt lgkmcnt(10)
    v_mfma_f32_16x16x32_bf16 v[108:111], a[56:59], v[168:171], v[108:111]
    ds_read_b64_tr_b16 v[192:193], v31 offset:49152
    ds_read_b64_tr_b16 v[194:195], v31 offset:50176
    v_mfma_f32_16x16x32_bf16 v[112:115], a[120:123], v[168:171], v[112:115]
    s_waitcnt lgkmcnt(10)
    v_mfma_f32_16x16x32_bf16 v[116:119], a[56:59], v[172:175], v[116:119]
    ds_read_b64_tr_b16 v[164:165], v24 offset:57344
    ds_read_b64_tr_b16 v[166:167], v24 offset:58368
    v_mfma_f32_16x16x32_bf16 v[120:123], a[120:123], v[172:175], v[120:123]
    s_waitcnt lgkmcnt(10)
    v_mfma_f32_16x16x32_bf16 v[124:127], a[56:59], v[176:179], v[124:127]
    ds_read_b64_tr_b16 v[168:169], v25 offset:57344
    ds_read_b64_tr_b16 v[170:171], v25 offset:58368
    v_mfma_f32_16x16x32_bf16 v[128:131], a[120:123], v[176:179], v[128:131]
    s_waitcnt lgkmcnt(10)
    v_mfma_f32_16x16x32_bf16 v[132:135], a[56:59], v[180:183], v[132:135]
    ds_read_b64_tr_b16 v[172:173], v26 offset:57344
    ds_read_b64_tr_b16 v[174:175], v26 offset:58368
    v_mfma_f32_16x16x32_bf16 v[136:139], a[120:123], v[180:183], v[136:139]
    s_waitcnt lgkmcnt(10)
    v_mfma_f32_16x16x32_bf16 v[140:143], a[56:59], v[184:187], v[140:143]
    ds_read_b64_tr_b16 v[176:177], v27 offset:57344
    ds_read_b64_tr_b16 v[178:179], v27 offset:58368
    v_mfma_f32_16x16x32_bf16 v[144:147], a[120:123], v[184:187], v[144:147]
    s_waitcnt lgkmcnt(10)
    v_mfma_f32_16x16x32_bf16 v[148:151], a[56:59], v[188:191], v[148:151]
    ds_read_b64_tr_b16 v[180:181], v28 offset:57344
    ds_read_b64_tr_b16 v[182:183], v28 offset:58368
    v_mfma_f32_16x16x32_bf16 v[152:155], a[120:123], v[188:191], v[152:155]
    s_waitcnt lgkmcnt(10)
    v_mfma_f32_16x16x32_bf16 v[156:159], a[56:59], v[192:195], v[156:159]
    ds_read_b64_tr_b16 v[184:185], v29 offset:57344
    ds_read_b64_tr_b16 v[186:187], v29 offset:58368
    v_mfma_f32_16x16x32_bf16 v[160:163], a[120:123], v[192:195], v[160:163]
    s_waitcnt lgkmcnt(10)
    v_mfma_f32_16x16x32_bf16 v[100:103], a[60:63], v[164:167], v[100:103]
    ds_read_b64_tr_b16 v[188:189], v30 offset:57344
    ds_read_b64_tr_b16 v[190:191], v30 offset:58368
    v_mfma_f32_16x16x32_bf16 v[104:107], a[124:127], v[164:167], v[104:107]
    s_waitcnt lgkmcnt(10)
    v_mfma_f32_16x16x32_bf16 v[108:111], a[60:63], v[168:171], v[108:111]
    ds_read_b64_tr_b16 v[192:193], v31 offset:57344
    ds_read_b64_tr_b16 v[194:195], v31 offset:58368
    v_mfma_f32_16x16x32_bf16 v[112:115], a[124:127], v[168:171], v[112:115]
    s_waitcnt lgkmcnt(10)
    v_mfma_f32_16x16x32_bf16 v[116:119], a[60:63], v[172:175], v[116:119]
    v_mfma_f32_16x16x32_bf16 v[120:123], a[124:127], v[172:175], v[120:123]
    s_waitcnt lgkmcnt(8)
    v_mfma_f32_16x16x32_bf16 v[124:127], a[60:63], v[176:179], v[124:127]
    v_mfma_f32_16x16x32_bf16 v[128:131], a[124:127], v[176:179], v[128:131]
    s_waitcnt lgkmcnt(6)
    v_mfma_f32_16x16x32_bf16 v[132:135], a[60:63], v[180:183], v[132:135]
    v_mfma_f32_16x16x32_bf16 v[136:139], a[124:127], v[180:183], v[136:139]
    s_waitcnt lgkmcnt(4)
    v_mfma_f32_16x16x32_bf16 v[140:143], a[60:63], v[184:187], v[140:143]
    v_mfma_f32_16x16x32_bf16 v[144:147], a[124:127], v[184:187], v[144:147]
    s_waitcnt lgkmcnt(2)
    v_mfma_f32_16x16x32_bf16 v[148:151], a[60:63], v[188:191], v[148:151]
    v_mfma_f32_16x16x32_bf16 v[152:155], a[124:127], v[188:191], v[152:155]
    s_waitcnt lgkmcnt(0)
    v_mfma_f32_16x16x32_bf16 v[156:159], a[60:63], v[192:195], v[156:159]
    v_mfma_f32_16x16x32_bf16 v[160:163], a[124:127], v[192:195], v[160:163]
    s_add_u32 s37, s36, 33554432
    v_cvt_pk_bf16_f32 v196, v100, v101
    v_cvt_pk_bf16_f32 v197, v102, v103
    v_cvt_pk_bf16_f32 v198, v104, v105
    v_cvt_pk_bf16_f32 v199, v106, v107
    buffer_store_dwordx4 v[196:199], v32, s[4:7], s37 offen offset:0 sc1
    v_cvt_pk_bf16_f32 v200, v108, v109
    v_cvt_pk_bf16_f32 v201, v110, v111
    v_cvt_pk_bf16_f32 v202, v112, v113
    v_cvt_pk_bf16_f32 v203, v114, v115
    buffer_store_dwordx4 v[200:203], v32, s[4:7], s37 offen offset:128 sc1
    v_cvt_pk_bf16_f32 v204, v116, v117
    v_cvt_pk_bf16_f32 v205, v118, v119
    v_cvt_pk_bf16_f32 v206, v120, v121
    v_cvt_pk_bf16_f32 v207, v122, v123
    buffer_store_dwordx4 v[204:207], v32, s[4:7], s37 offen offset:2048 sc1
    v_cvt_pk_bf16_f32 v208, v124, v125
    v_cvt_pk_bf16_f32 v209, v126, v127
    v_cvt_pk_bf16_f32 v210, v128, v129
    v_cvt_pk_bf16_f32 v211, v130, v131
    buffer_store_dwordx4 v[208:211], v32, s[4:7], s37 offen offset:2176 sc1
    v_cvt_pk_bf16_f32 v196, v132, v133
    v_cvt_pk_bf16_f32 v197, v134, v135
    v_cvt_pk_bf16_f32 v198, v136, v137
    v_cvt_pk_bf16_f32 v199, v138, v139
    s_add_u32 s37, s37, 4096
    buffer_store_dwordx4 v[196:199], v32, s[4:7], s37 offen offset:0 sc1
    v_cvt_pk_bf16_f32 v200, v140, v141
    v_cvt_pk_bf16_f32 v201, v142, v143
    v_cvt_pk_bf16_f32 v202, v144, v145
    v_cvt_pk_bf16_f32 v203, v146, v147
    buffer_store_dwordx4 v[200:203], v32, s[4:7], s37 offen offset:128 sc1
    v_cvt_pk_bf16_f32 v204, v148, v149
    v_cvt_pk_bf16_f32 v205, v150, v151
    v_cvt_pk_bf16_f32 v206, v152, v153
    v_cvt_pk_bf16_f32 v207, v154, v155
    buffer_store_dwordx4 v[204:207], v32, s[4:7], s37 offen offset:2048 sc1
    v_cvt_pk_bf16_f32 v208, v156, v157
    v_cvt_pk_bf16_f32 v209, v158, v159
    v_cvt_pk_bf16_f32 v210, v160, v161
    v_cvt_pk_bf16_f32 v211, v162, v163
    buffer_store_dwordx4 v[208:211], v32, s[4:7], s37 offen offset:2176 sc1
    s_waitcnt vmcnt(0)
    s_barrier
    s_cmp_lg_u32 s92, 0
    s_cbranch_scc1 L_s77_done
    s_lshl_b32 s79, s16, 7
    s_add_u32 s79, s79, 3934208
    v_mov_b32 v250, 0
    v_mov_b32 v251, 1
    s_mov_b64 exec, 1
    buffer_atomic_add v251, v250, s[4:7], s79 offen
    s_mov_b64 exec, -1
L_s77_done:
    s_waitcnt vmcnt(0) lgkmcnt(0)
    s_barrier
    v_accvgpr_read_b32 v0, a255
    s_branch L_adaLN_cond__memory_aug_recurrent_mem_tr__dense_activation_gelu__prompt_kernel_q_next
L_adaLN_cond__memory_aug_recurrent_mem_tr__dense_activation_gelu__prompt_kernel_q_full:
    s_sub_u32 s12, s10, 2
    s_lshl_b32 s2, s12, 5
    s_add_u32 s2, s2, s11
    s_mov_b32 s87, s2
    s_load_dwordx2 s[60:61], s[0:1], 24
    s_load_dwordx2 s[62:63], s[0:1], 32
    s_load_dwordx2 s[64:65], s[0:1], 16
    v_and_b32 v2, 63, v0
    s_lshr_b32 s16, s2, 5
    s_and_b32 s17, s2, 31
    s_lshl_b32 s9, s16, 3
    s_lshl_b32 s18, s92, 1
    s_add_u32 s9, s9, s18
    s_lshl_b32 s10, s17, 7
    v_lshlrev_b32 v3, 4, v2
    v_and_b32 v4, 15, v2
    v_lshrrev_b32 v5, 4, v2
    v_lshrrev_b32 v6, 4, v2
    v_and_b32 v7, 15, v2
    s_mov_b32 s20, 8192
    v_add_u32 v8, 0, v6
    v_and_b32 v20, 3, v8
    v_bfe_u32 v21, v8, 3, 1
    v_lshl_or_b32 v20, v21, 2, v20
    v_lshrrev_b32 v21, 1, v7
    v_xor_b32 v21, v21, v20
    v_and_b32 v22, 1, v7
    v_lshl_or_b32 v21, v21, 1, v22
    v_mul_lo_u32 v8, v8, s20
    v_lshl_add_u32 v8, v21, 4, v8
    v_add_u32 v9, 4, v6
    v_and_b32 v20, 3, v9
    v_bfe_u32 v21, v9, 3, 1
    v_lshl_or_b32 v20, v21, 2, v20
    v_lshrrev_b32 v21, 1, v7
    v_xor_b32 v21, v21, v20
    v_and_b32 v22, 1, v7
    v_lshl_or_b32 v21, v21, 1, v22
    v_mul_lo_u32 v9, v9, s20
    v_lshl_add_u32 v9, v21, 4, v9
    v_add_u32 v10, 8, v6
    v_and_b32 v20, 3, v10
    v_bfe_u32 v21, v10, 3, 1
    v_lshl_or_b32 v20, v21, 2, v20
    v_lshrrev_b32 v21, 1, v7
    v_xor_b32 v21, v21, v20
    v_and_b32 v22, 1, v7
    v_lshl_or_b32 v21, v21, 1, v22
    v_mul_lo_u32 v10, v10, s20
    v_lshl_add_u32 v10, v21, 4, v10
    v_add_u32 v11, 12, v6
    v_and_b32 v20, 3, v11
    v_bfe_u32 v21, v11, 3, 1
    v_lshl_or_b32 v20, v21, 2, v20
    v_lshrrev_b32 v21, 1, v7
    v_xor_b32 v21, v21, v20
    v_and_b32 v22, 1, v7
    v_lshl_or_b32 v21, v21, 1, v22
    v_mul_lo_u32 v11, v11, s20
    v_lshl_add_u32 v11, v21, 4, v11
    v_lshrrev_b32 v20, 2, v4
    v_lshl_add_u32 v21, v5, 3, v20
    v_and_b32 v22, 1, v5
    v_lshl_or_b32 v22, v22, 2, v20
    v_mul_u32_u24 v21, 256, v21
    v_and_b32 v23, 3, v2
    v_lshl_add_u32 v21, v23, 3, v21
    v_xor_b32 v23, 0, v22
    v_lshl_add_u32 v12, v23, 5, v21
    v_add_u32 v24, 0x10000, v12
    v_xor_b32 v23, 1, v22
    v_lshl_add_u32 v13, v23, 5, v21
    v_add_u32 v25, 0x10000, v13
    v_xor_b32 v23, 2, v22
    v_lshl_add_u32 v14, v23, 5, v21
    v_add_u32 v26, 0x10000, v14
    v_xor_b32 v23, 3, v22
    v_lshl_add_u32 v15, v23, 5, v21
    v_add_u32 v27, 0x10000, v15
    v_xor_b32 v23, 4, v22
    v_lshl_add_u32 v16, v23, 5, v21
    v_add_u32 v28, 0x10000, v16
    v_xor_b32 v23, 5, v22
    v_lshl_add_u32 v17, v23, 5, v21
    v_add_u32 v29, 0x10000, v17
    v_xor_b32 v23, 6, v22
    v_lshl_add_u32 v18, v23, 5, v21
    v_add_u32 v30, 0x10000, v18
    v_xor_b32 v23, 7, v22
    v_lshl_add_u32 v19, v23, 5, v21
    v_add_u32 v31, 0x10000, v19
    v_and_b32 v32, 1, v4
    v_lshlrev_b32 v32, 10, v32
    v_lshl_add_u32 v32, v5, 8, v32
    v_lshrrev_b32 v21, 1, v4
    v_lshl_add_u32 v32, v21, 4, v32
    s_waitcnt lgkmcnt(0)
    s_mov_b32 s12, s60
    s_and_b32 s13, s61, 0xffff
    s_mov_b32 s14, 4194304
    s_mov_b32 s15, 0x00020000
    s_mov_b32 s40, s62
    s_and_b32 s41, s63, 0xffff
    s_mov_b32 s42, 4194304
    s_mov_b32 s43, 0x00020000
    s_mov_b32 s44, s64
    s_and_b32 s45, s65, 0xffff
    s_mov_b32 s46, 4194304
    s_mov_b32 s47, 0x00020000
    s_mul_i32 s28, s92, 262144
    s_lshl_b32 s29, s10, 1
    s_add_u32 s28, s28, s29
    s_mul_i32 s30, s92, 8192
    s_lshr_b32 s36, s9, 1
    s_lshl_b32 s36, s36, 5
    s_add_u32 s36, s36, s17
    s_lshl_b32 s36, s36, 13
    s_barrier
    s_add_u32 s31, s28, 0
    s_add_u32 m0, s30, 0
    s_nop 0
    buffer_load_dwordx4 v8, s[12:15], s31 offen lds
    s_add_u32 m0, m0, 1024
    s_nop 0
    buffer_load_dwordx4 v9, s[12:15], s31 offen lds
    s_add_u32 m0, m0, 1024
    s_nop 0
    buffer_load_dwordx4 v10, s[12:15], s31 offen lds
    s_add_u32 m0, m0, 1024
    s_nop 0
    buffer_load_dwordx4 v11, s[12:15], s31 offen lds
    s_add_u32 m0, m0, 1024
    s_add_u32 s31, s31, 131072
    buffer_load_dwordx4 v8, s[12:15], s31 offen lds
    s_add_u32 m0, m0, 1024
    s_nop 0
    buffer_load_dwordx4 v9, s[12:15], s31 offen lds
    s_add_u32 m0, m0, 1024
    s_nop 0
    buffer_load_dwordx4 v10, s[12:15], s31 offen lds
    s_add_u32 m0, m0, 1024
    s_nop 0
    buffer_load_dwordx4 v11, s[12:15], s31 offen lds
    s_add_u32 s31, s28, 1048576
    s_add_u32 m0, s30, 32768
    s_nop 0
    buffer_load_dwordx4 v8, s[12:15], s31 offen lds
    s_add_u32 m0, m0, 1024
    s_nop 0
    buffer_load_dwordx4 v9, s[12:15], s31 offen lds
    s_add_u32 m0, m0, 1024
    s_nop 0
    buffer_load_dwordx4 v10, s[12:15], s31 offen lds
    s_add_u32 m0, m0, 1024
    s_nop 0
    buffer_load_dwordx4 v11, s[12:15], s31 offen lds
    s_add_u32 m0, m0, 1024
    s_add_u32 s31, s31, 131072
    buffer_load_dwordx4 v8, s[12:15], s31 offen lds
    s_add_u32 m0, m0, 1024
    s_nop 0
    buffer_load_dwordx4 v9, s[12:15], s31 offen lds
    s_add_u32 m0, m0, 1024
    s_nop 0
    buffer_load_dwordx4 v10, s[12:15], s31 offen lds
    s_add_u32 m0, m0, 1024
    s_nop 0
    buffer_load_dwordx4 v11, s[12:15], s31 offen lds
    s_add_u32 s31, s28, 2097152
    s_add_u32 m0, s30, 65536
    s_nop 0
    buffer_load_dwordx4 v8, s[12:15], s31 offen lds
    s_add_u32 m0, m0, 1024
    s_nop 0
    buffer_load_dwordx4 v9, s[12:15], s31 offen lds
    s_add_u32 m0, m0, 1024
    s_nop 0
    buffer_load_dwordx4 v10, s[12:15], s31 offen lds
    s_add_u32 m0, m0, 1024
    s_nop 0
    buffer_load_dwordx4 v11, s[12:15], s31 offen lds
    s_add_u32 m0, m0, 1024
    s_add_u32 s31, s31, 131072
    buffer_load_dwordx4 v8, s[12:15], s31 offen lds
    s_add_u32 m0, m0, 1024
    s_nop 0
    buffer_load_dwordx4 v9, s[12:15], s31 offen lds
    s_add_u32 m0, m0, 1024
    s_nop 0
    buffer_load_dwordx4 v10, s[12:15], s31 offen lds
    s_add_u32 m0, m0, 1024
    s_nop 0
    buffer_load_dwordx4 v11, s[12:15], s31 offen lds
    s_cmp_lg_u32 s92, 0
    s_cbranch_scc1 L_w78_done
    s_lshl_b32 s79, s16, 7
    s_add_u32 s79, s79, 3932160
    v_mov_b32 v250, 0
    s_mov_b32 s94, 400000
L_w78_spin:
    buffer_load_dword v251, v250, s[4:7], s79 offen sc1
    s_waitcnt vmcnt(0)
    v_readfirstlane_b32 s93, v251
    s_nop 3
    s_cmp_ge_u32 s93, 8
    s_cbranch_scc1 L_w78_done
    s_sleep 1
    s_sub_u32 s94, s94, 1
    s_cbranch_scc0 L_w78_spin
L_w78_done:
    s_barrier
    s_mul_i32 s23, s9, 16384
    s_add_u32 s23, s23, 0
    s_add_u32 s24, s23, 16384
    buffer_load_dwordx4 a[0:3], v3, s[4:7], s23 offen offset:0 sc1
    buffer_load_dwordx4 a[64:67], v3, s[4:7], s24 offen offset:0 sc1
    buffer_load_dwordx4 a[4:7], v3, s[4:7], s23 offen offset:1024 sc1
    buffer_load_dwordx4 a[68:71], v3, s[4:7], s24 offen offset:1024 sc1
    buffer_load_dwordx4 a[8:11], v3, s[4:7], s23 offen offset:2048 sc1
    buffer_load_dwordx4 a[72:75], v3, s[4:7], s24 offen offset:2048 sc1
    buffer_load_dwordx4 a[12:15], v3, s[4:7], s23 offen offset:3072 sc1
    buffer_load_dwordx4 a[76:79], v3, s[4:7], s24 offen offset:3072 sc1
    s_add_u32 s23, s23, 4096
    buffer_load_dwordx4 a[16:19], v3, s[4:7], s23 offen offset:0 sc1
    s_add_u32 s24, s24, 4096
    buffer_load_dwordx4 a[80:83], v3, s[4:7], s24 offen offset:0 sc1
    buffer_load_dwordx4 a[20:23], v3, s[4:7], s23 offen offset:1024 sc1
    buffer_load_dwordx4 a[84:87], v3, s[4:7], s24 offen offset:1024 sc1
    buffer_load_dwordx4 a[24:27], v3, s[4:7], s23 offen offset:2048 sc1
    buffer_load_dwordx4 a[88:91], v3, s[4:7], s24 offen offset:2048 sc1
    buffer_load_dwordx4 a[28:31], v3, s[4:7], s23 offen offset:3072 sc1
    buffer_load_dwordx4 a[92:95], v3, s[4:7], s24 offen offset:3072 sc1
    s_add_u32 s23, s23, 4096
    buffer_load_dwordx4 a[32:35], v3, s[4:7], s23 offen offset:0 sc1
    s_add_u32 s24, s24, 4096
    buffer_load_dwordx4 a[96:99], v3, s[4:7], s24 offen offset:0 sc1
    buffer_load_dwordx4 a[36:39], v3, s[4:7], s23 offen offset:1024 sc1
    buffer_load_dwordx4 a[100:103], v3, s[4:7], s24 offen offset:1024 sc1
    buffer_load_dwordx4 a[40:43], v3, s[4:7], s23 offen offset:2048 sc1
    buffer_load_dwordx4 a[104:107], v3, s[4:7], s24 offen offset:2048 sc1
    buffer_load_dwordx4 a[44:47], v3, s[4:7], s23 offen offset:3072 sc1
    buffer_load_dwordx4 a[108:111], v3, s[4:7], s24 offen offset:3072 sc1
    s_add_u32 s23, s23, 4096
    buffer_load_dwordx4 a[48:51], v3, s[4:7], s23 offen offset:0 sc1
    s_add_u32 s24, s24, 4096
    buffer_load_dwordx4 a[112:115], v3, s[4:7], s24 offen offset:0 sc1
    buffer_load_dwordx4 a[52:55], v3, s[4:7], s23 offen offset:1024 sc1
    buffer_load_dwordx4 a[116:119], v3, s[4:7], s24 offen offset:1024 sc1
    buffer_load_dwordx4 a[56:59], v3, s[4:7], s23 offen offset:2048 sc1
    buffer_load_dwordx4 a[120:123], v3, s[4:7], s24 offen offset:2048 sc1
    buffer_load_dwordx4 a[60:63], v3, s[4:7], s23 offen offset:3072 sc1
    buffer_load_dwordx4 a[124:127], v3, s[4:7], s24 offen offset:3072 sc1
    s_waitcnt vmcnt(48)
    s_barrier
    ds_read_b64_tr_b16 v[164:165], v12 offset:0
    ds_read_b64_tr_b16 v[166:167], v12 offset:1024
    ds_read_b64_tr_b16 v[168:169], v13 offset:0
    ds_read_b64_tr_b16 v[170:171], v13 offset:1024
    ds_read_b64_tr_b16 v[172:173], v14 offset:0
    ds_read_b64_tr_b16 v[174:175], v14 offset:1024
    ds_read_b64_tr_b16 v[176:177], v15 offset:0
    ds_read_b64_tr_b16 v[178:179], v15 offset:1024
    ds_read_b64_tr_b16 v[180:181], v16 offset:0
    ds_read_b64_tr_b16 v[182:183], v16 offset:1024
    ds_read_b64_tr_b16 v[184:185], v17 offset:0
    ds_read_b64_tr_b16 v[186:187], v17 offset:1024
    s_waitcnt vmcnt(31) lgkmcnt(10)
    v_mfma_f32_16x16x32_bf16 v[36:39], v[164:167], a[0:3], 0
    ds_read_b64_tr_b16 v[188:189], v18 offset:0
    ds_read_b64_tr_b16 v[190:191], v18 offset:1024
    s_waitcnt vmcnt(30)
    v_mfma_f32_16x16x32_bf16 v[40:43], v[164:167], a[64:67], 0
    s_waitcnt lgkmcnt(10)
    v_mfma_f32_16x16x32_bf16 v[44:47], v[168:171], a[0:3], 0
    ds_read_b64_tr_b16 v[192:193], v19 offset:0
    ds_read_b64_tr_b16 v[194:195], v19 offset:1024
    v_mfma_f32_16x16x32_bf16 v[48:51], v[168:171], a[64:67], 0
    s_waitcnt lgkmcnt(10)
    v_mfma_f32_16x16x32_bf16 v[52:55], v[172:175], a[0:3], 0
    ds_read_b64_tr_b16 v[164:165], v12 offset:8192
    ds_read_b64_tr_b16 v[166:167], v12 offset:9216
    v_mfma_f32_16x16x32_bf16 v[56:59], v[172:175], a[64:67], 0
    s_waitcnt lgkmcnt(10)
    v_mfma_f32_16x16x32_bf16 v[60:63], v[176:179], a[0:3], 0
    ds_read_b64_tr_b16 v[168:169], v13 offset:8192
    ds_read_b64_tr_b16 v[170:171], v13 offset:9216
    v_mfma_f32_16x16x32_bf16 v[64:67], v[176:179], a[64:67], 0
    s_waitcnt lgkmcnt(10)
    v_mfma_f32_16x16x32_bf16 v[68:71], v[180:183], a[0:3], 0
    ds_read_b64_tr_b16 v[172:173], v14 offset:8192
    ds_read_b64_tr_b16 v[174:175], v14 offset:9216
    v_mfma_f32_16x16x32_bf16 v[72:75], v[180:183], a[64:67], 0
    s_waitcnt lgkmcnt(10)
    v_mfma_f32_16x16x32_bf16 v[76:79], v[184:187], a[0:3], 0
    ds_read_b64_tr_b16 v[176:177], v15 offset:8192
    ds_read_b64_tr_b16 v[178:179], v15 offset:9216
    v_mfma_f32_16x16x32_bf16 v[80:83], v[184:187], a[64:67], 0
    s_waitcnt lgkmcnt(10)
    v_mfma_f32_16x16x32_bf16 v[84:87], v[188:191], a[0:3], 0
    ds_read_b64_tr_b16 v[180:181], v16 offset:8192
    ds_read_b64_tr_b16 v[182:183], v16 offset:9216
    v_mfma_f32_16x16x32_bf16 v[88:91], v[188:191], a[64:67], 0
    s_waitcnt lgkmcnt(10)
    v_mfma_f32_16x16x32_bf16 v[92:95], v[192:195], a[0:3], 0
    ds_read_b64_tr_b16 v[184:185], v17 offset:8192
    ds_read_b64_tr_b16 v[186:187], v17 offset:9216
    v_mfma_f32_16x16x32_bf16 v[96:99], v[192:195], a[64:67], 0
    s_waitcnt vmcnt(29) lgkmcnt(10)
    v_mfma_f32_16x16x32_bf16 v[36:39], v[164:167], a[4:7], v[36:39]
    ds_read_b64_tr_b16 v[188:189], v18 offset:8192
    ds_read_b64_tr_b16 v[190:191], v18 offset:9216
    s_waitcnt vmcnt(28)
    v_mfma_f32_16x16x32_bf16 v[40:43], v[164:167], a[68:71], v[40:43]
    s_waitcnt lgkmcnt(10)
    v_mfma_f32_16x16x32_bf16 v[44:47], v[168:171], a[4:7], v[44:47]
    ds_read_b64_tr_b16 v[192:193], v19 offset:8192
    ds_read_b64_tr_b16 v[194:195], v19 offset:9216
    v_mfma_f32_16x16x32_bf16 v[48:51], v[168:171], a[68:71], v[48:51]
    s_waitcnt lgkmcnt(10)
    v_mfma_f32_16x16x32_bf16 v[52:55], v[172:175], a[4:7], v[52:55]
    ds_read_b64_tr_b16 v[164:165], v12 offset:16384
    ds_read_b64_tr_b16 v[166:167], v12 offset:17408
    v_mfma_f32_16x16x32_bf16 v[56:59], v[172:175], a[68:71], v[56:59]
    s_waitcnt lgkmcnt(10)
    v_mfma_f32_16x16x32_bf16 v[60:63], v[176:179], a[4:7], v[60:63]
    ds_read_b64_tr_b16 v[168:169], v13 offset:16384
    ds_read_b64_tr_b16 v[170:171], v13 offset:17408
    v_mfma_f32_16x16x32_bf16 v[64:67], v[176:179], a[68:71], v[64:67]
    s_waitcnt lgkmcnt(10)
    v_mfma_f32_16x16x32_bf16 v[68:71], v[180:183], a[4:7], v[68:71]
    ds_read_b64_tr_b16 v[172:173], v14 offset:16384
    ds_read_b64_tr_b16 v[174:175], v14 offset:17408
    v_mfma_f32_16x16x32_bf16 v[72:75], v[180:183], a[68:71], v[72:75]
    s_waitcnt lgkmcnt(10)
    v_mfma_f32_16x16x32_bf16 v[76:79], v[184:187], a[4:7], v[76:79]
    ds_read_b64_tr_b16 v[176:177], v15 offset:16384
    ds_read_b64_tr_b16 v[178:179], v15 offset:17408
    v_mfma_f32_16x16x32_bf16 v[80:83], v[184:187], a[68:71], v[80:83]
    s_waitcnt lgkmcnt(10)
    v_mfma_f32_16x16x32_bf16 v[84:87], v[188:191], a[4:7], v[84:87]
    ds_read_b64_tr_b16 v[180:181], v16 offset:16384
    ds_read_b64_tr_b16 v[182:183], v16 offset:17408
    v_mfma_f32_16x16x32_bf16 v[88:91], v[188:191], a[68:71], v[88:91]
    s_waitcnt lgkmcnt(10)
    v_mfma_f32_16x16x32_bf16 v[92:95], v[192:195], a[4:7], v[92:95]
    ds_read_b64_tr_b16 v[184:185], v17 offset:16384
    ds_read_b64_tr_b16 v[186:187], v17 offset:17408
    v_mfma_f32_16x16x32_bf16 v[96:99], v[192:195], a[68:71], v[96:99]
    s_waitcnt vmcnt(27) lgkmcnt(10)
    v_mfma_f32_16x16x32_bf16 v[36:39], v[164:167], a[8:11], v[36:39]
    ds_read_b64_tr_b16 v[188:189], v18 offset:16384
    ds_read_b64_tr_b16 v[190:191], v18 offset:17408
    s_waitcnt vmcnt(26)
    v_mfma_f32_16x16x32_bf16 v[40:43], v[164:167], a[72:75], v[40:43]
    s_waitcnt lgkmcnt(10)
    v_mfma_f32_16x16x32_bf16 v[44:47], v[168:171], a[8:11], v[44:47]
    ds_read_b64_tr_b16 v[192:193], v19 offset:16384
    ds_read_b64_tr_b16 v[194:195], v19 offset:17408
    v_mfma_f32_16x16x32_bf16 v[48:51], v[168:171], a[72:75], v[48:51]
    s_waitcnt lgkmcnt(10)
    v_mfma_f32_16x16x32_bf16 v[52:55], v[172:175], a[8:11], v[52:55]
    ds_read_b64_tr_b16 v[164:165], v12 offset:24576
    ds_read_b64_tr_b16 v[166:167], v12 offset:25600
    v_mfma_f32_16x16x32_bf16 v[56:59], v[172:175], a[72:75], v[56:59]
    s_waitcnt lgkmcnt(10)
    v_mfma_f32_16x16x32_bf16 v[60:63], v[176:179], a[8:11], v[60:63]
    ds_read_b64_tr_b16 v[168:169], v13 offset:24576
    ds_read_b64_tr_b16 v[170:171], v13 offset:25600
    v_mfma_f32_16x16x32_bf16 v[64:67], v[176:179], a[72:75], v[64:67]
    s_waitcnt lgkmcnt(10)
    v_mfma_f32_16x16x32_bf16 v[68:71], v[180:183], a[8:11], v[68:71]
    ds_read_b64_tr_b16 v[172:173], v14 offset:24576
    ds_read_b64_tr_b16 v[174:175], v14 offset:25600
    v_mfma_f32_16x16x32_bf16 v[72:75], v[180:183], a[72:75], v[72:75]
    s_waitcnt lgkmcnt(10)
    v_mfma_f32_16x16x32_bf16 v[76:79], v[184:187], a[8:11], v[76:79]
    ds_read_b64_tr_b16 v[176:177], v15 offset:24576
    ds_read_b64_tr_b16 v[178:179], v15 offset:25600
    v_mfma_f32_16x16x32_bf16 v[80:83], v[184:187], a[72:75], v[80:83]
    s_waitcnt lgkmcnt(10)
    v_mfma_f32_16x16x32_bf16 v[84:87], v[188:191], a[8:11], v[84:87]
    ds_read_b64_tr_b16 v[180:181], v16 offset:24576
    ds_read_b64_tr_b16 v[182:183], v16 offset:25600
    v_mfma_f32_16x16x32_bf16 v[88:91], v[188:191], a[72:75], v[88:91]
    s_waitcnt lgkmcnt(10)
    v_mfma_f32_16x16x32_bf16 v[92:95], v[192:195], a[8:11], v[92:95]
    ds_read_b64_tr_b16 v[184:185], v17 offset:24576
    ds_read_b64_tr_b16 v[186:187], v17 offset:25600
    v_mfma_f32_16x16x32_bf16 v[96:99], v[192:195], a[72:75], v[96:99]
    s_waitcnt vmcnt(25) lgkmcnt(10)
    v_mfma_f32_16x16x32_bf16 v[36:39], v[164:167], a[12:15], v[36:39]
    ds_read_b64_tr_b16 v[188:189], v18 offset:24576
    ds_read_b64_tr_b16 v[190:191], v18 offset:25600
    s_waitcnt vmcnt(24)
    v_mfma_f32_16x16x32_bf16 v[40:43], v[164:167], a[76:79], v[40:43]
    s_waitcnt lgkmcnt(10)
    v_mfma_f32_16x16x32_bf16 v[44:47], v[168:171], a[12:15], v[44:47]
    ds_read_b64_tr_b16 v[192:193], v19 offset:24576
    ds_read_b64_tr_b16 v[194:195], v19 offset:25600
    v_mfma_f32_16x16x32_bf16 v[48:51], v[168:171], a[76:79], v[48:51]
    s_waitcnt lgkmcnt(10)
    v_mfma_f32_16x16x32_bf16 v[52:55], v[172:175], a[12:15], v[52:55]
    s_waitcnt vmcnt(40)
    s_barrier
    s_add_u32 s31, s28, 3145728
    s_add_u32 m0, s30, 98304
    s_nop 0
    buffer_load_dwordx4 v8, s[12:15], s31 offen lds
    s_add_u32 m0, m0, 1024
    s_nop 0
    buffer_load_dwordx4 v9, s[12:15], s31 offen lds
    s_add_u32 m0, m0, 1024
    s_nop 0
    buffer_load_dwordx4 v10, s[12:15], s31 offen lds
    s_add_u32 m0, m0, 1024
    s_nop 0
    buffer_load_dwordx4 v11, s[12:15], s31 offen lds
    s_add_u32 m0, m0, 1024
    s_add_u32 s31, s31, 131072
    buffer_load_dwordx4 v8, s[12:15], s31 offen lds
    s_add_u32 m0, m0, 1024
    s_nop 0
    buffer_load_dwordx4 v9, s[12:15], s31 offen lds
    s_add_u32 m0, m0, 1024
    s_nop 0
    buffer_load_dwordx4 v10, s[12:15], s31 offen lds
    s_add_u32 m0, m0, 1024
    s_nop 0
    buffer_load_dwordx4 v11, s[12:15], s31 offen lds
    ds_read_b64_tr_b16 v[164:165], v12 offset:32768
    ds_read_b64_tr_b16 v[166:167], v12 offset:33792
    v_mfma_f32_16x16x32_bf16 v[56:59], v[172:175], a[76:79], v[56:59]
    s_waitcnt lgkmcnt(10)
    v_mfma_f32_16x16x32_bf16 v[60:63], v[176:179], a[12:15], v[60:63]
    ds_read_b64_tr_b16 v[168:169], v13 offset:32768
    ds_read_b64_tr_b16 v[170:171], v13 offset:33792
    v_mfma_f32_16x16x32_bf16 v[64:67], v[176:179], a[76:79], v[64:67]
    s_waitcnt lgkmcnt(10)
    v_mfma_f32_16x16x32_bf16 v[68:71], v[180:183], a[12:15], v[68:71]
    ds_read_b64_tr_b16 v[172:173], v14 offset:32768
    ds_read_b64_tr_b16 v[174:175], v14 offset:33792
    v_mfma_f32_16x16x32_bf16 v[72:75], v[180:183], a[76:79], v[72:75]
    s_waitcnt lgkmcnt(10)
    v_mfma_f32_16x16x32_bf16 v[76:79], v[184:187], a[12:15], v[76:79]
    ds_read_b64_tr_b16 v[176:177], v15 offset:32768
    ds_read_b64_tr_b16 v[178:179], v15 offset:33792
    v_mfma_f32_16x16x32_bf16 v[80:83], v[184:187], a[76:79], v[80:83]
    s_waitcnt lgkmcnt(10)
    v_mfma_f32_16x16x32_bf16 v[84:87], v[188:191], a[12:15], v[84:87]
    ds_read_b64_tr_b16 v[180:181], v16 offset:32768
    ds_read_b64_tr_b16 v[182:183], v16 offset:33792
    v_mfma_f32_16x16x32_bf16 v[88:91], v[188:191], a[76:79], v[88:91]
    s_waitcnt lgkmcnt(10)
    v_mfma_f32_16x16x32_bf16 v[92:95], v[192:195], a[12:15], v[92:95]
    ds_read_b64_tr_b16 v[184:185], v17 offset:32768
    ds_read_b64_tr_b16 v[186:187], v17 offset:33792
    v_mfma_f32_16x16x32_bf16 v[96:99], v[192:195], a[76:79], v[96:99]
    s_waitcnt vmcnt(31) lgkmcnt(10)
    v_mfma_f32_16x16x32_bf16 v[36:39], v[164:167], a[16:19], v[36:39]
    ds_read_b64_tr_b16 v[188:189], v18 offset:32768
    ds_read_b64_tr_b16 v[190:191], v18 offset:33792
    s_waitcnt vmcnt(30)
    v_mfma_f32_16x16x32_bf16 v[40:43], v[164:167], a[80:83], v[40:43]
    s_waitcnt lgkmcnt(10)
    v_mfma_f32_16x16x32_bf16 v[44:47], v[168:171], a[16:19], v[44:47]
    ds_read_b64_tr_b16 v[192:193], v19 offset:32768
    ds_read_b64_tr_b16 v[194:195], v19 offset:33792
    v_mfma_f32_16x16x32_bf16 v[48:51], v[168:171], a[80:83], v[48:51]
    s_waitcnt lgkmcnt(10)
    v_mfma_f32_16x16x32_bf16 v[52:55], v[172:175], a[16:19], v[52:55]
    ds_read_b64_tr_b16 v[164:165], v12 offset:40960
    ds_read_b64_tr_b16 v[166:167], v12 offset:41984
    v_mfma_f32_16x16x32_bf16 v[56:59], v[172:175], a[80:83], v[56:59]
    s_waitcnt lgkmcnt(10)
    v_mfma_f32_16x16x32_bf16 v[60:63], v[176:179], a[16:19], v[60:63]
    ds_read_b64_tr_b16 v[168:169], v13 offset:40960
    ds_read_b64_tr_b16 v[170:171], v13 offset:41984
    v_mfma_f32_16x16x32_bf16 v[64:67], v[176:179], a[80:83], v[64:67]
    s_waitcnt lgkmcnt(10)
    v_mfma_f32_16x16x32_bf16 v[68:71], v[180:183], a[16:19], v[68:71]
    ds_read_b64_tr_b16 v[172:173], v14 offset:40960
    ds_read_b64_tr_b16 v[174:175], v14 offset:41984
    v_mfma_f32_16x16x32_bf16 v[72:75], v[180:183], a[80:83], v[72:75]
    s_waitcnt lgkmcnt(10)
    v_mfma_f32_16x16x32_bf16 v[76:79], v[184:187], a[16:19], v[76:79]
    ds_read_b64_tr_b16 v[176:177], v15 offset:40960
    ds_read_b64_tr_b16 v[178:179], v15 offset:41984
    v_mfma_f32_16x16x32_bf16 v[80:83], v[184:187], a[80:83], v[80:83]
    s_waitcnt lgkmcnt(10)
    v_mfma_f32_16x16x32_bf16 v[84:87], v[188:191], a[16:19], v[84:87]
    ds_read_b64_tr_b16 v[180:181], v16 offset:40960
    ds_read_b64_tr_b16 v[182:183], v16 offset:41984
    v_mfma_f32_16x16x32_bf16 v[88:91], v[188:191], a[80:83], v[88:91]
    s_waitcnt lgkmcnt(10)
    v_mfma_f32_16x16x32_bf16 v[92:95], v[192:195], a[16:19], v[92:95]
    ds_read_b64_tr_b16 v[184:185], v17 offset:40960
    ds_read_b64_tr_b16 v[186:187], v17 offset:41984
    v_mfma_f32_16x16x32_bf16 v[96:99], v[192:195], a[80:83], v[96:99]
    s_waitcnt vmcnt(29) lgkmcnt(10)
    v_mfma_f32_16x16x32_bf16 v[36:39], v[164:167], a[20:23], v[36:39]
    ds_read_b64_tr_b16 v[188:189], v18 offset:40960
    ds_read_b64_tr_b16 v[190:191], v18 offset:41984
    s_waitcnt vmcnt(28)
    v_mfma_f32_16x16x32_bf16 v[40:43], v[164:167], a[84:87], v[40:43]
    s_waitcnt lgkmcnt(10)
    v_mfma_f32_16x16x32_bf16 v[44:47], v[168:171], a[20:23], v[44:47]
    ds_read_b64_tr_b16 v[192:193], v19 offset:40960
    ds_read_b64_tr_b16 v[194:195], v19 offset:41984
    v_mfma_f32_16x16x32_bf16 v[48:51], v[168:171], a[84:87], v[48:51]
    s_waitcnt lgkmcnt(10)
    v_mfma_f32_16x16x32_bf16 v[52:55], v[172:175], a[20:23], v[52:55]
    ds_read_b64_tr_b16 v[164:165], v12 offset:49152
    ds_read_b64_tr_b16 v[166:167], v12 offset:50176
    v_mfma_f32_16x16x32_bf16 v[56:59], v[172:175], a[84:87], v[56:59]
    s_waitcnt lgkmcnt(10)
    v_mfma_f32_16x16x32_bf16 v[60:63], v[176:179], a[20:23], v[60:63]
    ds_read_b64_tr_b16 v[168:169], v13 offset:49152
    ds_read_b64_tr_b16 v[170:171], v13 offset:50176
    v_mfma_f32_16x16x32_bf16 v[64:67], v[176:179], a[84:87], v[64:67]
    s_waitcnt lgkmcnt(10)
    v_mfma_f32_16x16x32_bf16 v[68:71], v[180:183], a[20:23], v[68:71]
    ds_read_b64_tr_b16 v[172:173], v14 offset:49152
    ds_read_b64_tr_b16 v[174:175], v14 offset:50176
    v_mfma_f32_16x16x32_bf16 v[72:75], v[180:183], a[84:87], v[72:75]
    s_waitcnt lgkmcnt(10)
    v_mfma_f32_16x16x32_bf16 v[76:79], v[184:187], a[20:23], v[76:79]
    ds_read_b64_tr_b16 v[176:177], v15 offset:49152
    ds_read_b64_tr_b16 v[178:179], v15 offset:50176
    v_mfma_f32_16x16x32_bf16 v[80:83], v[184:187], a[84:87], v[80:83]
    s_waitcnt lgkmcnt(10)
    v_mfma_f32_16x16x32_bf16 v[84:87], v[188:191], a[20:23], v[84:87]
    ds_read_b64_tr_b16 v[180:181], v16 offset:49152
    ds_read_b64_tr_b16 v[182:183], v16 offset:50176
    v_mfma_f32_16x16x32_bf16 v[88:91], v[188:191], a[84:87], v[88:91]
    s_waitcnt lgkmcnt(10)
    v_mfma_f32_16x16x32_bf16 v[92:95], v[192:195], a[20:23], v[92:95]
    ds_read_b64_tr_b16 v[184:185], v17 offset:49152
    ds_read_b64_tr_b16 v[186:187], v17 offset:50176
    v_mfma_f32_16x16x32_bf16 v[96:99], v[192:195], a[84:87], v[96:99]
    s_waitcnt vmcnt(27) lgkmcnt(10)
    v_mfma_f32_16x16x32_bf16 v[36:39], v[164:167], a[24:27], v[36:39]
    ds_read_b64_tr_b16 v[188:189], v18 offset:49152
    ds_read_b64_tr_b16 v[190:191], v18 offset:50176
    s_waitcnt vmcnt(26)
    v_mfma_f32_16x16x32_bf16 v[40:43], v[164:167], a[88:91], v[40:43]
    s_waitcnt lgkmcnt(10)
    v_mfma_f32_16x16x32_bf16 v[44:47], v[168:171], a[24:27], v[44:47]
    ds_read_b64_tr_b16 v[192:193], v19 offset:49152
    ds_read_b64_tr_b16 v[194:195], v19 offset:50176
    v_mfma_f32_16x16x32_bf16 v[48:51], v[168:171], a[88:91], v[48:51]
    s_waitcnt lgkmcnt(10)
    v_mfma_f32_16x16x32_bf16 v[52:55], v[172:175], a[24:27], v[52:55]
    ds_read_b64_tr_b16 v[164:165], v12 offset:57344
    ds_read_b64_tr_b16 v[166:167], v12 offset:58368
    v_mfma_f32_16x16x32_bf16 v[56:59], v[172:175], a[88:91], v[56:59]
    s_waitcnt lgkmcnt(10)
    v_mfma_f32_16x16x32_bf16 v[60:63], v[176:179], a[24:27], v[60:63]
    ds_read_b64_tr_b16 v[168:169], v13 offset:57344
    ds_read_b64_tr_b16 v[170:171], v13 offset:58368
    v_mfma_f32_16x16x32_bf16 v[64:67], v[176:179], a[88:91], v[64:67]
    s_waitcnt lgkmcnt(10)
    v_mfma_f32_16x16x32_bf16 v[68:71], v[180:183], a[24:27], v[68:71]
    ds_read_b64_tr_b16 v[172:173], v14 offset:57344
    ds_read_b64_tr_b16 v[174:175], v14 offset:58368
    v_mfma_f32_16x16x32_bf16 v[72:75], v[180:183], a[88:91], v[72:75]
    s_waitcnt lgkmcnt(10)
    v_mfma_f32_16x16x32_bf16 v[76:79], v[184:187], a[24:27], v[76:79]
    ds_read_b64_tr_b16 v[176:177], v15 offset:57344
    ds_read_b64_tr_b16 v[178:179], v15 offset:58368
    v_mfma_f32_16x16x32_bf16 v[80:83], v[184:187], a[88:91], v[80:83]
    s_waitcnt lgkmcnt(10)
    v_mfma_f32_16x16x32_bf16 v[84:87], v[188:191], a[24:27], v[84:87]
    ds_read_b64_tr_b16 v[180:181], v16 offset:57344
    ds_read_b64_tr_b16 v[182:183], v16 offset:58368
    v_mfma_f32_16x16x32_bf16 v[88:91], v[188:191], a[88:91], v[88:91]
    s_waitcnt lgkmcnt(10)
    v_mfma_f32_16x16x32_bf16 v[92:95], v[192:195], a[24:27], v[92:95]
    ds_read_b64_tr_b16 v[184:185], v17 offset:57344
    ds_read_b64_tr_b16 v[186:187], v17 offset:58368
    v_mfma_f32_16x16x32_bf16 v[96:99], v[192:195], a[88:91], v[96:99]
    s_waitcnt vmcnt(25) lgkmcnt(10)
    v_mfma_f32_16x16x32_bf16 v[36:39], v[164:167], a[28:31], v[36:39]
    ds_read_b64_tr_b16 v[188:189], v18 offset:57344
    ds_read_b64_tr_b16 v[190:191], v18 offset:58368
    s_waitcnt vmcnt(24)
    v_mfma_f32_16x16x32_bf16 v[40:43], v[164:167], a[92:95], v[40:43]
    s_waitcnt lgkmcnt(10)
    v_mfma_f32_16x16x32_bf16 v[44:47], v[168:171], a[28:31], v[44:47]
    ds_read_b64_tr_b16 v[192:193], v19 offset:57344
    ds_read_b64_tr_b16 v[194:195], v19 offset:58368
    v_mfma_f32_16x16x32_bf16 v[48:51], v[168:171], a[92:95], v[48:51]
    s_waitcnt lgkmcnt(10)
    v_mfma_f32_16x16x32_bf16 v[52:55], v[172:175], a[28:31], v[52:55]
    s_waitcnt vmcnt(40)
    s_barrier
    s_add_u32 s31, s28, 0
    s_add_u32 m0, s30, 0
    s_nop 0
    buffer_load_dwordx4 v8, s[40:43], s31 offen lds
    s_add_u32 m0, m0, 1024
    s_nop 0
    buffer_load_dwordx4 v9, s[40:43], s31 offen lds
    s_add_u32 m0, m0, 1024
    s_nop 0
    buffer_load_dwordx4 v10, s[40:43], s31 offen lds
    s_add_u32 m0, m0, 1024
    s_nop 0
    buffer_load_dwordx4 v11, s[40:43], s31 offen lds
    s_add_u32 m0, m0, 1024
    s_add_u32 s31, s31, 131072
    buffer_load_dwordx4 v8, s[40:43], s31 offen lds
    s_add_u32 m0, m0, 1024
    s_nop 0
    buffer_load_dwordx4 v9, s[40:43], s31 offen lds
    s_add_u32 m0, m0, 1024
    s_nop 0
    buffer_load_dwordx4 v10, s[40:43], s31 offen lds
    s_add_u32 m0, m0, 1024
    s_nop 0
    buffer_load_dwordx4 v11, s[40:43], s31 offen lds
    ds_read_b64_tr_b16 v[164:165], v24 offset:0
    ds_read_b64_tr_b16 v[166:167], v24 offset:1024
    v_mfma_f32_16x16x32_bf16 v[56:59], v[172:175], a[92:95], v[56:59]
    s_waitcnt lgkmcnt(10)
    v_mfma_f32_16x16x32_bf16 v[60:63], v[176:179], a[28:31], v[60:63]
    ds_read_b64_tr_b16 v[168:169], v25 offset:0
    ds_read_b64_tr_b16 v[170:171], v25 offset:1024
    v_mfma_f32_16x16x32_bf16 v[64:67], v[176:179], a[92:95], v[64:67]
    s_waitcnt lgkmcnt(10)
    v_mfma_f32_16x16x32_bf16 v[68:71], v[180:183], a[28:31], v[68:71]
    ds_read_b64_tr_b16 v[172:173], v26 offset:0
    ds_read_b64_tr_b16 v[174:175], v26 offset:1024
    v_mfma_f32_16x16x32_bf16 v[72:75], v[180:183], a[92:95], v[72:75]
    s_waitcnt lgkmcnt(10)
    v_mfma_f32_16x16x32_bf16 v[76:79], v[184:187], a[28:31], v[76:79]
    ds_read_b64_tr_b16 v[176:177], v27 offset:0
    ds_read_b64_tr_b16 v[178:179], v27 offset:1024
    v_mfma_f32_16x16x32_bf16 v[80:83], v[184:187], a[92:95], v[80:83]
    s_waitcnt lgkmcnt(10)
    v_mfma_f32_16x16x32_bf16 v[84:87], v[188:191], a[28:31], v[84:87]
    ds_read_b64_tr_b16 v[180:181], v28 offset:0
    ds_read_b64_tr_b16 v[182:183], v28 offset:1024
    v_mfma_f32_16x16x32_bf16 v[88:91], v[188:191], a[92:95], v[88:91]
    s_waitcnt lgkmcnt(10)
    v_mfma_f32_16x16x32_bf16 v[92:95], v[192:195], a[28:31], v[92:95]
    ds_read_b64_tr_b16 v[184:185], v29 offset:0
    ds_read_b64_tr_b16 v[186:187], v29 offset:1024
    v_mfma_f32_16x16x32_bf16 v[96:99], v[192:195], a[92:95], v[96:99]
    s_waitcnt vmcnt(31) lgkmcnt(10)
    v_mfma_f32_16x16x32_bf16 v[36:39], v[164:167], a[32:35], v[36:39]
    ds_read_b64_tr_b16 v[188:189], v30 offset:0
    ds_read_b64_tr_b16 v[190:191], v30 offset:1024
    s_waitcnt vmcnt(30)
    v_mfma_f32_16x16x32_bf16 v[40:43], v[164:167], a[96:99], v[40:43]
    s_waitcnt lgkmcnt(10)
    v_mfma_f32_16x16x32_bf16 v[44:47], v[168:171], a[32:35], v[44:47]
    ds_read_b64_tr_b16 v[192:193], v31 offset:0
    ds_read_b64_tr_b16 v[194:195], v31 offset:1024
    v_mfma_f32_16x16x32_bf16 v[48:51], v[168:171], a[96:99], v[48:51]
    s_waitcnt lgkmcnt(10)
    v_mfma_f32_16x16x32_bf16 v[52:55], v[172:175], a[32:35], v[52:55]
    ds_read_b64_tr_b16 v[164:165], v24 offset:8192
    ds_read_b64_tr_b16 v[166:167], v24 offset:9216
    v_mfma_f32_16x16x32_bf16 v[56:59], v[172:175], a[96:99], v[56:59]
    s_waitcnt lgkmcnt(10)
    v_mfma_f32_16x16x32_bf16 v[60:63], v[176:179], a[32:35], v[60:63]
    ds_read_b64_tr_b16 v[168:169], v25 offset:8192
    ds_read_b64_tr_b16 v[170:171], v25 offset:9216
    v_mfma_f32_16x16x32_bf16 v[64:67], v[176:179], a[96:99], v[64:67]
    s_waitcnt lgkmcnt(10)
    v_mfma_f32_16x16x32_bf16 v[68:71], v[180:183], a[32:35], v[68:71]
    ds_read_b64_tr_b16 v[172:173], v26 offset:8192
    ds_read_b64_tr_b16 v[174:175], v26 offset:9216
    v_mfma_f32_16x16x32_bf16 v[72:75], v[180:183], a[96:99], v[72:75]
    s_waitcnt lgkmcnt(10)
    v_mfma_f32_16x16x32_bf16 v[76:79], v[184:187], a[32:35], v[76:79]
    ds_read_b64_tr_b16 v[176:177], v27 offset:8192
    ds_read_b64_tr_b16 v[178:179], v27 offset:9216
    v_mfma_f32_16x16x32_bf16 v[80:83], v[184:187], a[96:99], v[80:83]
    s_waitcnt lgkmcnt(10)
    v_mfma_f32_16x16x32_bf16 v[84:87], v[188:191], a[32:35], v[84:87]
    ds_read_b64_tr_b16 v[180:181], v28 offset:8192
    ds_read_b64_tr_b16 v[182:183], v28 offset:9216
    v_mfma_f32_16x16x32_bf16 v[88:91], v[188:191], a[96:99], v[88:91]
    s_waitcnt lgkmcnt(10)
    v_mfma_f32_16x16x32_bf16 v[92:95], v[192:195], a[32:35], v[92:95]
    ds_read_b64_tr_b16 v[184:185], v29 offset:8192
    ds_read_b64_tr_b16 v[186:187], v29 offset:9216
    v_mfma_f32_16x16x32_bf16 v[96:99], v[192:195], a[96:99], v[96:99]
    s_waitcnt vmcnt(29) lgkmcnt(10)
    v_mfma_f32_16x16x32_bf16 v[36:39], v[164:167], a[36:39], v[36:39]
    ds_read_b64_tr_b16 v[188:189], v30 offset:8192
    ds_read_b64_tr_b16 v[190:191], v30 offset:9216
    s_waitcnt vmcnt(28)
    v_mfma_f32_16x16x32_bf16 v[40:43], v[164:167], a[100:103], v[40:43]
    s_waitcnt lgkmcnt(10)
    v_mfma_f32_16x16x32_bf16 v[44:47], v[168:171], a[36:39], v[44:47]
    ds_read_b64_tr_b16 v[192:193], v31 offset:8192
    ds_read_b64_tr_b16 v[194:195], v31 offset:9216
    v_mfma_f32_16x16x32_bf16 v[48:51], v[168:171], a[100:103], v[48:51]
    s_waitcnt lgkmcnt(10)
    v_mfma_f32_16x16x32_bf16 v[52:55], v[172:175], a[36:39], v[52:55]
    ds_read_b64_tr_b16 v[164:165], v24 offset:16384
    ds_read_b64_tr_b16 v[166:167], v24 offset:17408
    v_mfma_f32_16x16x32_bf16 v[56:59], v[172:175], a[100:103], v[56:59]
    s_waitcnt lgkmcnt(10)
    v_mfma_f32_16x16x32_bf16 v[60:63], v[176:179], a[36:39], v[60:63]
    ds_read_b64_tr_b16 v[168:169], v25 offset:16384
    ds_read_b64_tr_b16 v[170:171], v25 offset:17408
    v_mfma_f32_16x16x32_bf16 v[64:67], v[176:179], a[100:103], v[64:67]
    s_waitcnt lgkmcnt(10)
    v_mfma_f32_16x16x32_bf16 v[68:71], v[180:183], a[36:39], v[68:71]
    ds_read_b64_tr_b16 v[172:173], v26 offset:16384
    ds_read_b64_tr_b16 v[174:175], v26 offset:17408
    v_mfma_f32_16x16x32_bf16 v[72:75], v[180:183], a[100:103], v[72:75]
    s_waitcnt lgkmcnt(10)
    v_mfma_f32_16x16x32_bf16 v[76:79], v[184:187], a[36:39], v[76:79]
    ds_read_b64_tr_b16 v[176:177], v27 offset:16384
    ds_read_b64_tr_b16 v[178:179], v27 offset:17408
    v_mfma_f32_16x16x32_bf16 v[80:83], v[184:187], a[100:103], v[80:83]
    s_waitcnt lgkmcnt(10)
    v_mfma_f32_16x16x32_bf16 v[84:87], v[188:191], a[36:39], v[84:87]
    ds_read_b64_tr_b16 v[180:181], v28 offset:16384
    ds_read_b64_tr_b16 v[182:183], v28 offset:17408
    v_mfma_f32_16x16x32_bf16 v[88:91], v[188:191], a[100:103], v[88:91]
    s_waitcnt lgkmcnt(10)
    v_mfma_f32_16x16x32_bf16 v[92:95], v[192:195], a[36:39], v[92:95]
    ds_read_b64_tr_b16 v[184:185], v29 offset:16384
    ds_read_b64_tr_b16 v[186:187], v29 offset:17408
    v_mfma_f32_16x16x32_bf16 v[96:99], v[192:195], a[100:103], v[96:99]
    s_waitcnt vmcnt(27) lgkmcnt(10)
    v_mfma_f32_16x16x32_bf16 v[36:39], v[164:167], a[40:43], v[36:39]
    ds_read_b64_tr_b16 v[188:189], v30 offset:16384
    ds_read_b64_tr_b16 v[190:191], v30 offset:17408
    s_waitcnt vmcnt(26)
    v_mfma_f32_16x16x32_bf16 v[40:43], v[164:167], a[104:107], v[40:43]
    s_waitcnt lgkmcnt(10)
    v_mfma_f32_16x16x32_bf16 v[44:47], v[168:171], a[40:43], v[44:47]
    ds_read_b64_tr_b16 v[192:193], v31 offset:16384
    ds_read_b64_tr_b16 v[194:195], v31 offset:17408
    v_mfma_f32_16x16x32_bf16 v[48:51], v[168:171], a[104:107], v[48:51]
    s_waitcnt lgkmcnt(10)
    v_mfma_f32_16x16x32_bf16 v[52:55], v[172:175], a[40:43], v[52:55]
    ds_read_b64_tr_b16 v[164:165], v24 offset:24576
    ds_read_b64_tr_b16 v[166:167], v24 offset:25600
    v_mfma_f32_16x16x32_bf16 v[56:59], v[172:175], a[104:107], v[56:59]
    s_waitcnt lgkmcnt(10)
    v_mfma_f32_16x16x32_bf16 v[60:63], v[176:179], a[40:43], v[60:63]
    ds_read_b64_tr_b16 v[168:169], v25 offset:24576
    ds_read_b64_tr_b16 v[170:171], v25 offset:25600
    v_mfma_f32_16x16x32_bf16 v[64:67], v[176:179], a[104:107], v[64:67]
    s_waitcnt lgkmcnt(10)
    v_mfma_f32_16x16x32_bf16 v[68:71], v[180:183], a[40:43], v[68:71]
    ds_read_b64_tr_b16 v[172:173], v26 offset:24576
    ds_read_b64_tr_b16 v[174:175], v26 offset:25600
    v_mfma_f32_16x16x32_bf16 v[72:75], v[180:183], a[104:107], v[72:75]
    s_waitcnt lgkmcnt(10)
    v_mfma_f32_16x16x32_bf16 v[76:79], v[184:187], a[40:43], v[76:79]
    ds_read_b64_tr_b16 v[176:177], v27 offset:24576
    ds_read_b64_tr_b16 v[178:179], v27 offset:25600
    v_mfma_f32_16x16x32_bf16 v[80:83], v[184:187], a[104:107], v[80:83]
    s_waitcnt lgkmcnt(10)
    v_mfma_f32_16x16x32_bf16 v[84:87], v[188:191], a[40:43], v[84:87]
    ds_read_b64_tr_b16 v[180:181], v28 offset:24576
    ds_read_b64_tr_b16 v[182:183], v28 offset:25600
    v_mfma_f32_16x16x32_bf16 v[88:91], v[188:191], a[104:107], v[88:91]
    s_waitcnt lgkmcnt(10)
    v_mfma_f32_16x16x32_bf16 v[92:95], v[192:195], a[40:43], v[92:95]
    ds_read_b64_tr_b16 v[184:185], v29 offset:24576
    ds_read_b64_tr_b16 v[186:187], v29 offset:25600
    v_mfma_f32_16x16x32_bf16 v[96:99], v[192:195], a[104:107], v[96:99]
    s_waitcnt vmcnt(25) lgkmcnt(10)
    v_mfma_f32_16x16x32_bf16 v[36:39], v[164:167], a[44:47], v[36:39]
    ds_read_b64_tr_b16 v[188:189], v30 offset:24576
    ds_read_b64_tr_b16 v[190:191], v30 offset:25600
    s_waitcnt vmcnt(24)
    v_mfma_f32_16x16x32_bf16 v[40:43], v[164:167], a[108:111], v[40:43]
    s_waitcnt lgkmcnt(10)
    v_mfma_f32_16x16x32_bf16 v[44:47], v[168:171], a[44:47], v[44:47]
    ds_read_b64_tr_b16 v[192:193], v31 offset:24576
    ds_read_b64_tr_b16 v[194:195], v31 offset:25600
    v_mfma_f32_16x16x32_bf16 v[48:51], v[168:171], a[108:111], v[48:51]
    s_waitcnt lgkmcnt(10)
    v_mfma_f32_16x16x32_bf16 v[52:55], v[172:175], a[44:47], v[52:55]
    s_waitcnt vmcnt(8)
    s_barrier
    s_add_u32 s31, s28, 1048576
    s_add_u32 m0, s30, 32768
    s_nop 0
    buffer_load_dwordx4 v8, s[40:43], s31 offen lds
    s_add_u32 m0, m0, 1024
    s_nop 0
    buffer_load_dwordx4 v9, s[40:43], s31 offen lds
    s_add_u32 m0, m0, 1024
    s_nop 0
    buffer_load_dwordx4 v10, s[40:43], s31 offen lds
    s_add_u32 m0, m0, 1024
    s_nop 0
    buffer_load_dwordx4 v11, s[40:43], s31 offen lds
    s_add_u32 m0, m0, 1024
    s_add_u32 s31, s31, 131072
    buffer_load_dwordx4 v8, s[40:43], s31 offen lds
    s_add_u32 m0, m0, 1024
    s_nop 0
    buffer_load_dwordx4 v9, s[40:43], s31 offen lds
    s_add_u32 m0, m0, 1024
    s_nop 0
    buffer_load_dwordx4 v10, s[40:43], s31 offen lds
    s_add_u32 m0, m0, 1024
    s_nop 0
    buffer_load_dwordx4 v11, s[40:43], s31 offen lds
    ds_read_b64_tr_b16 v[164:165], v24 offset:32768
    ds_read_b64_tr_b16 v[166:167], v24 offset:33792
    v_mfma_f32_16x16x32_bf16 v[56:59], v[172:175], a[108:111], v[56:59]
    s_waitcnt lgkmcnt(10)
    v_mfma_f32_16x16x32_bf16 v[60:63], v[176:179], a[44:47], v[60:63]
    ds_read_b64_tr_b16 v[168:169], v25 offset:32768
    ds_read_b64_tr_b16 v[170:171], v25 offset:33792
    v_mfma_f32_16x16x32_bf16 v[64:67], v[176:179], a[108:111], v[64:67]
    s_waitcnt lgkmcnt(10)
    v_mfma_f32_16x16x32_bf16 v[68:71], v[180:183], a[44:47], v[68:71]
    ds_read_b64_tr_b16 v[172:173], v26 offset:32768
    ds_read_b64_tr_b16 v[174:175], v26 offset:33792
    v_mfma_f32_16x16x32_bf16 v[72:75], v[180:183], a[108:111], v[72:75]
    s_waitcnt lgkmcnt(10)
    v_mfma_f32_16x16x32_bf16 v[76:79], v[184:187], a[44:47], v[76:79]
    ds_read_b64_tr_b16 v[176:177], v27 offset:32768
    ds_read_b64_tr_b16 v[178:179], v27 offset:33792
    v_mfma_f32_16x16x32_bf16 v[80:83], v[184:187], a[108:111], v[80:83]
    s_waitcnt lgkmcnt(10)
    v_mfma_f32_16x16x32_bf16 v[84:87], v[188:191], a[44:47], v[84:87]
    ds_read_b64_tr_b16 v[180:181], v28 offset:32768
    ds_read_b64_tr_b16 v[182:183], v28 offset:33792
    v_mfma_f32_16x16x32_bf16 v[88:91], v[188:191], a[108:111], v[88:91]
    s_waitcnt lgkmcnt(10)
    v_mfma_f32_16x16x32_bf16 v[92:95], v[192:195], a[44:47], v[92:95]
    ds_read_b64_tr_b16 v[184:185], v29 offset:32768
    ds_read_b64_tr_b16 v[186:187], v29 offset:33792
    v_mfma_f32_16x16x32_bf16 v[96:99], v[192:195], a[108:111], v[96:99]
    s_waitcnt lgkmcnt(10)
    v_mfma_f32_16x16x32_bf16 v[36:39], v[164:167], a[48:51], v[36:39]
    ds_read_b64_tr_b16 v[188:189], v30 offset:32768
    ds_read_b64_tr_b16 v[190:191], v30 offset:33792
    v_mfma_f32_16x16x32_bf16 v[40:43], v[164:167], a[112:115], v[40:43]
    s_waitcnt lgkmcnt(10)
    v_mfma_f32_16x16x32_bf16 v[44:47], v[168:171], a[48:51], v[44:47]
    ds_read_b64_tr_b16 v[192:193], v31 offset:32768
    ds_read_b64_tr_b16 v[194:195], v31 offset:33792
    v_mfma_f32_16x16x32_bf16 v[48:51], v[168:171], a[112:115], v[48:51]
    s_waitcnt lgkmcnt(10)
    v_mfma_f32_16x16x32_bf16 v[52:55], v[172:175], a[48:51], v[52:55]
    ds_read_b64_tr_b16 v[164:165], v24 offset:40960
    ds_read_b64_tr_b16 v[166:167], v24 offset:41984
    v_mfma_f32_16x16x32_bf16 v[56:59], v[172:175], a[112:115], v[56:59]
    s_waitcnt lgkmcnt(10)
    v_mfma_f32_16x16x32_bf16 v[60:63], v[176:179], a[48:51], v[60:63]
    ds_read_b64_tr_b16 v[168:169], v25 offset:40960
    ds_read_b64_tr_b16 v[170:171], v25 offset:41984
    v_mfma_f32_16x16x32_bf16 v[64:67], v[176:179], a[112:115], v[64:67]
    s_waitcnt lgkmcnt(10)
    v_mfma_f32_16x16x32_bf16 v[68:71], v[180:183], a[48:51], v[68:71]
    ds_read_b64_tr_b16 v[172:173], v26 offset:40960
    ds_read_b64_tr_b16 v[174:175], v26 offset:41984
    v_mfma_f32_16x16x32_bf16 v[72:75], v[180:183], a[112:115], v[72:75]
    s_waitcnt lgkmcnt(10)
    v_mfma_f32_16x16x32_bf16 v[76:79], v[184:187], a[48:51], v[76:79]
    ds_read_b64_tr_b16 v[176:177], v27 offset:40960
    ds_read_b64_tr_b16 v[178:179], v27 offset:41984
    v_mfma_f32_16x16x32_bf16 v[80:83], v[184:187], a[112:115], v[80:83]
    s_waitcnt lgkmcnt(10)
    v_mfma_f32_16x16x32_bf16 v[84:87], v[188:191], a[48:51], v[84:87]
    ds_read_b64_tr_b16 v[180:181], v28 offset:40960
    ds_read_b64_tr_b16 v[182:183], v28 offset:41984
    v_mfma_f32_16x16x32_bf16 v[88:91], v[188:191], a[112:115], v[88:91]
    s_waitcnt lgkmcnt(10)
    v_mfma_f32_16x16x32_bf16 v[92:95], v[192:195], a[48:51], v[92:95]
    ds_read_b64_tr_b16 v[184:185], v29 offset:40960
    ds_read_b64_tr_b16 v[186:187], v29 offset:41984
    v_mfma_f32_16x16x32_bf16 v[96:99], v[192:195], a[112:115], v[96:99]
    s_waitcnt lgkmcnt(10)
    v_mfma_f32_16x16x32_bf16 v[36:39], v[164:167], a[52:55], v[36:39]
    ds_read_b64_tr_b16 v[188:189], v30 offset:40960
    ds_read_b64_tr_b16 v[190:191], v30 offset:41984
    v_mfma_f32_16x16x32_bf16 v[40:43], v[164:167], a[116:119], v[40:43]
    s_waitcnt lgkmcnt(10)
    v_mfma_f32_16x16x32_bf16 v[44:47], v[168:171], a[52:55], v[44:47]
    ds_read_b64_tr_b16 v[192:193], v31 offset:40960
    ds_read_b64_tr_b16 v[194:195], v31 offset:41984
    v_mfma_f32_16x16x32_bf16 v[48:51], v[168:171], a[116:119], v[48:51]
    s_waitcnt lgkmcnt(10)
    v_mfma_f32_16x16x32_bf16 v[52:55], v[172:175], a[52:55], v[52:55]
    ds_read_b64_tr_b16 v[164:165], v24 offset:49152
    ds_read_b64_tr_b16 v[166:167], v24 offset:50176
    v_mfma_f32_16x16x32_bf16 v[56:59], v[172:175], a[116:119], v[56:59]
    s_waitcnt lgkmcnt(10)
    v_mfma_f32_16x16x32_bf16 v[60:63], v[176:179], a[52:55], v[60:63]
    ds_read_b64_tr_b16 v[168:169], v25 offset:49152
    ds_read_b64_tr_b16 v[170:171], v25 offset:50176
    v_mfma_f32_16x16x32_bf16 v[64:67], v[176:179], a[116:119], v[64:67]
    s_waitcnt lgkmcnt(10)
    v_mfma_f32_16x16x32_bf16 v[68:71], v[180:183], a[52:55], v[68:71]
    ds_read_b64_tr_b16 v[172:173], v26 offset:49152
    ds_read_b64_tr_b16 v[174:175], v26 offset:50176
    v_mfma_f32_16x16x32_bf16 v[72:75], v[180:183], a[116:119], v[72:75]
    s_waitcnt lgkmcnt(10)
    v_mfma_f32_16x16x32_bf16 v[76:79], v[184:187], a[52:55], v[76:79]
    ds_read_b64_tr_b16 v[176:177], v27 offset:49152
    ds_read_b64_tr_b16 v[178:179], v27 offset:50176
    v_mfma_f32_16x16x32_bf16 v[80:83], v[184:187], a[116:119], v[80:83]
    s_waitcnt lgkmcnt(10)
    v_mfma_f32_16x16x32_bf16 v[84:87], v[188:191], a[52:55], v[84:87]
    ds_read_b64_tr_b16 v[180:181], v28 offset:49152
    ds_read_b64_tr_b16 v[182:183], v28 offset:50176
    v_mfma_f32_16x16x32_bf16 v[88:91], v[188:191], a[116:119], v[88:91]
    s_waitcnt lgkmcnt(10)
    v_mfma_f32_16x16x32_bf16 v[92:95], v[192:195], a[52:55], v[92:95]
    ds_read_b64_tr_b16 v[184:185], v29 offset:49152
    ds_read_b64_tr_b16 v[186:187], v29 offset:50176
    v_mfma_f32_16x16x32_bf16 v[96:99], v[192:195], a[116:119], v[96:99]
    s_waitcnt lgkmcnt(10)
    v_mfma_f32_16x16x32_bf16 v[36:39], v[164:167], a[56:59], v[36:39]
    ds_read_b64_tr_b16 v[188:189], v30 offset:49152
    ds_read_b64_tr_b16 v[190:191], v30 offset:50176
    v_mfma_f32_16x16x32_bf16 v[40:43], v[164:167], a[120:123], v[40:43]
    s_waitcnt lgkmcnt(10)
    v_mfma_f32_16x16x32_bf16 v[44:47], v[168:171], a[56:59], v[44:47]
    ds_read_b64_tr_b16 v[192:193], v31 offset:49152
    ds_read_b64_tr_b16 v[194:195], v31 offset:50176
    v_mfma_f32_16x16x32_bf16 v[48:51], v[168:171], a[120:123], v[48:51]
    s_waitcnt lgkmcnt(10)
    v_mfma_f32_16x16x32_bf16 v[52:55], v[172:175], a[56:59], v[52:55]
    ds_read_b64_tr_b16 v[164:165], v24 offset:57344
    ds_read_b64_tr_b16 v[166:167], v24 offset:58368
    v_mfma_f32_16x16x32_bf16 v[56:59], v[172:175], a[120:123], v[56:59]
    s_waitcnt lgkmcnt(10)
    v_mfma_f32_16x16x32_bf16 v[60:63], v[176:179], a[56:59], v[60:63]
    ds_read_b64_tr_b16 v[168:169], v25 offset:57344
    ds_read_b64_tr_b16 v[170:171], v25 offset:58368
    v_mfma_f32_16x16x32_bf16 v[64:67], v[176:179], a[120:123], v[64:67]
    s_waitcnt lgkmcnt(10)
    v_mfma_f32_16x16x32_bf16 v[68:71], v[180:183], a[56:59], v[68:71]
    ds_read_b64_tr_b16 v[172:173], v26 offset:57344
    ds_read_b64_tr_b16 v[174:175], v26 offset:58368
    v_mfma_f32_16x16x32_bf16 v[72:75], v[180:183], a[120:123], v[72:75]
    s_waitcnt lgkmcnt(10)
    v_mfma_f32_16x16x32_bf16 v[76:79], v[184:187], a[56:59], v[76:79]
    ds_read_b64_tr_b16 v[176:177], v27 offset:57344
    ds_read_b64_tr_b16 v[178:179], v27 offset:58368
    v_mfma_f32_16x16x32_bf16 v[80:83], v[184:187], a[120:123], v[80:83]
    s_waitcnt lgkmcnt(10)
    v_mfma_f32_16x16x32_bf16 v[84:87], v[188:191], a[56:59], v[84:87]
    ds_read_b64_tr_b16 v[180:181], v28 offset:57344
    ds_read_b64_tr_b16 v[182:183], v28 offset:58368
    v_mfma_f32_16x16x32_bf16 v[88:91], v[188:191], a[120:123], v[88:91]
    s_waitcnt lgkmcnt(10)
    v_mfma_f32_16x16x32_bf16 v[92:95], v[192:195], a[56:59], v[92:95]
    ds_read_b64_tr_b16 v[184:185], v29 offset:57344
    ds_read_b64_tr_b16 v[186:187], v29 offset:58368
    v_mfma_f32_16x16x32_bf16 v[96:99], v[192:195], a[120:123], v[96:99]
    s_waitcnt lgkmcnt(10)
    v_mfma_f32_16x16x32_bf16 v[36:39], v[164:167], a[60:63], v[36:39]
    ds_read_b64_tr_b16 v[188:189], v30 offset:57344
    ds_read_b64_tr_b16 v[190:191], v30 offset:58368
    v_mfma_f32_16x16x32_bf16 v[40:43], v[164:167], a[124:127], v[40:43]
    s_waitcnt lgkmcnt(10)
    v_mfma_f32_16x16x32_bf16 v[44:47], v[168:171], a[60:63], v[44:47]
    ds_read_b64_tr_b16 v[192:193], v31 offset:57344
    ds_read_b64_tr_b16 v[194:195], v31 offset:58368
    v_mfma_f32_16x16x32_bf16 v[48:51], v[168:171], a[124:127], v[48:51]
    s_waitcnt lgkmcnt(10)
    v_mfma_f32_16x16x32_bf16 v[52:55], v[172:175], a[60:63], v[52:55]
    s_waitcnt vmcnt(8)
    s_barrier
    s_add_u32 s31, s28, 2097152
    s_add_u32 m0, s30, 65536
    s_nop 0
    buffer_load_dwordx4 v8, s[40:43], s31 offen lds
    s_add_u32 m0, m0, 1024
    s_nop 0
    buffer_load_dwordx4 v9, s[40:43], s31 offen lds
    s_add_u32 m0, m0, 1024
    s_nop 0
    buffer_load_dwordx4 v10, s[40:43], s31 offen lds
    s_add_u32 m0, m0, 1024
    s_nop 0
    buffer_load_dwordx4 v11, s[40:43], s31 offen lds
    s_add_u32 m0, m0, 1024
    s_add_u32 s31, s31, 131072
    buffer_load_dwordx4 v8, s[40:43], s31 offen lds
    s_add_u32 m0, m0, 1024
    s_nop 0
    buffer_load_dwordx4 v9, s[40:43], s31 offen lds
    s_add_u32 m0, m0, 1024
    s_nop 0
    buffer_load_dwordx4 v10, s[40:43], s31 offen lds
    s_add_u32 m0, m0, 1024
    s_nop 0
    buffer_load_dwordx4 v11, s[40:43], s31 offen lds
    ds_read_b64_tr_b16 v[164:165], v12 offset:0
    ds_read_b64_tr_b16 v[166:167], v12 offset:1024
    v_mfma_f32_16x16x32_bf16 v[56:59], v[172:175], a[124:127], v[56:59]
    s_waitcnt lgkmcnt(10)
    v_mfma_f32_16x16x32_bf16 v[60:63], v[176:179], a[60:63], v[60:63]
    ds_read_b64_tr_b16 v[168:169], v13 offset:0
    ds_read_b64_tr_b16 v[170:171], v13 offset:1024
    v_mfma_f32_16x16x32_bf16 v[64:67], v[176:179], a[124:127], v[64:67]
    s_waitcnt lgkmcnt(10)
    v_mfma_f32_16x16x32_bf16 v[68:71], v[180:183], a[60:63], v[68:71]
    ds_read_b64_tr_b16 v[172:173], v14 offset:0
    ds_read_b64_tr_b16 v[174:175], v14 offset:1024
    v_mfma_f32_16x16x32_bf16 v[72:75], v[180:183], a[124:127], v[72:75]
    s_waitcnt lgkmcnt(10)
    v_mfma_f32_16x16x32_bf16 v[76:79], v[184:187], a[60:63], v[76:79]
    ds_read_b64_tr_b16 v[176:177], v15 offset:0
    ds_read_b64_tr_b16 v[178:179], v15 offset:1024
    v_mfma_f32_16x16x32_bf16 v[80:83], v[184:187], a[124:127], v[80:83]
    s_waitcnt lgkmcnt(10)
    v_mfma_f32_16x16x32_bf16 v[84:87], v[188:191], a[60:63], v[84:87]
    ds_read_b64_tr_b16 v[180:181], v16 offset:0
    ds_read_b64_tr_b16 v[182:183], v16 offset:1024
    v_mfma_f32_16x16x32_bf16 v[88:91], v[188:191], a[124:127], v[88:91]
    s_waitcnt lgkmcnt(10)
    v_mfma_f32_16x16x32_bf16 v[92:95], v[192:195], a[60:63], v[92:95]
    ds_read_b64_tr_b16 v[184:185], v17 offset:0
    ds_read_b64_tr_b16 v[186:187], v17 offset:1024
    v_mfma_f32_16x16x32_bf16 v[96:99], v[192:195], a[124:127], v[96:99]
    s_waitcnt lgkmcnt(10)
    v_mfma_f32_16x16x32_bf16 v[100:103], a[0:3], v[164:167], 0
    ds_read_b64_tr_b16 v[188:189], v18 offset:0
    ds_read_b64_tr_b16 v[190:191], v18 offset:1024
    v_mfma_f32_16x16x32_bf16 v[104:107], a[64:67], v[164:167], 0
    s_waitcnt lgkmcnt(10)
    v_mfma_f32_16x16x32_bf16 v[108:111], a[0:3], v[168:171], 0
    ds_read_b64_tr_b16 v[192:193], v19 offset:0
    ds_read_b64_tr_b16 v[194:195], v19 offset:1024
    v_mfma_f32_16x16x32_bf16 v[112:115], a[64:67], v[168:171], 0
    s_waitcnt lgkmcnt(10)
    v_mfma_f32_16x16x32_bf16 v[116:119], a[0:3], v[172:175], 0
    ds_read_b64_tr_b16 v[164:165], v12 offset:8192
    ds_read_b64_tr_b16 v[166:167], v12 offset:9216
    s_add_u32 s37, s36, 16777216
    v_mfma_f32_16x16x32_bf16 v[120:123], a[64:67], v[172:175], 0
    v_cvt_pk_bf16_f32 v196, v36, v37
    s_waitcnt lgkmcnt(10)
    v_mfma_f32_16x16x32_bf16 v[124:127], a[0:3], v[176:179], 0
    ds_read_b64_tr_b16 v[168:169], v13 offset:8192
    ds_read_b64_tr_b16 v[170:171], v13 offset:9216
    v_cvt_pk_bf16_f32 v197, v38, v39
    v_mfma_f32_16x16x32_bf16 v[128:131], a[64:67], v[176:179], 0
    v_cvt_pk_bf16_f32 v198, v44, v45
    s_waitcnt lgkmcnt(10)
    v_mfma_f32_16x16x32_bf16 v[132:135], a[0:3], v[180:183], 0
    ds_read_b64_tr_b16 v[172:173], v14 offset:8192
    ds_read_b64_tr_b16 v[174:175], v14 offset:9216
    v_cvt_pk_bf16_f32 v199, v46, v47
    v_mfma_f32_16x16x32_bf16 v[136:139], a[64:67], v[180:183], 0
    buffer_store_dwordx4 v[196:199], v3, s[4:7], s37 offen offset:0 sc1
    s_waitcnt lgkmcnt(10)
    v_mfma_f32_16x16x32_bf16 v[140:143], a[0:3], v[184:187], 0
    ds_read_b64_tr_b16 v[176:177], v15 offset:8192
    ds_read_b64_tr_b16 v[178:179], v15 offset:9216
    v_cvt_pk_bf16_f32 v200, v52, v53
    v_mfma_f32_16x16x32_bf16 v[144:147], a[64:67], v[184:187], 0
    v_cvt_pk_bf16_f32 v201, v54, v55
    s_waitcnt lgkmcnt(10)
    v_mfma_f32_16x16x32_bf16 v[148:151], a[0:3], v[188:191], 0
    ds_read_b64_tr_b16 v[180:181], v16 offset:8192
    ds_read_b64_tr_b16 v[182:183], v16 offset:9216
    v_cvt_pk_bf16_f32 v202, v60, v61
    v_mfma_f32_16x16x32_bf16 v[152:155], a[64:67], v[188:191], 0
    v_cvt_pk_bf16_f32 v203, v62, v63
    s_waitcnt lgkmcnt(10)
    v_mfma_f32_16x16x32_bf16 v[156:159], a[0:3], v[192:195], 0
    ds_read_b64_tr_b16 v[184:185], v17 offset:8192
    ds_read_b64_tr_b16 v[186:187], v17 offset:9216
    buffer_store_dwordx4 v[200:203], v3, s[4:7], s37 offen offset:1024 sc1
    v_mfma_f32_16x16x32_bf16 v[160:163], a[64:67], v[192:195], 0
    v_cvt_pk_bf16_f32 v204, v68, v69
    s_waitcnt lgkmcnt(10)
    v_mfma_f32_16x16x32_bf16 v[100:103], a[4:7], v[164:167], v[100:103]
    ds_read_b64_tr_b16 v[188:189], v18 offset:8192
    ds_read_b64_tr_b16 v[190:191], v18 offset:9216
    v_cvt_pk_bf16_f32 v205, v70, v71
    v_mfma_f32_16x16x32_bf16 v[104:107], a[68:71], v[164:167], v[104:107]
    v_cvt_pk_bf16_f32 v206, v76, v77
    s_waitcnt lgkmcnt(10)
    v_mfma_f32_16x16x32_bf16 v[108:111], a[4:7], v[168:171], v[108:111]
    ds_read_b64_tr_b16 v[192:193], v19 offset:8192
    ds_read_b64_tr_b16 v[194:195], v19 offset:9216
    v_cvt_pk_bf16_f32 v207, v78, v79
    v_mfma_f32_16x16x32_bf16 v[112:115], a[68:71], v[168:171], v[112:115]
    buffer_store_dwordx4 v[204:207], v3, s[4:7], s37 offen offset:2048 sc1
    s_waitcnt lgkmcnt(10)
    v_mfma_f32_16x16x32_bf16 v[116:119], a[4:7], v[172:175], v[116:119]
    ds_read_b64_tr_b16 v[164:165], v12 offset:16384
    ds_read_b64_tr_b16 v[166:167], v12 offset:17408
    v_cvt_pk_bf16_f32 v208, v84, v85
    v_mfma_f32_16x16x32_bf16 v[120:123], a[68:71], v[172:175], v[120:123]
    v_cvt_pk_bf16_f32 v209, v86, v87
    s_waitcnt lgkmcnt(10)
    v_mfma_f32_16x16x32_bf16 v[124:127], a[4:7], v[176:179], v[124:127]
    ds_read_b64_tr_b16 v[168:169], v13 offset:16384
    ds_read_b64_tr_b16 v[170:171], v13 offset:17408
    v_cvt_pk_bf16_f32 v210, v92, v93
    v_mfma_f32_16x16x32_bf16 v[128:131], a[68:71], v[176:179], v[128:131]
    v_cvt_pk_bf16_f32 v211, v94, v95
    s_waitcnt lgkmcnt(10)
    v_mfma_f32_16x16x32_bf16 v[132:135], a[4:7], v[180:183], v[132:135]
    ds_read_b64_tr_b16 v[172:173], v14 offset:16384
    ds_read_b64_tr_b16 v[174:175], v14 offset:17408
    buffer_store_dwordx4 v[208:211], v3, s[4:7], s37 offen offset:3072 sc1
    v_mfma_f32_16x16x32_bf16 v[136:139], a[68:71], v[180:183], v[136:139]
    s_add_u32 s37, s37, 4096
    s_waitcnt lgkmcnt(10)
    v_mfma_f32_16x16x32_bf16 v[140:143], a[4:7], v[184:187], v[140:143]
    ds_read_b64_tr_b16 v[176:177], v15 offset:16384
    ds_read_b64_tr_b16 v[178:179], v15 offset:17408
    v_cvt_pk_bf16_f32 v196, v40, v41
    v_mfma_f32_16x16x32_bf16 v[144:147], a[68:71], v[184:187], v[144:147]
    v_cvt_pk_bf16_f32 v197, v42, v43
    s_waitcnt lgkmcnt(10)
    v_mfma_f32_16x16x32_bf16 v[148:151], a[4:7], v[188:191], v[148:151]
    ds_read_b64_tr_b16 v[180:181], v16 offset:16384
    ds_read_b64_tr_b16 v[182:183], v16 offset:17408
    v_cvt_pk_bf16_f32 v198, v48, v49
    v_mfma_f32_16x16x32_bf16 v[152:155], a[68:71], v[188:191], v[152:155]
    v_cvt_pk_bf16_f32 v199, v50, v51
    s_waitcnt lgkmcnt(10)
    v_mfma_f32_16x16x32_bf16 v[156:159], a[4:7], v[192:195], v[156:159]
    ds_read_b64_tr_b16 v[184:185], v17 offset:16384
    ds_read_b64_tr_b16 v[186:187], v17 offset:17408
    buffer_store_dwordx4 v[196:199], v3, s[4:7], s37 offen offset:0 sc1
    v_mfma_f32_16x16x32_bf16 v[160:163], a[68:71], v[192:195], v[160:163]
    v_cvt_pk_bf16_f32 v200, v56, v57
    s_waitcnt lgkmcnt(10)
    v_mfma_f32_16x16x32_bf16 v[100:103], a[8:11], v[164:167], v[100:103]
    ds_read_b64_tr_b16 v[188:189], v18 offset:16384
    ds_read_b64_tr_b16 v[190:191], v18 offset:17408
    v_cvt_pk_bf16_f32 v201, v58, v59
    v_mfma_f32_16x16x32_bf16 v[104:107], a[72:75], v[164:167], v[104:107]
    v_cvt_pk_bf16_f32 v202, v64, v65
    s_waitcnt lgkmcnt(10)
    v_mfma_f32_16x16x32_bf16 v[108:111], a[8:11], v[168:171], v[108:111]
    ds_read_b64_tr_b16 v[192:193], v19 offset:16384
    ds_read_b64_tr_b16 v[194:195], v19 offset:17408
    v_cvt_pk_bf16_f32 v203, v66, v67
    v_mfma_f32_16x16x32_bf16 v[112:115], a[72:75], v[168:171], v[112:115]
    buffer_store_dwordx4 v[200:203], v3, s[4:7], s37 offen offset:1024 sc1
    s_waitcnt lgkmcnt(10)
    v_mfma_f32_16x16x32_bf16 v[116:119], a[8:11], v[172:175], v[116:119]
    ds_read_b64_tr_b16 v[164:165], v12 offset:24576
    ds_read_b64_tr_b16 v[166:167], v12 offset:25600
    v_cvt_pk_bf16_f32 v204, v72, v73
    v_mfma_f32_16x16x32_bf16 v[120:123], a[72:75], v[172:175], v[120:123]
    v_cvt_pk_bf16_f32 v205, v74, v75
    s_waitcnt lgkmcnt(10)
    v_mfma_f32_16x16x32_bf16 v[124:127], a[8:11], v[176:179], v[124:127]
    ds_read_b64_tr_b16 v[168:169], v13 offset:24576
    ds_read_b64_tr_b16 v[170:171], v13 offset:25600
    v_cvt_pk_bf16_f32 v206, v80, v81
    v_mfma_f32_16x16x32_bf16 v[128:131], a[72:75], v[176:179], v[128:131]
    v_cvt_pk_bf16_f32 v207, v82, v83
    s_waitcnt lgkmcnt(10)
    v_mfma_f32_16x16x32_bf16 v[132:135], a[8:11], v[180:183], v[132:135]
    ds_read_b64_tr_b16 v[172:173], v14 offset:24576
    ds_read_b64_tr_b16 v[174:175], v14 offset:25600
    buffer_store_dwordx4 v[204:207], v3, s[4:7], s37 offen offset:2048 sc1
    v_mfma_f32_16x16x32_bf16 v[136:139], a[72:75], v[180:183], v[136:139]
    v_cvt_pk_bf16_f32 v208, v88, v89
    s_waitcnt lgkmcnt(10)
    v_mfma_f32_16x16x32_bf16 v[140:143], a[8:11], v[184:187], v[140:143]
    ds_read_b64_tr_b16 v[176:177], v15 offset:24576
    ds_read_b64_tr_b16 v[178:179], v15 offset:25600
    v_cvt_pk_bf16_f32 v209, v90, v91
    v_mfma_f32_16x16x32_bf16 v[144:147], a[72:75], v[184:187], v[144:147]
    v_cvt_pk_bf16_f32 v210, v96, v97
    s_waitcnt lgkmcnt(10)
    v_mfma_f32_16x16x32_bf16 v[148:151], a[8:11], v[188:191], v[148:151]
    ds_read_b64_tr_b16 v[180:181], v16 offset:24576
    ds_read_b64_tr_b16 v[182:183], v16 offset:25600
    v_cvt_pk_bf16_f32 v211, v98, v99
    v_mfma_f32_16x16x32_bf16 v[152:155], a[72:75], v[188:191], v[152:155]
    buffer_store_dwordx4 v[208:211], v3, s[4:7], s37 offen offset:3072 sc1
    s_waitcnt lgkmcnt(10)
    v_mfma_f32_16x16x32_bf16 v[156:159], a[8:11], v[192:195], v[156:159]
    ds_read_b64_tr_b16 v[184:185], v17 offset:24576
    ds_read_b64_tr_b16 v[186:187], v17 offset:25600
    v_mfma_f32_16x16x32_bf16 v[160:163], a[72:75], v[192:195], v[160:163]
    s_waitcnt lgkmcnt(10)
    v_mfma_f32_16x16x32_bf16 v[100:103], a[12:15], v[164:167], v[100:103]
    ds_read_b64_tr_b16 v[188:189], v18 offset:24576
    ds_read_b64_tr_b16 v[190:191], v18 offset:25600
    v_mfma_f32_16x16x32_bf16 v[104:107], a[76:79], v[164:167], v[104:107]
    s_waitcnt lgkmcnt(10)
    v_mfma_f32_16x16x32_bf16 v[108:111], a[12:15], v[168:171], v[108:111]
    ds_read_b64_tr_b16 v[192:193], v19 offset:24576
    ds_read_b64_tr_b16 v[194:195], v19 offset:25600
    v_mfma_f32_16x16x32_bf16 v[112:115], a[76:79], v[168:171], v[112:115]
    s_waitcnt lgkmcnt(10)
    v_mfma_f32_16x16x32_bf16 v[116:119], a[12:15], v[172:175], v[116:119]
    s_waitcnt vmcnt(16)
    s_barrier
    s_add_u32 s31, s28, 3145728
    s_add_u32 m0, s30, 98304
    s_nop 0
    buffer_load_dwordx4 v8, s[40:43], s31 offen lds
    s_add_u32 m0, m0, 1024
    s_nop 0
    buffer_load_dwordx4 v9, s[40:43], s31 offen lds
    s_add_u32 m0, m0, 1024
    s_nop 0
    buffer_load_dwordx4 v10, s[40:43], s31 offen lds
    s_add_u32 m0, m0, 1024
    s_nop 0
    buffer_load_dwordx4 v11, s[40:43], s31 offen lds
    s_add_u32 m0, m0, 1024
    s_add_u32 s31, s31, 131072
    buffer_load_dwordx4 v8, s[40:43], s31 offen lds
    s_add_u32 m0, m0, 1024
    s_nop 0
    buffer_load_dwordx4 v9, s[40:43], s31 offen lds
    s_add_u32 m0, m0, 1024
    s_nop 0
    buffer_load_dwordx4 v10, s[40:43], s31 offen lds
    s_add_u32 m0, m0, 1024
    s_nop 0
    buffer_load_dwordx4 v11, s[40:43], s31 offen lds
    ds_read_b64_tr_b16 v[164:165], v12 offset:32768
    ds_read_b64_tr_b16 v[166:167], v12 offset:33792
    v_mfma_f32_16x16x32_bf16 v[120:123], a[76:79], v[172:175], v[120:123]
    s_waitcnt lgkmcnt(10)
    v_mfma_f32_16x16x32_bf16 v[124:127], a[12:15], v[176:179], v[124:127]
    ds_read_b64_tr_b16 v[168:169], v13 offset:32768
    ds_read_b64_tr_b16 v[170:171], v13 offset:33792
    v_mfma_f32_16x16x32_bf16 v[128:131], a[76:79], v[176:179], v[128:131]
    s_waitcnt lgkmcnt(10)
    v_mfma_f32_16x16x32_bf16 v[132:135], a[12:15], v[180:183], v[132:135]
    ds_read_b64_tr_b16 v[172:173], v14 offset:32768
    ds_read_b64_tr_b16 v[174:175], v14 offset:33792
    v_mfma_f32_16x16x32_bf16 v[136:139], a[76:79], v[180:183], v[136:139]
    s_waitcnt lgkmcnt(10)
    v_mfma_f32_16x16x32_bf16 v[140:143], a[12:15], v[184:187], v[140:143]
    ds_read_b64_tr_b16 v[176:177], v15 offset:32768
    ds_read_b64_tr_b16 v[178:179], v15 offset:33792
    v_mfma_f32_16x16x32_bf16 v[144:147], a[76:79], v[184:187], v[144:147]
    s_waitcnt lgkmcnt(10)
    v_mfma_f32_16x16x32_bf16 v[148:151], a[12:15], v[188:191], v[148:151]
    ds_read_b64_tr_b16 v[180:181], v16 offset:32768
    ds_read_b64_tr_b16 v[182:183], v16 offset:33792
    v_mfma_f32_16x16x32_bf16 v[152:155], a[76:79], v[188:191], v[152:155]
    s_waitcnt lgkmcnt(10)
    v_mfma_f32_16x16x32_bf16 v[156:159], a[12:15], v[192:195], v[156:159]
    ds_read_b64_tr_b16 v[184:185], v17 offset:32768
    ds_read_b64_tr_b16 v[186:187], v17 offset:33792
    v_mfma_f32_16x16x32_bf16 v[160:163], a[76:79], v[192:195], v[160:163]
    s_waitcnt lgkmcnt(10)
    v_mfma_f32_16x16x32_bf16 v[100:103], a[16:19], v[164:167], v[100:103]
    ds_read_b64_tr_b16 v[188:189], v18 offset:32768
    ds_read_b64_tr_b16 v[190:191], v18 offset:33792
    v_mfma_f32_16x16x32_bf16 v[104:107], a[80:83], v[164:167], v[104:107]
    s_waitcnt lgkmcnt(10)
    v_mfma_f32_16x16x32_bf16 v[108:111], a[16:19], v[168:171], v[108:111]
    ds_read_b64_tr_b16 v[192:193], v19 offset:32768
    ds_read_b64_tr_b16 v[194:195], v19 offset:33792
    v_mfma_f32_16x16x32_bf16 v[112:115], a[80:83], v[168:171], v[112:115]
    s_waitcnt lgkmcnt(10)
    v_mfma_f32_16x16x32_bf16 v[116:119], a[16:19], v[172:175], v[116:119]
    ds_read_b64_tr_b16 v[164:165], v12 offset:40960
    ds_read_b64_tr_b16 v[166:167], v12 offset:41984
    v_mfma_f32_16x16x32_bf16 v[120:123], a[80:83], v[172:175], v[120:123]
    s_waitcnt lgkmcnt(10)
    v_mfma_f32_16x16x32_bf16 v[124:127], a[16:19], v[176:179], v[124:127]
    ds_read_b64_tr_b16 v[168:169], v13 offset:40960
    ds_read_b64_tr_b16 v[170:171], v13 offset:41984
    v_mfma_f32_16x16x32_bf16 v[128:131], a[80:83], v[176:179], v[128:131]
    s_waitcnt lgkmcnt(10)
    v_mfma_f32_16x16x32_bf16 v[132:135], a[16:19], v[180:183], v[132:135]
    ds_read_b64_tr_b16 v[172:173], v14 offset:40960
    ds_read_b64_tr_b16 v[174:175], v14 offset:41984
    v_mfma_f32_16x16x32_bf16 v[136:139], a[80:83], v[180:183], v[136:139]
    s_waitcnt lgkmcnt(10)
    v_mfma_f32_16x16x32_bf16 v[140:143], a[16:19], v[184:187], v[140:143]
    ds_read_b64_tr_b16 v[176:177], v15 offset:40960
    ds_read_b64_tr_b16 v[178:179], v15 offset:41984
    v_mfma_f32_16x16x32_bf16 v[144:147], a[80:83], v[184:187], v[144:147]
    s_waitcnt lgkmcnt(10)
    v_mfma_f32_16x16x32_bf16 v[148:151], a[16:19], v[188:191], v[148:151]
    ds_read_b64_tr_b16 v[180:181], v16 offset:40960
    ds_read_b64_tr_b16 v[182:183], v16 offset:41984
    v_mfma_f32_16x16x32_bf16 v[152:155], a[80:83], v[188:191], v[152:155]
    s_waitcnt lgkmcnt(10)
    v_mfma_f32_16x16x32_bf16 v[156:159], a[16:19], v[192:195], v[156:159]
    ds_read_b64_tr_b16 v[184:185], v17 offset:40960
    ds_read_b64_tr_b16 v[186:187], v17 offset:41984
    v_mfma_f32_16x16x32_bf16 v[160:163], a[80:83], v[192:195], v[160:163]
    s_waitcnt lgkmcnt(10)
    v_mfma_f32_16x16x32_bf16 v[100:103], a[20:23], v[164:167], v[100:103]
    ds_read_b64_tr_b16 v[188:189], v18 offset:40960
    ds_read_b64_tr_b16 v[190:191], v18 offset:41984
    v_mfma_f32_16x16x32_bf16 v[104:107], a[84:87], v[164:167], v[104:107]
    s_waitcnt lgkmcnt(10)
    v_mfma_f32_16x16x32_bf16 v[108:111], a[20:23], v[168:171], v[108:111]
    ds_read_b64_tr_b16 v[192:193], v19 offset:40960
    ds_read_b64_tr_b16 v[194:195], v19 offset:41984
    v_mfma_f32_16x16x32_bf16 v[112:115], a[84:87], v[168:171], v[112:115]
    s_waitcnt lgkmcnt(10)
    v_mfma_f32_16x16x32_bf16 v[116:119], a[20:23], v[172:175], v[116:119]
    ds_read_b64_tr_b16 v[164:165], v12 offset:49152
    ds_read_b64_tr_b16 v[166:167], v12 offset:50176
    v_mfma_f32_16x16x32_bf16 v[120:123], a[84:87], v[172:175], v[120:123]
    s_waitcnt lgkmcnt(10)
    v_mfma_f32_16x16x32_bf16 v[124:127], a[20:23], v[176:179], v[124:127]
    ds_read_b64_tr_b16 v[168:169], v13 offset:49152
    ds_read_b64_tr_b16 v[170:171], v13 offset:50176
    v_mfma_f32_16x16x32_bf16 v[128:131], a[84:87], v[176:179], v[128:131]
    s_waitcnt lgkmcnt(10)
    v_mfma_f32_16x16x32_bf16 v[132:135], a[20:23], v[180:183], v[132:135]
    ds_read_b64_tr_b16 v[172:173], v14 offset:49152
    ds_read_b64_tr_b16 v[174:175], v14 offset:50176
    v_mfma_f32_16x16x32_bf16 v[136:139], a[84:87], v[180:183], v[136:139]
    s_waitcnt lgkmcnt(10)
    v_mfma_f32_16x16x32_bf16 v[140:143], a[20:23], v[184:187], v[140:143]
    ds_read_b64_tr_b16 v[176:177], v15 offset:49152
    ds_read_b64_tr_b16 v[178:179], v15 offset:50176
    v_mfma_f32_16x16x32_bf16 v[144:147], a[84:87], v[184:187], v[144:147]
    s_waitcnt lgkmcnt(10)
    v_mfma_f32_16x16x32_bf16 v[148:151], a[20:23], v[188:191], v[148:151]
    ds_read_b64_tr_b16 v[180:181], v16 offset:49152
    ds_read_b64_tr_b16 v[182:183], v16 offset:50176
    v_mfma_f32_16x16x32_bf16 v[152:155], a[84:87], v[188:191], v[152:155]
    s_waitcnt lgkmcnt(10)
    v_mfma_f32_16x16x32_bf16 v[156:159], a[20:23], v[192:195], v[156:159]
    ds_read_b64_tr_b16 v[184:185], v17 offset:49152
    ds_read_b64_tr_b16 v[186:187], v17 offset:50176
    v_mfma_f32_16x16x32_bf16 v[160:163], a[84:87], v[192:195], v[160:163]
    s_waitcnt lgkmcnt(10)
    v_mfma_f32_16x16x32_bf16 v[100:103], a[24:27], v[164:167], v[100:103]
    ds_read_b64_tr_b16 v[188:189], v18 offset:49152
    ds_read_b64_tr_b16 v[190:191], v18 offset:50176
    v_mfma_f32_16x16x32_bf16 v[104:107], a[88:91], v[164:167], v[104:107]
    s_waitcnt lgkmcnt(10)
    v_mfma_f32_16x16x32_bf16 v[108:111], a[24:27], v[168:171], v[108:111]
    ds_read_b64_tr_b16 v[192:193], v19 offset:49152
    ds_read_b64_tr_b16 v[194:195], v19 offset:50176
    v_mfma_f32_16x16x32_bf16 v[112:115], a[88:91], v[168:171], v[112:115]
    s_waitcnt lgkmcnt(10)
    v_mfma_f32_16x16x32_bf16 v[116:119], a[24:27], v[172:175], v[116:119]
    ds_read_b64_tr_b16 v[164:165], v12 offset:57344
    ds_read_b64_tr_b16 v[166:167], v12 offset:58368
    v_mfma_f32_16x16x32_bf16 v[120:123], a[88:91], v[172:175], v[120:123]
    s_waitcnt lgkmcnt(10)
    v_mfma_f32_16x16x32_bf16 v[124:127], a[24:27], v[176:179], v[124:127]
    ds_read_b64_tr_b16 v[168:169], v13 offset:57344
    ds_read_b64_tr_b16 v[170:171], v13 offset:58368
    v_mfma_f32_16x16x32_bf16 v[128:131], a[88:91], v[176:179], v[128:131]
    s_waitcnt lgkmcnt(10)
    v_mfma_f32_16x16x32_bf16 v[132:135], a[24:27], v[180:183], v[132:135]
    ds_read_b64_tr_b16 v[172:173], v14 offset:57344
    ds_read_b64_tr_b16 v[174:175], v14 offset:58368
    v_mfma_f32_16x16x32_bf16 v[136:139], a[88:91], v[180:183], v[136:139]
    s_waitcnt lgkmcnt(10)
    v_mfma_f32_16x16x32_bf16 v[140:143], a[24:27], v[184:187], v[140:143]
    ds_read_b64_tr_b16 v[176:177], v15 offset:57344
    ds_read_b64_tr_b16 v[178:179], v15 offset:58368
    v_mfma_f32_16x16x32_bf16 v[144:147], a[88:91], v[184:187], v[144:147]
    s_waitcnt lgkmcnt(10)
    v_mfma_f32_16x16x32_bf16 v[148:151], a[24:27], v[188:191], v[148:151]
    ds_read_b64_tr_b16 v[180:181], v16 offset:57344
    ds_read_b64_tr_b16 v[182:183], v16 offset:58368
    v_mfma_f32_16x16x32_bf16 v[152:155], a[88:91], v[188:191], v[152:155]
    s_waitcnt lgkmcnt(10)
    v_mfma_f32_16x16x32_bf16 v[156:159], a[24:27], v[192:195], v[156:159]
    ds_read_b64_tr_b16 v[184:185], v17 offset:57344
    ds_read_b64_tr_b16 v[186:187], v17 offset:58368
    v_mfma_f32_16x16x32_bf16 v[160:163], a[88:91], v[192:195], v[160:163]
    s_waitcnt lgkmcnt(10)
    v_mfma_f32_16x16x32_bf16 v[100:103], a[28:31], v[164:167], v[100:103]
    ds_read_b64_tr_b16 v[188:189], v18 offset:57344
    ds_read_b64_tr_b16 v[190:191], v18 offset:58368
    v_mfma_f32_16x16x32_bf16 v[104:107], a[92:95], v[164:167], v[104:107]
    s_waitcnt lgkmcnt(10)
    v_mfma_f32_16x16x32_bf16 v[108:111], a[28:31], v[168:171], v[108:111]
    ds_read_b64_tr_b16 v[192:193], v19 offset:57344
    ds_read_b64_tr_b16 v[194:195], v19 offset:58368
    v_mfma_f32_16x16x32_bf16 v[112:115], a[92:95], v[168:171], v[112:115]
    s_waitcnt lgkmcnt(10)
    v_mfma_f32_16x16x32_bf16 v[116:119], a[28:31], v[172:175], v[116:119]
    s_waitcnt vmcnt(16)
    s_barrier
    s_add_u32 s31, s28, 0
    s_add_u32 m0, s30, 0
    s_nop 0
    buffer_load_dwordx4 v8, s[44:47], s31 offen lds
    s_add_u32 m0, m0, 1024
    s_nop 0
    buffer_load_dwordx4 v9, s[44:47], s31 offen lds
    s_add_u32 m0, m0, 1024
    s_nop 0
    buffer_load_dwordx4 v10, s[44:47], s31 offen lds
    s_add_u32 m0, m0, 1024
    s_nop 0
    buffer_load_dwordx4 v11, s[44:47], s31 offen lds
    s_add_u32 m0, m0, 1024
    s_add_u32 s31, s31, 131072
    buffer_load_dwordx4 v8, s[44:47], s31 offen lds
    s_add_u32 m0, m0, 1024
    s_nop 0
    buffer_load_dwordx4 v9, s[44:47], s31 offen lds
    s_add_u32 m0, m0, 1024
    s_nop 0
    buffer_load_dwordx4 v10, s[44:47], s31 offen lds
    s_add_u32 m0, m0, 1024
    s_nop 0
    buffer_load_dwordx4 v11, s[44:47], s31 offen lds
    ds_read_b64_tr_b16 v[164:165], v24 offset:0
    ds_read_b64_tr_b16 v[166:167], v24 offset:1024
    v_mfma_f32_16x16x32_bf16 v[120:123], a[92:95], v[172:175], v[120:123]
    s_waitcnt lgkmcnt(10)
    v_mfma_f32_16x16x32_bf16 v[124:127], a[28:31], v[176:179], v[124:127]
    ds_read_b64_tr_b16 v[168:169], v25 offset:0
    ds_read_b64_tr_b16 v[170:171], v25 offset:1024
    v_mfma_f32_16x16x32_bf16 v[128:131], a[92:95], v[176:179], v[128:131]
    s_waitcnt lgkmcnt(10)
    v_mfma_f32_16x16x32_bf16 v[132:135], a[28:31], v[180:183], v[132:135]
    ds_read_b64_tr_b16 v[172:173], v26 offset:0
    ds_read_b64_tr_b16 v[174:175], v26 offset:1024
    v_mfma_f32_16x16x32_bf16 v[136:139], a[92:95], v[180:183], v[136:139]
    s_waitcnt lgkmcnt(10)
    v_mfma_f32_16x16x32_bf16 v[140:143], a[28:31], v[184:187], v[140:143]
    ds_read_b64_tr_b16 v[176:177], v27 offset:0
    ds_read_b64_tr_b16 v[178:179], v27 offset:1024
    v_mfma_f32_16x16x32_bf16 v[144:147], a[92:95], v[184:187], v[144:147]
    s_waitcnt lgkmcnt(10)
    v_mfma_f32_16x16x32_bf16 v[148:151], a[28:31], v[188:191], v[148:151]
    ds_read_b64_tr_b16 v[180:181], v28 offset:0
    ds_read_b64_tr_b16 v[182:183], v28 offset:1024
    v_mfma_f32_16x16x32_bf16 v[152:155], a[92:95], v[188:191], v[152:155]
    s_waitcnt lgkmcnt(10)
    v_mfma_f32_16x16x32_bf16 v[156:159], a[28:31], v[192:195], v[156:159]
    ds_read_b64_tr_b16 v[184:185], v29 offset:0
    ds_read_b64_tr_b16 v[186:187], v29 offset:1024
    v_mfma_f32_16x16x32_bf16 v[160:163], a[92:95], v[192:195], v[160:163]
    s_waitcnt lgkmcnt(10)
    v_mfma_f32_16x16x32_bf16 v[100:103], a[32:35], v[164:167], v[100:103]
    ds_read_b64_tr_b16 v[188:189], v30 offset:0
    ds_read_b64_tr_b16 v[190:191], v30 offset:1024
    v_mfma_f32_16x16x32_bf16 v[104:107], a[96:99], v[164:167], v[104:107]
    s_waitcnt lgkmcnt(10)
    v_mfma_f32_16x16x32_bf16 v[108:111], a[32:35], v[168:171], v[108:111]
    ds_read_b64_tr_b16 v[192:193], v31 offset:0
    ds_read_b64_tr_b16 v[194:195], v31 offset:1024
    v_mfma_f32_16x16x32_bf16 v[112:115], a[96:99], v[168:171], v[112:115]
    s_waitcnt lgkmcnt(10)
    v_mfma_f32_16x16x32_bf16 v[116:119], a[32:35], v[172:175], v[116:119]
    ds_read_b64_tr_b16 v[164:165], v24 offset:8192
    ds_read_b64_tr_b16 v[166:167], v24 offset:9216
    v_mfma_f32_16x16x32_bf16 v[120:123], a[96:99], v[172:175], v[120:123]
    s_waitcnt lgkmcnt(10)
    v_mfma_f32_16x16x32_bf16 v[124:127], a[32:35], v[176:179], v[124:127]
    ds_read_b64_tr_b16 v[168:169], v25 offset:8192
    ds_read_b64_tr_b16 v[170:171], v25 offset:9216
    v_mfma_f32_16x16x32_bf16 v[128:131], a[96:99], v[176:179], v[128:131]
    s_waitcnt lgkmcnt(10)
    v_mfma_f32_16x16x32_bf16 v[132:135], a[32:35], v[180:183], v[132:135]
    ds_read_b64_tr_b16 v[172:173], v26 offset:8192
    ds_read_b64_tr_b16 v[174:175], v26 offset:9216
    v_mfma_f32_16x16x32_bf16 v[136:139], a[96:99], v[180:183], v[136:139]
    s_waitcnt lgkmcnt(10)
    v_mfma_f32_16x16x32_bf16 v[140:143], a[32:35], v[184:187], v[140:143]
    ds_read_b64_tr_b16 v[176:177], v27 offset:8192
    ds_read_b64_tr_b16 v[178:179], v27 offset:9216
    v_mfma_f32_16x16x32_bf16 v[144:147], a[96:99], v[184:187], v[144:147]
    s_waitcnt lgkmcnt(10)
    v_mfma_f32_16x16x32_bf16 v[148:151], a[32:35], v[188:191], v[148:151]
    ds_read_b64_tr_b16 v[180:181], v28 offset:8192
    ds_read_b64_tr_b16 v[182:183], v28 offset:9216
    v_mfma_f32_16x16x32_bf16 v[152:155], a[96:99], v[188:191], v[152:155]
    s_waitcnt lgkmcnt(10)
    v_mfma_f32_16x16x32_bf16 v[156:159], a[32:35], v[192:195], v[156:159]
    ds_read_b64_tr_b16 v[184:185], v29 offset:8192
    ds_read_b64_tr_b16 v[186:187], v29 offset:9216
    v_mfma_f32_16x16x32_bf16 v[160:163], a[96:99], v[192:195], v[160:163]
    s_waitcnt lgkmcnt(10)
    v_mfma_f32_16x16x32_bf16 v[100:103], a[36:39], v[164:167], v[100:103]
    ds_read_b64_tr_b16 v[188:189], v30 offset:8192
    ds_read_b64_tr_b16 v[190:191], v30 offset:9216
    v_mfma_f32_16x16x32_bf16 v[104:107], a[100:103], v[164:167], v[104:107]
    s_waitcnt lgkmcnt(10)
    v_mfma_f32_16x16x32_bf16 v[108:111], a[36:39], v[168:171], v[108:111]
    ds_read_b64_tr_b16 v[192:193], v31 offset:8192
    ds_read_b64_tr_b16 v[194:195], v31 offset:9216
    v_mfma_f32_16x16x32_bf16 v[112:115], a[100:103], v[168:171], v[112:115]
    s_waitcnt lgkmcnt(10)
    v_mfma_f32_16x16x32_bf16 v[116:119], a[36:39], v[172:175], v[116:119]
    ds_read_b64_tr_b16 v[164:165], v24 offset:16384
    ds_read_b64_tr_b16 v[166:167], v24 offset:17408
    v_mfma_f32_16x16x32_bf16 v[120:123], a[100:103], v[172:175], v[120:123]
    s_waitcnt lgkmcnt(10)
    v_mfma_f32_16x16x32_bf16 v[124:127], a[36:39], v[176:179], v[124:127]
    ds_read_b64_tr_b16 v[168:169], v25 offset:16384
    ds_read_b64_tr_b16 v[170:171], v25 offset:17408
    v_mfma_f32_16x16x32_bf16 v[128:131], a[100:103], v[176:179], v[128:131]
    s_waitcnt lgkmcnt(10)
    v_mfma_f32_16x16x32_bf16 v[132:135], a[36:39], v[180:183], v[132:135]
    ds_read_b64_tr_b16 v[172:173], v26 offset:16384
    ds_read_b64_tr_b16 v[174:175], v26 offset:17408
    v_mfma_f32_16x16x32_bf16 v[136:139], a[100:103], v[180:183], v[136:139]
    s_waitcnt lgkmcnt(10)
    v_mfma_f32_16x16x32_bf16 v[140:143], a[36:39], v[184:187], v[140:143]
    ds_read_b64_tr_b16 v[176:177], v27 offset:16384
    ds_read_b64_tr_b16 v[178:179], v27 offset:17408
    v_mfma_f32_16x16x32_bf16 v[144:147], a[100:103], v[184:187], v[144:147]
    s_waitcnt lgkmcnt(10)
    v_mfma_f32_16x16x32_bf16 v[148:151], a[36:39], v[188:191], v[148:151]
    ds_read_b64_tr_b16 v[180:181], v28 offset:16384
    ds_read_b64_tr_b16 v[182:183], v28 offset:17408
    v_mfma_f32_16x16x32_bf16 v[152:155], a[100:103], v[188:191], v[152:155]
    s_waitcnt lgkmcnt(10)
    v_mfma_f32_16x16x32_bf16 v[156:159], a[36:39], v[192:195], v[156:159]
    ds_read_b64_tr_b16 v[184:185], v29 offset:16384
    ds_read_b64_tr_b16 v[186:187], v29 offset:17408
    v_mfma_f32_16x16x32_bf16 v[160:163], a[100:103], v[192:195], v[160:163]
    s_waitcnt lgkmcnt(10)
    v_mfma_f32_16x16x32_bf16 v[100:103], a[40:43], v[164:167], v[100:103]
    ds_read_b64_tr_b16 v[188:189], v30 offset:16384
    ds_read_b64_tr_b16 v[190:191], v30 offset:17408
    v_mfma_f32_16x16x32_bf16 v[104:107], a[104:107], v[164:167], v[104:107]
    s_waitcnt lgkmcnt(10)
    v_mfma_f32_16x16x32_bf16 v[108:111], a[40:43], v[168:171], v[108:111]
    ds_read_b64_tr_b16 v[192:193], v31 offset:16384
    ds_read_b64_tr_b16 v[194:195], v31 offset:17408
    v_mfma_f32_16x16x32_bf16 v[112:115], a[104:107], v[168:171], v[112:115]
    s_waitcnt lgkmcnt(10)
    v_mfma_f32_16x16x32_bf16 v[116:119], a[40:43], v[172:175], v[116:119]
    ds_read_b64_tr_b16 v[164:165], v24 offset:24576
    ds_read_b64_tr_b16 v[166:167], v24 offset:25600
    v_mfma_f32_16x16x32_bf16 v[120:123], a[104:107], v[172:175], v[120:123]
    s_waitcnt lgkmcnt(10)
    v_mfma_f32_16x16x32_bf16 v[124:127], a[40:43], v[176:179], v[124:127]
    ds_read_b64_tr_b16 v[168:169], v25 offset:24576
    ds_read_b64_tr_b16 v[170:171], v25 offset:25600
    v_mfma_f32_16x16x32_bf16 v[128:131], a[104:107], v[176:179], v[128:131]
    s_waitcnt lgkmcnt(10)
    v_mfma_f32_16x16x32_bf16 v[132:135], a[40:43], v[180:183], v[132:135]
    ds_read_b64_tr_b16 v[172:173], v26 offset:24576
    ds_read_b64_tr_b16 v[174:175], v26 offset:25600
    v_mfma_f32_16x16x32_bf16 v[136:139], a[104:107], v[180:183], v[136:139]
    s_waitcnt lgkmcnt(10)
    v_mfma_f32_16x16x32_bf16 v[140:143], a[40:43], v[184:187], v[140:143]
    ds_read_b64_tr_b16 v[176:177], v27 offset:24576
    ds_read_b64_tr_b16 v[178:179], v27 offset:25600
    v_mfma_f32_16x16x32_bf16 v[144:147], a[104:107], v[184:187], v[144:147]
    s_waitcnt lgkmcnt(10)
    v_mfma_f32_16x16x32_bf16 v[148:151], a[40:43], v[188:191], v[148:151]
    ds_read_b64_tr_b16 v[180:181], v28 offset:24576
    ds_read_b64_tr_b16 v[182:183], v28 offset:25600
    v_mfma_f32_16x16x32_bf16 v[152:155], a[104:107], v[188:191], v[152:155]
    s_waitcnt lgkmcnt(10)
    v_mfma_f32_16x16x32_bf16 v[156:159], a[40:43], v[192:195], v[156:159]
    ds_read_b64_tr_b16 v[184:185], v29 offset:24576
    ds_read_b64_tr_b16 v[186:187], v29 offset:25600
    v_mfma_f32_16x16x32_bf16 v[160:163], a[104:107], v[192:195], v[160:163]
    s_waitcnt lgkmcnt(10)
    v_mfma_f32_16x16x32_bf16 v[100:103], a[44:47], v[164:167], v[100:103]
    ds_read_b64_tr_b16 v[188:189], v30 offset:24576
    ds_read_b64_tr_b16 v[190:191], v30 offset:25600
    v_mfma_f32_16x16x32_bf16 v[104:107], a[108:111], v[164:167], v[104:107]
    s_waitcnt lgkmcnt(10)
    v_mfma_f32_16x16x32_bf16 v[108:111], a[44:47], v[168:171], v[108:111]
    ds_read_b64_tr_b16 v[192:193], v31 offset:24576
    ds_read_b64_tr_b16 v[194:195], v31 offset:25600
    v_mfma_f32_16x16x32_bf16 v[112:115], a[108:111], v[168:171], v[112:115]
    s_waitcnt lgkmcnt(10)
    v_mfma_f32_16x16x32_bf16 v[116:119], a[44:47], v[172:175], v[116:119]
    s_waitcnt vmcnt(8)
    s_barrier
    s_add_u32 s31, s28, 1048576
    s_add_u32 m0, s30, 32768
    s_nop 0
    buffer_load_dwordx4 v8, s[44:47], s31 offen lds
    s_add_u32 m0, m0, 1024
    s_nop 0
    buffer_load_dwordx4 v9, s[44:47], s31 offen lds
    s_add_u32 m0, m0, 1024
    s_nop 0
    buffer_load_dwordx4 v10, s[44:47], s31 offen lds
    s_add_u32 m0, m0, 1024
    s_nop 0
    buffer_load_dwordx4 v11, s[44:47], s31 offen lds
    s_add_u32 m0, m0, 1024
    s_add_u32 s31, s31, 131072
    buffer_load_dwordx4 v8, s[44:47], s31 offen lds
    s_add_u32 m0, m0, 1024
    s_nop 0
    buffer_load_dwordx4 v9, s[44:47], s31 offen lds
    s_add_u32 m0, m0, 1024
    s_nop 0
    buffer_load_dwordx4 v10, s[44:47], s31 offen lds
    s_add_u32 m0, m0, 1024
    s_nop 0
    buffer_load_dwordx4 v11, s[44:47], s31 offen lds
    ds_read_b64_tr_b16 v[164:165], v24 offset:32768
    ds_read_b64_tr_b16 v[166:167], v24 offset:33792
    v_mfma_f32_16x16x32_bf16 v[120:123], a[108:111], v[172:175], v[120:123]
    s_waitcnt lgkmcnt(10)
    v_mfma_f32_16x16x32_bf16 v[124:127], a[44:47], v[176:179], v[124:127]
    ds_read_b64_tr_b16 v[168:169], v25 offset:32768
    ds_read_b64_tr_b16 v[170:171], v25 offset:33792
    v_mfma_f32_16x16x32_bf16 v[128:131], a[108:111], v[176:179], v[128:131]
    s_waitcnt lgkmcnt(10)
    v_mfma_f32_16x16x32_bf16 v[132:135], a[44:47], v[180:183], v[132:135]
    ds_read_b64_tr_b16 v[172:173], v26 offset:32768
    ds_read_b64_tr_b16 v[174:175], v26 offset:33792
    v_mfma_f32_16x16x32_bf16 v[136:139], a[108:111], v[180:183], v[136:139]
    s_waitcnt lgkmcnt(10)
    v_mfma_f32_16x16x32_bf16 v[140:143], a[44:47], v[184:187], v[140:143]
    ds_read_b64_tr_b16 v[176:177], v27 offset:32768
    ds_read_b64_tr_b16 v[178:179], v27 offset:33792
    v_mfma_f32_16x16x32_bf16 v[144:147], a[108:111], v[184:187], v[144:147]
    s_waitcnt lgkmcnt(10)
    v_mfma_f32_16x16x32_bf16 v[148:151], a[44:47], v[188:191], v[148:151]
    ds_read_b64_tr_b16 v[180:181], v28 offset:32768
    ds_read_b64_tr_b16 v[182:183], v28 offset:33792
    v_mfma_f32_16x16x32_bf16 v[152:155], a[108:111], v[188:191], v[152:155]
    s_waitcnt lgkmcnt(10)
    v_mfma_f32_16x16x32_bf16 v[156:159], a[44:47], v[192:195], v[156:159]
    ds_read_b64_tr_b16 v[184:185], v29 offset:32768
    ds_read_b64_tr_b16 v[186:187], v29 offset:33792
    v_mfma_f32_16x16x32_bf16 v[160:163], a[108:111], v[192:195], v[160:163]
    s_waitcnt lgkmcnt(10)
    v_mfma_f32_16x16x32_bf16 v[100:103], a[48:51], v[164:167], v[100:103]
    ds_read_b64_tr_b16 v[188:189], v30 offset:32768
    ds_read_b64_tr_b16 v[190:191], v30 offset:33792
    v_mfma_f32_16x16x32_bf16 v[104:107], a[112:115], v[164:167], v[104:107]
    s_waitcnt lgkmcnt(10)
    v_mfma_f32_16x16x32_bf16 v[108:111], a[48:51], v[168:171], v[108:111]
    ds_read_b64_tr_b16 v[192:193], v31 offset:32768
    ds_read_b64_tr_b16 v[194:195], v31 offset:33792
    v_mfma_f32_16x16x32_bf16 v[112:115], a[112:115], v[168:171], v[112:115]
    s_waitcnt lgkmcnt(10)
    v_mfma_f32_16x16x32_bf16 v[116:119], a[48:51], v[172:175], v[116:119]
    ds_read_b64_tr_b16 v[164:165], v24 offset:40960
    ds_read_b64_tr_b16 v[166:167], v24 offset:41984
    v_mfma_f32_16x16x32_bf16 v[120:123], a[112:115], v[172:175], v[120:123]
    s_waitcnt lgkmcnt(10)
    v_mfma_f32_16x16x32_bf16 v[124:127], a[48:51], v[176:179], v[124:127]
    ds_read_b64_tr_b16 v[168:169], v25 offset:40960
    ds_read_b64_tr_b16 v[170:171], v25 offset:41984
    v_mfma_f32_16x16x32_bf16 v[128:131], a[112:115], v[176:179], v[128:131]
    s_waitcnt lgkmcnt(10)
    v_mfma_f32_16x16x32_bf16 v[132:135], a[48:51], v[180:183], v[132:135]
    ds_read_b64_tr_b16 v[172:173], v26 offset:40960
    ds_read_b64_tr_b16 v[174:175], v26 offset:41984
    v_mfma_f32_16x16x32_bf16 v[136:139], a[112:115], v[180:183], v[136:139]
    s_waitcnt lgkmcnt(10)
    v_mfma_f32_16x16x32_bf16 v[140:143], a[48:51], v[184:187], v[140:143]
    ds_read_b64_tr_b16 v[176:177], v27 offset:40960
    ds_read_b64_tr_b16 v[178:179], v27 offset:41984
    v_mfma_f32_16x16x32_bf16 v[144:147], a[112:115], v[184:187], v[144:147]
    s_waitcnt lgkmcnt(10)
    v_mfma_f32_16x16x32_bf16 v[148:151], a[48:51], v[188:191], v[148:151]
    ds_read_b64_tr_b16 v[180:181], v28 offset:40960
    ds_read_b64_tr_b16 v[182:183], v28 offset:41984
    v_mfma_f32_16x16x32_bf16 v[152:155], a[112:115], v[188:191], v[152:155]
    s_waitcnt lgkmcnt(10)
    v_mfma_f32_16x16x32_bf16 v[156:159], a[48:51], v[192:195], v[156:159]
    ds_read_b64_tr_b16 v[184:185], v29 offset:40960
    ds_read_b64_tr_b16 v[186:187], v29 offset:41984
    v_mfma_f32_16x16x32_bf16 v[160:163], a[112:115], v[192:195], v[160:163]
    s_waitcnt lgkmcnt(10)
    v_mfma_f32_16x16x32_bf16 v[100:103], a[52:55], v[164:167], v[100:103]
    ds_read_b64_tr_b16 v[188:189], v30 offset:40960
    ds_read_b64_tr_b16 v[190:191], v30 offset:41984
    v_mfma_f32_16x16x32_bf16 v[104:107], a[116:119], v[164:167], v[104:107]
    s_waitcnt lgkmcnt(10)
    v_mfma_f32_16x16x32_bf16 v[108:111], a[52:55], v[168:171], v[108:111]
    ds_read_b64_tr_b16 v[192:193], v31 offset:40960
    ds_read_b64_tr_b16 v[194:195], v31 offset:41984
    v_mfma_f32_16x16x32_bf16 v[112:115], a[116:119], v[168:171], v[112:115]
    s_waitcnt lgkmcnt(10)
    v_mfma_f32_16x16x32_bf16 v[116:119], a[52:55], v[172:175], v[116:119]
    ds_read_b64_tr_b16 v[164:165], v24 offset:49152
    ds_read_b64_tr_b16 v[166:167], v24 offset:50176
    v_mfma_f32_16x16x32_bf16 v[120:123], a[116:119], v[172:175], v[120:123]
    s_waitcnt lgkmcnt(10)
    v_mfma_f32_16x16x32_bf16 v[124:127], a[52:55], v[176:179], v[124:127]
    ds_read_b64_tr_b16 v[168:169], v25 offset:49152
    ds_read_b64_tr_b16 v[170:171], v25 offset:50176
    v_mfma_f32_16x16x32_bf16 v[128:131], a[116:119], v[176:179], v[128:131]
    s_waitcnt lgkmcnt(10)
    v_mfma_f32_16x16x32_bf16 v[132:135], a[52:55], v[180:183], v[132:135]
    ds_read_b64_tr_b16 v[172:173], v26 offset:49152
    ds_read_b64_tr_b16 v[174:175], v26 offset:50176
    v_mfma_f32_16x16x32_bf16 v[136:139], a[116:119], v[180:183], v[136:139]
    s_waitcnt lgkmcnt(10)
    v_mfma_f32_16x16x32_bf16 v[140:143], a[52:55], v[184:187], v[140:143]
    ds_read_b64_tr_b16 v[176:177], v27 offset:49152
    ds_read_b64_tr_b16 v[178:179], v27 offset:50176
    v_mfma_f32_16x16x32_bf16 v[144:147], a[116:119], v[184:187], v[144:147]
    s_waitcnt lgkmcnt(10)
    v_mfma_f32_16x16x32_bf16 v[148:151], a[52:55], v[188:191], v[148:151]
    ds_read_b64_tr_b16 v[180:181], v28 offset:49152
    ds_read_b64_tr_b16 v[182:183], v28 offset:50176
    v_mfma_f32_16x16x32_bf16 v[152:155], a[116:119], v[188:191], v[152:155]
    s_waitcnt lgkmcnt(10)
    v_mfma_f32_16x16x32_bf16 v[156:159], a[52:55], v[192:195], v[156:159]
    ds_read_b64_tr_b16 v[184:185], v29 offset:49152
    ds_read_b64_tr_b16 v[186:187], v29 offset:50176
    v_mfma_f32_16x16x32_bf16 v[160:163], a[116:119], v[192:195], v[160:163]
    s_waitcnt lgkmcnt(10)
    v_mfma_f32_16x16x32_bf16 v[100:103], a[56:59], v[164:167], v[100:103]
    ds_read_b64_tr_b16 v[188:189], v30 offset:49152
    ds_read_b64_tr_b16 v[190:191], v30 offset:50176
    v_mfma_f32_16x16x32_bf16 v[104:107], a[120:123], v[164:167], v[104:107]
    s_waitcnt lgkmcnt(10)
    v_mfma_f32_16x16x32_bf16 v[108:111], a[56:59], v[168:171], v[108:111]
    ds_read_b64_tr_b16 v[192:193], v31 offset:49152
    ds_read_b64_tr_b16 v[194:195], v31 offset:50176
    v_mfma_f32_16x16x32_bf16 v[112:115], a[120:123], v[168:171], v[112:115]
    s_waitcnt lgkmcnt(10)
    v_mfma_f32_16x16x32_bf16 v[116:119], a[56:59], v[172:175], v[116:119]
    ds_read_b64_tr_b16 v[164:165], v24 offset:57344
    ds_read_b64_tr_b16 v[166:167], v24 offset:58368
    v_mfma_f32_16x16x32_bf16 v[120:123], a[120:123], v[172:175], v[120:123]
    s_waitcnt lgkmcnt(10)
    v_mfma_f32_16x16x32_bf16 v[124:127], a[56:59], v[176:179], v[124:127]
    ds_read_b64_tr_b16 v[168:169], v25 offset:57344
    ds_read_b64_tr_b16 v[170:171], v25 offset:58368
    v_mfma_f32_16x16x32_bf16 v[128:131], a[120:123], v[176:179], v[128:131]
    s_waitcnt lgkmcnt(10)
    v_mfma_f32_16x16x32_bf16 v[132:135], a[56:59], v[180:183], v[132:135]
    ds_read_b64_tr_b16 v[172:173], v26 offset:57344
    ds_read_b64_tr_b16 v[174:175], v26 offset:58368
    v_mfma_f32_16x16x32_bf16 v[136:139], a[120:123], v[180:183], v[136:139]
    s_waitcnt lgkmcnt(10)
    v_mfma_f32_16x16x32_bf16 v[140:143], a[56:59], v[184:187], v[140:143]
    ds_read_b64_tr_b16 v[176:177], v27 offset:57344
    ds_read_b64_tr_b16 v[178:179], v27 offset:58368
    v_mfma_f32_16x16x32_bf16 v[144:147], a[120:123], v[184:187], v[144:147]
    s_waitcnt lgkmcnt(10)
    v_mfma_f32_16x16x32_bf16 v[148:151], a[56:59], v[188:191], v[148:151]
    ds_read_b64_tr_b16 v[180:181], v28 offset:57344
    ds_read_b64_tr_b16 v[182:183], v28 offset:58368
    v_mfma_f32_16x16x32_bf16 v[152:155], a[120:123], v[188:191], v[152:155]
    s_waitcnt lgkmcnt(10)
    v_mfma_f32_16x16x32_bf16 v[156:159], a[56:59], v[192:195], v[156:159]
    ds_read_b64_tr_b16 v[184:185], v29 offset:57344
    ds_read_b64_tr_b16 v[186:187], v29 offset:58368
    v_mfma_f32_16x16x32_bf16 v[160:163], a[120:123], v[192:195], v[160:163]
    s_waitcnt lgkmcnt(10)
    v_mfma_f32_16x16x32_bf16 v[100:103], a[60:63], v[164:167], v[100:103]
    ds_read_b64_tr_b16 v[188:189], v30 offset:57344
    ds_read_b64_tr_b16 v[190:191], v30 offset:58368
    v_mfma_f32_16x16x32_bf16 v[104:107], a[124:127], v[164:167], v[104:107]
    s_waitcnt lgkmcnt(10)
    v_mfma_f32_16x16x32_bf16 v[108:111], a[60:63], v[168:171], v[108:111]
    ds_read_b64_tr_b16 v[192:193], v31 offset:57344
    ds_read_b64_tr_b16 v[194:195], v31 offset:58368
    v_mfma_f32_16x16x32_bf16 v[112:115], a[124:127], v[168:171], v[112:115]
    s_waitcnt lgkmcnt(10)
    v_mfma_f32_16x16x32_bf16 v[116:119], a[60:63], v[172:175], v[116:119]
    s_waitcnt vmcnt(8)
    s_barrier
    s_add_u32 s31, s28, 2097152
    s_add_u32 m0, s30, 65536
    s_nop 0
    buffer_load_dwordx4 v8, s[44:47], s31 offen lds
    s_add_u32 m0, m0, 1024
    s_nop 0
    buffer_load_dwordx4 v9, s[44:47], s31 offen lds
    s_add_u32 m0, m0, 1024
    s_nop 0
    buffer_load_dwordx4 v10, s[44:47], s31 offen lds
    s_add_u32 m0, m0, 1024
    s_nop 0
    buffer_load_dwordx4 v11, s[44:47], s31 offen lds
    s_add_u32 m0, m0, 1024
    s_add_u32 s31, s31, 131072
    buffer_load_dwordx4 v8, s[44:47], s31 offen lds
    s_add_u32 m0, m0, 1024
    s_nop 0
    buffer_load_dwordx4 v9, s[44:47], s31 offen lds
    s_add_u32 m0, m0, 1024
    s_nop 0
    buffer_load_dwordx4 v10, s[44:47], s31 offen lds
    s_add_u32 m0, m0, 1024
    s_nop 0
    buffer_load_dwordx4 v11, s[44:47], s31 offen lds
    ds_read_b64_tr_b16 v[164:165], v12 offset:0
    ds_read_b64_tr_b16 v[166:167], v12 offset:1024
    v_mfma_f32_16x16x32_bf16 v[120:123], a[124:127], v[172:175], v[120:123]
    s_waitcnt lgkmcnt(10)
    v_mfma_f32_16x16x32_bf16 v[124:127], a[60:63], v[176:179], v[124:127]
    ds_read_b64_tr_b16 v[168:169], v13 offset:0
    ds_read_b64_tr_b16 v[170:171], v13 offset:1024
    v_mfma_f32_16x16x32_bf16 v[128:131], a[124:127], v[176:179], v[128:131]
    s_waitcnt lgkmcnt(10)
    v_mfma_f32_16x16x32_bf16 v[132:135], a[60:63], v[180:183], v[132:135]
    ds_read_b64_tr_b16 v[172:173], v14 offset:0
    ds_read_b64_tr_b16 v[174:175], v14 offset:1024
    v_mfma_f32_16x16x32_bf16 v[136:139], a[124:127], v[180:183], v[136:139]
    s_waitcnt lgkmcnt(10)
    v_mfma_f32_16x16x32_bf16 v[140:143], a[60:63], v[184:187], v[140:143]
    ds_read_b64_tr_b16 v[176:177], v15 offset:0
    ds_read_b64_tr_b16 v[178:179], v15 offset:1024
    v_mfma_f32_16x16x32_bf16 v[144:147], a[124:127], v[184:187], v[144:147]
    s_waitcnt lgkmcnt(10)
    v_mfma_f32_16x16x32_bf16 v[148:151], a[60:63], v[188:191], v[148:151]
    ds_read_b64_tr_b16 v[180:181], v16 offset:0
    ds_read_b64_tr_b16 v[182:183], v16 offset:1024
    v_mfma_f32_16x16x32_bf16 v[152:155], a[124:127], v[188:191], v[152:155]
    s_waitcnt lgkmcnt(10)
    v_mfma_f32_16x16x32_bf16 v[156:159], a[60:63], v[192:195], v[156:159]
    ds_read_b64_tr_b16 v[184:185], v17 offset:0
    ds_read_b64_tr_b16 v[186:187], v17 offset:1024
    v_mfma_f32_16x16x32_bf16 v[160:163], a[124:127], v[192:195], v[160:163]
    s_waitcnt lgkmcnt(10)
    v_mfma_f32_16x16x32_bf16 v[36:39], v[164:167], a[0:3], 0
    ds_read_b64_tr_b16 v[188:189], v18 offset:0
    ds_read_b64_tr_b16 v[190:191], v18 offset:1024
    v_mfma_f32_16x16x32_bf16 v[40:43], v[164:167], a[64:67], 0
    s_waitcnt lgkmcnt(10)
    v_mfma_f32_16x16x32_bf16 v[44:47], v[168:171], a[0:3], 0
    ds_read_b64_tr_b16 v[192:193], v19 offset:0
    ds_read_b64_tr_b16 v[194:195], v19 offset:1024
    v_mfma_f32_16x16x32_bf16 v[48:51], v[168:171], a[64:67], 0
    s_waitcnt lgkmcnt(10)
    v_mfma_f32_16x16x32_bf16 v[52:55], v[172:175], a[0:3], 0
    ds_read_b64_tr_b16 v[164:165], v12 offset:8192
    ds_read_b64_tr_b16 v[166:167], v12 offset:9216
    s_add_u32 s37, s36, 33554432
    v_mfma_f32_16x16x32_bf16 v[56:59], v[172:175], a[64:67], 0
    v_cvt_pk_bf16_f32 v196, v100, v101
    s_waitcnt lgkmcnt(10)
    v_mfma_f32_16x16x32_bf16 v[60:63], v[176:179], a[0:3], 0
    ds_read_b64_tr_b16 v[168:169], v13 offset:8192
    ds_read_b64_tr_b16 v[170:171], v13 offset:9216
    v_cvt_pk_bf16_f32 v197, v102, v103
    v_mfma_f32_16x16x32_bf16 v[64:67], v[176:179], a[64:67], 0
    v_cvt_pk_bf16_f32 v198, v104, v105
    s_waitcnt lgkmcnt(10)
    v_mfma_f32_16x16x32_bf16 v[68:71], v[180:183], a[0:3], 0
    ds_read_b64_tr_b16 v[172:173], v14 offset:8192
    ds_read_b64_tr_b16 v[174:175], v14 offset:9216
    v_cvt_pk_bf16_f32 v199, v106, v107
    v_mfma_f32_16x16x32_bf16 v[72:75], v[180:183], a[64:67], 0
    buffer_store_dwordx4 v[196:199], v32, s[4:7], s37 offen offset:0 sc1
    s_waitcnt lgkmcnt(10)
    v_mfma_f32_16x16x32_bf16 v[76:79], v[184:187], a[0:3], 0
    ds_read_b64_tr_b16 v[176:177], v15 offset:8192
    ds_read_b64_tr_b16 v[178:179], v15 offset:9216
    v_cvt_pk_bf16_f32 v200, v108, v109
    v_mfma_f32_16x16x32_bf16 v[80:83], v[184:187], a[64:67], 0
    v_cvt_pk_bf16_f32 v201, v110, v111
    s_waitcnt lgkmcnt(10)
    v_mfma_f32_16x16x32_bf16 v[84:87], v[188:191], a[0:3], 0
    ds_read_b64_tr_b16 v[180:181], v16 offset:8192
    ds_read_b64_tr_b16 v[182:183], v16 offset:9216
    v_cvt_pk_bf16_f32 v202, v112, v113
    v_mfma_f32_16x16x32_bf16 v[88:91], v[188:191], a[64:67], 0
    v_cvt_pk_bf16_f32 v203, v114, v115
    s_waitcnt lgkmcnt(10)
    v_mfma_f32_16x16x32_bf16 v[92:95], v[192:195], a[0:3], 0
    ds_read_b64_tr_b16 v[184:185], v17 offset:8192
    ds_read_b64_tr_b16 v[186:187], v17 offset:9216
    buffer_store_dwordx4 v[200:203], v32, s[4:7], s37 offen offset:128 sc1
    v_mfma_f32_16x16x32_bf16 v[96:99], v[192:195], a[64:67], 0
    v_cvt_pk_bf16_f32 v204, v116, v117
    s_waitcnt lgkmcnt(10)
    v_mfma_f32_16x16x32_bf16 v[36:39], v[164:167], a[4:7], v[36:39]
    ds_read_b64_tr_b16 v[188:189], v18 offset:8192
    ds_read_b64_tr_b16 v[190:191], v18 offset:9216
    v_cvt_pk_bf16_f32 v205, v118, v119
    v_mfma_f32_16x16x32_bf16 v[40:43], v[164:167], a[68:71], v[40:43]
    v_cvt_pk_bf16_f32 v206, v120, v121
    s_waitcnt lgkmcnt(10)
    v_mfma_f32_16x16x32_bf16 v[44:47], v[168:171], a[4:7], v[44:47]
    ds_read_b64_tr_b16 v[192:193], v19 offset:8192
    ds_read_b64_tr_b16 v[194:195], v19 offset:9216
    v_cvt_pk_bf16_f32 v207, v122, v123
    v_mfma_f32_16x16x32_bf16 v[48:51], v[168:171], a[68:71], v[48:51]
    buffer_store_dwordx4 v[204:207], v32, s[4:7], s37 offen offset:2048 sc1
    s_waitcnt lgkmcnt(10)
    v_mfma_f32_16x16x32_bf16 v[52:55], v[172:175], a[4:7], v[52:55]
    ds_read_b64_tr_b16 v[164:165], v12 offset:16384
    ds_read_b64_tr_b16 v[166:167], v12 offset:17408
    v_cvt_pk_bf16_f32 v208, v124, v125
    v_mfma_f32_16x16x32_bf16 v[56:59], v[172:175], a[68:71], v[56:59]
    v_cvt_pk_bf16_f32 v209, v126, v127
    s_waitcnt lgkmcnt(10)
    v_mfma_f32_16x16x32_bf16 v[60:63], v[176:179], a[4:7], v[60:63]
    ds_read_b64_tr_b16 v[168:169], v13 offset:16384
    ds_read_b64_tr_b16 v[170:171], v13 offset:17408
    v_cvt_pk_bf16_f32 v210, v128, v129
    v_mfma_f32_16x16x32_bf16 v[64:67], v[176:179], a[68:71], v[64:67]
    v_cvt_pk_bf16_f32 v211, v130, v131
    s_waitcnt lgkmcnt(10)
    v_mfma_f32_16x16x32_bf16 v[68:71], v[180:183], a[4:7], v[68:71]
    ds_read_b64_tr_b16 v[172:173], v14 offset:16384
    ds_read_b64_tr_b16 v[174:175], v14 offset:17408
    buffer_store_dwordx4 v[208:211], v32, s[4:7], s37 offen offset:2176 sc1
    v_mfma_f32_16x16x32_bf16 v[72:75], v[180:183], a[68:71], v[72:75]
    v_cvt_pk_bf16_f32 v196, v132, v133
    s_waitcnt lgkmcnt(10)
    v_mfma_f32_16x16x32_bf16 v[76:79], v[184:187], a[4:7], v[76:79]
    ds_read_b64_tr_b16 v[176:177], v15 offset:16384
    ds_read_b64_tr_b16 v[178:179], v15 offset:17408
    v_cvt_pk_bf16_f32 v197, v134, v135
    v_mfma_f32_16x16x32_bf16 v[80:83], v[184:187], a[68:71], v[80:83]
    v_cvt_pk_bf16_f32 v198, v136, v137
    s_waitcnt lgkmcnt(10)
    v_mfma_f32_16x16x32_bf16 v[84:87], v[188:191], a[4:7], v[84:87]
    ds_read_b64_tr_b16 v[180:181], v16 offset:16384
    ds_read_b64_tr_b16 v[182:183], v16 offset:17408
    v_cvt_pk_bf16_f32 v199, v138, v139
    v_mfma_f32_16x16x32_bf16 v[88:91], v[188:191], a[68:71], v[88:91]
    s_add_u32 s37, s37, 4096
    s_waitcnt lgkmcnt(10)
    v_mfma_f32_16x16x32_bf16 v[92:95], v[192:195], a[4:7], v[92:95]
    ds_read_b64_tr_b16 v[184:185], v17 offset:16384
    ds_read_b64_tr_b16 v[186:187], v17 offset:17408
    buffer_store_dwordx4 v[196:199], v32, s[4:7], s37 offen offset:0 sc1
    v_mfma_f32_16x16x32_bf16 v[96:99], v[192:195], a[68:71], v[96:99]
    v_cvt_pk_bf16_f32 v200, v140, v141
    s_waitcnt lgkmcnt(10)
    v_mfma_f32_16x16x32_bf16 v[36:39], v[164:167], a[8:11], v[36:39]
    ds_read_b64_tr_b16 v[188:189], v18 offset:16384
    ds_read_b64_tr_b16 v[190:191], v18 offset:17408
    v_cvt_pk_bf16_f32 v201, v142, v143
    v_mfma_f32_16x16x32_bf16 v[40:43], v[164:167], a[72:75], v[40:43]
    v_cvt_pk_bf16_f32 v202, v144, v145
    s_waitcnt lgkmcnt(10)
    v_mfma_f32_16x16x32_bf16 v[44:47], v[168:171], a[8:11], v[44:47]
    ds_read_b64_tr_b16 v[192:193], v19 offset:16384
    ds_read_b64_tr_b16 v[194:195], v19 offset:17408
    v_cvt_pk_bf16_f32 v203, v146, v147
    v_mfma_f32_16x16x32_bf16 v[48:51], v[168:171], a[72:75], v[48:51]
    buffer_store_dwordx4 v[200:203], v32, s[4:7], s37 offen offset:128 sc1
    s_waitcnt lgkmcnt(10)
    v_mfma_f32_16x16x32_bf16 v[52:55], v[172:175], a[8:11], v[52:55]
    ds_read_b64_tr_b16 v[164:165], v12 offset:24576
    ds_read_b64_tr_b16 v[166:167], v12 offset:25600
    v_cvt_pk_bf16_f32 v204, v148, v149
    v_mfma_f32_16x16x32_bf16 v[56:59], v[172:175], a[72:75], v[56:59]
    v_cvt_pk_bf16_f32 v205, v150, v151
    s_waitcnt lgkmcnt(10)
    v_mfma_f32_16x16x32_bf16 v[60:63], v[176:179], a[8:11], v[60:63]
    ds_read_b64_tr_b16 v[168:169], v13 offset:24576
    ds_read_b64_tr_b16 v[170:171], v13 offset:25600
    v_cvt_pk_bf16_f32 v206, v152, v153
    v_mfma_f32_16x16x32_bf16 v[64:67], v[176:179], a[72:75], v[64:67]
    v_cvt_pk_bf16_f32 v207, v154, v155
    s_waitcnt lgkmcnt(10)
    v_mfma_f32_16x16x32_bf16 v[68:71], v[180:183], a[8:11], v[68:71]
    ds_read_b64_tr_b16 v[172:173], v14 offset:24576
    ds_read_b64_tr_b16 v[174:175], v14 offset:25600
    buffer_store_dwordx4 v[204:207], v32, s[4:7], s37 offen offset:2048 sc1
    v_mfma_f32_16x16x32_bf16 v[72:75], v[180:183], a[72:75], v[72:75]
    v_cvt_pk_bf16_f32 v208, v156, v157
    s_waitcnt lgkmcnt(10)
    v_mfma_f32_16x16x32_bf16 v[76:79], v[184:187], a[8:11], v[76:79]
    ds_read_b64_tr_b16 v[176:177], v15 offset:24576
    ds_read_b64_tr_b16 v[178:179], v15 offset:25600
    v_cvt_pk_bf16_f32 v209, v158, v159
    v_mfma_f32_16x16x32_bf16 v[80:83], v[184:187], a[72:75], v[80:83]
    v_cvt_pk_bf16_f32 v210, v160, v161
    s_waitcnt lgkmcnt(10)
    v_mfma_f32_16x16x32_bf16 v[84:87], v[188:191], a[8:11], v[84:87]
    ds_read_b64_tr_b16 v[180:181], v16 offset:24576
    ds_read_b64_tr_b16 v[182:183], v16 offset:25600
    v_cvt_pk_bf16_f32 v211, v162, v163
    v_mfma_f32_16x16x32_bf16 v[88:91], v[188:191], a[72:75], v[88:91]
    buffer_store_dwordx4 v[208:211], v32, s[4:7], s37 offen offset:2176 sc1
    s_waitcnt lgkmcnt(10)
    v_mfma_f32_16x16x32_bf16 v[92:95], v[192:195], a[8:11], v[92:95]
    ds_read_b64_tr_b16 v[184:185], v17 offset:24576
    ds_read_b64_tr_b16 v[186:187], v17 offset:25600
    v_mfma_f32_16x16x32_bf16 v[96:99], v[192:195], a[72:75], v[96:99]
    s_waitcnt lgkmcnt(10)
    v_mfma_f32_16x16x32_bf16 v[36:39], v[164:167], a[12:15], v[36:39]
    ds_read_b64_tr_b16 v[188:189], v18 offset:24576
    ds_read_b64_tr_b16 v[190:191], v18 offset:25600
    v_mfma_f32_16x16x32_bf16 v[40:43], v[164:167], a[76:79], v[40:43]
    s_waitcnt lgkmcnt(10)
    v_mfma_f32_16x16x32_bf16 v[44:47], v[168:171], a[12:15], v[44:47]
    ds_read_b64_tr_b16 v[192:193], v19 offset:24576
    ds_read_b64_tr_b16 v[194:195], v19 offset:25600
    v_mfma_f32_16x16x32_bf16 v[48:51], v[168:171], a[76:79], v[48:51]
    s_waitcnt lgkmcnt(10)
    v_mfma_f32_16x16x32_bf16 v[52:55], v[172:175], a[12:15], v[52:55]
    s_waitcnt vmcnt(16)
    s_barrier
    s_add_u32 s31, s28, 3145728
    s_add_u32 m0, s30, 98304
    s_nop 0
    buffer_load_dwordx4 v8, s[44:47], s31 offen lds
    s_add_u32 m0, m0, 1024
    s_nop 0
    buffer_load_dwordx4 v9, s[44:47], s31 offen lds
    s_add_u32 m0, m0, 1024
    s_nop 0
    buffer_load_dwordx4 v10, s[44:47], s31 offen lds
    s_add_u32 m0, m0, 1024
    s_nop 0
    buffer_load_dwordx4 v11, s[44:47], s31 offen lds
    s_add_u32 m0, m0, 1024
    s_add_u32 s31, s31, 131072
    buffer_load_dwordx4 v8, s[44:47], s31 offen lds
    s_add_u32 m0, m0, 1024
    s_nop 0
    buffer_load_dwordx4 v9, s[44:47], s31 offen lds
    s_add_u32 m0, m0, 1024
    s_nop 0
    buffer_load_dwordx4 v10, s[44:47], s31 offen lds
    s_add_u32 m0, m0, 1024
    s_nop 0
    buffer_load_dwordx4 v11, s[44:47], s31 offen lds
    ds_read_b64_tr_b16 v[164:165], v12 offset:32768
    ds_read_b64_tr_b16 v[166:167], v12 offset:33792
    v_mfma_f32_16x16x32_bf16 v[56:59], v[172:175], a[76:79], v[56:59]
    s_waitcnt lgkmcnt(10)
    v_mfma_f32_16x16x32_bf16 v[60:63], v[176:179], a[12:15], v[60:63]
    ds_read_b64_tr_b16 v[168:169], v13 offset:32768
    ds_read_b64_tr_b16 v[170:171], v13 offset:33792
    v_mfma_f32_16x16x32_bf16 v[64:67], v[176:179], a[76:79], v[64:67]
    s_waitcnt lgkmcnt(10)
    v_mfma_f32_16x16x32_bf16 v[68:71], v[180:183], a[12:15], v[68:71]
    ds_read_b64_tr_b16 v[172:173], v14 offset:32768
    ds_read_b64_tr_b16 v[174:175], v14 offset:33792
    v_mfma_f32_16x16x32_bf16 v[72:75], v[180:183], a[76:79], v[72:75]
    s_waitcnt lgkmcnt(10)
    v_mfma_f32_16x16x32_bf16 v[76:79], v[184:187], a[12:15], v[76:79]
    ds_read_b64_tr_b16 v[176:177], v15 offset:32768
    ds_read_b64_tr_b16 v[178:179], v15 offset:33792
    v_mfma_f32_16x16x32_bf16 v[80:83], v[184:187], a[76:79], v[80:83]
    s_waitcnt lgkmcnt(10)
    v_mfma_f32_16x16x32_bf16 v[84:87], v[188:191], a[12:15], v[84:87]
    ds_read_b64_tr_b16 v[180:181], v16 offset:32768
    ds_read_b64_tr_b16 v[182:183], v16 offset:33792
    v_mfma_f32_16x16x32_bf16 v[88:91], v[188:191], a[76:79], v[88:91]
    s_waitcnt lgkmcnt(10)
    v_mfma_f32_16x16x32_bf16 v[92:95], v[192:195], a[12:15], v[92:95]
    ds_read_b64_tr_b16 v[184:185], v17 offset:32768
    ds_read_b64_tr_b16 v[186:187], v17 offset:33792
    v_mfma_f32_16x16x32_bf16 v[96:99], v[192:195], a[76:79], v[96:99]
    s_waitcnt lgkmcnt(10)
    v_mfma_f32_16x16x32_bf16 v[36:39], v[164:167], a[16:19], v[36:39]
    ds_read_b64_tr_b16 v[188:189], v18 offset:32768
    ds_read_b64_tr_b16 v[190:191], v18 offset:33792
    v_mfma_f32_16x16x32_bf16 v[40:43], v[164:167], a[80:83], v[40:43]
    s_waitcnt lgkmcnt(10)
    v_mfma_f32_16x16x32_bf16 v[44:47], v[168:171], a[16:19], v[44:47]
    ds_read_b64_tr_b16 v[192:193], v19 offset:32768
    ds_read_b64_tr_b16 v[194:195], v19 offset:33792
    v_mfma_f32_16x16x32_bf16 v[48:51], v[168:171], a[80:83], v[48:51]
    s_waitcnt lgkmcnt(10)
    v_mfma_f32_16x16x32_bf16 v[52:55], v[172:175], a[16:19], v[52:55]
    ds_read_b64_tr_b16 v[164:165], v12 offset:40960
    ds_read_b64_tr_b16 v[166:167], v12 offset:41984
    v_mfma_f32_16x16x32_bf16 v[56:59], v[172:175], a[80:83], v[56:59]
    s_waitcnt lgkmcnt(10)
    v_mfma_f32_16x16x32_bf16 v[60:63], v[176:179], a[16:19], v[60:63]
    ds_read_b64_tr_b16 v[168:169], v13 offset:40960
    ds_read_b64_tr_b16 v[170:171], v13 offset:41984
    v_mfma_f32_16x16x32_bf16 v[64:67], v[176:179], a[80:83], v[64:67]
    s_waitcnt lgkmcnt(10)
    v_mfma_f32_16x16x32_bf16 v[68:71], v[180:183], a[16:19], v[68:71]
    ds_read_b64_tr_b16 v[172:173], v14 offset:40960
    ds_read_b64_tr_b16 v[174:175], v14 offset:41984
    v_mfma_f32_16x16x32_bf16 v[72:75], v[180:183], a[80:83], v[72:75]
    s_waitcnt lgkmcnt(10)
    v_mfma_f32_16x16x32_bf16 v[76:79], v[184:187], a[16:19], v[76:79]
    ds_read_b64_tr_b16 v[176:177], v15 offset:40960
    ds_read_b64_tr_b16 v[178:179], v15 offset:41984
    v_mfma_f32_16x16x32_bf16 v[80:83], v[184:187], a[80:83], v[80:83]
    s_waitcnt lgkmcnt(10)
    v_mfma_f32_16x16x32_bf16 v[84:87], v[188:191], a[16:19], v[84:87]
    ds_read_b64_tr_b16 v[180:181], v16 offset:40960
    ds_read_b64_tr_b16 v[182:183], v16 offset:41984
    v_mfma_f32_16x16x32_bf16 v[88:91], v[188:191], a[80:83], v[88:91]
    s_waitcnt lgkmcnt(10)
    v_mfma_f32_16x16x32_bf16 v[92:95], v[192:195], a[16:19], v[92:95]
    ds_read_b64_tr_b16 v[184:185], v17 offset:40960
    ds_read_b64_tr_b16 v[186:187], v17 offset:41984
    v_mfma_f32_16x16x32_bf16 v[96:99], v[192:195], a[80:83], v[96:99]
    s_waitcnt lgkmcnt(10)
    v_mfma_f32_16x16x32_bf16 v[36:39], v[164:167], a[20:23], v[36:39]
    ds_read_b64_tr_b16 v[188:189], v18 offset:40960
    ds_read_b64_tr_b16 v[190:191], v18 offset:41984
    v_mfma_f32_16x16x32_bf16 v[40:43], v[164:167], a[84:87], v[40:43]
    s_waitcnt lgkmcnt(10)
    v_mfma_f32_16x16x32_bf16 v[44:47], v[168:171], a[20:23], v[44:47]
    ds_read_b64_tr_b16 v[192:193], v19 offset:40960
    ds_read_b64_tr_b16 v[194:195], v19 offset:41984
    v_mfma_f32_16x16x32_bf16 v[48:51], v[168:171], a[84:87], v[48:51]
    s_waitcnt lgkmcnt(10)
    v_mfma_f32_16x16x32_bf16 v[52:55], v[172:175], a[20:23], v[52:55]
    ds_read_b64_tr_b16 v[164:165], v12 offset:49152
    ds_read_b64_tr_b16 v[166:167], v12 offset:50176
    v_mfma_f32_16x16x32_bf16 v[56:59], v[172:175], a[84:87], v[56:59]
    s_waitcnt lgkmcnt(10)
    v_mfma_f32_16x16x32_bf16 v[60:63], v[176:179], a[20:23], v[60:63]
    ds_read_b64_tr_b16 v[168:169], v13 offset:49152
    ds_read_b64_tr_b16 v[170:171], v13 offset:50176
    v_mfma_f32_16x16x32_bf16 v[64:67], v[176:179], a[84:87], v[64:67]
    s_waitcnt lgkmcnt(10)
    v_mfma_f32_16x16x32_bf16 v[68:71], v[180:183], a[20:23], v[68:71]
    ds_read_b64_tr_b16 v[172:173], v14 offset:49152
    ds_read_b64_tr_b16 v[174:175], v14 offset:50176
    v_mfma_f32_16x16x32_bf16 v[72:75], v[180:183], a[84:87], v[72:75]
    s_waitcnt lgkmcnt(10)
    v_mfma_f32_16x16x32_bf16 v[76:79], v[184:187], a[20:23], v[76:79]
    ds_read_b64_tr_b16 v[176:177], v15 offset:49152
    ds_read_b64_tr_b16 v[178:179], v15 offset:50176
    v_mfma_f32_16x16x32_bf16 v[80:83], v[184:187], a[84:87], v[80:83]
    s_waitcnt lgkmcnt(10)
    v_mfma_f32_16x16x32_bf16 v[84:87], v[188:191], a[20:23], v[84:87]
    ds_read_b64_tr_b16 v[180:181], v16 offset:49152
    ds_read_b64_tr_b16 v[182:183], v16 offset:50176
    v_mfma_f32_16x16x32_bf16 v[88:91], v[188:191], a[84:87], v[88:91]
    s_waitcnt lgkmcnt(10)
    v_mfma_f32_16x16x32_bf16 v[92:95], v[192:195], a[20:23], v[92:95]
    ds_read_b64_tr_b16 v[184:185], v17 offset:49152
    ds_read_b64_tr_b16 v[186:187], v17 offset:50176
    v_mfma_f32_16x16x32_bf16 v[96:99], v[192:195], a[84:87], v[96:99]
    s_waitcnt lgkmcnt(10)
    v_mfma_f32_16x16x32_bf16 v[36:39], v[164:167], a[24:27], v[36:39]
    ds_read_b64_tr_b16 v[188:189], v18 offset:49152
    ds_read_b64_tr_b16 v[190:191], v18 offset:50176
    v_mfma_f32_16x16x32_bf16 v[40:43], v[164:167], a[88:91], v[40:43]
    s_waitcnt lgkmcnt(10)
    v_mfma_f32_16x16x32_bf16 v[44:47], v[168:171], a[24:27], v[44:47]
    ds_read_b64_tr_b16 v[192:193], v19 offset:49152
    ds_read_b64_tr_b16 v[194:195], v19 offset:50176
    v_mfma_f32_16x16x32_bf16 v[48:51], v[168:171], a[88:91], v[48:51]
    s_waitcnt lgkmcnt(10)
    v_mfma_f32_16x16x32_bf16 v[52:55], v[172:175], a[24:27], v[52:55]
    ds_read_b64_tr_b16 v[164:165], v12 offset:57344
    ds_read_b64_tr_b16 v[166:167], v12 offset:58368
    v_mfma_f32_16x16x32_bf16 v[56:59], v[172:175], a[88:91], v[56:59]
    s_waitcnt lgkmcnt(10)
    v_mfma_f32_16x16x32_bf16 v[60:63], v[176:179], a[24:27], v[60:63]
    ds_read_b64_tr_b16 v[168:169], v13 offset:57344
    ds_read_b64_tr_b16 v[170:171], v13 offset:58368
    v_mfma_f32_16x16x32_bf16 v[64:67], v[176:179], a[88:91], v[64:67]
    s_waitcnt lgkmcnt(10)
    v_mfma_f32_16x16x32_bf16 v[68:71], v[180:183], a[24:27], v[68:71]
    ds_read_b64_tr_b16 v[172:173], v14 offset:57344
    ds_read_b64_tr_b16 v[174:175], v14 offset:58368
    v_mfma_f32_16x16x32_bf16 v[72:75], v[180:183], a[88:91], v[72:75]
    s_waitcnt lgkmcnt(10)
    v_mfma_f32_16x16x32_bf16 v[76:79], v[184:187], a[24:27], v[76:79]
    ds_read_b64_tr_b16 v[176:177], v15 offset:57344
    ds_read_b64_tr_b16 v[178:179], v15 offset:58368
    v_mfma_f32_16x16x32_bf16 v[80:83], v[184:187], a[88:91], v[80:83]
    s_waitcnt lgkmcnt(10)
    v_mfma_f32_16x16x32_bf16 v[84:87], v[188:191], a[24:27], v[84:87]
    ds_read_b64_tr_b16 v[180:181], v16 offset:57344
    ds_read_b64_tr_b16 v[182:183], v16 offset:58368
    v_mfma_f32_16x16x32_bf16 v[88:91], v[188:191], a[88:91], v[88:91]
    s_waitcnt lgkmcnt(10)
    v_mfma_f32_16x16x32_bf16 v[92:95], v[192:195], a[24:27], v[92:95]
    ds_read_b64_tr_b16 v[184:185], v17 offset:57344
    ds_read_b64_tr_b16 v[186:187], v17 offset:58368
    v_mfma_f32_16x16x32_bf16 v[96:99], v[192:195], a[88:91], v[96:99]
    s_waitcnt lgkmcnt(10)
    v_mfma_f32_16x16x32_bf16 v[36:39], v[164:167], a[28:31], v[36:39]
    ds_read_b64_tr_b16 v[188:189], v18 offset:57344
    ds_read_b64_tr_b16 v[190:191], v18 offset:58368
    v_mfma_f32_16x16x32_bf16 v[40:43], v[164:167], a[92:95], v[40:43]
    s_waitcnt lgkmcnt(10)
    v_mfma_f32_16x16x32_bf16 v[44:47], v[168:171], a[28:31], v[44:47]
    ds_read_b64_tr_b16 v[192:193], v19 offset:57344
    ds_read_b64_tr_b16 v[194:195], v19 offset:58368
    v_mfma_f32_16x16x32_bf16 v[48:51], v[168:171], a[92:95], v[48:51]
    s_waitcnt lgkmcnt(10)
    v_mfma_f32_16x16x32_bf16 v[52:55], v[172:175], a[28:31], v[52:55]
    s_waitcnt vmcnt(8)
    s_waitcnt vmcnt(16)
    s_barrier
    s_cmp_lg_u32 s92, 0
    s_cbranch_scc1 L_s79_done
    s_lshl_b32 s79, s16, 7
    s_add_u32 s79, s79, 3934208
    v_mov_b32 v250, 0
    v_mov_b32 v251, 2
    s_mov_b64 exec, 1
    buffer_atomic_add v251, v250, s[4:7], s79 offen
    s_mov_b64 exec, -1
L_s79_done:
    ds_read_b64_tr_b16 v[164:165], v24 offset:0
    ds_read_b64_tr_b16 v[166:167], v24 offset:1024
    v_mfma_f32_16x16x32_bf16 v[56:59], v[172:175], a[92:95], v[56:59]
    s_waitcnt lgkmcnt(10)
    v_mfma_f32_16x16x32_bf16 v[60:63], v[176:179], a[28:31], v[60:63]
    ds_read_b64_tr_b16 v[168:169], v25 offset:0
    ds_read_b64_tr_b16 v[170:171], v25 offset:1024
    v_mfma_f32_16x16x32_bf16 v[64:67], v[176:179], a[92:95], v[64:67]
    s_waitcnt lgkmcnt(10)
    v_mfma_f32_16x16x32_bf16 v[68:71], v[180:183], a[28:31], v[68:71]
    ds_read_b64_tr_b16 v[172:173], v26 offset:0
    ds_read_b64_tr_b16 v[174:175], v26 offset:1024
    v_mfma_f32_16x16x32_bf16 v[72:75], v[180:183], a[92:95], v[72:75]
    s_waitcnt lgkmcnt(10)
    v_mfma_f32_16x16x32_bf16 v[76:79], v[184:187], a[28:31], v[76:79]
    ds_read_b64_tr_b16 v[176:177], v27 offset:0
    ds_read_b64_tr_b16 v[178:179], v27 offset:1024
    v_mfma_f32_16x16x32_bf16 v[80:83], v[184:187], a[92:95], v[80:83]
    s_waitcnt lgkmcnt(10)
    v_mfma_f32_16x16x32_bf16 v[84:87], v[188:191], a[28:31], v[84:87]
    ds_read_b64_tr_b16 v[180:181], v28 offset:0
    ds_read_b64_tr_b16 v[182:183], v28 offset:1024
    v_mfma_f32_16x16x32_bf16 v[88:91], v[188:191], a[92:95], v[88:91]
    s_waitcnt lgkmcnt(10)
    v_mfma_f32_16x16x32_bf16 v[92:95], v[192:195], a[28:31], v[92:95]
    ds_read_b64_tr_b16 v[184:185], v29 offset:0
    ds_read_b64_tr_b16 v[186:187], v29 offset:1024
    v_mfma_f32_16x16x32_bf16 v[96:99], v[192:195], a[92:95], v[96:99]
    s_waitcnt lgkmcnt(10)
    v_mfma_f32_16x16x32_bf16 v[36:39], v[164:167], a[32:35], v[36:39]
    ds_read_b64_tr_b16 v[188:189], v30 offset:0
    ds_read_b64_tr_b16 v[190:191], v30 offset:1024
    v_mfma_f32_16x16x32_bf16 v[40:43], v[164:167], a[96:99], v[40:43]
    s_waitcnt lgkmcnt(10)
    v_mfma_f32_16x16x32_bf16 v[44:47], v[168:171], a[32:35], v[44:47]
    ds_read_b64_tr_b16 v[192:193], v31 offset:0
    ds_read_b64_tr_b16 v[194:195], v31 offset:1024
    v_mfma_f32_16x16x32_bf16 v[48:51], v[168:171], a[96:99], v[48:51]
    s_waitcnt lgkmcnt(10)
    v_mfma_f32_16x16x32_bf16 v[52:55], v[172:175], a[32:35], v[52:55]
    ds_read_b64_tr_b16 v[164:165], v24 offset:8192
    ds_read_b64_tr_b16 v[166:167], v24 offset:9216
    v_mfma_f32_16x16x32_bf16 v[56:59], v[172:175], a[96:99], v[56:59]
    s_waitcnt lgkmcnt(10)
    v_mfma_f32_16x16x32_bf16 v[60:63], v[176:179], a[32:35], v[60:63]
    ds_read_b64_tr_b16 v[168:169], v25 offset:8192
    ds_read_b64_tr_b16 v[170:171], v25 offset:9216
    v_mfma_f32_16x16x32_bf16 v[64:67], v[176:179], a[96:99], v[64:67]
    s_waitcnt lgkmcnt(10)
    v_mfma_f32_16x16x32_bf16 v[68:71], v[180:183], a[32:35], v[68:71]
    ds_read_b64_tr_b16 v[172:173], v26 offset:8192
    ds_read_b64_tr_b16 v[174:175], v26 offset:9216
    v_mfma_f32_16x16x32_bf16 v[72:75], v[180:183], a[96:99], v[72:75]
    s_waitcnt lgkmcnt(10)
    v_mfma_f32_16x16x32_bf16 v[76:79], v[184:187], a[32:35], v[76:79]
    ds_read_b64_tr_b16 v[176:177], v27 offset:8192
    ds_read_b64_tr_b16 v[178:179], v27 offset:9216
    v_mfma_f32_16x16x32_bf16 v[80:83], v[184:187], a[96:99], v[80:83]
    s_waitcnt lgkmcnt(10)
    v_mfma_f32_16x16x32_bf16 v[84:87], v[188:191], a[32:35], v[84:87]
    ds_read_b64_tr_b16 v[180:181], v28 offset:8192
    ds_read_b64_tr_b16 v[182:183], v28 offset:9216
    v_mfma_f32_16x16x32_bf16 v[88:91], v[188:191], a[96:99], v[88:91]
    s_waitcnt lgkmcnt(10)
    v_mfma_f32_16x16x32_bf16 v[92:95], v[192:195], a[32:35], v[92:95]
    ds_read_b64_tr_b16 v[184:185], v29 offset:8192
    ds_read_b64_tr_b16 v[186:187], v29 offset:9216
    v_mfma_f32_16x16x32_bf16 v[96:99], v[192:195], a[96:99], v[96:99]
    s_waitcnt lgkmcnt(10)
    v_mfma_f32_16x16x32_bf16 v[36:39], v[164:167], a[36:39], v[36:39]
    ds_read_b64_tr_b16 v[188:189], v30 offset:8192
    ds_read_b64_tr_b16 v[190:191], v30 offset:9216
    v_mfma_f32_16x16x32_bf16 v[40:43], v[164:167], a[100:103], v[40:43]
    s_waitcnt lgkmcnt(10)
    v_mfma_f32_16x16x32_bf16 v[44:47], v[168:171], a[36:39], v[44:47]
    ds_read_b64_tr_b16 v[192:193], v31 offset:8192
    ds_read_b64_tr_b16 v[194:195], v31 offset:9216
    v_mfma_f32_16x16x32_bf16 v[48:51], v[168:171], a[100:103], v[48:51]
    s_waitcnt lgkmcnt(10)
    v_mfma_f32_16x16x32_bf16 v[52:55], v[172:175], a[36:39], v[52:55]
    ds_read_b64_tr_b16 v[164:165], v24 offset:16384
    ds_read_b64_tr_b16 v[166:167], v24 offset:17408
    v_mfma_f32_16x16x32_bf16 v[56:59], v[172:175], a[100:103], v[56:59]
    s_waitcnt lgkmcnt(10)
    v_mfma_f32_16x16x32_bf16 v[60:63], v[176:179], a[36:39], v[60:63]
    ds_read_b64_tr_b16 v[168:169], v25 offset:16384
    ds_read_b64_tr_b16 v[170:171], v25 offset:17408
    v_mfma_f32_16x16x32_bf16 v[64:67], v[176:179], a[100:103], v[64:67]
    s_waitcnt lgkmcnt(10)
    v_mfma_f32_16x16x32_bf16 v[68:71], v[180:183], a[36:39], v[68:71]
    ds_read_b64_tr_b16 v[172:173], v26 offset:16384
    ds_read_b64_tr_b16 v[174:175], v26 offset:17408
    v_mfma_f32_16x16x32_bf16 v[72:75], v[180:183], a[100:103], v[72:75]
    s_waitcnt lgkmcnt(10)
    v_mfma_f32_16x16x32_bf16 v[76:79], v[184:187], a[36:39], v[76:79]
    ds_read_b64_tr_b16 v[176:177], v27 offset:16384
    ds_read_b64_tr_b16 v[178:179], v27 offset:17408
    v_mfma_f32_16x16x32_bf16 v[80:83], v[184:187], a[100:103], v[80:83]
    s_waitcnt lgkmcnt(10)
    v_mfma_f32_16x16x32_bf16 v[84:87], v[188:191], a[36:39], v[84:87]
    ds_read_b64_tr_b16 v[180:181], v28 offset:16384
    ds_read_b64_tr_b16 v[182:183], v28 offset:17408
    v_mfma_f32_16x16x32_bf16 v[88:91], v[188:191], a[100:103], v[88:91]
    s_waitcnt lgkmcnt(10)
    v_mfma_f32_16x16x32_bf16 v[92:95], v[192:195], a[36:39], v[92:95]
    ds_read_b64_tr_b16 v[184:185], v29 offset:16384
    ds_read_b64_tr_b16 v[186:187], v29 offset:17408
    v_mfma_f32_16x16x32_bf16 v[96:99], v[192:195], a[100:103], v[96:99]
    s_waitcnt lgkmcnt(10)
    v_mfma_f32_16x16x32_bf16 v[36:39], v[164:167], a[40:43], v[36:39]
    ds_read_b64_tr_b16 v[188:189], v30 offset:16384
    ds_read_b64_tr_b16 v[190:191], v30 offset:17408
    v_mfma_f32_16x16x32_bf16 v[40:43], v[164:167], a[104:107], v[40:43]
    s_waitcnt lgkmcnt(10)
    v_mfma_f32_16x16x32_bf16 v[44:47], v[168:171], a[40:43], v[44:47]
    ds_read_b64_tr_b16 v[192:193], v31 offset:16384
    ds_read_b64_tr_b16 v[194:195], v31 offset:17408
    v_mfma_f32_16x16x32_bf16 v[48:51], v[168:171], a[104:107], v[48:51]
    s_waitcnt lgkmcnt(10)
    v_mfma_f32_16x16x32_bf16 v[52:55], v[172:175], a[40:43], v[52:55]
    ds_read_b64_tr_b16 v[164:165], v24 offset:24576
    ds_read_b64_tr_b16 v[166:167], v24 offset:25600
    v_mfma_f32_16x16x32_bf16 v[56:59], v[172:175], a[104:107], v[56:59]
    s_waitcnt lgkmcnt(10)
    v_mfma_f32_16x16x32_bf16 v[60:63], v[176:179], a[40:43], v[60:63]
    ds_read_b64_tr_b16 v[168:169], v25 offset:24576
    ds_read_b64_tr_b16 v[170:171], v25 offset:25600
    v_mfma_f32_16x16x32_bf16 v[64:67], v[176:179], a[104:107], v[64:67]
    s_waitcnt lgkmcnt(10)
    v_mfma_f32_16x16x32_bf16 v[68:71], v[180:183], a[40:43], v[68:71]
    ds_read_b64_tr_b16 v[172:173], v26 offset:24576
    ds_read_b64_tr_b16 v[174:175], v26 offset:25600
    v_mfma_f32_16x16x32_bf16 v[72:75], v[180:183], a[104:107], v[72:75]
    s_waitcnt lgkmcnt(10)
    v_mfma_f32_16x16x32_bf16 v[76:79], v[184:187], a[40:43], v[76:79]
    ds_read_b64_tr_b16 v[176:177], v27 offset:24576
    ds_read_b64_tr_b16 v[178:179], v27 offset:25600
    v_mfma_f32_16x16x32_bf16 v[80:83], v[184:187], a[104:107], v[80:83]
    s_waitcnt lgkmcnt(10)
    v_mfma_f32_16x16x32_bf16 v[84:87], v[188:191], a[40:43], v[84:87]
    ds_read_b64_tr_b16 v[180:181], v28 offset:24576
    ds_read_b64_tr_b16 v[182:183], v28 offset:25600
    v_mfma_f32_16x16x32_bf16 v[88:91], v[188:191], a[104:107], v[88:91]
    s_waitcnt lgkmcnt(10)
    v_mfma_f32_16x16x32_bf16 v[92:95], v[192:195], a[40:43], v[92:95]
    ds_read_b64_tr_b16 v[184:185], v29 offset:24576
    ds_read_b64_tr_b16 v[186:187], v29 offset:25600
    v_mfma_f32_16x16x32_bf16 v[96:99], v[192:195], a[104:107], v[96:99]
    s_waitcnt lgkmcnt(10)
    v_mfma_f32_16x16x32_bf16 v[36:39], v[164:167], a[44:47], v[36:39]
    ds_read_b64_tr_b16 v[188:189], v30 offset:24576
    ds_read_b64_tr_b16 v[190:191], v30 offset:25600
    v_mfma_f32_16x16x32_bf16 v[40:43], v[164:167], a[108:111], v[40:43]
    s_waitcnt lgkmcnt(10)
    v_mfma_f32_16x16x32_bf16 v[44:47], v[168:171], a[44:47], v[44:47]
    ds_read_b64_tr_b16 v[192:193], v31 offset:24576
    ds_read_b64_tr_b16 v[194:195], v31 offset:25600
    v_mfma_f32_16x16x32_bf16 v[48:51], v[168:171], a[108:111], v[48:51]
    s_waitcnt lgkmcnt(10)
    v_mfma_f32_16x16x32_bf16 v[52:55], v[172:175], a[44:47], v[52:55]
    s_waitcnt vmcnt(0)
    s_barrier
    ds_read_b64_tr_b16 v[164:165], v24 offset:32768
    ds_read_b64_tr_b16 v[166:167], v24 offset:33792
    v_mfma_f32_16x16x32_bf16 v[56:59], v[172:175], a[108:111], v[56:59]
    s_waitcnt lgkmcnt(10)
    v_mfma_f32_16x16x32_bf16 v[60:63], v[176:179], a[44:47], v[60:63]
    ds_read_b64_tr_b16 v[168:169], v25 offset:32768
    ds_read_b64_tr_b16 v[170:171], v25 offset:33792
    v_mfma_f32_16x16x32_bf16 v[64:67], v[176:179], a[108:111], v[64:67]
    s_waitcnt lgkmcnt(10)
    v_mfma_f32_16x16x32_bf16 v[68:71], v[180:183], a[44:47], v[68:71]
    ds_read_b64_tr_b16 v[172:173], v26 offset:32768
    ds_read_b64_tr_b16 v[174:175], v26 offset:33792
    v_mfma_f32_16x16x32_bf16 v[72:75], v[180:183], a[108:111], v[72:75]
    s_waitcnt lgkmcnt(10)
    v_mfma_f32_16x16x32_bf16 v[76:79], v[184:187], a[44:47], v[76:79]
    ds_read_b64_tr_b16 v[176:177], v27 offset:32768
    ds_read_b64_tr_b16 v[178:179], v27 offset:33792
    v_mfma_f32_16x16x32_bf16 v[80:83], v[184:187], a[108:111], v[80:83]
    s_waitcnt lgkmcnt(10)
    v_mfma_f32_16x16x32_bf16 v[84:87], v[188:191], a[44:47], v[84:87]
    ds_read_b64_tr_b16 v[180:181], v28 offset:32768
    ds_read_b64_tr_b16 v[182:183], v28 offset:33792
    v_mfma_f32_16x16x32_bf16 v[88:91], v[188:191], a[108:111], v[88:91]
    s_waitcnt lgkmcnt(10)
    v_mfma_f32_16x16x32_bf16 v[92:95], v[192:195], a[44:47], v[92:95]
    ds_read_b64_tr_b16 v[184:185], v29 offset:32768
    ds_read_b64_tr_b16 v[186:187], v29 offset:33792
    v_mfma_f32_16x16x32_bf16 v[96:99], v[192:195], a[108:111], v[96:99]
    s_waitcnt lgkmcnt(10)
    v_mfma_f32_16x16x32_bf16 v[36:39], v[164:167], a[48:51], v[36:39]
    ds_read_b64_tr_b16 v[188:189], v30 offset:32768
    ds_read_b64_tr_b16 v[190:191], v30 offset:33792
    v_mfma_f32_16x16x32_bf16 v[40:43], v[164:167], a[112:115], v[40:43]
    s_waitcnt lgkmcnt(10)
    v_mfma_f32_16x16x32_bf16 v[44:47], v[168:171], a[48:51], v[44:47]
    ds_read_b64_tr_b16 v[192:193], v31 offset:32768
    ds_read_b64_tr_b16 v[194:195], v31 offset:33792
    v_mfma_f32_16x16x32_bf16 v[48:51], v[168:171], a[112:115], v[48:51]
    s_waitcnt lgkmcnt(10)
    v_mfma_f32_16x16x32_bf16 v[52:55], v[172:175], a[48:51], v[52:55]
    ds_read_b64_tr_b16 v[164:165], v24 offset:40960
    ds_read_b64_tr_b16 v[166:167], v24 offset:41984
    v_mfma_f32_16x16x32_bf16 v[56:59], v[172:175], a[112:115], v[56:59]
    s_waitcnt lgkmcnt(10)
    v_mfma_f32_16x16x32_bf16 v[60:63], v[176:179], a[48:51], v[60:63]
    ds_read_b64_tr_b16 v[168:169], v25 offset:40960
    ds_read_b64_tr_b16 v[170:171], v25 offset:41984
    v_mfma_f32_16x16x32_bf16 v[64:67], v[176:179], a[112:115], v[64:67]
    s_waitcnt lgkmcnt(10)
    v_mfma_f32_16x16x32_bf16 v[68:71], v[180:183], a[48:51], v[68:71]
    ds_read_b64_tr_b16 v[172:173], v26 offset:40960
    ds_read_b64_tr_b16 v[174:175], v26 offset:41984
    v_mfma_f32_16x16x32_bf16 v[72:75], v[180:183], a[112:115], v[72:75]
    s_waitcnt lgkmcnt(10)
    v_mfma_f32_16x16x32_bf16 v[76:79], v[184:187], a[48:51], v[76:79]
    ds_read_b64_tr_b16 v[176:177], v27 offset:40960
    ds_read_b64_tr_b16 v[178:179], v27 offset:41984
    v_mfma_f32_16x16x32_bf16 v[80:83], v[184:187], a[112:115], v[80:83]
    s_waitcnt lgkmcnt(10)
    v_mfma_f32_16x16x32_bf16 v[84:87], v[188:191], a[48:51], v[84:87]
    ds_read_b64_tr_b16 v[180:181], v28 offset:40960
    ds_read_b64_tr_b16 v[182:183], v28 offset:41984
    v_mfma_f32_16x16x32_bf16 v[88:91], v[188:191], a[112:115], v[88:91]
    s_waitcnt lgkmcnt(10)
    v_mfma_f32_16x16x32_bf16 v[92:95], v[192:195], a[48:51], v[92:95]
    ds_read_b64_tr_b16 v[184:185], v29 offset:40960
    ds_read_b64_tr_b16 v[186:187], v29 offset:41984
    v_mfma_f32_16x16x32_bf16 v[96:99], v[192:195], a[112:115], v[96:99]
    s_waitcnt lgkmcnt(10)
    v_mfma_f32_16x16x32_bf16 v[36:39], v[164:167], a[52:55], v[36:39]
    ds_read_b64_tr_b16 v[188:189], v30 offset:40960
    ds_read_b64_tr_b16 v[190:191], v30 offset:41984
    v_mfma_f32_16x16x32_bf16 v[40:43], v[164:167], a[116:119], v[40:43]
    s_waitcnt lgkmcnt(10)
    v_mfma_f32_16x16x32_bf16 v[44:47], v[168:171], a[52:55], v[44:47]
    ds_read_b64_tr_b16 v[192:193], v31 offset:40960
    ds_read_b64_tr_b16 v[194:195], v31 offset:41984
    v_mfma_f32_16x16x32_bf16 v[48:51], v[168:171], a[116:119], v[48:51]
    s_waitcnt lgkmcnt(10)
    v_mfma_f32_16x16x32_bf16 v[52:55], v[172:175], a[52:55], v[52:55]
    ds_read_b64_tr_b16 v[164:165], v24 offset:49152
    ds_read_b64_tr_b16 v[166:167], v24 offset:50176
    v_mfma_f32_16x16x32_bf16 v[56:59], v[172:175], a[116:119], v[56:59]
    s_waitcnt lgkmcnt(10)
    v_mfma_f32_16x16x32_bf16 v[60:63], v[176:179], a[52:55], v[60:63]
    ds_read_b64_tr_b16 v[168:169], v25 offset:49152
    ds_read_b64_tr_b16 v[170:171], v25 offset:50176
    v_mfma_f32_16x16x32_bf16 v[64:67], v[176:179], a[116:119], v[64:67]
    s_waitcnt lgkmcnt(10)
    v_mfma_f32_16x16x32_bf16 v[68:71], v[180:183], a[52:55], v[68:71]
    ds_read_b64_tr_b16 v[172:173], v26 offset:49152
    ds_read_b64_tr_b16 v[174:175], v26 offset:50176
    v_mfma_f32_16x16x32_bf16 v[72:75], v[180:183], a[116:119], v[72:75]
    s_waitcnt lgkmcnt(10)
    v_mfma_f32_16x16x32_bf16 v[76:79], v[184:187], a[52:55], v[76:79]
    ds_read_b64_tr_b16 v[176:177], v27 offset:49152
    ds_read_b64_tr_b16 v[178:179], v27 offset:50176
    v_mfma_f32_16x16x32_bf16 v[80:83], v[184:187], a[116:119], v[80:83]
    s_waitcnt lgkmcnt(10)
    v_mfma_f32_16x16x32_bf16 v[84:87], v[188:191], a[52:55], v[84:87]
    ds_read_b64_tr_b16 v[180:181], v28 offset:49152
    ds_read_b64_tr_b16 v[182:183], v28 offset:50176
    v_mfma_f32_16x16x32_bf16 v[88:91], v[188:191], a[116:119], v[88:91]
    s_waitcnt lgkmcnt(10)
    v_mfma_f32_16x16x32_bf16 v[92:95], v[192:195], a[52:55], v[92:95]
    ds_read_b64_tr_b16 v[184:185], v29 offset:49152
    ds_read_b64_tr_b16 v[186:187], v29 offset:50176
    v_mfma_f32_16x16x32_bf16 v[96:99], v[192:195], a[116:119], v[96:99]
    s_waitcnt lgkmcnt(10)
    v_mfma_f32_16x16x32_bf16 v[36:39], v[164:167], a[56:59], v[36:39]
    ds_read_b64_tr_b16 v[188:189], v30 offset:49152
    ds_read_b64_tr_b16 v[190:191], v30 offset:50176
    v_mfma_f32_16x16x32_bf16 v[40:43], v[164:167], a[120:123], v[40:43]
    s_waitcnt lgkmcnt(10)
    v_mfma_f32_16x16x32_bf16 v[44:47], v[168:171], a[56:59], v[44:47]
    ds_read_b64_tr_b16 v[192:193], v31 offset:49152
    ds_read_b64_tr_b16 v[194:195], v31 offset:50176
    v_mfma_f32_16x16x32_bf16 v[48:51], v[168:171], a[120:123], v[48:51]
    s_waitcnt lgkmcnt(10)
    v_mfma_f32_16x16x32_bf16 v[52:55], v[172:175], a[56:59], v[52:55]
    ds_read_b64_tr_b16 v[164:165], v24 offset:57344
    ds_read_b64_tr_b16 v[166:167], v24 offset:58368
    v_mfma_f32_16x16x32_bf16 v[56:59], v[172:175], a[120:123], v[56:59]
    s_waitcnt lgkmcnt(10)
    v_mfma_f32_16x16x32_bf16 v[60:63], v[176:179], a[56:59], v[60:63]
    ds_read_b64_tr_b16 v[168:169], v25 offset:57344
    ds_read_b64_tr_b16 v[170:171], v25 offset:58368
    v_mfma_f32_16x16x32_bf16 v[64:67], v[176:179], a[120:123], v[64:67]
    s_waitcnt lgkmcnt(10)
    v_mfma_f32_16x16x32_bf16 v[68:71], v[180:183], a[56:59], v[68:71]
    ds_read_b64_tr_b16 v[172:173], v26 offset:57344
    ds_read_b64_tr_b16 v[174:175], v26 offset:58368
    v_mfma_f32_16x16x32_bf16 v[72:75], v[180:183], a[120:123], v[72:75]
    s_waitcnt lgkmcnt(10)
    v_mfma_f32_16x16x32_bf16 v[76:79], v[184:187], a[56:59], v[76:79]
    ds_read_b64_tr_b16 v[176:177], v27 offset:57344
    ds_read_b64_tr_b16 v[178:179], v27 offset:58368
    v_mfma_f32_16x16x32_bf16 v[80:83], v[184:187], a[120:123], v[80:83]
    s_waitcnt lgkmcnt(10)
    v_mfma_f32_16x16x32_bf16 v[84:87], v[188:191], a[56:59], v[84:87]
    ds_read_b64_tr_b16 v[180:181], v28 offset:57344
    ds_read_b64_tr_b16 v[182:183], v28 offset:58368
    v_mfma_f32_16x16x32_bf16 v[88:91], v[188:191], a[120:123], v[88:91]
    s_waitcnt lgkmcnt(10)
    v_mfma_f32_16x16x32_bf16 v[92:95], v[192:195], a[56:59], v[92:95]
    ds_read_b64_tr_b16 v[184:185], v29 offset:57344
    ds_read_b64_tr_b16 v[186:187], v29 offset:58368
    v_mfma_f32_16x16x32_bf16 v[96:99], v[192:195], a[120:123], v[96:99]
    s_waitcnt lgkmcnt(10)
    v_mfma_f32_16x16x32_bf16 v[36:39], v[164:167], a[60:63], v[36:39]
    ds_read_b64_tr_b16 v[188:189], v30 offset:57344
    ds_read_b64_tr_b16 v[190:191], v30 offset:58368
    v_mfma_f32_16x16x32_bf16 v[40:43], v[164:167], a[124:127], v[40:43]
    s_waitcnt lgkmcnt(10)
    v_mfma_f32_16x16x32_bf16 v[44:47], v[168:171], a[60:63], v[44:47]
    ds_read_b64_tr_b16 v[192:193], v31 offset:57344
    ds_read_b64_tr_b16 v[194:195], v31 offset:58368
    v_mfma_f32_16x16x32_bf16 v[48:51], v[168:171], a[124:127], v[48:51]
    s_waitcnt lgkmcnt(10)
    v_mfma_f32_16x16x32_bf16 v[52:55], v[172:175], a[60:63], v[52:55]
    v_mfma_f32_16x16x32_bf16 v[56:59], v[172:175], a[124:127], v[56:59]
    s_waitcnt lgkmcnt(8)
    v_mfma_f32_16x16x32_bf16 v[60:63], v[176:179], a[60:63], v[60:63]
    v_mfma_f32_16x16x32_bf16 v[64:67], v[176:179], a[124:127], v[64:67]
    s_waitcnt lgkmcnt(6)
    v_mfma_f32_16x16x32_bf16 v[68:71], v[180:183], a[60:63], v[68:71]
    v_mfma_f32_16x16x32_bf16 v[72:75], v[180:183], a[124:127], v[72:75]
    s_waitcnt lgkmcnt(4)
    v_mfma_f32_16x16x32_bf16 v[76:79], v[184:187], a[60:63], v[76:79]
    v_mfma_f32_16x16x32_bf16 v[80:83], v[184:187], a[124:127], v[80:83]
    s_waitcnt lgkmcnt(2)
    v_mfma_f32_16x16x32_bf16 v[84:87], v[188:191], a[60:63], v[84:87]
    v_mfma_f32_16x16x32_bf16 v[88:91], v[188:191], a[124:127], v[88:91]
    s_waitcnt lgkmcnt(0)
    v_mfma_f32_16x16x32_bf16 v[92:95], v[192:195], a[60:63], v[92:95]
    v_mfma_f32_16x16x32_bf16 v[96:99], v[192:195], a[124:127], v[96:99]
    s_add_u32 s37, s36, 50331648
    v_cvt_pk_bf16_f32 v196, v36, v37
    v_cvt_pk_bf16_f32 v197, v38, v39
    v_cvt_pk_bf16_f32 v198, v44, v45
    v_cvt_pk_bf16_f32 v199, v46, v47
    buffer_store_dwordx4 v[196:199], v3, s[4:7], s37 offen offset:0 sc1
    v_cvt_pk_bf16_f32 v200, v52, v53
    v_cvt_pk_bf16_f32 v201, v54, v55
    v_cvt_pk_bf16_f32 v202, v60, v61
    v_cvt_pk_bf16_f32 v203, v62, v63
    buffer_store_dwordx4 v[200:203], v3, s[4:7], s37 offen offset:1024 sc1
    v_cvt_pk_bf16_f32 v204, v68, v69
    v_cvt_pk_bf16_f32 v205, v70, v71
    v_cvt_pk_bf16_f32 v206, v76, v77
    v_cvt_pk_bf16_f32 v207, v78, v79
    buffer_store_dwordx4 v[204:207], v3, s[4:7], s37 offen offset:2048 sc1
    v_cvt_pk_bf16_f32 v208, v84, v85
    v_cvt_pk_bf16_f32 v209, v86, v87
    v_cvt_pk_bf16_f32 v210, v92, v93
    v_cvt_pk_bf16_f32 v211, v94, v95
    buffer_store_dwordx4 v[208:211], v3, s[4:7], s37 offen offset:3072 sc1
    s_add_u32 s37, s37, 4096
    v_cvt_pk_bf16_f32 v196, v40, v41
    v_cvt_pk_bf16_f32 v197, v42, v43
    v_cvt_pk_bf16_f32 v198, v48, v49
    v_cvt_pk_bf16_f32 v199, v50, v51
    buffer_store_dwordx4 v[196:199], v3, s[4:7], s37 offen offset:0 sc1
    v_cvt_pk_bf16_f32 v200, v56, v57
    v_cvt_pk_bf16_f32 v201, v58, v59
    v_cvt_pk_bf16_f32 v202, v64, v65
    v_cvt_pk_bf16_f32 v203, v66, v67
    buffer_store_dwordx4 v[200:203], v3, s[4:7], s37 offen offset:1024 sc1
    v_cvt_pk_bf16_f32 v204, v72, v73
    v_cvt_pk_bf16_f32 v205, v74, v75
    v_cvt_pk_bf16_f32 v206, v80, v81
    v_cvt_pk_bf16_f32 v207, v82, v83
    buffer_store_dwordx4 v[204:207], v3, s[4:7], s37 offen offset:2048 sc1
    v_cvt_pk_bf16_f32 v208, v88, v89
    v_cvt_pk_bf16_f32 v209, v90, v91
    v_cvt_pk_bf16_f32 v210, v96, v97
    v_cvt_pk_bf16_f32 v211, v98, v99
    buffer_store_dwordx4 v[208:211], v3, s[4:7], s37 offen offset:3072 sc1
    s_waitcnt vmcnt(0)
    s_barrier
    s_cmp_lg_u32 s92, 0
    s_cbranch_scc1 L_s80_done
    s_lshl_b32 s79, s16, 7
    s_add_u32 s79, s79, 3936256
    v_mov_b32 v250, 0
    v_mov_b32 v251, 1
    s_mov_b64 exec, 1
    buffer_atomic_add v251, v250, s[4:7], s79 offen
    s_mov_b64 exec, -1
L_s80_done:
    s_waitcnt vmcnt(0) lgkmcnt(0)
    s_barrier
    v_accvgpr_read_b32 v0, a255
L_adaLN_cond__memory_aug_recurrent_mem_tr__dense_activation_gelu__prompt_kernel_q_next:
    s_add_u32 s85, s85, 32
    s_branch L_adaLN_cond__memory_aug_recurrent_mem_tr__dense_activation_gelu__prompt_kernel_qloop
L_adaLN_cond__memory_aug_recurrent_mem_tr__dense_activation_gelu__prompt_kernel_ph3:
    s_lshr_b32 s84, s95, 5
    s_and_b32 s85, s95, 31
    s_cmp_eq_u32 s80, 1
    s_cbranch_scc1 L_adaLN_cond__memory_aug_recurrent_mem_tr__dense_activation_gelu__prompt_kernel_postf
    s_mov_b32 s83, s85
    s_mov_b32 s81, s84
    s_mov_b32 s82, 1
    s_cmp_lg_u32 s92, 0
    s_cbranch_scc1 L_w81_done
    v_mov_b32 v250, 224
    s_mov_b32 s94, 400000
L_w81_spin:
    global_load_dword v251, v250, s[90:91] sc1
    s_waitcnt vmcnt(0)
    v_readfirstlane_b32 s93, v251
    s_nop 3
    s_cmp_ge_u32 s93, 28
    s_cbranch_scc1 L_w81_done
    s_sleep 1
    s_sub_u32 s94, s94, 1
    s_cbranch_scc0 L_w81_spin
L_w81_done:
    s_barrier
    s_barrier
    s_cmp_ge_u32 s83, 22
    s_cbranch_scc1 L_adaLN_cond__memory_aug_recurrent_mem_tr__dense_activation_gelu__prompt_kernel_ps_i1
    s_load_dwordx2 s[60:61], s[0:1], 64
    s_lshl_b32 s10, s83, 6
    s_mov_b32 s11, 0
    v_and_b32 v2, 63, v0
    v_lshrrev_b32 v6, 3, v2
    v_and_b32 v7, 7, v2
    s_mov_b32 s20, 2752
    v_add_u32 v8, 0, v6
    v_bfe_u32 v20, v8, 1, 1
    v_bfe_u32 v21, v8, 3, 1
    v_lshl_or_b32 v20, v21, 1, v20
    v_lshrrev_b32 v21, 1, v7
    v_xor_b32 v21, v21, v20
    v_and_b32 v22, 1, v7
    v_lshl_or_b32 v21, v21, 1, v22
    v_mul_lo_u32 v8, v8, s20
    v_lshl_add_u32 v8, v21, 4, v8
    v_add_u32 v9, 8, v6
    v_bfe_u32 v20, v9, 1, 1
    v_bfe_u32 v21, v9, 3, 1
    v_lshl_or_b32 v20, v21, 1, v20
    v_lshrrev_b32 v21, 1, v7
    v_xor_b32 v21, v21, v20
    v_and_b32 v22, 1, v7
    v_lshl_or_b32 v21, v21, 1, v22
    v_mul_lo_u32 v9, v9, s20
    v_lshl_add_u32 v9, v21, 4, v9
    s_waitcnt lgkmcnt(0)
    s_mov_b32 s12, s60
    s_and_b32 s13, s61, 0xffff
    s_mov_b32 s14, 1409024
    s_mov_b32 s15, 0x00020000
    s_sub_u32 s18, s92, 0
    s_lshl_b32 s29, s10, 1
    s_mul_i32 s28, s11, 88064
    s_add_u32 s28, s28, s29
    s_mul_i32 s29, s18, 44032
    s_add_u32 s16, s28, s29
    s_mul_i32 s30, s18, 2048
    s_add_u32 s17, s30, 0
    s_add_u32 s31, s16, 0
    s_add_u32 m0, s17, 0
    s_nop 0
    buffer_load_dwordx4 v8, s[12:15], s31 offen lds
    s_add_u32 m0, m0, 1024
    s_nop 0
    buffer_load_dwordx4 v9, s[12:15], s31 offen lds
    s_add_u32 s31, s16, 176128
    s_add_u32 m0, s17, 8192
    s_nop 0
    buffer_load_dwordx4 v8, s[12:15], s31 offen lds
    s_add_u32 m0, m0, 1024
    s_nop 0
    buffer_load_dwordx4 v9, s[12:15], s31 offen lds
    s_add_u32 s31, s16, 352256
    s_add_u32 m0, s17, 16384
    s_nop 0
    buffer_load_dwordx4 v8, s[12:15], s31 offen lds
    s_add_u32 m0, m0, 1024
    s_nop 0
    buffer_load_dwordx4 v9, s[12:15], s31 offen lds
    s_add_u32 s31, s16, 528384
    s_add_u32 m0, s17, 24576
    s_nop 0
    buffer_load_dwordx4 v8, s[12:15], s31 offen lds
    s_add_u32 m0, m0, 1024
    s_nop 0
    buffer_load_dwordx4 v9, s[12:15], s31 offen lds
    s_add_u32 s31, s16, 704512
    s_add_u32 m0, s17, 32768
    s_nop 0
    buffer_load_dwordx4 v8, s[12:15], s31 offen lds
    s_add_u32 m0, m0, 1024
    s_nop 0
    buffer_load_dwordx4 v9, s[12:15], s31 offen lds
    s_add_u32 s31, s16, 880640
    s_add_u32 m0, s17, 40960
    s_nop 0
    buffer_load_dwordx4 v8, s[12:15], s31 offen lds
    s_add_u32 m0, m0, 1024
    s_nop 0
    buffer_load_dwordx4 v9, s[12:15], s31 offen lds
    s_add_u32 s31, s16, 1056768
    s_add_u32 m0, s17, 49152
    s_nop 0
    buffer_load_dwordx4 v8, s[12:15], s31 offen lds
    s_add_u32 m0, m0, 1024
    s_nop 0
    buffer_load_dwordx4 v9, s[12:15], s31 offen lds
    s_add_u32 s31, s16, 1232896
    s_add_u32 m0, s17, 57344
    s_nop 0
    buffer_load_dwordx4 v8, s[12:15], s31 offen lds
    s_add_u32 m0, m0, 1024
    s_nop 0
    buffer_load_dwordx4 v9, s[12:15], s31 offen lds
L_adaLN_cond__memory_aug_recurrent_mem_tr__dense_activation_gelu__prompt_kernel_ps_i1:
    s_load_dwordx2 s[60:61], s[0:1], 80
    s_lshr_b32 s17, s83, 1
    s_and_b32 s19, s83, 1
    s_lshl_b32 s10, s17, 5
    s_mov_b32 s11, 0
    v_and_b32 v2, 63, v0
    v_lshrrev_b32 v6, 2, v2
    v_and_b32 v7, 3, v2
    s_mov_b32 s20, 1024
    v_add_u32 v8, 0, v6
    v_bfe_u32 v20, v8, 2, 1
    v_lshrrev_b32 v21, 1, v7
    v_xor_b32 v21, v21, v20
    v_and_b32 v22, 1, v7
    v_lshl_or_b32 v21, v21, 1, v22
    v_mul_lo_u32 v8, v8, s20
    v_lshl_add_u32 v8, v21, 4, v8
    s_waitcnt lgkmcnt(0)
    s_mov_b32 s12, s60
    s_and_b32 s13, s61, 0xffff
    s_mov_b32 s14, 1409024
    s_mov_b32 s15, 0x00020000
    s_sub_u32 s18, s92, 0
    s_lshl_b32 s29, s10, 1
    s_mul_i32 s28, s11, 32768
    s_add_u32 s28, s28, s29
    s_mul_i32 s29, s18, 16384
    s_add_u32 s16, s28, s29
    s_mul_i32 s30, s18, 1024
    s_add_u32 s17, s30, 65536
    s_add_u32 s31, s16, 0
    s_add_u32 m0, s17, 0
    s_nop 0
    buffer_load_dwordx4 v8, s[12:15], s31 offen lds
    s_add_u32 s31, s16, 65536
    s_add_u32 m0, s17, 4096
    s_nop 0
    buffer_load_dwordx4 v8, s[12:15], s31 offen lds
    s_add_u32 s31, s16, 131072
    s_add_u32 m0, s17, 8192
    s_nop 0
    buffer_load_dwordx4 v8, s[12:15], s31 offen lds
    s_add_u32 s31, s16, 196608
    s_add_u32 m0, s17, 12288
    s_nop 0
    buffer_load_dwordx4 v8, s[12:15], s31 offen lds
    s_add_u32 s31, s16, 262144
    s_add_u32 m0, s17, 16384
    s_nop 0
    buffer_load_dwordx4 v8, s[12:15], s31 offen lds
    s_add_u32 s31, s16, 327680
    s_add_u32 m0, s17, 20480
    s_nop 0
    buffer_load_dwordx4 v8, s[12:15], s31 offen lds
    s_add_u32 s31, s16, 393216
    s_add_u32 m0, s17, 24576
    s_nop 0
    buffer_load_dwordx4 v8, s[12:15], s31 offen lds
    s_add_u32 s31, s16, 458752
    s_add_u32 m0, s17, 28672
    s_nop 0
    buffer_load_dwordx4 v8, s[12:15], s31 offen lds
    s_add_u32 s31, s16, 524288
    s_add_u32 m0, s17, 32768
    s_nop 0
    buffer_load_dwordx4 v8, s[12:15], s31 offen lds
    s_add_u32 s31, s16, 589824
    s_add_u32 m0, s17, 36864
    s_nop 0
    buffer_load_dwordx4 v8, s[12:15], s31 offen lds
    s_add_u32 s31, s16, 655360
    s_add_u32 m0, s17, 40960
    s_nop 0
    buffer_load_dwordx4 v8, s[12:15], s31 offen lds
    s_add_u32 s31, s16, 720896
    s_add_u32 m0, s17, 45056
    s_nop 0
    buffer_load_dwordx4 v8, s[12:15], s31 offen lds
    s_add_u32 s31, s16, 786432
    s_add_u32 m0, s17, 49152
    s_nop 0
    buffer_load_dwordx4 v8, s[12:15], s31 offen lds
    s_add_u32 s31, s16, 851968
    s_add_u32 m0, s17, 53248
    s_nop 0
    buffer_load_dwordx4 v8, s[12:15], s31 offen lds
    s_add_u32 s31, s16, 917504
    s_add_u32 m0, s17, 57344
    s_nop 0
    buffer_load_dwordx4 v8, s[12:15], s31 offen lds
    s_add_u32 s31, s16, 983040
    s_add_u32 m0, s17, 61440
    s_nop 0
    buffer_load_dwordx4 v8, s[12:15], s31 offen lds
    s_add_u32 s31, s16, 1048576
    s_add_u32 m0, s17, 65536
    s_nop 0
    buffer_load_dwordx4 v8, s[12:15], s31 offen lds
    s_add_u32 s31, s16, 1114112
    s_add_u32 m0, s17, 69632
    s_nop 0
    buffer_load_dwordx4 v8, s[12:15], s31 offen lds
    s_add_u32 s31, s16, 1179648
    s_add_u32 m0, s17, 73728
    s_nop 0
    buffer_load_dwordx4 v8, s[12:15], s31 offen lds
    s_add_u32 s31, s16, 1245184
    s_add_u32 m0, s17, 77824
    s_nop 0
    buffer_load_dwordx4 v8, s[12:15], s31 offen lds
    s_add_u32 s31, s16, 1310720
    s_add_u32 m0, s17, 81920
    s_nop 0
    buffer_load_dwordx4 v8, s[12:15], s31 offen lds
    s_add_u32 s31, s16, 1376256
    s_add_u32 m0, s17, 86016
    s_nop 0
    buffer_load_dwordx4 v8, s[12:15], s31 offen lds
    s_waitcnt vmcnt(0)
    s_barrier
    v_and_b32 v7, 63, v0
    v_lshlrev_b32 v7, 4, v7
    s_lshl_b32 s9, s92, 14
    v_add_u32 v6, s9, v7
    s_mul_i32 s9, s92, 22528
    s_add_u32 s9, s9, 65536
    v_add_u32 v7, s9, v7
    ds_read_b128 a[128:131], v6 offset:0
    ds_read_b128 a[132:135], v6 offset:1024
    ds_read_b128 a[136:139], v6 offset:2048
    ds_read_b128 a[140:143], v6 offset:3072
    ds_read_b128 a[144:147], v6 offset:4096
    ds_read_b128 a[148:151], v6 offset:5120
    ds_read_b128 a[152:155], v6 offset:6144
    ds_read_b128 a[156:159], v6 offset:7168
    ds_read_b128 a[160:163], v6 offset:8192
    ds_read_b128 a[164:167], v6 offset:9216
    ds_read_b128 a[168:171], v6 offset:10240
    ds_read_b128 a[172:175], v6 offset:11264
    ds_read_b128 a[176:179], v6 offset:12288
    ds_read_b128 a[180:183], v6 offset:13312
    ds_read_b128 a[184:187], v6 offset:14336
    ds_read_b128 a[188:191], v6 offset:15360
    ds_read_b128 a[192:195], v7 offset:0
    ds_read_b128 a[196:199], v7 offset:1024
    ds_read_b128 a[200:203], v7 offset:2048
    ds_read_b128 a[204:207], v7 offset:3072
    ds_read_b128 a[208:211], v7 offset:4096
    ds_read_b128 a[212:215], v7 offset:5120
    ds_read_b128 a[216:219], v7 offset:6144
    ds_read_b128 a[220:223], v7 offset:7168
    ds_read_b128 a[224:227], v7 offset:8192
    ds_read_b128 a[228:231], v7 offset:9216
    ds_read_b128 a[232:235], v7 offset:10240
    ds_read_b128 a[236:239], v7 offset:11264
    ds_read_b128 a[240:243], v7 offset:12288
    ds_read_b128 a[244:247], v7 offset:13312
    ds_read_b128 a[248:251], v7 offset:14336
    ds_read_b128 v[200:203], v7 offset:15360
    ds_read_b128 v[204:207], v7 offset:16384
    ds_read_b128 v[208:211], v7 offset:17408
    ds_read_b128 v[212:215], v7 offset:18432
    ds_read_b128 v[216:219], v7 offset:19456
    ds_read_b128 v[220:223], v7 offset:20480
    ds_read_b128 v[224:227], v7 offset:21504
    s_waitcnt lgkmcnt(0)
    s_barrier
L_adaLN_cond__memory_aug_recurrent_mem_tr__dense_activation_gelu__prompt_kernel_ps_loop:
    s_cmp_ge_u32 s81, 32
    s_cbranch_scc1 L_adaLN_cond__memory_aug_recurrent_mem_tr__dense_activation_gelu__prompt_kernel_ps_end
    s_load_dwordx2 s[60:61], s[0:1], 40
    s_lshr_b32 s17, s83, 3
    s_and_b32 s22, s83, 7
    s_lshl_b32 s10, s17, 7
    s_lshl_b32 s11, s22, 4
    v_and_b32 v2, 63, v0
    v_lshrrev_b32 v6, 4, v2
    v_and_b32 v7, 15, v2
    s_mov_b32 s20, 1024
    v_add_u32 v8, 0, v6
    v_and_b32 v20, 3, v8
    v_bfe_u32 v21, v8, 3, 1
    v_lshl_or_b32 v20, v21, 2, v20
    v_lshrrev_b32 v21, 1, v7
    v_xor_b32 v21, v21, v20
    v_and_b32 v22, 1, v7
    v_lshl_or_b32 v21, v21, 1, v22
    v_mul_lo_u32 v8, v8, s20
    v_lshl_add_u32 v8, v21, 4, v8
    v_add_u32 v9, 4, v6
    v_and_b32 v20, 3, v9
    v_bfe_u32 v21, v9, 3, 1
    v_lshl_or_b32 v20, v21, 2, v20
    v_lshrrev_b32 v21, 1, v7
    v_xor_b32 v21, v21, v20
    v_and_b32 v22, 1, v7
    v_lshl_or_b32 v21, v21, 1, v22
    v_mul_lo_u32 v9, v9, s20
    v_lshl_add_u32 v9, v21, 4, v9
    v_add_u32 v10, 8, v6
    v_and_b32 v20, 3, v10
    v_bfe_u32 v21, v10, 3, 1
    v_lshl_or_b32 v20, v21, 2, v20
    v_lshrrev_b32 v21, 1, v7
    v_xor_b32 v21, v21, v20
    v_and_b32 v22, 1, v7
    v_lshl_or_b32 v21, v21, 1, v22
    v_mul_lo_u32 v10, v10, s20
    v_lshl_add_u32 v10, v21, 4, v10
    v_add_u32 v11, 12, v6
    v_and_b32 v20, 3, v11
    v_bfe_u32 v21, v11, 3, 1
    v_lshl_or_b32 v20, v21, 2, v20
    v_lshrrev_b32 v21, 1, v7
    v_xor_b32 v21, v21, v20
    v_and_b32 v22, 1, v7
    v_lshl_or_b32 v21, v21, 1, v22
    v_mul_lo_u32 v11, v11, s20
    v_lshl_add_u32 v11, v21, 4, v11
    s_waitcnt lgkmcnt(0)
    s_mov_b32 s12, s60
    s_and_b32 s13, s61, 0xffff
    s_mov_b32 s14, 4194304
    s_mov_b32 s15, 0x00020000
    s_sub_u32 s18, s92, 0
    s_lshl_b32 s29, s10, 1
    s_mul_i32 s28, s11, 32768
    s_add_u32 s28, s28, s29
    s_mul_i32 s29, s18, 16384
    s_add_u32 s16, s28, s29
    s_mul_i32 s30, s18, 4096
    s_add_u32 s17, s30, 0
    s_add_u32 s31, s16, 0
    s_add_u32 m0, s17, 0
    s_nop 0
    buffer_load_dwordx4 v8, s[12:15], s31 offen lds
    s_add_u32 m0, m0, 1024
    s_nop 0
    buffer_load_dwordx4 v9, s[12:15], s31 offen lds
    s_add_u32 m0, m0, 1024
    s_nop 0
    buffer_load_dwordx4 v10, s[12:15], s31 offen lds
    s_add_u32 m0, m0, 1024
    s_nop 0
    buffer_load_dwordx4 v11, s[12:15], s31 offen lds
    s_add_u32 s31, s16, 65536
    s_add_u32 m0, s17, 16384
    s_nop 0
    buffer_load_dwordx4 v8, s[12:15], s31 offen lds
    s_add_u32 m0, m0, 1024
    s_nop 0
    buffer_load_dwordx4 v9, s[12:15], s31 offen lds
    s_add_u32 m0, m0, 1024
    s_nop 0
    buffer_load_dwordx4 v10, s[12:15], s31 offen lds
    s_add_u32 m0, m0, 1024
    s_nop 0
    buffer_load_dwordx4 v11, s[12:15], s31 offen lds
    s_add_u32 s31, s16, 131072
    s_add_u32 m0, s17, 32768
    s_nop 0
    buffer_load_dwordx4 v8, s[12:15], s31 offen lds
    s_add_u32 m0, m0, 1024
    s_nop 0
    buffer_load_dwordx4 v9, s[12:15], s31 offen lds
    s_add_u32 m0, m0, 1024
    s_nop 0
    buffer_load_dwordx4 v10, s[12:15], s31 offen lds
    s_add_u32 m0, m0, 1024
    s_nop 0
    buffer_load_dwordx4 v11, s[12:15], s31 offen lds
    s_add_u32 s31, s16, 196608
    s_add_u32 m0, s17, 49152
    s_nop 0
    buffer_load_dwordx4 v8, s[12:15], s31 offen lds
    s_add_u32 m0, m0, 1024
    s_nop 0
    buffer_load_dwordx4 v9, s[12:15], s31 offen lds
    s_add_u32 m0, m0, 1024
    s_nop 0
    buffer_load_dwordx4 v10, s[12:15], s31 offen lds
    s_add_u32 m0, m0, 1024
    s_nop 0
    buffer_load_dwordx4 v11, s[12:15], s31 offen lds
    s_add_u32 s31, s16, 262144
    s_add_u32 m0, s17, 65536
    s_nop 0
    buffer_load_dwordx4 v8, s[12:15], s31 offen lds
    s_add_u32 m0, m0, 1024
    s_nop 0
    buffer_load_dwordx4 v9, s[12:15], s31 offen lds
    s_add_u32 m0, m0, 1024
    s_nop 0
    buffer_load_dwordx4 v10, s[12:15], s31 offen lds
    s_add_u32 m0, m0, 1024
    s_nop 0
    buffer_load_dwordx4 v11, s[12:15], s31 offen lds
    s_add_u32 s31, s16, 327680
    s_add_u32 m0, s17, 81920
    s_nop 0
    buffer_load_dwordx4 v8, s[12:15], s31 offen lds
    s_add_u32 m0, m0, 1024
    s_nop 0
    buffer_load_dwordx4 v9, s[12:15], s31 offen lds
    s_add_u32 m0, m0, 1024
    s_nop 0
    buffer_load_dwordx4 v10, s[12:15], s31 offen lds
    s_add_u32 m0, m0, 1024
    s_nop 0
    buffer_load_dwordx4 v11, s[12:15], s31 offen lds
    s_add_u32 s31, s16, 393216
    s_add_u32 m0, s17, 98304
    s_nop 0
    buffer_load_dwordx4 v8, s[12:15], s31 offen lds
    s_add_u32 m0, m0, 1024
    s_nop 0
    buffer_load_dwordx4 v9, s[12:15], s31 offen lds
    s_add_u32 m0, m0, 1024
    s_nop 0
    buffer_load_dwordx4 v10, s[12:15], s31 offen lds
    s_add_u32 m0, m0, 1024
    s_nop 0
    buffer_load_dwordx4 v11, s[12:15], s31 offen lds
    s_add_u32 s31, s16, 458752
    s_add_u32 m0, s17, 114688
    s_nop 0
    buffer_load_dwordx4 v8, s[12:15], s31 offen lds
    s_add_u32 m0, m0, 1024
    s_nop 0
    buffer_load_dwordx4 v9, s[12:15], s31 offen lds
    s_add_u32 m0, m0, 1024
    s_nop 0
    buffer_load_dwordx4 v10, s[12:15], s31 offen lds
    s_add_u32 m0, m0, 1024
    s_nop 0
    buffer_load_dwordx4 v11, s[12:15], s31 offen lds
    s_cmp_ge_u32 s83, 16
    s_cbranch_scc1 L_adaLN_cond__memory_aug_recurrent_mem_tr__dense_activation_gelu__prompt_kernel_ps_noatt
    s_lshl_b32 s2, s81, 4
    s_add_u32 s2, s2, s83
    v_and_b32 v2, 63, v0
    s_lshr_b32 s22, s2, 5
    s_lshr_b32 s23, s2, 3
    s_and_b32 s24, s2, 7
    s_lshl_b32 s24, s24, 2
    s_add_u32 s24, s24, s92
    s_lshl_b32 s9, s23, 5
    s_add_u32 s9, s9, s24
    v_lshlrev_b32 v3, 4, v2
    v_and_b32 v4, 15, v2
    v_lshrrev_b32 v5, 4, v2
    s_lshl_b32 s10, s9, 13
    s_add_u32 s11, s10, 50331648
    s_add_u32 s12, s10, 16777216
    s_add_u32 s13, s10, 33554432
    s_lshl_b32 s14, s9, 11
    s_add_u32 s14, s14, 4194304
    s_lshl_b32 s15, s9, 12
    s_add_u32 s15, s15, 8388608
    s_cmp_lg_u32 s92, 0
    s_cbranch_scc1 L_w82_done
    s_lshl_b32 s79, s22, 7
    s_add_u32 s79, s79, 3936256
    v_mov_b32 v250, 0
    s_mov_b32 s94, 400000
L_w82_spin:
    buffer_load_dword v251, v250, s[4:7], s79 offen sc1
    s_waitcnt vmcnt(0)
    v_readfirstlane_b32 s93, v251
    s_nop 3
    s_cmp_ge_u32 s93, 32
    s_cbranch_scc1 L_w82_done
    s_sleep 1
    s_sub_u32 s94, s94, 1
    s_cbranch_scc0 L_w82_spin
L_w82_done:
    s_barrier
    buffer_load_dwordx4 v[8:11], v3, s[4:7], s11 offen offset:0 sc1
    buffer_load_dwordx4 v[12:15], v3, s[4:7], s11 offen offset:1024 sc1
    buffer_load_dwordx4 v[16:19], v3, s[4:7], s11 offen offset:2048 sc1
    buffer_load_dwordx4 v[20:23], v3, s[4:7], s11 offen offset:3072 sc1
    s_add_u32 s11, s11, 4096
    buffer_load_dwordx4 v[24:27], v3, s[4:7], s11 offen offset:0 sc1
    buffer_load_dwordx4 v[28:31], v3, s[4:7], s11 offen offset:1024 sc1
    buffer_load_dwordx4 v[32:35], v3, s[4:7], s11 offen offset:2048 sc1
    buffer_load_dwordx4 v[36:39], v3, s[4:7], s11 offen offset:3072 sc1
    buffer_load_dwordx4 v[40:43], v3, s[4:7], s12 offen offset:0 sc1
    buffer_load_dwordx4 v[44:47], v3, s[4:7], s12 offen offset:1024 sc1
    buffer_load_dwordx4 v[48:51], v3, s[4:7], s12 offen offset:2048 sc1
    buffer_load_dwordx4 v[52:55], v3, s[4:7], s12 offen offset:3072 sc1
    s_add_u32 s12, s12, 4096
    buffer_load_dwordx4 v[56:59], v3, s[4:7], s12 offen offset:0 sc1
    buffer_load_dwordx4 v[60:63], v3, s[4:7], s12 offen offset:1024 sc1
    buffer_load_dwordx4 v[64:67], v3, s[4:7], s12 offen offset:2048 sc1
    buffer_load_dwordx4 v[68:71], v3, s[4:7], s12 offen offset:3072 sc1
    buffer_load_dwordx4 v[72:75], v3, s[4:7], s13 offen offset:0 sc1
    buffer_load_dwordx4 v[76:79], v3, s[4:7], s13 offen offset:1024 sc1
    buffer_load_dwordx4 v[80:83], v3, s[4:7], s13 offen offset:2048 sc1
    buffer_load_dwordx4 v[84:87], v3, s[4:7], s13 offen offset:3072 sc1
    s_add_u32 s13, s13, 4096
    buffer_load_dwordx4 v[88:91], v3, s[4:7], s13 offen offset:0 sc1
    buffer_load_dwordx4 v[92:95], v3, s[4:7], s13 offen offset:1024 sc1
    buffer_load_dwordx4 v[96:99], v3, s[4:7], s13 offen offset:2048 sc1
    buffer_load_dwordx4 v[100:103], v3, s[4:7], s13 offen offset:3072 sc1
    v_lshlrev_b32 v104, 2, v5
    v_sub_u32 v104, v4, v104
    v_mov_b32 v108, 0x3f803f80
    v_mov_b32 v109, 0x3f803f80
    v_mov_b32 v110, 0x3f803f80
    v_mov_b32 v111, 0x3f803f80
    v_mov_b32 v106, 0x3f003f00
    v_mov_b32 v107, 0x3f003f00
    s_mov_b32 s20, 0x3e0293ee
    s_mov_b32 s21, 0xff800000
    s_lshl_b32 s17, s23, 18
    s_lshl_b32 s18, s24, 12
    s_add_u32 s17, s17, s18
    s_add_u32 s17, s17, 67108864
    s_waitcnt vmcnt(15)
    v_mfma_f32_16x16x32_bf16 v[112:115], v[40:43], v[8:11], 0
    s_waitcnt vmcnt(14)
    v_mfma_f32_16x16x32_bf16 v[112:115], v[44:47], v[12:15], v[112:115]
    s_waitcnt vmcnt(13)
    v_mfma_f32_16x16x32_bf16 v[112:115], v[48:51], v[16:19], v[112:115]
    s_waitcnt vmcnt(12)
    v_mfma_f32_16x16x32_bf16 v[112:115], v[52:55], v[20:23], v[112:115]
    v_mov_b32 v105, s21
    v_cmp_le_i32 vcc, 0, v104
    s_nop 5
    v_cndmask_b32 v112, v105, v112, vcc
    v_cmp_le_i32 vcc, 1, v104
    s_nop 1
    v_cndmask_b32 v113, v105, v113, vcc
    v_cmp_le_i32 vcc, 2, v104
    s_nop 1
    v_cndmask_b32 v114, v105, v114, vcc
    v_cmp_le_i32 vcc, 3, v104
    s_nop 1
    v_cndmask_b32 v115, v105, v115, vcc
    v_mfma_f32_16x16x32_bf16 v[116:119], v[40:43], v[24:27], 0
    s_waitcnt vmcnt(11)
    v_mfma_f32_16x16x32_bf16 v[40:43], v[56:59], v[24:27], 0
    v_mfma_f32_16x16x32_bf16 v[116:119], v[44:47], v[28:31], v[116:119]
    s_waitcnt vmcnt(10)
    v_mfma_f32_16x16x32_bf16 v[40:43], v[60:63], v[28:31], v[40:43]
    v_mfma_f32_16x16x32_bf16 v[116:119], v[48:51], v[32:35], v[116:119]
    s_waitcnt vmcnt(9)
    v_mfma_f32_16x16x32_bf16 v[40:43], v[64:67], v[32:35], v[40:43]
    v_mfma_f32_16x16x32_bf16 v[116:119], v[52:55], v[36:39], v[116:119]
    s_waitcnt vmcnt(8)
    v_mfma_f32_16x16x32_bf16 v[40:43], v[68:71], v[36:39], v[40:43]
    v_mov_b32 v44, s21
    v_cmp_le_i32 vcc, 0, v104
    s_nop 5
    v_cndmask_b32 v40, v44, v40, vcc
    v_cmp_le_i32 vcc, 1, v104
    s_nop 1
    v_cndmask_b32 v41, v44, v41, vcc
    v_cmp_le_i32 vcc, 2, v104
    s_nop 1
    v_cndmask_b32 v42, v44, v42, vcc
    v_cmp_le_i32 vcc, 3, v104
    s_nop 1
    v_cndmask_b32 v43, v44, v43, vcc
    s_add_u32 s26, s23, 1
    s_cmp_ge_u32 s23, 62
    s_cselect_b32 s27, 1, 0
    s_cselect_b32 s26, 32, s26
    s_cmp_lg_u32 s92, 0
    s_cbranch_scc1 L_w83_done
    s_lshl_b32 s79, s27, 7
    s_add_u32 s79, s79, 3946496
    v_mov_b32 v250, 0
    s_mov_b32 s94, 400000
L_w83_spin:
    buffer_load_dword v251, v250, s[4:7], s79 offen sc1
    s_waitcnt vmcnt(0)
    v_readfirstlane_b32 s93, v251
    s_nop 3
    s_cmp_ge_u32 s93, s26
    s_cbranch_scc1 L_w83_done
    s_cmp_eq_u32 s27, 1
    s_cbranch_scc1 L_w83_fast
    s_sleep 16
L_w83_fast:
    s_sleep 1
    s_sub_u32 s94, s94, 1
    s_cbranch_scc0 L_w83_spin
L_w83_done:
    s_barrier
    v_lshrrev_b32 v44, 1, v3
    buffer_load_dwordx2 v[46:47], v44, s[4:7], s14 offen offset:0 sc1
    buffer_load_dwordx2 v[48:49], v44, s[4:7], s14 offen offset:512 sc1
    buffer_load_dwordx2 v[50:51], v44, s[4:7], s14 offen offset:1024 sc1
    buffer_load_dwordx2 v[52:53], v44, s[4:7], s14 offen offset:1536 sc1
    buffer_load_dwordx4 v[56:59], v3, s[4:7], s15 offen offset:0 sc1
    buffer_load_dwordx4 v[60:63], v3, s[4:7], s15 offen offset:1024 sc1
    buffer_load_dwordx4 v[64:67], v3, s[4:7], s15 offen offset:2048 sc1
    buffer_load_dwordx4 v[68:71], v3, s[4:7], s15 offen offset:3072 sc1
    s_mul_i32 s16, s92, 2176
    s_add_u32 s16, s16, 131072
    v_and_b32 v44, 1, v5
    v_mul_u32_u24 v44, 1088, v44
    v_lshrrev_b32 v45, 1, v5
    v_lshl_add_u32 v45, v4, 1, v45
    v_lshl_add_u32 v44, v45, 3, v44
    v_add_u32 v44, s16, v44
    s_waitcnt vmcnt(7)
    ds_write_b64 v44, v[46:47] offset:0
    s_waitcnt vmcnt(6)
    ds_write_b64 v44, v[48:49] offset:256
    s_waitcnt vmcnt(5)
    ds_write_b64 v44, v[50:51] offset:512
    s_waitcnt vmcnt(4)
    ds_write_b64 v44, v[52:53] offset:768
    v_and_b32 v44, 1, v2
    v_mul_u32_u24 v44, 1088, v44
    v_lshrrev_b32 v45, 2, v4
    v_lshl_add_u32 v45, v5, 2, v45
    v_lshl_add_u32 v44, v45, 3, v44
    v_add_u32 v44, s16, v44
    s_waitcnt lgkmcnt(0)
    ds_read_b64_tr_b16 v[48:49], v44 offset:0
    ds_read_b64_tr_b16 v[50:51], v44 offset:128
    ds_read_b64_tr_b16 v[52:53], v44 offset:256
    ds_read_b64_tr_b16 v[54:55], v44 offset:384
    ds_read_b64_tr_b16 v[120:121], v44 offset:512
    ds_read_b64_tr_b16 v[122:123], v44 offset:640
    ds_read_b64_tr_b16 v[124:125], v44 offset:768
    ds_read_b64_tr_b16 v[126:127], v44 offset:896
    s_waitcnt lgkmcnt(6)
    v_mfma_f32_16x16x32_bf16 v[44:47], v[48:51], v[8:11], 0
    s_waitcnt lgkmcnt(4)
    v_mfma_f32_16x16x32_bf16 v[44:47], v[52:55], v[12:15], v[44:47]
    s_waitcnt lgkmcnt(2)
    v_mfma_f32_16x16x32_bf16 v[44:47], v[120:123], v[16:19], v[44:47]
    s_waitcnt lgkmcnt(0)
    v_mfma_f32_16x16x32_bf16 v[44:47], v[124:127], v[20:23], v[44:47]
    v_max3_f32 v8, v112, v113, v114
    s_nop 6
    v_max3_f32 v8, v8, v115, v44
    v_max3_f32 v8, v8, v45, v46
    v_max_f32 v8, v8, v47
    v_mov_b32 v9, v8
    s_nop 1
    v_permlane32_swap_b32 v8, v9
    v_max_f32 v8, v8, v9
    v_mov_b32 v9, v8
    s_nop 1
    v_permlane16_swap_b32 v8, v9
    v_max_f32 v8, v8, v9
    v_mul_f32 v8, s20, v8
    v_fma_f32 v112, v112, s20, -v8
    v_fma_f32 v113, v113, s20, -v8
    v_fma_f32 v114, v114, s20, -v8
    v_fma_f32 v115, v115, s20, -v8
    v_fma_f32 v44, v44, s20, -v8
    v_fma_f32 v45, v45, s20, -v8
    v_fma_f32 v46, v46, s20, -v8
    v_fma_f32 v47, v47, s20, -v8
    v_exp_f32 v112, v112
    v_exp_f32 v113, v113
    v_exp_f32 v114, v114
    v_exp_f32 v115, v115
    v_exp_f32 v44, v44
    v_exp_f32 v45, v45
    v_exp_f32 v46, v46
    v_exp_f32 v47, v47
    v_cvt_pk_bf16_f32 v8, v112, v113
    v_cvt_pk_bf16_f32 v9, v114, v115
    v_mov_b32 v10, 0
    v_mov_b32 v11, 0
    v_cvt_pk_bf16_f32 v12, v44, v45
    v_cvt_pk_bf16_f32 v13, v46, v47
    v_mfma_f32_16x16x32_bf16 v[16:19], v[108:111], v[8:11], 0
    v_mfma_f32_16x16x32_bf16 v[20:23], v[72:75], v[8:11], 0
    v_mfma_f32_16x16x32_bf16 v[44:47], v[76:79], v[8:11], 0
    v_mfma_f32_16x16x32_bf16 v[112:115], v[80:83], v[8:11], 0
    v_mfma_f32_16x16x32_bf16 v[128:131], v[84:87], v[8:11], 0
    v_mfma_f32_16x16x32_bf16 v[132:135], v[88:91], v[8:11], 0
    v_mfma_f32_16x16x32_bf16 v[136:139], v[92:95], v[8:11], 0
    v_mfma_f32_16x16x32_bf16 v[140:143], v[96:99], v[8:11], 0
    v_mfma_f32_16x16x32_bf16 v[144:147], v[100:103], v[8:11], 0
    v_mfma_f32_16x16x16_bf16 v[16:19], v[106:107], v[12:13], v[16:19]
    s_waitcnt vmcnt(3)
    v_mfma_f32_16x16x16_bf16 v[20:23], v[56:57], v[12:13], v[20:23]
    v_mfma_f32_16x16x16_bf16 v[44:47], v[58:59], v[12:13], v[44:47]
    s_waitcnt vmcnt(2)
    v_mfma_f32_16x16x16_bf16 v[112:115], v[60:61], v[12:13], v[112:115]
    v_mfma_f32_16x16x16_bf16 v[128:131], v[62:63], v[12:13], v[128:131]
    s_waitcnt vmcnt(1)
    v_mfma_f32_16x16x16_bf16 v[132:135], v[64:65], v[12:13], v[132:135]
    v_mfma_f32_16x16x16_bf16 v[136:139], v[66:67], v[12:13], v[136:139]
    s_waitcnt vmcnt(0)
    v_mfma_f32_16x16x16_bf16 v[140:143], v[68:69], v[12:13], v[140:143]
    v_mfma_f32_16x16x16_bf16 v[144:147], v[70:71], v[12:13], v[144:147]
    v_rcp_f32 v8, v16
    s_nop 0
    v_mul_f32 v20, v20, v8
    v_mul_f32 v44, v44, v8
    v_cvt_pk_bf16_f32 v12, v20, v44
    v_mul_f32 v21, v21, v8
    v_mul_f32 v45, v45, v8
    v_cvt_pk_bf16_f32 v13, v21, v45
    v_mul_f32 v22, v22, v8
    v_mul_f32 v46, v46, v8
    v_cvt_pk_bf16_f32 v14, v22, v46
    v_mul_f32 v23, v23, v8
    v_mul_f32 v47, v47, v8
    v_cvt_pk_bf16_f32 v15, v23, v47
    buffer_store_dwordx4 v[12:15], v3, s[4:7], s17 offen offset:0 sc1
    v_mul_f32 v112, v112, v8
    v_mul_f32 v128, v128, v8
    v_cvt_pk_bf16_f32 v12, v112, v128
    v_mul_f32 v113, v113, v8
    v_mul_f32 v129, v129, v8
    v_cvt_pk_bf16_f32 v13, v113, v129
    v_mul_f32 v114, v114, v8
    v_mul_f32 v130, v130, v8
    v_cvt_pk_bf16_f32 v14, v114, v130
    v_mul_f32 v115, v115, v8
    v_mul_f32 v131, v131, v8
    v_cvt_pk_bf16_f32 v15, v115, v131
    buffer_store_dwordx4 v[12:15], v3, s[4:7], s17 offen offset:1024 sc1
    v_mul_f32 v132, v132, v8
    v_mul_f32 v136, v136, v8
    v_cvt_pk_bf16_f32 v12, v132, v136
    v_mul_f32 v133, v133, v8
    v_mul_f32 v137, v137, v8
    v_cvt_pk_bf16_f32 v13, v133, v137
    v_mul_f32 v134, v134, v8
    v_mul_f32 v138, v138, v8
    v_cvt_pk_bf16_f32 v14, v134, v138
    v_mul_f32 v135, v135, v8
    v_mul_f32 v139, v139, v8
    v_cvt_pk_bf16_f32 v15, v135, v139
    buffer_store_dwordx4 v[12:15], v3, s[4:7], s17 offen offset:2048 sc1
    v_mul_f32 v140, v140, v8
    v_mul_f32 v144, v144, v8
    v_cvt_pk_bf16_f32 v12, v140, v144
    v_mul_f32 v141, v141, v8
    v_mul_f32 v145, v145, v8
    v_cvt_pk_bf16_f32 v13, v141, v145
    v_mul_f32 v142, v142, v8
    v_mul_f32 v146, v146, v8
    v_cvt_pk_bf16_f32 v14, v142, v146
    v_mul_f32 v143, v143, v8
    v_mul_f32 v147, v147, v8
    v_cvt_pk_bf16_f32 v15, v143, v147
    buffer_store_dwordx4 v[12:15], v3, s[4:7], s17 offen offset:3072 sc1
    s_add_u32 s17, s17, 131072
    v_mfma_f32_16x16x32_bf16 v[8:11], v[48:51], v[24:27], 0
    v_mfma_f32_16x16x32_bf16 v[8:11], v[52:55], v[28:31], v[8:11]
    v_mfma_f32_16x16x32_bf16 v[8:11], v[120:123], v[32:35], v[8:11]
    v_mfma_f32_16x16x32_bf16 v[8:11], v[124:127], v[36:39], v[8:11]
    v_max3_f32 v12, v116, v117, v118
    v_max3_f32 v12, v12, v119, v40
    v_max3_f32 v12, v12, v41, v42
    s_nop 4
    v_max3_f32 v12, v12, v43, v8
    v_max3_f32 v12, v12, v9, v10
    v_max_f32 v12, v12, v11
    v_mov_b32 v13, v12
    s_nop 1
    v_permlane32_swap_b32 v12, v13
    v_max_f32 v12, v12, v13
    v_mov_b32 v13, v12
    s_nop 1
    v_permlane16_swap_b32 v12, v13
    v_max_f32 v12, v12, v13
    v_mul_f32 v12, s20, v12
    v_fma_f32 v116, v116, s20, -v12
    v_fma_f32 v117, v117, s20, -v12
    v_fma_f32 v118, v118, s20, -v12
    v_fma_f32 v119, v119, s20, -v12
    v_fma_f32 v40, v40, s20, -v12
    v_fma_f32 v41, v41, s20, -v12
    v_fma_f32 v42, v42, s20, -v12
    v_fma_f32 v43, v43, s20, -v12
    v_fma_f32 v8, v8, s20, -v12
    v_fma_f32 v9, v9, s20, -v12
    v_fma_f32 v10, v10, s20, -v12
    v_fma_f32 v11, v11, s20, -v12
    v_exp_f32 v116, v116
    v_exp_f32 v117, v117
    v_exp_f32 v118, v118
    v_exp_f32 v119, v119
    v_exp_f32 v40, v40
    v_exp_f32 v41, v41
    v_exp_f32 v42, v42
    v_exp_f32 v43, v43
    v_exp_f32 v8, v8
    v_exp_f32 v9, v9
    v_exp_f32 v10, v10
    v_exp_f32 v11, v11
    v_cvt_pk_bf16_f32 v12, v116, v117
    v_cvt_pk_bf16_f32 v13, v118, v119
    v_cvt_pk_bf16_f32 v14, v40, v41
    v_cvt_pk_bf16_f32 v15, v42, v43
    v_cvt_pk_bf16_f32 v16, v8, v9
    v_cvt_pk_bf16_f32 v17, v10, v11
    v_mfma_f32_16x16x32_bf16 v[8:11], v[108:111], v[12:15], 0
    v_mfma_f32_16x16x32_bf16 v[20:23], v[72:75], v[12:15], 0
    v_mfma_f32_16x16x32_bf16 v[24:27], v[76:79], v[12:15], 0
    v_mfma_f32_16x16x32_bf16 v[28:31], v[80:83], v[12:15], 0
    v_mfma_f32_16x16x32_bf16 v[32:35], v[84:87], v[12:15], 0
    v_mfma_f32_16x16x32_bf16 v[36:39], v[88:91], v[12:15], 0
    v_mfma_f32_16x16x32_bf16 v[40:43], v[92:95], v[12:15], 0
    v_mfma_f32_16x16x32_bf16 v[44:47], v[96:99], v[12:15], 0
    v_mfma_f32_16x16x32_bf16 v[48:51], v[100:103], v[12:15], 0
    v_mfma_f32_16x16x16_bf16 v[8:11], v[106:107], v[16:17], v[8:11]
    v_mfma_f32_16x16x16_bf16 v[20:23], v[56:57], v[16:17], v[20:23]
    v_mfma_f32_16x16x16_bf16 v[24:27], v[58:59], v[16:17], v[24:27]
    v_mfma_f32_16x16x16_bf16 v[28:31], v[60:61], v[16:17], v[28:31]
    v_mfma_f32_16x16x16_bf16 v[32:35], v[62:63], v[16:17], v[32:35]
    v_mfma_f32_16x16x16_bf16 v[36:39], v[64:65], v[16:17], v[36:39]
    v_mfma_f32_16x16x16_bf16 v[40:43], v[66:67], v[16:17], v[40:43]
    v_mfma_f32_16x16x16_bf16 v[44:47], v[68:69], v[16:17], v[44:47]
    v_mfma_f32_16x16x16_bf16 v[48:51], v[70:71], v[16:17], v[48:51]
    v_rcp_f32 v12, v8
    s_nop 0
    v_mul_f32 v20, v20, v12
    v_mul_f32 v24, v24, v12
    v_cvt_pk_bf16_f32 v8, v20, v24
    v_mul_f32 v21, v21, v12
    v_mul_f32 v25, v25, v12
    v_cvt_pk_bf16_f32 v9, v21, v25
    v_mul_f32 v22, v22, v12
    v_mul_f32 v26, v26, v12
    v_cvt_pk_bf16_f32 v10, v22, v26
    v_mul_f32 v23, v23, v12
    v_mul_f32 v27, v27, v12
    v_cvt_pk_bf16_f32 v11, v23, v27
    buffer_store_dwordx4 v[8:11], v3, s[4:7], s17 offen offset:0 sc1
    v_mul_f32 v28, v28, v12
    v_mul_f32 v32, v32, v12
    v_cvt_pk_bf16_f32 v8, v28, v32
    v_mul_f32 v29, v29, v12
    v_mul_f32 v33, v33, v12
    v_cvt_pk_bf16_f32 v9, v29, v33
    v_mul_f32 v30, v30, v12
    v_mul_f32 v34, v34, v12
    v_cvt_pk_bf16_f32 v10, v30, v34
    v_mul_f32 v31, v31, v12
    v_mul_f32 v35, v35, v12
    v_cvt_pk_bf16_f32 v11, v31, v35
    buffer_store_dwordx4 v[8:11], v3, s[4:7], s17 offen offset:1024 sc1
    v_mul_f32 v36, v36, v12
    v_mul_f32 v40, v40, v12
    v_cvt_pk_bf16_f32 v8, v36, v40
    v_mul_f32 v37, v37, v12
    v_mul_f32 v41, v41, v12
    v_cvt_pk_bf16_f32 v9, v37, v41
    v_mul_f32 v38, v38, v12
    v_mul_f32 v42, v42, v12
    v_cvt_pk_bf16_f32 v10, v38, v42
    v_mul_f32 v39, v39, v12
    v_mul_f32 v43, v43, v12
    v_cvt_pk_bf16_f32 v11, v39, v43
    buffer_store_dwordx4 v[8:11], v3, s[4:7], s17 offen offset:2048 sc1
    v_mul_f32 v44, v44, v12
    v_mul_f32 v48, v48, v12
    v_cvt_pk_bf16_f32 v8, v44, v48
    v_mul_f32 v45, v45, v12
    v_mul_f32 v49, v49, v12
    v_cvt_pk_bf16_f32 v9, v45, v49
    v_mul_f32 v46, v46, v12
    v_mul_f32 v50, v50, v12
    v_cvt_pk_bf16_f32 v10, v46, v50
    v_mul_f32 v47, v47, v12
    v_mul_f32 v51, v51, v12
    v_cvt_pk_bf16_f32 v11, v47, v51
    buffer_store_dwordx4 v[8:11], v3, s[4:7], s17 offen offset:3072 sc1
    s_waitcnt vmcnt(0)
    s_barrier
    s_cmp_lg_u32 s92, 0
    s_cbranch_scc1 L_g84_done
    s_lshl_b32 s79, s84, 9
    s_lshl_b32 s93, s83, 2
    s_add_u32 s79, s79, s93
    s_add_u32 s79, s79, 3948544
    v_mov_b32 v250, 0
    v_mov_b32 v251, s82
    s_mov_b64 exec, 1
    buffer_store_dword v251, v250, s[4:7], s79 offen sc1
    s_mov_b64 exec, -1
L_g84_done:
L_adaLN_cond__memory_aug_recurrent_mem_tr__dense_activation_gelu__prompt_kernel_ps_noatt:
    s_mov_b32 s16, s81
    s_lshr_b32 s17, s83, 3
    s_and_b32 s22, s83, 7
    s_lshl_b32 s10, s17, 7
    s_lshl_b32 s11, s22, 4
    v_and_b32 v2, 63, v0
    v_lshlrev_b32 v3, 4, v2
    v_and_b32 v4, 15, v2
    v_lshrrev_b32 v5, 4, v2
    v_lshrrev_b32 v20, 2, v4
    v_lshl_add_u32 v23, v5, 3, v20
    v_and_b32 v22, 3, v23
    v_bfe_u32 v21, v23, 3, 1
    v_lshl_or_b32 v22, v21, 2, v22
    v_mul_u32_u24 v21, 256, v23
    v_and_b32 v23, 3, v2
    v_lshl_add_u32 v21, v23, 3, v21
    v_xor_b32 v23, 0, v22
    v_lshl_add_u32 v12, v23, 5, v21
    v_add_u32 v24, 0x10000, v12
    v_xor_b32 v23, 1, v22
    v_lshl_add_u32 v13, v23, 5, v21
    v_add_u32 v25, 0x10000, v13
    v_xor_b32 v23, 2, v22
    v_lshl_add_u32 v14, v23, 5, v21
    v_add_u32 v26, 0x10000, v14
    v_xor_b32 v23, 3, v22
    v_lshl_add_u32 v15, v23, 5, v21
    v_add_u32 v27, 0x10000, v15
    v_xor_b32 v23, 4, v22
    v_lshl_add_u32 v16, v23, 5, v21
    v_add_u32 v28, 0x10000, v16
    v_xor_b32 v23, 5, v22
    v_lshl_add_u32 v17, v23, 5, v21
    v_add_u32 v29, 0x10000, v17
    v_xor_b32 v23, 6, v22
    v_lshl_add_u32 v18, v23, 5, v21
    v_add_u32 v30, 0x10000, v18
    v_xor_b32 v23, 7, v22
    v_lshl_add_u32 v19, v23, 5, v21
    v_add_u32 v31, 0x10000, v19
    s_waitcnt lgkmcnt(0)
    s_waitcnt vmcnt(0)
    s_cmp_lg_u32 s92, 0
    s_cbranch_scc1 L_g85_done
    s_lshl_b32 s79, s84, 9
    s_add_u32 s79, s79, 3948544
    v_mbcnt_lo_u32_b32 v250, -1, 0
    v_mbcnt_hi_u32_b32 v250, -1, v250
    v_min_u32 v250, 15, v250
    v_lshlrev_b32 v250, 2, v250
    s_mov_b32 s94, 400000
L_g85_spin:
    buffer_load_dword v251, v250, s[4:7], s79 offen sc1
    s_waitcnt vmcnt(0)
    v_cmp_gt_u32 vcc, s82, v251
    s_cbranch_vccz L_g85_done
    s_sub_u32 s94, s94, 1
    s_cbranch_scc0 L_g85_spin
L_g85_done:
    s_barrier
    s_lshl_b32 s9, s16, 2
    s_add_u32 s9, s9, s92
    s_and_b32 s8, s9, 3
    s_lshl_b32 s18, s84, 3
    s_add_u32 s8, s8, s18
    s_mul_i32 s23, s9, 131072
    s_lshl_b32 s24, s11, 10
    s_add_u32 s23, s23, s24
    s_add_u32 s23, s23, 67108864
    s_add_u32 s24, s23, 131072
    buffer_load_dwordx4 a[0:3], v3, s[4:7], s23 offen offset:0 sc1
    buffer_load_dwordx4 a[4:7], v3, s[4:7], s23 offen offset:1024 sc1
    buffer_load_dwordx4 a[8:11], v3, s[4:7], s23 offen offset:2048 sc1
    buffer_load_dwordx4 a[12:15], v3, s[4:7], s23 offen offset:3072 sc1
    s_add_u32 s23, s23, 4096
    buffer_load_dwordx4 a[16:19], v3, s[4:7], s23 offen offset:0 sc1
    buffer_load_dwordx4 a[20:23], v3, s[4:7], s23 offen offset:1024 sc1
    buffer_load_dwordx4 a[24:27], v3, s[4:7], s23 offen offset:2048 sc1
    buffer_load_dwordx4 a[28:31], v3, s[4:7], s23 offen offset:3072 sc1
    s_add_u32 s23, s23, 4096
    buffer_load_dwordx4 a[32:35], v3, s[4:7], s23 offen offset:0 sc1
    buffer_load_dwordx4 a[36:39], v3, s[4:7], s23 offen offset:1024 sc1
    buffer_load_dwordx4 a[40:43], v3, s[4:7], s23 offen offset:2048 sc1
    buffer_load_dwordx4 a[44:47], v3, s[4:7], s23 offen offset:3072 sc1
    s_add_u32 s23, s23, 4096
    buffer_load_dwordx4 a[48:51], v3, s[4:7], s23 offen offset:0 sc1
    buffer_load_dwordx4 a[52:55], v3, s[4:7], s23 offen offset:1024 sc1
    buffer_load_dwordx4 a[56:59], v3, s[4:7], s23 offen offset:2048 sc1
    buffer_load_dwordx4 a[60:63], v3, s[4:7], s23 offen offset:3072 sc1
    s_lshl_b32 s36, s22, 22
    s_lshl_b32 s37, s9, 15
    s_add_u32 s36, s36, s37
    s_lshl_b32 s37, s10, 2
    s_add_u32 s36, s36, s37
    s_add_u32 s36, s36, 134217728
    s_add_u32 s37, s36, 32768
    v_lshlrev_b32 v20, 11, v4
    v_lshl_add_u32 v20, v5, 4, v20
    ds_read_b64_tr_b16 v[64:65], v12 offset:0
    ds_read_b64_tr_b16 v[66:67], v12 offset:1024
    ds_read_b64_tr_b16 v[68:69], v12 offset:8192
    ds_read_b64_tr_b16 v[70:71], v12 offset:9216
    ds_read_b64_tr_b16 v[72:73], v12 offset:16384
    ds_read_b64_tr_b16 v[74:75], v12 offset:17408
    ds_read_b64_tr_b16 v[76:77], v12 offset:24576
    ds_read_b64_tr_b16 v[78:79], v12 offset:25600
    ds_read_b64_tr_b16 v[80:81], v12 offset:32768
    ds_read_b64_tr_b16 v[82:83], v12 offset:33792
    ds_read_b64_tr_b16 v[84:85], v12 offset:40960
    ds_read_b64_tr_b16 v[86:87], v12 offset:41984
    s_waitcnt vmcnt(15) lgkmcnt(10)
    v_mfma_f32_16x16x32_bf16 v[32:35], v[64:67], a[0:3], 0
    ds_read_b64_tr_b16 v[88:89], v12 offset:49152
    ds_read_b64_tr_b16 v[90:91], v12 offset:50176
    s_waitcnt vmcnt(14) lgkmcnt(10)
    v_mfma_f32_16x16x32_bf16 v[32:35], v[68:71], a[4:7], v[32:35]
    ds_read_b64_tr_b16 v[92:93], v12 offset:57344
    ds_read_b64_tr_b16 v[94:95], v12 offset:58368
    s_waitcnt vmcnt(13) lgkmcnt(10)
    v_mfma_f32_16x16x32_bf16 v[32:35], v[72:75], a[8:11], v[32:35]
    ds_read_b64_tr_b16 v[64:65], v24 offset:0
    ds_read_b64_tr_b16 v[66:67], v24 offset:1024
    s_waitcnt vmcnt(12) lgkmcnt(10)
    v_mfma_f32_16x16x32_bf16 v[32:35], v[76:79], a[12:15], v[32:35]
    ds_read_b64_tr_b16 v[68:69], v24 offset:8192
    ds_read_b64_tr_b16 v[70:71], v24 offset:9216
    s_waitcnt vmcnt(11) lgkmcnt(10)
    v_mfma_f32_16x16x32_bf16 v[32:35], v[80:83], a[16:19], v[32:35]
    ds_read_b64_tr_b16 v[72:73], v24 offset:16384
    ds_read_b64_tr_b16 v[74:75], v24 offset:17408
    s_waitcnt vmcnt(10) lgkmcnt(10)
    v_mfma_f32_16x16x32_bf16 v[32:35], v[84:87], a[20:23], v[32:35]
    ds_read_b64_tr_b16 v[76:77], v24 offset:24576
    ds_read_b64_tr_b16 v[78:79], v24 offset:25600
    s_waitcnt vmcnt(9) lgkmcnt(10)
    v_mfma_f32_16x16x32_bf16 v[32:35], v[88:91], a[24:27], v[32:35]
    ds_read_b64_tr_b16 v[80:81], v24 offset:32768
    ds_read_b64_tr_b16 v[82:83], v24 offset:33792
    s_waitcnt vmcnt(8) lgkmcnt(10)
    v_mfma_f32_16x16x32_bf16 v[32:35], v[92:95], a[28:31], v[32:35]
    ds_read_b64_tr_b16 v[84:85], v24 offset:40960
    ds_read_b64_tr_b16 v[86:87], v24 offset:41984
    s_waitcnt vmcnt(7) lgkmcnt(10)
    v_mfma_f32_16x16x32_bf16 v[32:35], v[64:67], a[32:35], v[32:35]
    ds_read_b64_tr_b16 v[88:89], v24 offset:49152
    ds_read_b64_tr_b16 v[90:91], v24 offset:50176
    s_waitcnt vmcnt(6) lgkmcnt(10)
    v_mfma_f32_16x16x32_bf16 v[32:35], v[68:71], a[36:39], v[32:35]
    ds_read_b64_tr_b16 v[92:93], v24 offset:57344
    ds_read_b64_tr_b16 v[94:95], v24 offset:58368
    s_waitcnt vmcnt(5) lgkmcnt(10)
    v_mfma_f32_16x16x32_bf16 v[32:35], v[72:75], a[40:43], v[32:35]
    ds_read_b64_tr_b16 v[64:65], v13 offset:0
    ds_read_b64_tr_b16 v[66:67], v13 offset:1024
    s_waitcnt vmcnt(4) lgkmcnt(10)
    v_mfma_f32_16x16x32_bf16 v[32:35], v[76:79], a[44:47], v[32:35]
    ds_read_b64_tr_b16 v[68:69], v13 offset:8192
    ds_read_b64_tr_b16 v[70:71], v13 offset:9216
    s_waitcnt vmcnt(3) lgkmcnt(10)
    v_mfma_f32_16x16x32_bf16 v[32:35], v[80:83], a[48:51], v[32:35]
    ds_read_b64_tr_b16 v[72:73], v13 offset:16384
    ds_read_b64_tr_b16 v[74:75], v13 offset:17408
    s_waitcnt vmcnt(2) lgkmcnt(10)
    v_mfma_f32_16x16x32_bf16 v[32:35], v[84:87], a[52:55], v[32:35]
    ds_read_b64_tr_b16 v[76:77], v13 offset:24576
    ds_read_b64_tr_b16 v[78:79], v13 offset:25600
    s_waitcnt vmcnt(1) lgkmcnt(10)
    v_mfma_f32_16x16x32_bf16 v[32:35], v[88:91], a[56:59], v[32:35]
    ds_read_b64_tr_b16 v[80:81], v13 offset:32768
    ds_read_b64_tr_b16 v[82:83], v13 offset:33792
    s_waitcnt vmcnt(0) lgkmcnt(10)
    v_mfma_f32_16x16x32_bf16 v[32:35], v[92:95], a[60:63], v[32:35]
    ds_read_b64_tr_b16 v[84:85], v13 offset:40960
    ds_read_b64_tr_b16 v[86:87], v13 offset:41984
    s_waitcnt lgkmcnt(10)
    v_mfma_f32_16x16x32_bf16 v[36:39], v[64:67], a[0:3], 0
    ds_read_b64_tr_b16 v[88:89], v13 offset:49152
    ds_read_b64_tr_b16 v[90:91], v13 offset:50176
    s_waitcnt lgkmcnt(10)
    v_mfma_f32_16x16x32_bf16 v[36:39], v[68:71], a[4:7], v[36:39]
    ds_read_b64_tr_b16 v[92:93], v13 offset:57344
    ds_read_b64_tr_b16 v[94:95], v13 offset:58368
    s_waitcnt lgkmcnt(10)
    v_mfma_f32_16x16x32_bf16 v[36:39], v[72:75], a[8:11], v[36:39]
    ds_read_b64_tr_b16 v[64:65], v25 offset:0
    ds_read_b64_tr_b16 v[66:67], v25 offset:1024
    s_waitcnt lgkmcnt(10)
    v_mfma_f32_16x16x32_bf16 v[36:39], v[76:79], a[12:15], v[36:39]
    ds_read_b64_tr_b16 v[68:69], v25 offset:8192
    ds_read_b64_tr_b16 v[70:71], v25 offset:9216
    buffer_store_dwordx4 v[32:35], v20, s[4:7], s36 offen offset:0 sc1
    s_waitcnt lgkmcnt(10)
    v_mfma_f32_16x16x32_bf16 v[36:39], v[80:83], a[16:19], v[36:39]
    ds_read_b64_tr_b16 v[72:73], v25 offset:16384
    ds_read_b64_tr_b16 v[74:75], v25 offset:17408
    s_waitcnt lgkmcnt(10)
    v_mfma_f32_16x16x32_bf16 v[36:39], v[84:87], a[20:23], v[36:39]
    ds_read_b64_tr_b16 v[76:77], v25 offset:24576
    ds_read_b64_tr_b16 v[78:79], v25 offset:25600
    s_waitcnt lgkmcnt(10)
    v_mfma_f32_16x16x32_bf16 v[36:39], v[88:91], a[24:27], v[36:39]
    ds_read_b64_tr_b16 v[80:81], v25 offset:32768
    ds_read_b64_tr_b16 v[82:83], v25 offset:33792
    s_waitcnt lgkmcnt(10)
    v_mfma_f32_16x16x32_bf16 v[36:39], v[92:95], a[28:31], v[36:39]
    ds_read_b64_tr_b16 v[84:85], v25 offset:40960
    ds_read_b64_tr_b16 v[86:87], v25 offset:41984
    s_waitcnt lgkmcnt(10)
    v_mfma_f32_16x16x32_bf16 v[36:39], v[64:67], a[32:35], v[36:39]
    ds_read_b64_tr_b16 v[88:89], v25 offset:49152
    ds_read_b64_tr_b16 v[90:91], v25 offset:50176
    s_waitcnt lgkmcnt(10)
    v_mfma_f32_16x16x32_bf16 v[36:39], v[68:71], a[36:39], v[36:39]
    ds_read_b64_tr_b16 v[92:93], v25 offset:57344
    ds_read_b64_tr_b16 v[94:95], v25 offset:58368
    s_waitcnt lgkmcnt(10)
    v_mfma_f32_16x16x32_bf16 v[36:39], v[72:75], a[40:43], v[36:39]
    ds_read_b64_tr_b16 v[64:65], v14 offset:0
    ds_read_b64_tr_b16 v[66:67], v14 offset:1024
    s_waitcnt lgkmcnt(10)
    v_mfma_f32_16x16x32_bf16 v[36:39], v[76:79], a[44:47], v[36:39]
    ds_read_b64_tr_b16 v[68:69], v14 offset:8192
    ds_read_b64_tr_b16 v[70:71], v14 offset:9216
    s_waitcnt lgkmcnt(10)
    v_mfma_f32_16x16x32_bf16 v[36:39], v[80:83], a[48:51], v[36:39]
    ds_read_b64_tr_b16 v[72:73], v14 offset:16384
    ds_read_b64_tr_b16 v[74:75], v14 offset:17408
    s_waitcnt lgkmcnt(10)
    v_mfma_f32_16x16x32_bf16 v[36:39], v[84:87], a[52:55], v[36:39]
    ds_read_b64_tr_b16 v[76:77], v14 offset:24576
    ds_read_b64_tr_b16 v[78:79], v14 offset:25600
    s_waitcnt lgkmcnt(10)
    v_mfma_f32_16x16x32_bf16 v[36:39], v[88:91], a[56:59], v[36:39]
    ds_read_b64_tr_b16 v[80:81], v14 offset:32768
    ds_read_b64_tr_b16 v[82:83], v14 offset:33792
    s_waitcnt lgkmcnt(10)
    v_mfma_f32_16x16x32_bf16 v[36:39], v[92:95], a[60:63], v[36:39]
    ds_read_b64_tr_b16 v[84:85], v14 offset:40960
    ds_read_b64_tr_b16 v[86:87], v14 offset:41984
    s_waitcnt lgkmcnt(10)
    v_mfma_f32_16x16x32_bf16 v[40:43], v[64:67], a[0:3], 0
    ds_read_b64_tr_b16 v[88:89], v14 offset:49152
    ds_read_b64_tr_b16 v[90:91], v14 offset:50176
    s_waitcnt lgkmcnt(10)
    v_mfma_f32_16x16x32_bf16 v[40:43], v[68:71], a[4:7], v[40:43]
    ds_read_b64_tr_b16 v[92:93], v14 offset:57344
    ds_read_b64_tr_b16 v[94:95], v14 offset:58368
    s_waitcnt lgkmcnt(10)
    v_mfma_f32_16x16x32_bf16 v[40:43], v[72:75], a[8:11], v[40:43]
    ds_read_b64_tr_b16 v[64:65], v26 offset:0
    ds_read_b64_tr_b16 v[66:67], v26 offset:1024
    s_waitcnt lgkmcnt(10)
    v_mfma_f32_16x16x32_bf16 v[40:43], v[76:79], a[12:15], v[40:43]
    ds_read_b64_tr_b16 v[68:69], v26 offset:8192
    ds_read_b64_tr_b16 v[70:71], v26 offset:9216
    buffer_store_dwordx4 v[36:39], v20, s[4:7], s36 offen offset:64 sc1
    s_waitcnt lgkmcnt(10)
    v_mfma_f32_16x16x32_bf16 v[40:43], v[80:83], a[16:19], v[40:43]
    ds_read_b64_tr_b16 v[72:73], v26 offset:16384
    ds_read_b64_tr_b16 v[74:75], v26 offset:17408
    s_waitcnt lgkmcnt(10)
    v_mfma_f32_16x16x32_bf16 v[40:43], v[84:87], a[20:23], v[40:43]
    ds_read_b64_tr_b16 v[76:77], v26 offset:24576
    ds_read_b64_tr_b16 v[78:79], v26 offset:25600
    s_waitcnt lgkmcnt(10)
    v_mfma_f32_16x16x32_bf16 v[40:43], v[88:91], a[24:27], v[40:43]
    ds_read_b64_tr_b16 v[80:81], v26 offset:32768
    ds_read_b64_tr_b16 v[82:83], v26 offset:33792
    s_waitcnt lgkmcnt(10)
    v_mfma_f32_16x16x32_bf16 v[40:43], v[92:95], a[28:31], v[40:43]
    ds_read_b64_tr_b16 v[84:85], v26 offset:40960
    ds_read_b64_tr_b16 v[86:87], v26 offset:41984
    s_waitcnt lgkmcnt(10)
    v_mfma_f32_16x16x32_bf16 v[40:43], v[64:67], a[32:35], v[40:43]
    ds_read_b64_tr_b16 v[88:89], v26 offset:49152
    ds_read_b64_tr_b16 v[90:91], v26 offset:50176
    s_waitcnt lgkmcnt(10)
    v_mfma_f32_16x16x32_bf16 v[40:43], v[68:71], a[36:39], v[40:43]
    ds_read_b64_tr_b16 v[92:93], v26 offset:57344
    ds_read_b64_tr_b16 v[94:95], v26 offset:58368
    s_waitcnt lgkmcnt(10)
    v_mfma_f32_16x16x32_bf16 v[40:43], v[72:75], a[40:43], v[40:43]
    ds_read_b64_tr_b16 v[64:65], v15 offset:0
    ds_read_b64_tr_b16 v[66:67], v15 offset:1024
    s_waitcnt lgkmcnt(10)
    v_mfma_f32_16x16x32_bf16 v[40:43], v[76:79], a[44:47], v[40:43]
    ds_read_b64_tr_b16 v[68:69], v15 offset:8192
    ds_read_b64_tr_b16 v[70:71], v15 offset:9216
    s_waitcnt lgkmcnt(10)
    v_mfma_f32_16x16x32_bf16 v[40:43], v[80:83], a[48:51], v[40:43]
    ds_read_b64_tr_b16 v[72:73], v15 offset:16384
    ds_read_b64_tr_b16 v[74:75], v15 offset:17408
    s_waitcnt lgkmcnt(10)
    v_mfma_f32_16x16x32_bf16 v[40:43], v[84:87], a[52:55], v[40:43]
    ds_read_b64_tr_b16 v[76:77], v15 offset:24576
    ds_read_b64_tr_b16 v[78:79], v15 offset:25600
    s_waitcnt lgkmcnt(10)
    v_mfma_f32_16x16x32_bf16 v[40:43], v[88:91], a[56:59], v[40:43]
    ds_read_b64_tr_b16 v[80:81], v15 offset:32768
    ds_read_b64_tr_b16 v[82:83], v15 offset:33792
    s_waitcnt lgkmcnt(10)
    v_mfma_f32_16x16x32_bf16 v[40:43], v[92:95], a[60:63], v[40:43]
    ds_read_b64_tr_b16 v[84:85], v15 offset:40960
    ds_read_b64_tr_b16 v[86:87], v15 offset:41984
    s_waitcnt lgkmcnt(10)
    v_mfma_f32_16x16x32_bf16 v[44:47], v[64:67], a[0:3], 0
    ds_read_b64_tr_b16 v[88:89], v15 offset:49152
    ds_read_b64_tr_b16 v[90:91], v15 offset:50176
    s_waitcnt lgkmcnt(10)
    v_mfma_f32_16x16x32_bf16 v[44:47], v[68:71], a[4:7], v[44:47]
    ds_read_b64_tr_b16 v[92:93], v15 offset:57344
    ds_read_b64_tr_b16 v[94:95], v15 offset:58368
    s_waitcnt lgkmcnt(10)
    v_mfma_f32_16x16x32_bf16 v[44:47], v[72:75], a[8:11], v[44:47]
    ds_read_b64_tr_b16 v[64:65], v27 offset:0
    ds_read_b64_tr_b16 v[66:67], v27 offset:1024
    s_waitcnt lgkmcnt(10)
    v_mfma_f32_16x16x32_bf16 v[44:47], v[76:79], a[12:15], v[44:47]
    ds_read_b64_tr_b16 v[68:69], v27 offset:8192
    ds_read_b64_tr_b16 v[70:71], v27 offset:9216
    buffer_store_dwordx4 v[40:43], v20, s[4:7], s36 offen offset:128 sc1
    s_waitcnt lgkmcnt(10)
    v_mfma_f32_16x16x32_bf16 v[44:47], v[80:83], a[16:19], v[44:47]
    ds_read_b64_tr_b16 v[72:73], v27 offset:16384
    ds_read_b64_tr_b16 v[74:75], v27 offset:17408
    s_waitcnt lgkmcnt(10)
    v_mfma_f32_16x16x32_bf16 v[44:47], v[84:87], a[20:23], v[44:47]
    ds_read_b64_tr_b16 v[76:77], v27 offset:24576
    ds_read_b64_tr_b16 v[78:79], v27 offset:25600
    s_waitcnt lgkmcnt(10)
    v_mfma_f32_16x16x32_bf16 v[44:47], v[88:91], a[24:27], v[44:47]
    ds_read_b64_tr_b16 v[80:81], v27 offset:32768
    ds_read_b64_tr_b16 v[82:83], v27 offset:33792
    s_waitcnt lgkmcnt(10)
    v_mfma_f32_16x16x32_bf16 v[44:47], v[92:95], a[28:31], v[44:47]
    ds_read_b64_tr_b16 v[84:85], v27 offset:40960
    ds_read_b64_tr_b16 v[86:87], v27 offset:41984
    s_waitcnt lgkmcnt(10)
    v_mfma_f32_16x16x32_bf16 v[44:47], v[64:67], a[32:35], v[44:47]
    ds_read_b64_tr_b16 v[88:89], v27 offset:49152
    ds_read_b64_tr_b16 v[90:91], v27 offset:50176
    s_waitcnt lgkmcnt(10)
    v_mfma_f32_16x16x32_bf16 v[44:47], v[68:71], a[36:39], v[44:47]
    ds_read_b64_tr_b16 v[92:93], v27 offset:57344
    ds_read_b64_tr_b16 v[94:95], v27 offset:58368
    s_waitcnt lgkmcnt(10)
    v_mfma_f32_16x16x32_bf16 v[44:47], v[72:75], a[40:43], v[44:47]
    ds_read_b64_tr_b16 v[64:65], v16 offset:0
    ds_read_b64_tr_b16 v[66:67], v16 offset:1024
    s_waitcnt lgkmcnt(10)
    v_mfma_f32_16x16x32_bf16 v[44:47], v[76:79], a[44:47], v[44:47]
    ds_read_b64_tr_b16 v[68:69], v16 offset:8192
    ds_read_b64_tr_b16 v[70:71], v16 offset:9216
    s_waitcnt lgkmcnt(10)
    v_mfma_f32_16x16x32_bf16 v[44:47], v[80:83], a[48:51], v[44:47]
    ds_read_b64_tr_b16 v[72:73], v16 offset:16384
    ds_read_b64_tr_b16 v[74:75], v16 offset:17408
    s_waitcnt lgkmcnt(10)
    v_mfma_f32_16x16x32_bf16 v[44:47], v[84:87], a[52:55], v[44:47]
    ds_read_b64_tr_b16 v[76:77], v16 offset:24576
    ds_read_b64_tr_b16 v[78:79], v16 offset:25600
    s_waitcnt lgkmcnt(10)
    v_mfma_f32_16x16x32_bf16 v[44:47], v[88:91], a[56:59], v[44:47]
    ds_read_b64_tr_b16 v[80:81], v16 offset:32768
    ds_read_b64_tr_b16 v[82:83], v16 offset:33792
    s_waitcnt lgkmcnt(10)
    v_mfma_f32_16x16x32_bf16 v[44:47], v[92:95], a[60:63], v[44:47]
    ds_read_b64_tr_b16 v[84:85], v16 offset:40960
    ds_read_b64_tr_b16 v[86:87], v16 offset:41984
    s_waitcnt lgkmcnt(10)
    v_mfma_f32_16x16x32_bf16 v[48:51], v[64:67], a[0:3], 0
    ds_read_b64_tr_b16 v[88:89], v16 offset:49152
    ds_read_b64_tr_b16 v[90:91], v16 offset:50176
    s_waitcnt lgkmcnt(10)
    v_mfma_f32_16x16x32_bf16 v[48:51], v[68:71], a[4:7], v[48:51]
    ds_read_b64_tr_b16 v[92:93], v16 offset:57344
    ds_read_b64_tr_b16 v[94:95], v16 offset:58368
    s_waitcnt lgkmcnt(10)
    v_mfma_f32_16x16x32_bf16 v[48:51], v[72:75], a[8:11], v[48:51]
    ds_read_b64_tr_b16 v[64:65], v28 offset:0
    ds_read_b64_tr_b16 v[66:67], v28 offset:1024
    s_waitcnt lgkmcnt(10)
    v_mfma_f32_16x16x32_bf16 v[48:51], v[76:79], a[12:15], v[48:51]
    ds_read_b64_tr_b16 v[68:69], v28 offset:8192
    ds_read_b64_tr_b16 v[70:71], v28 offset:9216
    buffer_store_dwordx4 v[44:47], v20, s[4:7], s36 offen offset:192 sc1
    s_waitcnt lgkmcnt(10)
    v_mfma_f32_16x16x32_bf16 v[48:51], v[80:83], a[16:19], v[48:51]
    ds_read_b64_tr_b16 v[72:73], v28 offset:16384
    ds_read_b64_tr_b16 v[74:75], v28 offset:17408
    s_waitcnt lgkmcnt(10)
    v_mfma_f32_16x16x32_bf16 v[48:51], v[84:87], a[20:23], v[48:51]
    ds_read_b64_tr_b16 v[76:77], v28 offset:24576
    ds_read_b64_tr_b16 v[78:79], v28 offset:25600
    s_waitcnt lgkmcnt(10)
    v_mfma_f32_16x16x32_bf16 v[48:51], v[88:91], a[24:27], v[48:51]
    ds_read_b64_tr_b16 v[80:81], v28 offset:32768
    ds_read_b64_tr_b16 v[82:83], v28 offset:33792
    s_waitcnt lgkmcnt(10)
    v_mfma_f32_16x16x32_bf16 v[48:51], v[92:95], a[28:31], v[48:51]
    ds_read_b64_tr_b16 v[84:85], v28 offset:40960
    ds_read_b64_tr_b16 v[86:87], v28 offset:41984
    s_waitcnt lgkmcnt(10)
    v_mfma_f32_16x16x32_bf16 v[48:51], v[64:67], a[32:35], v[48:51]
    ds_read_b64_tr_b16 v[88:89], v28 offset:49152
    ds_read_b64_tr_b16 v[90:91], v28 offset:50176
    s_waitcnt lgkmcnt(10)
    v_mfma_f32_16x16x32_bf16 v[48:51], v[68:71], a[36:39], v[48:51]
    ds_read_b64_tr_b16 v[92:93], v28 offset:57344
    ds_read_b64_tr_b16 v[94:95], v28 offset:58368
    s_waitcnt lgkmcnt(10)
    v_mfma_f32_16x16x32_bf16 v[48:51], v[72:75], a[40:43], v[48:51]
    ds_read_b64_tr_b16 v[64:65], v17 offset:0
    ds_read_b64_tr_b16 v[66:67], v17 offset:1024
    s_waitcnt lgkmcnt(10)
    v_mfma_f32_16x16x32_bf16 v[48:51], v[76:79], a[44:47], v[48:51]
    ds_read_b64_tr_b16 v[68:69], v17 offset:8192
    ds_read_b64_tr_b16 v[70:71], v17 offset:9216
    s_waitcnt lgkmcnt(10)
    v_mfma_f32_16x16x32_bf16 v[48:51], v[80:83], a[48:51], v[48:51]
    ds_read_b64_tr_b16 v[72:73], v17 offset:16384
    ds_read_b64_tr_b16 v[74:75], v17 offset:17408
    s_waitcnt lgkmcnt(10)
    v_mfma_f32_16x16x32_bf16 v[48:51], v[84:87], a[52:55], v[48:51]
    ds_read_b64_tr_b16 v[76:77], v17 offset:24576
    ds_read_b64_tr_b16 v[78:79], v17 offset:25600
    s_waitcnt lgkmcnt(10)
    v_mfma_f32_16x16x32_bf16 v[48:51], v[88:91], a[56:59], v[48:51]
    ds_read_b64_tr_b16 v[80:81], v17 offset:32768
    ds_read_b64_tr_b16 v[82:83], v17 offset:33792
    s_waitcnt lgkmcnt(10)
    v_mfma_f32_16x16x32_bf16 v[48:51], v[92:95], a[60:63], v[48:51]
    ds_read_b64_tr_b16 v[84:85], v17 offset:40960
    ds_read_b64_tr_b16 v[86:87], v17 offset:41984
    s_waitcnt lgkmcnt(10)
    v_mfma_f32_16x16x32_bf16 v[52:55], v[64:67], a[0:3], 0
    ds_read_b64_tr_b16 v[88:89], v17 offset:49152
    ds_read_b64_tr_b16 v[90:91], v17 offset:50176
    s_waitcnt lgkmcnt(10)
    v_mfma_f32_16x16x32_bf16 v[52:55], v[68:71], a[4:7], v[52:55]
    ds_read_b64_tr_b16 v[92:93], v17 offset:57344
    ds_read_b64_tr_b16 v[94:95], v17 offset:58368
    s_waitcnt lgkmcnt(10)
    v_mfma_f32_16x16x32_bf16 v[52:55], v[72:75], a[8:11], v[52:55]
    ds_read_b64_tr_b16 v[64:65], v29 offset:0
    ds_read_b64_tr_b16 v[66:67], v29 offset:1024
    s_waitcnt lgkmcnt(10)
    v_mfma_f32_16x16x32_bf16 v[52:55], v[76:79], a[12:15], v[52:55]
    ds_read_b64_tr_b16 v[68:69], v29 offset:8192
    ds_read_b64_tr_b16 v[70:71], v29 offset:9216
    buffer_store_dwordx4 v[48:51], v20, s[4:7], s36 offen offset:256 sc1
    s_waitcnt lgkmcnt(10)
    v_mfma_f32_16x16x32_bf16 v[52:55], v[80:83], a[16:19], v[52:55]
    ds_read_b64_tr_b16 v[72:73], v29 offset:16384
    ds_read_b64_tr_b16 v[74:75], v29 offset:17408
    s_waitcnt lgkmcnt(10)
    v_mfma_f32_16x16x32_bf16 v[52:55], v[84:87], a[20:23], v[52:55]
    ds_read_b64_tr_b16 v[76:77], v29 offset:24576
    ds_read_b64_tr_b16 v[78:79], v29 offset:25600
    s_waitcnt lgkmcnt(10)
    v_mfma_f32_16x16x32_bf16 v[52:55], v[88:91], a[24:27], v[52:55]
    ds_read_b64_tr_b16 v[80:81], v29 offset:32768
    ds_read_b64_tr_b16 v[82:83], v29 offset:33792
    s_waitcnt lgkmcnt(10)
    v_mfma_f32_16x16x32_bf16 v[52:55], v[92:95], a[28:31], v[52:55]
    ds_read_b64_tr_b16 v[84:85], v29 offset:40960
    ds_read_b64_tr_b16 v[86:87], v29 offset:41984
    s_waitcnt lgkmcnt(10)
    v_mfma_f32_16x16x32_bf16 v[52:55], v[64:67], a[32:35], v[52:55]
    ds_read_b64_tr_b16 v[88:89], v29 offset:49152
    ds_read_b64_tr_b16 v[90:91], v29 offset:50176
    s_waitcnt lgkmcnt(10)
    v_mfma_f32_16x16x32_bf16 v[52:55], v[68:71], a[36:39], v[52:55]
    ds_read_b64_tr_b16 v[92:93], v29 offset:57344
    ds_read_b64_tr_b16 v[94:95], v29 offset:58368
    s_waitcnt lgkmcnt(10)
    v_mfma_f32_16x16x32_bf16 v[52:55], v[72:75], a[40:43], v[52:55]
    ds_read_b64_tr_b16 v[64:65], v18 offset:0
    ds_read_b64_tr_b16 v[66:67], v18 offset:1024
    s_waitcnt lgkmcnt(10)
    v_mfma_f32_16x16x32_bf16 v[52:55], v[76:79], a[44:47], v[52:55]
    ds_read_b64_tr_b16 v[68:69], v18 offset:8192
    ds_read_b64_tr_b16 v[70:71], v18 offset:9216
    s_waitcnt lgkmcnt(10)
    v_mfma_f32_16x16x32_bf16 v[52:55], v[80:83], a[48:51], v[52:55]
    ds_read_b64_tr_b16 v[72:73], v18 offset:16384
    ds_read_b64_tr_b16 v[74:75], v18 offset:17408
    s_waitcnt lgkmcnt(10)
    v_mfma_f32_16x16x32_bf16 v[52:55], v[84:87], a[52:55], v[52:55]
    ds_read_b64_tr_b16 v[76:77], v18 offset:24576
    ds_read_b64_tr_b16 v[78:79], v18 offset:25600
    s_waitcnt lgkmcnt(10)
    v_mfma_f32_16x16x32_bf16 v[52:55], v[88:91], a[56:59], v[52:55]
    ds_read_b64_tr_b16 v[80:81], v18 offset:32768
    ds_read_b64_tr_b16 v[82:83], v18 offset:33792
    s_waitcnt lgkmcnt(10)
    v_mfma_f32_16x16x32_bf16 v[52:55], v[92:95], a[60:63], v[52:55]
    ds_read_b64_tr_b16 v[84:85], v18 offset:40960
    ds_read_b64_tr_b16 v[86:87], v18 offset:41984
    s_waitcnt lgkmcnt(10)
    v_mfma_f32_16x16x32_bf16 v[56:59], v[64:67], a[0:3], 0
    ds_read_b64_tr_b16 v[88:89], v18 offset:49152
    ds_read_b64_tr_b16 v[90:91], v18 offset:50176
    s_waitcnt lgkmcnt(10)
    v_mfma_f32_16x16x32_bf16 v[56:59], v[68:71], a[4:7], v[56:59]
    ds_read_b64_tr_b16 v[92:93], v18 offset:57344
    ds_read_b64_tr_b16 v[94:95], v18 offset:58368
    s_waitcnt lgkmcnt(10)
    v_mfma_f32_16x16x32_bf16 v[56:59], v[72:75], a[8:11], v[56:59]
    ds_read_b64_tr_b16 v[64:65], v30 offset:0
    ds_read_b64_tr_b16 v[66:67], v30 offset:1024
    s_waitcnt lgkmcnt(10)
    v_mfma_f32_16x16x32_bf16 v[56:59], v[76:79], a[12:15], v[56:59]
    ds_read_b64_tr_b16 v[68:69], v30 offset:8192
    ds_read_b64_tr_b16 v[70:71], v30 offset:9216
    buffer_store_dwordx4 v[52:55], v20, s[4:7], s36 offen offset:320 sc1
    s_waitcnt lgkmcnt(10)
    v_mfma_f32_16x16x32_bf16 v[56:59], v[80:83], a[16:19], v[56:59]
    ds_read_b64_tr_b16 v[72:73], v30 offset:16384
    ds_read_b64_tr_b16 v[74:75], v30 offset:17408
    s_waitcnt lgkmcnt(10)
    v_mfma_f32_16x16x32_bf16 v[56:59], v[84:87], a[20:23], v[56:59]
    ds_read_b64_tr_b16 v[76:77], v30 offset:24576
    ds_read_b64_tr_b16 v[78:79], v30 offset:25600
    s_waitcnt lgkmcnt(10)
    v_mfma_f32_16x16x32_bf16 v[56:59], v[88:91], a[24:27], v[56:59]
    ds_read_b64_tr_b16 v[80:81], v30 offset:32768
    ds_read_b64_tr_b16 v[82:83], v30 offset:33792
    s_waitcnt lgkmcnt(10)
    v_mfma_f32_16x16x32_bf16 v[56:59], v[92:95], a[28:31], v[56:59]
    ds_read_b64_tr_b16 v[84:85], v30 offset:40960
    ds_read_b64_tr_b16 v[86:87], v30 offset:41984
    s_waitcnt lgkmcnt(10)
    v_mfma_f32_16x16x32_bf16 v[56:59], v[64:67], a[32:35], v[56:59]
    ds_read_b64_tr_b16 v[88:89], v30 offset:49152
    ds_read_b64_tr_b16 v[90:91], v30 offset:50176
    s_waitcnt lgkmcnt(10)
    v_mfma_f32_16x16x32_bf16 v[56:59], v[68:71], a[36:39], v[56:59]
    ds_read_b64_tr_b16 v[92:93], v30 offset:57344
    ds_read_b64_tr_b16 v[94:95], v30 offset:58368
    s_waitcnt lgkmcnt(10)
    v_mfma_f32_16x16x32_bf16 v[56:59], v[72:75], a[40:43], v[56:59]
    ds_read_b64_tr_b16 v[64:65], v19 offset:0
    ds_read_b64_tr_b16 v[66:67], v19 offset:1024
    s_waitcnt lgkmcnt(10)
    v_mfma_f32_16x16x32_bf16 v[56:59], v[76:79], a[44:47], v[56:59]
    ds_read_b64_tr_b16 v[68:69], v19 offset:8192
    ds_read_b64_tr_b16 v[70:71], v19 offset:9216
    s_waitcnt lgkmcnt(10)
    v_mfma_f32_16x16x32_bf16 v[56:59], v[80:83], a[48:51], v[56:59]
    ds_read_b64_tr_b16 v[72:73], v19 offset:16384
    ds_read_b64_tr_b16 v[74:75], v19 offset:17408
    s_waitcnt lgkmcnt(10)
    v_mfma_f32_16x16x32_bf16 v[56:59], v[84:87], a[52:55], v[56:59]
    ds_read_b64_tr_b16 v[76:77], v19 offset:24576
    ds_read_b64_tr_b16 v[78:79], v19 offset:25600
    s_waitcnt lgkmcnt(10)
    v_mfma_f32_16x16x32_bf16 v[56:59], v[88:91], a[56:59], v[56:59]
    ds_read_b64_tr_b16 v[80:81], v19 offset:32768
    ds_read_b64_tr_b16 v[82:83], v19 offset:33792
    s_waitcnt lgkmcnt(10)
    v_mfma_f32_16x16x32_bf16 v[56:59], v[92:95], a[60:63], v[56:59]
    ds_read_b64_tr_b16 v[84:85], v19 offset:40960
    ds_read_b64_tr_b16 v[86:87], v19 offset:41984
    s_waitcnt lgkmcnt(10)
    v_mfma_f32_16x16x32_bf16 v[60:63], v[64:67], a[0:3], 0
    ds_read_b64_tr_b16 v[88:89], v19 offset:49152
    ds_read_b64_tr_b16 v[90:91], v19 offset:50176
    s_waitcnt lgkmcnt(10)
    v_mfma_f32_16x16x32_bf16 v[60:63], v[68:71], a[4:7], v[60:63]
    ds_read_b64_tr_b16 v[92:93], v19 offset:57344
    ds_read_b64_tr_b16 v[94:95], v19 offset:58368
    s_waitcnt lgkmcnt(10)
    v_mfma_f32_16x16x32_bf16 v[60:63], v[72:75], a[8:11], v[60:63]
    ds_read_b64_tr_b16 v[64:65], v31 offset:0
    ds_read_b64_tr_b16 v[66:67], v31 offset:1024
    s_waitcnt lgkmcnt(10)
    v_mfma_f32_16x16x32_bf16 v[60:63], v[76:79], a[12:15], v[60:63]
    ds_read_b64_tr_b16 v[68:69], v31 offset:8192
    ds_read_b64_tr_b16 v[70:71], v31 offset:9216
    buffer_store_dwordx4 v[56:59], v20, s[4:7], s36 offen offset:384 sc1
    s_waitcnt lgkmcnt(10)
    v_mfma_f32_16x16x32_bf16 v[60:63], v[80:83], a[16:19], v[60:63]
    ds_read_b64_tr_b16 v[72:73], v31 offset:16384
    ds_read_b64_tr_b16 v[74:75], v31 offset:17408
    s_waitcnt lgkmcnt(10)
    v_mfma_f32_16x16x32_bf16 v[60:63], v[84:87], a[20:23], v[60:63]
    ds_read_b64_tr_b16 v[76:77], v31 offset:24576
    ds_read_b64_tr_b16 v[78:79], v31 offset:25600
    s_waitcnt lgkmcnt(10)
    v_mfma_f32_16x16x32_bf16 v[60:63], v[88:91], a[24:27], v[60:63]
    ds_read_b64_tr_b16 v[80:81], v31 offset:32768
    ds_read_b64_tr_b16 v[82:83], v31 offset:33792
    s_waitcnt lgkmcnt(10)
    v_mfma_f32_16x16x32_bf16 v[60:63], v[92:95], a[28:31], v[60:63]
    ds_read_b64_tr_b16 v[84:85], v31 offset:40960
    ds_read_b64_tr_b16 v[86:87], v31 offset:41984
    s_waitcnt lgkmcnt(10)
    v_mfma_f32_16x16x32_bf16 v[60:63], v[64:67], a[32:35], v[60:63]
    ds_read_b64_tr_b16 v[88:89], v31 offset:49152
    ds_read_b64_tr_b16 v[90:91], v31 offset:50176
    s_waitcnt lgkmcnt(10)
    v_mfma_f32_16x16x32_bf16 v[60:63], v[68:71], a[36:39], v[60:63]
    ds_read_b64_tr_b16 v[92:93], v31 offset:57344
    ds_read_b64_tr_b16 v[94:95], v31 offset:58368
    s_waitcnt lgkmcnt(10)
    v_mfma_f32_16x16x32_bf16 v[60:63], v[72:75], a[40:43], v[60:63]
    s_waitcnt lgkmcnt(8)
    v_mfma_f32_16x16x32_bf16 v[60:63], v[76:79], a[44:47], v[60:63]
    s_waitcnt lgkmcnt(6)
    v_mfma_f32_16x16x32_bf16 v[60:63], v[80:83], a[48:51], v[60:63]
    s_waitcnt lgkmcnt(4)
    v_mfma_f32_16x16x32_bf16 v[60:63], v[84:87], a[52:55], v[60:63]
    s_waitcnt lgkmcnt(2)
    v_mfma_f32_16x16x32_bf16 v[60:63], v[88:91], a[56:59], v[60:63]
    s_waitcnt lgkmcnt(0)
    v_mfma_f32_16x16x32_bf16 v[60:63], v[92:95], a[60:63], v[60:63]
    s_nop 7
    buffer_store_dwordx4 v[60:63], v20, s[4:7], s36 offen offset:448 sc1
    s_waitcnt vmcnt(0)
    s_barrier
    s_cmp_lg_u32 s92, 0
    s_cbranch_scc1 L_g86_done
    s_lshl_b32 s79, s84, 9
    s_lshl_b32 s93, s83, 2
    s_add_u32 s79, s79, s93
    s_add_u32 s79, s79, 3948672
    v_mov_b32 v250, 0
    v_mov_b32 v251, s82
    s_mov_b64 exec, 1
    buffer_store_dword v251, v250, s[4:7], s79 offen sc1
    s_mov_b64 exec, -1
L_g86_done:
    s_mov_b32 s16, s81
    s_load_dwordx2 s[12:13], s[0:1], 0
    v_and_b32 v2, 63, v0
    s_waitcnt lgkmcnt(0)
    s_mov_b32 s40, s12
    s_and_b32 s41, s13, 0xffff
    s_mov_b32 s42, 2097152
    s_mov_b32 s43, 0x00020000
    v_lshlrev_b32 v5, 4, v2
    v_lshlrev_b32 v6, 5, v2
    s_mov_b32 s20, 2101248
    buffer_load_dwordx4 v[16:19], v6, s[4:7], s20 offen offset:0 sc1
    buffer_load_dwordx4 v[20:23], v6, s[4:7], s20 offen offset:16 sc1
    s_mov_b32 s20, 2103296
    buffer_load_dwordx4 v[24:27], v6, s[4:7], s20 offen offset:0 sc1
    buffer_load_dwordx4 v[28:31], v6, s[4:7], s20 offen offset:16 sc1
    s_mov_b32 s20, 2105344
    buffer_load_dwordx4 v[32:35], v6, s[4:7], s20 offen offset:0 sc1
    buffer_load_dwordx4 v[36:39], v6, s[4:7], s20 offen offset:16 sc1
    v_lshrrev_b32 v7, 2, v2
    v_lshlrev_b32 v7, 10, v7
    v_and_b32 v8, 3, v2
    v_lshl_add_u32 v7, v8, 8, v7
    s_lshl_b32 s9, s16, 6
    s_lshl_b32 s10, s83, 1
    s_add_u32 s9, s9, s10
    s_and_b32 s10, s92, 1
    s_add_u32 s9, s9, s10
    s_lshl_b32 s10, s9, 10
    buffer_load_dwordx4 v[8:11], v5, s[40:43], s10 offen
    s_waitcnt vmcnt(0)
    v_lshlrev_b32 v40, 16, v8
    v_and_b32 v41, 0xffff0000, v8
    v_lshlrev_b32 v42, 16, v9
    v_and_b32 v43, 0xffff0000, v9
    v_lshlrev_b32 v44, 16, v10
    v_and_b32 v45, 0xffff0000, v10
    v_lshlrev_b32 v46, 16, v11
    v_and_b32 v47, 0xffff0000, v11
    s_lshl_b32 s11, s9, 11
    s_and_b32 s8, s9, 63
    s_lshl_b32 s18, s84, 7
    s_add_u32 s8, s8, s18
    s_lshl_b32 s15, s8, 11
    s_lshr_b32 s12, s8, 4
    s_lshl_b32 s12, s12, 14
    s_and_b32 s13, s8, 15
    s_lshl_b32 s13, s13, 4
    s_add_u32 s12, s12, s13
    s_add_u32 s12, s12, 104857600
    s_cmp_lg_u32 s92, 0
    s_cbranch_scc1 L_g87_done
    s_lshl_b32 s79, s84, 9
    s_add_u32 s79, s79, 3948672
    v_mbcnt_lo_u32_b32 v250, -1, 0
    v_mbcnt_hi_u32_b32 v250, -1, v250
    v_min_u32 v250, 31, v250
    v_lshlrev_b32 v250, 2, v250
    s_mov_b32 s94, 400000
L_g87_spin:
    buffer_load_dword v251, v250, s[4:7], s79 offen sc1
    s_waitcnt vmcnt(0)
    v_cmp_gt_u32 vcc, s82, v251
    s_cbranch_vccz L_g87_done
    s_sub_u32 s94, s94, 1
    s_cbranch_scc0 L_g87_spin
L_g87_done:
    s_barrier
    s_cmp_ge_u32 s92, 2
    s_cbranch_scc1 L_adaLN_cond__memory_aug_recurrent_mem_tr__dense_activation_gelu__prompt_kernel_ps_ln2_oth
    s_add_u32 s23, s11, 134217728
    buffer_load_dwordx4 v[64:67], v6, s[4:7], s23 offen offset:0 sc1
    buffer_load_dwordx4 v[68:71], v6, s[4:7], s23 offen offset:16 sc1
    s_add_u32 s23, s11, 138412032
    buffer_load_dwordx4 v[72:75], v6, s[4:7], s23 offen offset:0 sc1
    buffer_load_dwordx4 v[76:79], v6, s[4:7], s23 offen offset:16 sc1
    s_add_u32 s23, s11, 142606336
    buffer_load_dwordx4 v[80:83], v6, s[4:7], s23 offen offset:0 sc1
    buffer_load_dwordx4 v[84:87], v6, s[4:7], s23 offen offset:16 sc1
    s_add_u32 s23, s11, 146800640
    buffer_load_dwordx4 v[88:91], v6, s[4:7], s23 offen offset:0 sc1
    buffer_load_dwordx4 v[92:95], v6, s[4:7], s23 offen offset:16 sc1
    s_add_u32 s23, s11, 150994944
    buffer_load_dwordx4 v[96:99], v6, s[4:7], s23 offen offset:0 sc1
    buffer_load_dwordx4 v[100:103], v6, s[4:7], s23 offen offset:16 sc1
    s_add_u32 s23, s11, 155189248
    buffer_load_dwordx4 v[104:107], v6, s[4:7], s23 offen offset:0 sc1
    buffer_load_dwordx4 v[108:111], v6, s[4:7], s23 offen offset:16 sc1
    s_add_u32 s23, s11, 159383552
    buffer_load_dwordx4 v[112:115], v6, s[4:7], s23 offen offset:0 sc1
    buffer_load_dwordx4 v[116:119], v6, s[4:7], s23 offen offset:16 sc1
    s_add_u32 s23, s11, 163577856
    buffer_load_dwordx4 v[120:123], v6, s[4:7], s23 offen offset:0 sc1
    buffer_load_dwordx4 v[124:127], v6, s[4:7], s23 offen offset:16 sc1
    v_and_b32 v53, 63, v0
    v_lshlrev_b32 v53, 4, v53
    s_lshl_b32 s14, s92, 14
    v_add_u32 v52, s14, v53
    ds_write_b128 v52, a[128:131] offset:0
    ds_write_b128 v52, a[132:135] offset:1024
    ds_write_b128 v52, a[136:139] offset:2048
    ds_write_b128 v52, a[140:143] offset:3072
    ds_write_b128 v52, a[144:147] offset:4096
    ds_write_b128 v52, a[148:151] offset:5120
    ds_write_b128 v52, a[152:155] offset:6144
    ds_write_b128 v52, a[156:159] offset:7168
    ds_write_b128 v52, a[160:163] offset:8192
    ds_write_b128 v52, a[164:167] offset:9216
    ds_write_b128 v52, a[168:171] offset:10240
    ds_write_b128 v52, a[172:175] offset:11264
    ds_write_b128 v52, a[176:179] offset:12288
    ds_write_b128 v52, a[180:183] offset:13312
    ds_write_b128 v52, a[184:187] offset:14336
    ds_write_b128 v52, a[188:191] offset:15360
    s_waitcnt vmcnt(13)
    v_pk_add_f32 v[64:65], v[64:65], v[72:73]
    v_pk_add_f32 v[66:67], v[66:67], v[74:75]
    s_waitcnt vmcnt(12)
    v_pk_add_f32 v[68:69], v[68:69], v[76:77]
    v_pk_add_f32 v[70:71], v[70:71], v[78:79]
    s_waitcnt vmcnt(11)
    v_pk_add_f32 v[64:65], v[64:65], v[80:81]
    v_pk_add_f32 v[66:67], v[66:67], v[82:83]
    s_waitcnt vmcnt(10)
    v_pk_add_f32 v[68:69], v[68:69], v[84:85]
    v_pk_add_f32 v[70:71], v[70:71], v[86:87]
    s_waitcnt vmcnt(9)
    v_pk_add_f32 v[64:65], v[64:65], v[88:89]
    v_pk_add_f32 v[66:67], v[66:67], v[90:91]
    s_waitcnt vmcnt(8)
    v_pk_add_f32 v[68:69], v[68:69], v[92:93]
    v_pk_add_f32 v[70:71], v[70:71], v[94:95]
    s_waitcnt vmcnt(7)
    v_pk_add_f32 v[64:65], v[64:65], v[96:97]
    v_pk_add_f32 v[66:67], v[66:67], v[98:99]
    s_waitcnt vmcnt(6)
    v_pk_add_f32 v[68:69], v[68:69], v[100:101]
    v_pk_add_f32 v[70:71], v[70:71], v[102:103]
    s_waitcnt vmcnt(5)
    v_pk_add_f32 v[64:65], v[64:65], v[104:105]
    v_pk_add_f32 v[66:67], v[66:67], v[106:107]
    s_waitcnt vmcnt(4)
    v_pk_add_f32 v[68:69], v[68:69], v[108:109]
    v_pk_add_f32 v[70:71], v[70:71], v[110:111]
    s_waitcnt vmcnt(3)
    v_pk_add_f32 v[64:65], v[64:65], v[112:113]
    v_pk_add_f32 v[66:67], v[66:67], v[114:115]
    s_waitcnt vmcnt(2)
    v_pk_add_f32 v[68:69], v[68:69], v[116:117]
    v_pk_add_f32 v[70:71], v[70:71], v[118:119]
    s_waitcnt vmcnt(1)
    v_pk_add_f32 v[64:65], v[64:65], v[120:121]
    v_pk_add_f32 v[66:67], v[66:67], v[122:123]
    s_waitcnt vmcnt(0)
    v_pk_add_f32 v[68:69], v[68:69], v[124:125]
    v_pk_add_f32 v[70:71], v[70:71], v[126:127]
    v_fmac_f32 v40, v16, v64
    v_fmac_f32 v41, v17, v65
    v_fmac_f32 v42, v18, v66
    v_fmac_f32 v43, v19, v67
    v_fmac_f32 v44, v20, v68
    v_fmac_f32 v45, v21, v69
    v_fmac_f32 v46, v22, v70
    v_fmac_f32 v47, v23, v71
    s_add_u32 s23, s15, 100663296
    buffer_store_dwordx4 v[40:43], v6, s[4:7], s23 offen offset:0 sc1
    buffer_store_dwordx4 v[44:47], v6, s[4:7], s23 offen offset:16 sc1
    v_add_f32 v13, v40, v41
    v_add_f32 v13, v13, v42
    v_add_f32 v13, v13, v43
    v_add_f32 v13, v13, v44
    v_add_f32 v13, v13, v45
    v_add_f32 v13, v13, v46
    v_add_f32 v13, v13, v47
    s_nop 1
    v_add_f32_dpp v13, v13, v13 row_ror:1 row_mask:0xf bank_mask:0xf
    s_nop 1
    v_add_f32_dpp v13, v13, v13 row_ror:2 row_mask:0xf bank_mask:0xf
    s_nop 1
    v_add_f32_dpp v13, v13, v13 row_ror:4 row_mask:0xf bank_mask:0xf
    s_nop 1
    v_add_f32_dpp v13, v13, v13 row_ror:8 row_mask:0xf bank_mask:0xf
    v_mov_b32 v12, v13
    s_nop 1
    v_permlane16_swap_b32 v13, v12
    v_add_f32 v13, v13, v12
    v_mov_b32 v12, v13
    s_nop 1
    v_permlane32_swap_b32 v13, v12
    v_add_f32 v13, v13, v12
    v_mul_f32 v13, 0x3b000000, v13
    v_sub_f32 v56, v40, v13
    v_sub_f32 v57, v41, v13
    v_sub_f32 v58, v42, v13
    v_sub_f32 v59, v43, v13
    v_sub_f32 v60, v44, v13
    v_sub_f32 v61, v45, v13
    v_sub_f32 v62, v46, v13
    v_sub_f32 v63, v47, v13
    v_mul_f32 v14, v56, v56
    v_fmac_f32 v14, v57, v57
    v_fmac_f32 v14, v58, v58
    v_fmac_f32 v14, v59, v59
    v_fmac_f32 v14, v60, v60
    v_fmac_f32 v14, v61, v61
    v_fmac_f32 v14, v62, v62
    v_fmac_f32 v14, v63, v63
    s_nop 1
    v_add_f32_dpp v14, v14, v14 row_ror:1 row_mask:0xf bank_mask:0xf
    s_nop 1
    v_add_f32_dpp v14, v14, v14 row_ror:2 row_mask:0xf bank_mask:0xf
    s_nop 1
    v_add_f32_dpp v14, v14, v14 row_ror:4 row_mask:0xf bank_mask:0xf
    s_nop 1
    v_add_f32_dpp v14, v14, v14 row_ror:8 row_mask:0xf bank_mask:0xf
    v_mov_b32 v12, v14
    s_nop 1
    v_permlane16_swap_b32 v14, v12
    v_add_f32 v14, v14, v12
    v_mov_b32 v12, v14
    s_nop 1
    v_permlane32_swap_b32 v14, v12
    v_add_f32 v14, v14, v12
    v_mov_b32 v15, 0x3727c5ac
    v_fmac_f32 v15, 0x3b000000, v14
    v_rsq_f32 v15, v15
    s_nop 0
    v_mul_f32 v56, v56, v15
    v_fma_f32 v56, v56, v32, v24
    v_mul_f32 v57, v57, v15
    v_fma_f32 v57, v57, v33, v25
    v_mul_f32 v58, v58, v15
    v_fma_f32 v58, v58, v34, v26
    v_mul_f32 v59, v59, v15
    v_fma_f32 v59, v59, v35, v27
    v_mul_f32 v60, v60, v15
    v_fma_f32 v60, v60, v36, v28
    v_mul_f32 v61, v61, v15
    v_fma_f32 v61, v61, v37, v29
    v_mul_f32 v62, v62, v15
    v_fma_f32 v62, v62, v38, v30
    v_mul_f32 v63, v63, v15
    v_fma_f32 v63, v63, v39, v31
    v_cvt_pk_bf16_f32 v48, v56, v57
    v_cvt_pk_bf16_f32 v49, v58, v59
    v_cvt_pk_bf16_f32 v50, v60, v61
    v_cvt_pk_bf16_f32 v51, v62, v63
    buffer_store_dwordx4 v[48:51], v7, s[4:7], s12 offen sc1
    s_branch L_adaLN_cond__memory_aug_recurrent_mem_tr__dense_activation_gelu__prompt_kernel_ps_ln2_end
L_adaLN_cond__memory_aug_recurrent_mem_tr__dense_activation_gelu__prompt_kernel_ps_ln2_oth:
    v_and_b32 v53, 63, v0
    v_lshlrev_b32 v53, 4, v53
    s_lshl_b32 s14, s92, 14
    v_add_u32 v52, s14, v53
    ds_write_b128 v52, a[128:131] offset:0
    ds_write_b128 v52, a[132:135] offset:1024
    ds_write_b128 v52, a[136:139] offset:2048
    ds_write_b128 v52, a[140:143] offset:3072
    ds_write_b128 v52, a[144:147] offset:4096
    ds_write_b128 v52, a[148:151] offset:5120
    ds_write_b128 v52, a[152:155] offset:6144
    ds_write_b128 v52, a[156:159] offset:7168
    ds_write_b128 v52, a[160:163] offset:8192
    ds_write_b128 v52, a[164:167] offset:9216
    ds_write_b128 v52, a[168:171] offset:10240
    ds_write_b128 v52, a[172:175] offset:11264
    ds_write_b128 v52, a[176:179] offset:12288
    ds_write_b128 v52, a[180:183] offset:13312
    ds_write_b128 v52, a[184:187] offset:14336
    ds_write_b128 v52, a[188:191] offset:15360
L_adaLN_cond__memory_aug_recurrent_mem_tr__dense_activation_gelu__prompt_kernel_ps_ln2_end:
    s_waitcnt lgkmcnt(0)
    s_waitcnt vmcnt(0)
    s_barrier
    s_cmp_lg_u32 s92, 0
    s_cbranch_scc1 L_g88_done
    s_lshl_b32 s79, s84, 9
    s_lshl_b32 s93, s83, 2
    s_add_u32 s79, s79, s93
    s_add_u32 s79, s79, 3948800
    v_mov_b32 v250, 0
    v_mov_b32 v251, s82
    s_mov_b64 exec, 1
    buffer_store_dword v251, v250, s[4:7], s79 offen sc1
    s_mov_b64 exec, -1
L_g88_done:
    s_cmp_ge_u32 s83, 22
    s_cbranch_scc1 L_adaLN_cond__memory_aug_recurrent_mem_tr__dense_activation_gelu__prompt_kernel_ps_nof1b
    s_mov_b32 s16, s81
    s_lshl_b32 s10, s83, 6
    s_mov_b32 s11, 0
    s_load_dwordx2 s[66:67], s[0:1], 72
    v_and_b32 v2, 63, v0
    v_lshlrev_b32 v3, 4, v2
    v_and_b32 v4, 15, v2
    v_lshrrev_b32 v5, 4, v2
    v_lshrrev_b32 v20, 2, v4
    v_lshl_add_u32 v23, v5, 3, v20
    v_bfe_u32 v22, v23, 1, 1
    v_bfe_u32 v21, v23, 3, 1
    v_lshl_or_b32 v22, v21, 1, v22
    v_mul_u32_u24 v21, 128, v23
    v_and_b32 v23, 3, v2
    v_lshl_add_u32 v21, v23, 3, v21
    v_xor_b32 v23, 0, v22
    v_lshl_add_u32 v12, v23, 5, v21
    v_add_u32 v24, 0x10000, v12
    v_xor_b32 v23, 1, v22
    v_lshl_add_u32 v13, v23, 5, v21
    v_add_u32 v25, 0x10000, v13
    v_xor_b32 v23, 2, v22
    v_lshl_add_u32 v14, v23, 5, v21
    v_add_u32 v26, 0x10000, v14
    v_xor_b32 v23, 3, v22
    v_lshl_add_u32 v15, v23, 5, v21
    v_add_u32 v27, 0x10000, v15
    s_waitcnt lgkmcnt(0)
    s_mov_b32 s48, s66
    s_and_b32 s49, s67, 0xffff
    s_mov_b32 s50, 2752
    s_mov_b32 s51, 0x00020000
    v_lshlrev_b32 v20, 3, v5
    s_lshl_b32 s37, s10, 1
    buffer_load_dwordx2 v[96:97], v20, s[48:51], s37 offen offset:0
    buffer_load_dwordx2 v[98:99], v20, s[48:51], s37 offen offset:32
    buffer_load_dwordx2 v[100:101], v20, s[48:51], s37 offen offset:64
    buffer_load_dwordx2 v[102:103], v20, s[48:51], s37 offen offset:96
    s_cmp_lg_u32 s92, 0
    s_cbranch_scc1 L_g89_done
    s_lshl_b32 s79, s84, 9
    s_add_u32 s79, s79, 3948800
    v_mbcnt_lo_u32_b32 v250, -1, 0
    v_mbcnt_hi_u32_b32 v250, -1, v250
    v_min_u32 v250, 31, v250
    v_lshlrev_b32 v250, 2, v250
    s_mov_b32 s94, 400000
L_g89_spin:
    buffer_load_dword v251, v250, s[4:7], s79 offen sc1
    s_waitcnt vmcnt(0)
    v_cmp_gt_u32 vcc, s82, v251
    s_cbranch_vccz L_g89_done
    s_sub_u32 s94, s94, 1
    s_cbranch_scc0 L_g89_spin
L_g89_done:
    s_barrier
    s_lshl_b32 s9, s16, 2
    s_add_u32 s9, s9, s92
    s_and_b32 s8, s9, 3
    s_lshl_b32 s18, s84, 3
    s_add_u32 s8, s8, s18
    s_mul_i32 s23, s8, 16384
    s_lshl_b32 s24, s11, 10
    s_add_u32 s23, s23, s24
    s_add_u32 s23, s23, 104857600
    s_add_u32 s24, s23, 16384
    buffer_load_dwordx4 a[0:3], v3, s[4:7], s23 offen offset:0 sc1
    buffer_load_dwordx4 a[4:7], v3, s[4:7], s23 offen offset:1024 sc1
    buffer_load_dwordx4 a[8:11], v3, s[4:7], s23 offen offset:2048 sc1
    buffer_load_dwordx4 a[12:15], v3, s[4:7], s23 offen offset:3072 sc1
    s_add_u32 s23, s23, 4096
    buffer_load_dwordx4 a[16:19], v3, s[4:7], s23 offen offset:0 sc1
    buffer_load_dwordx4 a[20:23], v3, s[4:7], s23 offen offset:1024 sc1
    buffer_load_dwordx4 a[24:27], v3, s[4:7], s23 offen offset:2048 sc1
    buffer_load_dwordx4 a[28:31], v3, s[4:7], s23 offen offset:3072 sc1
    s_add_u32 s23, s23, 4096
    buffer_load_dwordx4 a[32:35], v3, s[4:7], s23 offen offset:0 sc1
    buffer_load_dwordx4 a[36:39], v3, s[4:7], s23 offen offset:1024 sc1
    buffer_load_dwordx4 a[40:43], v3, s[4:7], s23 offen offset:2048 sc1
    buffer_load_dwordx4 a[44:47], v3, s[4:7], s23 offen offset:3072 sc1
    s_add_u32 s23, s23, 4096
    buffer_load_dwordx4 a[48:51], v3, s[4:7], s23 offen offset:0 sc1
    buffer_load_dwordx4 a[52:55], v3, s[4:7], s23 offen offset:1024 sc1
    buffer_load_dwordx4 a[56:59], v3, s[4:7], s23 offen offset:2048 sc1
    buffer_load_dwordx4 a[60:63], v3, s[4:7], s23 offen offset:3072 sc1
    ds_read_b64_tr_b16 v[48:49], v12 offset:0
    ds_read_b64_tr_b16 v[50:51], v12 offset:512
    ds_read_b64_tr_b16 v[52:53], v13 offset:0
    ds_read_b64_tr_b16 v[54:55], v13 offset:512
    ds_read_b64_tr_b16 v[56:57], v14 offset:0
    ds_read_b64_tr_b16 v[58:59], v14 offset:512
    ds_read_b64_tr_b16 v[60:61], v15 offset:0
    ds_read_b64_tr_b16 v[62:63], v15 offset:512
    ds_read_b64_tr_b16 v[64:65], v12 offset:4096
    ds_read_b64_tr_b16 v[66:67], v12 offset:4608
    ds_read_b64_tr_b16 v[68:69], v13 offset:4096
    ds_read_b64_tr_b16 v[70:71], v13 offset:4608
    s_waitcnt vmcnt(15) lgkmcnt(10)
    v_mfma_f32_16x16x32_bf16 v[32:35], v[48:51], a[0:3], 0
    ds_read_b64_tr_b16 v[72:73], v14 offset:4096
    ds_read_b64_tr_b16 v[74:75], v14 offset:4608
    s_waitcnt lgkmcnt(10)
    v_mfma_f32_16x16x32_bf16 v[36:39], v[52:55], a[0:3], 0
    ds_read_b64_tr_b16 v[76:77], v15 offset:4096
    ds_read_b64_tr_b16 v[78:79], v15 offset:4608
    s_waitcnt lgkmcnt(10)
    v_mfma_f32_16x16x32_bf16 v[40:43], v[56:59], a[0:3], 0
    ds_read_b64_tr_b16 v[48:49], v12 offset:8192
    ds_read_b64_tr_b16 v[50:51], v12 offset:8704
    s_waitcnt lgkmcnt(10)
    v_mfma_f32_16x16x32_bf16 v[44:47], v[60:63], a[0:3], 0
    ds_read_b64_tr_b16 v[52:53], v13 offset:8192
    ds_read_b64_tr_b16 v[54:55], v13 offset:8704
    s_waitcnt vmcnt(14) lgkmcnt(10)
    v_mfma_f32_16x16x32_bf16 v[32:35], v[64:67], a[4:7], v[32:35]
    ds_read_b64_tr_b16 v[56:57], v14 offset:8192
    ds_read_b64_tr_b16 v[58:59], v14 offset:8704
    s_waitcnt lgkmcnt(10)
    v_mfma_f32_16x16x32_bf16 v[36:39], v[68:71], a[4:7], v[36:39]
    ds_read_b64_tr_b16 v[60:61], v15 offset:8192
    ds_read_b64_tr_b16 v[62:63], v15 offset:8704
    s_waitcnt lgkmcnt(10)
    v_mfma_f32_16x16x32_bf16 v[40:43], v[72:75], a[4:7], v[40:43]
    ds_read_b64_tr_b16 v[64:65], v12 offset:12288
    ds_read_b64_tr_b16 v[66:67], v12 offset:12800
    s_waitcnt lgkmcnt(10)
    v_mfma_f32_16x16x32_bf16 v[44:47], v[76:79], a[4:7], v[44:47]
    ds_read_b64_tr_b16 v[68:69], v13 offset:12288
    ds_read_b64_tr_b16 v[70:71], v13 offset:12800
    s_waitcnt vmcnt(13) lgkmcnt(10)
    v_mfma_f32_16x16x32_bf16 v[32:35], v[48:51], a[8:11], v[32:35]
    ds_read_b64_tr_b16 v[72:73], v14 offset:12288
    ds_read_b64_tr_b16 v[74:75], v14 offset:12800
    s_waitcnt lgkmcnt(10)
    v_mfma_f32_16x16x32_bf16 v[36:39], v[52:55], a[8:11], v[36:39]
    ds_read_b64_tr_b16 v[76:77], v15 offset:12288
    ds_read_b64_tr_b16 v[78:79], v15 offset:12800
    s_waitcnt lgkmcnt(10)
    v_mfma_f32_16x16x32_bf16 v[40:43], v[56:59], a[8:11], v[40:43]
    ds_read_b64_tr_b16 v[48:49], v12 offset:16384
    ds_read_b64_tr_b16 v[50:51], v12 offset:16896
    s_waitcnt lgkmcnt(10)
    v_mfma_f32_16x16x32_bf16 v[44:47], v[60:63], a[8:11], v[44:47]
    ds_read_b64_tr_b16 v[52:53], v13 offset:16384
    ds_read_b64_tr_b16 v[54:55], v13 offset:16896
    s_waitcnt vmcnt(12) lgkmcnt(10)
    v_mfma_f32_16x16x32_bf16 v[32:35], v[64:67], a[12:15], v[32:35]
    ds_read_b64_tr_b16 v[56:57], v14 offset:16384
    ds_read_b64_tr_b16 v[58:59], v14 offset:16896
    s_waitcnt lgkmcnt(10)
    v_mfma_f32_16x16x32_bf16 v[36:39], v[68:71], a[12:15], v[36:39]
    ds_read_b64_tr_b16 v[60:61], v15 offset:16384
    ds_read_b64_tr_b16 v[62:63], v15 offset:16896
    s_waitcnt lgkmcnt(10)
    v_mfma_f32_16x16x32_bf16 v[40:43], v[72:75], a[12:15], v[40:43]
    ds_read_b64_tr_b16 v[64:65], v12 offset:20480
    ds_read_b64_tr_b16 v[66:67], v12 offset:20992
    s_waitcnt lgkmcnt(10)
    v_mfma_f32_16x16x32_bf16 v[44:47], v[76:79], a[12:15], v[44:47]
    ds_read_b64_tr_b16 v[68:69], v13 offset:20480
    ds_read_b64_tr_b16 v[70:71], v13 offset:20992
    s_waitcnt vmcnt(11) lgkmcnt(10)
    v_mfma_f32_16x16x32_bf16 v[32:35], v[48:51], a[16:19], v[32:35]
    ds_read_b64_tr_b16 v[72:73], v14 offset:20480
    ds_read_b64_tr_b16 v[74:75], v14 offset:20992
    s_waitcnt lgkmcnt(10)
    v_mfma_f32_16x16x32_bf16 v[36:39], v[52:55], a[16:19], v[36:39]
    ds_read_b64_tr_b16 v[76:77], v15 offset:20480
    ds_read_b64_tr_b16 v[78:79], v15 offset:20992
    s_waitcnt lgkmcnt(10)
    v_mfma_f32_16x16x32_bf16 v[40:43], v[56:59], a[16:19], v[40:43]
    ds_read_b64_tr_b16 v[48:49], v12 offset:24576
    ds_read_b64_tr_b16 v[50:51], v12 offset:25088
    s_waitcnt lgkmcnt(10)
    v_mfma_f32_16x16x32_bf16 v[44:47], v[60:63], a[16:19], v[44:47]
    ds_read_b64_tr_b16 v[52:53], v13 offset:24576
    ds_read_b64_tr_b16 v[54:55], v13 offset:25088
    s_waitcnt vmcnt(10) lgkmcnt(10)
    v_mfma_f32_16x16x32_bf16 v[32:35], v[64:67], a[20:23], v[32:35]
    ds_read_b64_tr_b16 v[56:57], v14 offset:24576
    ds_read_b64_tr_b16 v[58:59], v14 offset:25088
    s_waitcnt lgkmcnt(10)
    v_mfma_f32_16x16x32_bf16 v[36:39], v[68:71], a[20:23], v[36:39]
    ds_read_b64_tr_b16 v[60:61], v15 offset:24576
    ds_read_b64_tr_b16 v[62:63], v15 offset:25088
    s_waitcnt lgkmcnt(10)
    v_mfma_f32_16x16x32_bf16 v[40:43], v[72:75], a[20:23], v[40:43]
    ds_read_b64_tr_b16 v[64:65], v12 offset:28672
    ds_read_b64_tr_b16 v[66:67], v12 offset:29184
    s_waitcnt lgkmcnt(10)
    v_mfma_f32_16x16x32_bf16 v[44:47], v[76:79], a[20:23], v[44:47]
    ds_read_b64_tr_b16 v[68:69], v13 offset:28672
    ds_read_b64_tr_b16 v[70:71], v13 offset:29184
    s_waitcnt vmcnt(9) lgkmcnt(10)
    v_mfma_f32_16x16x32_bf16 v[32:35], v[48:51], a[24:27], v[32:35]
    ds_read_b64_tr_b16 v[72:73], v14 offset:28672
    ds_read_b64_tr_b16 v[74:75], v14 offset:29184
    s_waitcnt lgkmcnt(10)
    v_mfma_f32_16x16x32_bf16 v[36:39], v[52:55], a[24:27], v[36:39]
    ds_read_b64_tr_b16 v[76:77], v15 offset:28672
    ds_read_b64_tr_b16 v[78:79], v15 offset:29184
    s_waitcnt lgkmcnt(10)
    v_mfma_f32_16x16x32_bf16 v[40:43], v[56:59], a[24:27], v[40:43]
    ds_read_b64_tr_b16 v[48:49], v12 offset:32768
    ds_read_b64_tr_b16 v[50:51], v12 offset:33280
    s_waitcnt lgkmcnt(10)
    v_mfma_f32_16x16x32_bf16 v[44:47], v[60:63], a[24:27], v[44:47]
    ds_read_b64_tr_b16 v[52:53], v13 offset:32768
    ds_read_b64_tr_b16 v[54:55], v13 offset:33280
    s_waitcnt vmcnt(8) lgkmcnt(10)
    v_mfma_f32_16x16x32_bf16 v[32:35], v[64:67], a[28:31], v[32:35]
    ds_read_b64_tr_b16 v[56:57], v14 offset:32768
    ds_read_b64_tr_b16 v[58:59], v14 offset:33280
    s_waitcnt lgkmcnt(10)
    v_mfma_f32_16x16x32_bf16 v[36:39], v[68:71], a[28:31], v[36:39]
    ds_read_b64_tr_b16 v[60:61], v15 offset:32768
    ds_read_b64_tr_b16 v[62:63], v15 offset:33280
    s_waitcnt lgkmcnt(10)
    v_mfma_f32_16x16x32_bf16 v[40:43], v[72:75], a[28:31], v[40:43]
    ds_read_b64_tr_b16 v[64:65], v12 offset:36864
    ds_read_b64_tr_b16 v[66:67], v12 offset:37376
    s_waitcnt lgkmcnt(10)
    v_mfma_f32_16x16x32_bf16 v[44:47], v[76:79], a[28:31], v[44:47]
    ds_read_b64_tr_b16 v[68:69], v13 offset:36864
    ds_read_b64_tr_b16 v[70:71], v13 offset:37376
    s_waitcnt vmcnt(7) lgkmcnt(10)
    v_mfma_f32_16x16x32_bf16 v[32:35], v[48:51], a[32:35], v[32:35]
    ds_read_b64_tr_b16 v[72:73], v14 offset:36864
    ds_read_b64_tr_b16 v[74:75], v14 offset:37376
    s_waitcnt lgkmcnt(10)
    v_mfma_f32_16x16x32_bf16 v[36:39], v[52:55], a[32:35], v[36:39]
    ds_read_b64_tr_b16 v[76:77], v15 offset:36864
    ds_read_b64_tr_b16 v[78:79], v15 offset:37376
    s_waitcnt lgkmcnt(10)
    v_mfma_f32_16x16x32_bf16 v[40:43], v[56:59], a[32:35], v[40:43]
    ds_read_b64_tr_b16 v[48:49], v12 offset:40960
    ds_read_b64_tr_b16 v[50:51], v12 offset:41472
    s_waitcnt lgkmcnt(10)
    v_mfma_f32_16x16x32_bf16 v[44:47], v[60:63], a[32:35], v[44:47]
    ds_read_b64_tr_b16 v[52:53], v13 offset:40960
    ds_read_b64_tr_b16 v[54:55], v13 offset:41472
    s_waitcnt vmcnt(6) lgkmcnt(10)
    v_mfma_f32_16x16x32_bf16 v[32:35], v[64:67], a[36:39], v[32:35]
    ds_read_b64_tr_b16 v[56:57], v14 offset:40960
    ds_read_b64_tr_b16 v[58:59], v14 offset:41472
    s_waitcnt lgkmcnt(10)
    v_mfma_f32_16x16x32_bf16 v[36:39], v[68:71], a[36:39], v[36:39]
    ds_read_b64_tr_b16 v[60:61], v15 offset:40960
    ds_read_b64_tr_b16 v[62:63], v15 offset:41472
    s_waitcnt lgkmcnt(10)
    v_mfma_f32_16x16x32_bf16 v[40:43], v[72:75], a[36:39], v[40:43]
    ds_read_b64_tr_b16 v[64:65], v12 offset:45056
    ds_read_b64_tr_b16 v[66:67], v12 offset:45568
    s_waitcnt lgkmcnt(10)
    v_mfma_f32_16x16x32_bf16 v[44:47], v[76:79], a[36:39], v[44:47]
    ds_read_b64_tr_b16 v[68:69], v13 offset:45056
    ds_read_b64_tr_b16 v[70:71], v13 offset:45568
    s_waitcnt vmcnt(5) lgkmcnt(10)
    v_mfma_f32_16x16x32_bf16 v[32:35], v[48:51], a[40:43], v[32:35]
    ds_read_b64_tr_b16 v[72:73], v14 offset:45056
    ds_read_b64_tr_b16 v[74:75], v14 offset:45568
    s_waitcnt lgkmcnt(10)
    v_mfma_f32_16x16x32_bf16 v[36:39], v[52:55], a[40:43], v[36:39]
    ds_read_b64_tr_b16 v[76:77], v15 offset:45056
    ds_read_b64_tr_b16 v[78:79], v15 offset:45568
    s_waitcnt lgkmcnt(10)
    v_mfma_f32_16x16x32_bf16 v[40:43], v[56:59], a[40:43], v[40:43]
    ds_read_b64_tr_b16 v[48:49], v12 offset:49152
    ds_read_b64_tr_b16 v[50:51], v12 offset:49664
    s_waitcnt lgkmcnt(10)
    v_mfma_f32_16x16x32_bf16 v[44:47], v[60:63], a[40:43], v[44:47]
    ds_read_b64_tr_b16 v[52:53], v13 offset:49152
    ds_read_b64_tr_b16 v[54:55], v13 offset:49664
    s_waitcnt vmcnt(4) lgkmcnt(10)
    v_mfma_f32_16x16x32_bf16 v[32:35], v[64:67], a[44:47], v[32:35]
    ds_read_b64_tr_b16 v[56:57], v14 offset:49152
    ds_read_b64_tr_b16 v[58:59], v14 offset:49664
    s_waitcnt lgkmcnt(10)
    v_mfma_f32_16x16x32_bf16 v[36:39], v[68:71], a[44:47], v[36:39]
    ds_read_b64_tr_b16 v[60:61], v15 offset:49152
    ds_read_b64_tr_b16 v[62:63], v15 offset:49664
    s_waitcnt lgkmcnt(10)
    v_mfma_f32_16x16x32_bf16 v[40:43], v[72:75], a[44:47], v[40:43]
    ds_read_b64_tr_b16 v[64:65], v12 offset:53248
    ds_read_b64_tr_b16 v[66:67], v12 offset:53760
    s_waitcnt lgkmcnt(10)
    v_mfma_f32_16x16x32_bf16 v[44:47], v[76:79], a[44:47], v[44:47]
    ds_read_b64_tr_b16 v[68:69], v13 offset:53248
    ds_read_b64_tr_b16 v[70:71], v13 offset:53760
    s_waitcnt vmcnt(3) lgkmcnt(10)
    v_mfma_f32_16x16x32_bf16 v[32:35], v[48:51], a[48:51], v[32:35]
    ds_read_b64_tr_b16 v[72:73], v14 offset:53248
    ds_read_b64_tr_b16 v[74:75], v14 offset:53760
    s_waitcnt lgkmcnt(10)
    v_mfma_f32_16x16x32_bf16 v[36:39], v[52:55], a[48:51], v[36:39]
    ds_read_b64_tr_b16 v[76:77], v15 offset:53248
    ds_read_b64_tr_b16 v[78:79], v15 offset:53760
    s_waitcnt lgkmcnt(10)
    v_mfma_f32_16x16x32_bf16 v[40:43], v[56:59], a[48:51], v[40:43]
    ds_read_b64_tr_b16 v[48:49], v12 offset:57344
    ds_read_b64_tr_b16 v[50:51], v12 offset:57856
    s_waitcnt lgkmcnt(10)
    v_mfma_f32_16x16x32_bf16 v[44:47], v[60:63], a[48:51], v[44:47]
    ds_read_b64_tr_b16 v[52:53], v13 offset:57344
    ds_read_b64_tr_b16 v[54:55], v13 offset:57856
    s_waitcnt vmcnt(2) lgkmcnt(10)
    v_mfma_f32_16x16x32_bf16 v[32:35], v[64:67], a[52:55], v[32:35]
    ds_read_b64_tr_b16 v[56:57], v14 offset:57344
    ds_read_b64_tr_b16 v[58:59], v14 offset:57856
    s_waitcnt lgkmcnt(10)
    v_mfma_f32_16x16x32_bf16 v[36:39], v[68:71], a[52:55], v[36:39]
    ds_read_b64_tr_b16 v[60:61], v15 offset:57344
    ds_read_b64_tr_b16 v[62:63], v15 offset:57856
    s_waitcnt lgkmcnt(10)
    v_mfma_f32_16x16x32_bf16 v[40:43], v[72:75], a[52:55], v[40:43]
    ds_read_b64_tr_b16 v[64:65], v12 offset:61440
    ds_read_b64_tr_b16 v[66:67], v12 offset:61952
    s_waitcnt lgkmcnt(10)
    v_mfma_f32_16x16x32_bf16 v[44:47], v[76:79], a[52:55], v[44:47]
    ds_read_b64_tr_b16 v[68:69], v13 offset:61440
    ds_read_b64_tr_b16 v[70:71], v13 offset:61952
    s_waitcnt vmcnt(1) lgkmcnt(10)
    v_mfma_f32_16x16x32_bf16 v[32:35], v[48:51], a[56:59], v[32:35]
    ds_read_b64_tr_b16 v[72:73], v14 offset:61440
    ds_read_b64_tr_b16 v[74:75], v14 offset:61952
    s_waitcnt lgkmcnt(10)
    v_mfma_f32_16x16x32_bf16 v[36:39], v[52:55], a[56:59], v[36:39]
    ds_read_b64_tr_b16 v[76:77], v15 offset:61440
    ds_read_b64_tr_b16 v[78:79], v15 offset:61952
    s_waitcnt lgkmcnt(10)
    v_mfma_f32_16x16x32_bf16 v[40:43], v[56:59], a[56:59], v[40:43]
    s_waitcnt lgkmcnt(8)
    v_mfma_f32_16x16x32_bf16 v[44:47], v[60:63], a[56:59], v[44:47]
    s_waitcnt vmcnt(0) lgkmcnt(6)
    v_mfma_f32_16x16x32_bf16 v[32:35], v[64:67], a[60:63], v[32:35]
    s_waitcnt lgkmcnt(4)
    v_mfma_f32_16x16x32_bf16 v[36:39], v[68:71], a[60:63], v[36:39]
    s_waitcnt lgkmcnt(2)
    v_mfma_f32_16x16x32_bf16 v[40:43], v[72:75], a[60:63], v[40:43]
    s_waitcnt lgkmcnt(0)
    v_mfma_f32_16x16x32_bf16 v[44:47], v[76:79], a[60:63], v[44:47]
    v_and_b32 v197, 63, v0
    v_lshlrev_b32 v197, 4, v197
    s_mul_i32 s40, s92, 22528
    s_add_u32 s40, s40, 65536
    v_add_u32 v197, s40, v197
    ds_write_b128 v197, a[192:195] offset:0
    ds_write_b128 v197, a[196:199] offset:1024
    ds_write_b128 v197, a[200:203] offset:2048
    ds_write_b128 v197, a[204:207] offset:3072
    ds_write_b128 v197, a[208:211] offset:4096
    ds_write_b128 v197, a[212:215] offset:5120
    ds_write_b128 v197, a[216:219] offset:6144
    ds_write_b128 v197, a[220:223] offset:7168
    ds_write_b128 v197, a[224:227] offset:8192
    ds_write_b128 v197, a[228:231] offset:9216
    ds_write_b128 v197, a[232:235] offset:10240
    ds_write_b128 v197, a[236:239] offset:11264
    ds_write_b128 v197, a[240:243] offset:12288
    ds_write_b128 v197, a[244:247] offset:13312
    ds_write_b128 v197, a[248:251] offset:14336
    ds_write_b128 v197, v[200:203] offset:15360
    ds_write_b128 v197, v[204:207] offset:16384
    ds_write_b128 v197, v[208:211] offset:17408
    ds_write_b128 v197, v[212:215] offset:18432
    ds_write_b128 v197, v[216:219] offset:19456
    ds_write_b128 v197, v[220:223] offset:20480
    ds_write_b128 v197, v[224:227] offset:21504
    s_mul_i32 s36, s8, 44032
    s_lshr_b32 s38, s10, 5
    s_lshl_b32 s39, s38, 10
    s_add_u32 s36, s36, s39
    s_add_u32 s36, s36, 109051904
    s_mov_b32 s52, 0x3d372713
    s_mov_b32 s54, 0x40135761
    s_mov_b32 s55, 0x40135761
    s_mov_b32 s56, 1.0
    s_mov_b32 s57, 1.0
    v_lshlrev_b32 v88, 16, v96
    v_and_b32 v89, 0xffff0000, v96
    v_lshlrev_b32 v90, 16, v97
    v_and_b32 v91, 0xffff0000, v97
    v_pk_add_f32 v[32:33], v[32:33], v[88:89]
    v_pk_add_f32 v[34:35], v[34:35], v[90:91]
    v_pk_mul_f32 v[88:89], v[32:33], v[32:33]
    v_pk_mul_f32 v[90:91], v[34:35], v[34:35]
    v_fma_f32 v88, v88, s52, 1.0
    v_fma_f32 v89, v89, s52, 1.0
    v_fma_f32 v90, v90, s52, 1.0
    v_fma_f32 v91, v91, s52, 1.0
    v_pk_mul_f32 v[88:89], v[88:89], v[32:33]
    v_pk_mul_f32 v[90:91], v[90:91], v[34:35]
    v_pk_mul_f32 v[88:89], v[88:89], s[54:55]
    v_pk_mul_f32 v[90:91], v[90:91], s[54:55]
    v_exp_f32 v88, -v88
    v_exp_f32 v89, -v89
    v_exp_f32 v90, -v90
    v_exp_f32 v91, -v91
    v_pk_add_f32 v[88:89], v[88:89], s[56:57]
    v_pk_add_f32 v[90:91], v[90:91], s[56:57]
    v_rcp_f32 v88, v88
    v_rcp_f32 v89, v89
    v_rcp_f32 v90, v90
    v_rcp_f32 v91, v91
    v_pk_mul_f32 v[32:33], v[32:33], v[88:89]
    v_pk_mul_f32 v[34:35], v[34:35], v[90:91]
    v_cvt_pk_bf16_f32 v80, v32, v33
    v_cvt_pk_bf16_f32 v81, v34, v35
    v_lshlrev_b32 v88, 16, v98
    v_and_b32 v89, 0xffff0000, v98
    v_lshlrev_b32 v90, 16, v99
    v_and_b32 v91, 0xffff0000, v99
    v_pk_add_f32 v[36:37], v[36:37], v[88:89]
    v_pk_add_f32 v[38:39], v[38:39], v[90:91]
    v_pk_mul_f32 v[88:89], v[36:37], v[36:37]
    v_pk_mul_f32 v[90:91], v[38:39], v[38:39]
    v_fma_f32 v88, v88, s52, 1.0
    v_fma_f32 v89, v89, s52, 1.0
    v_fma_f32 v90, v90, s52, 1.0
    v_fma_f32 v91, v91, s52, 1.0
    v_pk_mul_f32 v[88:89], v[88:89], v[36:37]
    v_pk_mul_f32 v[90:91], v[90:91], v[38:39]
    v_pk_mul_f32 v[88:89], v[88:89], s[54:55]
    v_pk_mul_f32 v[90:91], v[90:91], s[54:55]
    v_exp_f32 v88, -v88
    v_exp_f32 v89, -v89
    v_exp_f32 v90, -v90
    v_exp_f32 v91, -v91
    v_pk_add_f32 v[88:89], v[88:89], s[56:57]
    v_pk_add_f32 v[90:91], v[90:91], s[56:57]
    v_rcp_f32 v88, v88
    v_rcp_f32 v89, v89
    v_rcp_f32 v90, v90
    v_rcp_f32 v91, v91
    v_pk_mul_f32 v[36:37], v[36:37], v[88:89]
    v_pk_mul_f32 v[38:39], v[38:39], v[90:91]
    v_cvt_pk_bf16_f32 v82, v36, v37
    v_cvt_pk_bf16_f32 v83, v38, v39
    s_add_u32 s39, s38, 0
    s_cmp_ge_u32 s39, 43
    s_cbranch_scc1 L_adaLN_cond__memory_aug_recurrent_mem_tr__dense_activation_gelu__prompt_kernel_ps_f1_sk00
    buffer_store_dwordx4 v[80:83], v3, s[4:7], s36 offen offset:0 sc1
L_adaLN_cond__memory_aug_recurrent_mem_tr__dense_activation_gelu__prompt_kernel_ps_f1_sk00:
    v_lshlrev_b32 v88, 16, v100
    v_and_b32 v89, 0xffff0000, v100
    v_lshlrev_b32 v90, 16, v101
    v_and_b32 v91, 0xffff0000, v101
    v_pk_add_f32 v[40:41], v[40:41], v[88:89]
    v_pk_add_f32 v[42:43], v[42:43], v[90:91]
    v_pk_mul_f32 v[88:89], v[40:41], v[40:41]
    v_pk_mul_f32 v[90:91], v[42:43], v[42:43]
    v_fma_f32 v88, v88, s52, 1.0
    v_fma_f32 v89, v89, s52, 1.0
    v_fma_f32 v90, v90, s52, 1.0
    v_fma_f32 v91, v91, s52, 1.0
    v_pk_mul_f32 v[88:89], v[88:89], v[40:41]
    v_pk_mul_f32 v[90:91], v[90:91], v[42:43]
    v_pk_mul_f32 v[88:89], v[88:89], s[54:55]
    v_pk_mul_f32 v[90:91], v[90:91], s[54:55]
    v_exp_f32 v88, -v88
    v_exp_f32 v89, -v89
    v_exp_f32 v90, -v90
    v_exp_f32 v91, -v91
    v_pk_add_f32 v[88:89], v[88:89], s[56:57]
    v_pk_add_f32 v[90:91], v[90:91], s[56:57]
    v_rcp_f32 v88, v88
    v_rcp_f32 v89, v89
    v_rcp_f32 v90, v90
    v_rcp_f32 v91, v91
    v_pk_mul_f32 v[40:41], v[40:41], v[88:89]
    v_pk_mul_f32 v[42:43], v[42:43], v[90:91]
    v_cvt_pk_bf16_f32 v84, v40, v41
    v_cvt_pk_bf16_f32 v85, v42, v43
    v_lshlrev_b32 v88, 16, v102
    v_and_b32 v89, 0xffff0000, v102
    v_lshlrev_b32 v90, 16, v103
    v_and_b32 v91, 0xffff0000, v103
    v_pk_add_f32 v[44:45], v[44:45], v[88:89]
    v_pk_add_f32 v[46:47], v[46:47], v[90:91]
    v_pk_mul_f32 v[88:89], v[44:45], v[44:45]
    v_pk_mul_f32 v[90:91], v[46:47], v[46:47]
    v_fma_f32 v88, v88, s52, 1.0
    v_fma_f32 v89, v89, s52, 1.0
    v_fma_f32 v90, v90, s52, 1.0
    v_fma_f32 v91, v91, s52, 1.0
    v_pk_mul_f32 v[88:89], v[88:89], v[44:45]
    v_pk_mul_f32 v[90:91], v[90:91], v[46:47]
    v_pk_mul_f32 v[88:89], v[88:89], s[54:55]
    v_pk_mul_f32 v[90:91], v[90:91], s[54:55]
    v_exp_f32 v88, -v88
    v_exp_f32 v89, -v89
    v_exp_f32 v90, -v90
    v_exp_f32 v91, -v91
    v_pk_add_f32 v[88:89], v[88:89], s[56:57]
    v_pk_add_f32 v[90:91], v[90:91], s[56:57]
    v_rcp_f32 v88, v88
    v_rcp_f32 v89, v89
    v_rcp_f32 v90, v90
    v_rcp_f32 v91, v91
    v_pk_mul_f32 v[44:45], v[44:45], v[88:89]
    v_pk_mul_f32 v[46:47], v[46:47], v[90:91]
    v_cvt_pk_bf16_f32 v86, v44, v45
    v_cvt_pk_bf16_f32 v87, v46, v47
    s_add_u32 s39, s38, 1
    s_cmp_ge_u32 s39, 43
    s_cbranch_scc1 L_adaLN_cond__memory_aug_recurrent_mem_tr__dense_activation_gelu__prompt_kernel_ps_f1_sk01
    buffer_store_dwordx4 v[84:87], v3, s[4:7], s36 offen offset:1024 sc1
L_adaLN_cond__memory_aug_recurrent_mem_tr__dense_activation_gelu__prompt_kernel_ps_f1_sk01:
    s_add_u32 s36, s36, 44032
    s_waitcnt lgkmcnt(0)
    s_waitcnt vmcnt(0)
    s_barrier
    s_cmp_lg_u32 s92, 0
    s_cbranch_scc1 L_g90_done
    s_lshl_b32 s79, s84, 9
    s_lshl_b32 s93, s83, 2
    s_add_u32 s79, s79, s93
    s_add_u32 s79, s79, 3948928
    v_mov_b32 v250, 0
    v_mov_b32 v251, s82
    s_mov_b64 exec, 1
    buffer_store_dword v251, v250, s[4:7], s79 offen sc1
    s_mov_b64 exec, -1
L_g90_done:
    s_branch L_adaLN_cond__memory_aug_recurrent_mem_tr__dense_activation_gelu__prompt_kernel_ps_f1d
L_adaLN_cond__memory_aug_recurrent_mem_tr__dense_activation_gelu__prompt_kernel_ps_nof1b:
    v_and_b32 v197, 63, v0
    v_lshlrev_b32 v197, 4, v197
    s_mul_i32 s40, s92, 22528
    s_add_u32 s40, s40, 65536
    v_add_u32 v197, s40, v197
    ds_write_b128 v197, a[192:195] offset:0
    ds_write_b128 v197, a[196:199] offset:1024
    ds_write_b128 v197, a[200:203] offset:2048
    ds_write_b128 v197, a[204:207] offset:3072
    ds_write_b128 v197, a[208:211] offset:4096
    ds_write_b128 v197, a[212:215] offset:5120
    ds_write_b128 v197, a[216:219] offset:6144
    ds_write_b128 v197, a[220:223] offset:7168
    ds_write_b128 v197, a[224:227] offset:8192
    ds_write_b128 v197, a[228:231] offset:9216
    ds_write_b128 v197, a[232:235] offset:10240
    ds_write_b128 v197, a[236:239] offset:11264
    ds_write_b128 v197, a[240:243] offset:12288
    ds_write_b128 v197, a[244:247] offset:13312
    ds_write_b128 v197, a[248:251] offset:14336
    ds_write_b128 v197, v[200:203] offset:15360
    ds_write_b128 v197, v[204:207] offset:16384
    ds_write_b128 v197, v[208:211] offset:17408
    ds_write_b128 v197, v[212:215] offset:18432
    ds_write_b128 v197, v[216:219] offset:19456
    ds_write_b128 v197, v[220:223] offset:20480
    ds_write_b128 v197, v[224:227] offset:21504
    s_waitcnt lgkmcnt(0)
L_adaLN_cond__memory_aug_recurrent_mem_tr__dense_activation_gelu__prompt_kernel_ps_f1d:
    s_mov_b32 s16, s81
    s_lshr_b32 s17, s83, 1
    s_and_b32 s19, s83, 1
    s_lshl_b32 s10, s17, 5
    s_mov_b32 s11, 0
    s_load_dwordx2 s[66:67], s[0:1], 88
    s_load_dwordx2 s[68:69], s[0:1], 112
    v_and_b32 v2, 63, v0
    v_lshlrev_b32 v3, 4, v2
    v_and_b32 v4, 15, v2
    v_lshrrev_b32 v5, 4, v2
    v_lshrrev_b32 v20, 2, v4
    v_lshl_add_u32 v23, v5, 2, v20
    v_bfe_u32 v22, v23, 2, 1
    v_mul_u32_u24 v21, 64, v23
    v_and_b32 v23, 3, v2
    v_lshl_add_u32 v21, v23, 3, v21
    v_xor_b32 v23, 0, v22
    v_lshl_add_u32 v12, v23, 5, v21
    v_add_u32 v24, 0x10000, v12
    v_xor_b32 v23, 1, v22
    v_lshl_add_u32 v13, v23, 5, v21
    v_add_u32 v25, 0x10000, v13
    s_waitcnt lgkmcnt(0)
    s_mov_b32 s48, s66
    s_and_b32 s49, s67, 0xffff
    s_mov_b32 s50, 1024
    s_mov_b32 s51, 0x00020000
    v_lshlrev_b32 v20, 3, v5
    s_lshl_b32 s37, s10, 1
    buffer_load_dwordx2 v[88:89], v20, s[48:51], s37 offen offset:0
    buffer_load_dwordx2 v[90:91], v20, s[48:51], s37 offen offset:32
    s_mov_b32 s52, s68
    s_and_b32 s53, s69, 0xffff
    s_mov_b32 s54, 2097152
    s_mov_b32 s55, 0x00020000
    s_cmp_lg_u32 s92, 0
    s_cbranch_scc1 L_g91_done
    s_lshl_b32 s79, s84, 9
    s_add_u32 s79, s79, 3948928
    v_mbcnt_lo_u32_b32 v250, -1, 0
    v_mbcnt_hi_u32_b32 v250, -1, v250
    v_min_u32 v250, 21, v250
    v_lshlrev_b32 v250, 2, v250
    s_mov_b32 s94, 400000
L_g91_spin:
    buffer_load_dword v251, v250, s[4:7], s79 offen sc1
    s_waitcnt vmcnt(0)
    v_cmp_gt_u32 vcc, s82, v251
    s_cbranch_vccz L_g91_done
    s_sub_u32 s94, s94, 1
    s_cbranch_scc0 L_g91_spin
L_g91_done:
    s_barrier
    s_cmp_ge_u32 s92, 2
    s_cbranch_scc1 L_adaLN_cond__memory_aug_recurrent_mem_tr__dense_activation_gelu__prompt_kernel_ps_f2_skip
    s_lshl_b32 s9, s16, 2
    s_lshl_b32 s18, s19, 1
    s_add_u32 s9, s9, s18
    s_add_u32 s9, s9, s92
    s_and_b32 s8, s9, 3
    s_lshl_b32 s18, s84, 3
    s_add_u32 s8, s8, s18
    s_mul_i32 s23, s8, 44032
    s_lshl_b32 s24, s11, 10
    s_add_u32 s23, s23, s24
    s_add_u32 s23, s23, 109051904
    s_add_u32 s24, s23, 44032
    buffer_load_dwordx4 a[0:3], v3, s[4:7], s23 offen offset:0 sc1
    buffer_load_dwordx4 a[4:7], v3, s[4:7], s23 offen offset:1024 sc1
    buffer_load_dwordx4 a[8:11], v3, s[4:7], s23 offen offset:2048 sc1
    buffer_load_dwordx4 a[12:15], v3, s[4:7], s23 offen offset:3072 sc1
    s_add_u32 s23, s23, 4096
    buffer_load_dwordx4 a[16:19], v3, s[4:7], s23 offen offset:0 sc1
    buffer_load_dwordx4 a[20:23], v3, s[4:7], s23 offen offset:1024 sc1
    buffer_load_dwordx4 a[24:27], v3, s[4:7], s23 offen offset:2048 sc1
    buffer_load_dwordx4 a[28:31], v3, s[4:7], s23 offen offset:3072 sc1
    s_add_u32 s23, s23, 4096
    buffer_load_dwordx4 a[32:35], v3, s[4:7], s23 offen offset:0 sc1
    buffer_load_dwordx4 a[36:39], v3, s[4:7], s23 offen offset:1024 sc1
    buffer_load_dwordx4 a[40:43], v3, s[4:7], s23 offen offset:2048 sc1
    buffer_load_dwordx4 a[44:47], v3, s[4:7], s23 offen offset:3072 sc1
    s_add_u32 s23, s23, 4096
    buffer_load_dwordx4 a[48:51], v3, s[4:7], s23 offen offset:0 sc1
    buffer_load_dwordx4 a[52:55], v3, s[4:7], s23 offen offset:1024 sc1
    buffer_load_dwordx4 a[56:59], v3, s[4:7], s23 offen offset:2048 sc1
    buffer_load_dwordx4 a[60:63], v3, s[4:7], s23 offen offset:3072 sc1
    s_add_u32 s23, s23, 4096
    buffer_load_dwordx4 a[64:67], v3, s[4:7], s23 offen offset:0 sc1
    buffer_load_dwordx4 a[68:71], v3, s[4:7], s23 offen offset:1024 sc1
    buffer_load_dwordx4 a[72:75], v3, s[4:7], s23 offen offset:2048 sc1
    buffer_load_dwordx4 a[76:79], v3, s[4:7], s23 offen offset:3072 sc1
    s_add_u32 s23, s23, 4096
    buffer_load_dwordx4 a[80:83], v3, s[4:7], s23 offen offset:0 sc1
    buffer_load_dwordx4 a[84:87], v3, s[4:7], s23 offen offset:1024 sc1
    buffer_load_dwordx4 a[88:91], v3, s[4:7], s23 offen offset:2048 sc1
    buffer_load_dwordx4 a[92:95], v3, s[4:7], s23 offen offset:3072 sc1
    s_add_u32 s23, s23, 4096
    buffer_load_dwordx4 a[96:99], v3, s[4:7], s23 offen offset:0 sc1
    buffer_load_dwordx4 a[100:103], v3, s[4:7], s23 offen offset:1024 sc1
    buffer_load_dwordx4 a[104:107], v3, s[4:7], s23 offen offset:2048 sc1
    buffer_load_dwordx4 a[108:111], v3, s[4:7], s23 offen offset:3072 sc1
    s_add_u32 s23, s23, 4096
    buffer_load_dwordx4 a[112:115], v3, s[4:7], s23 offen offset:0 sc1
    buffer_load_dwordx4 a[116:119], v3, s[4:7], s23 offen offset:1024 sc1
    buffer_load_dwordx4 a[120:123], v3, s[4:7], s23 offen offset:2048 sc1
    buffer_load_dwordx4 a[124:127], v3, s[4:7], s23 offen offset:3072 sc1
    s_add_u32 s23, s23, 4096
    buffer_load_dwordx4 v[112:115], v3, s[4:7], s23 offen offset:0 sc1
    buffer_load_dwordx4 v[116:119], v3, s[4:7], s23 offen offset:1024 sc1
    buffer_load_dwordx4 v[120:123], v3, s[4:7], s23 offen offset:2048 sc1
    buffer_load_dwordx4 v[124:127], v3, s[4:7], s23 offen offset:3072 sc1
    s_add_u32 s23, s23, 4096
    buffer_load_dwordx4 v[128:131], v3, s[4:7], s23 offen offset:0 sc1
    buffer_load_dwordx4 v[132:135], v3, s[4:7], s23 offen offset:1024 sc1
    buffer_load_dwordx4 v[136:139], v3, s[4:7], s23 offen offset:2048 sc1
    buffer_load_dwordx4 v[140:143], v3, s[4:7], s23 offen offset:3072 sc1
    s_add_u32 s23, s23, 4096
    buffer_load_dwordx4 v[144:147], v3, s[4:7], s23 offen offset:0 sc1
    buffer_load_dwordx4 v[148:151], v3, s[4:7], s23 offen offset:1024 sc1
    buffer_load_dwordx4 v[152:155], v3, s[4:7], s23 offen offset:2048 sc1
    v_lshlrev_b32 v21, 4, v5
    s_lshl_b32 s38, s10, 2
    s_add_u32 s38, s38, 2107392
    v_lshlrev_b32 v22, 11, v4
    v_lshl_add_u32 v22, v5, 4, v22
    s_lshl_b32 s39, s8, 15
    s_lshl_b32 s56, s10, 2
    s_add_u32 s39, s39, s56
    s_add_u32 s39, s39, 100663296
    buffer_load_dwordx4 v[96:99], v21, s[4:7], s38 offen offset:0 sc1
    buffer_load_dwordx4 v[104:107], v22, s[4:7], s39 offen offset:0 sc1
    buffer_load_dwordx4 v[100:103], v21, s[4:7], s38 offen offset:64 sc1
    buffer_load_dwordx4 v[108:111], v22, s[4:7], s39 offen offset:64 sc1
    v_add_u32 v28, 0x20000, v12
    v_add_u32 v29, 0x20000, v13
    ds_read_b64_tr_b16 v[40:41], v24 offset:0
    ds_read_b64_tr_b16 v[42:43], v24 offset:1024
    ds_read_b64_tr_b16 v[44:45], v25 offset:0
    ds_read_b64_tr_b16 v[46:47], v25 offset:1024
    ds_read_b64_tr_b16 v[48:49], v24 offset:2048
    ds_read_b64_tr_b16 v[50:51], v24 offset:3072
    ds_read_b64_tr_b16 v[52:53], v25 offset:2048
    ds_read_b64_tr_b16 v[54:55], v25 offset:3072
    ds_read_b64_tr_b16 v[56:57], v24 offset:4096
    ds_read_b64_tr_b16 v[58:59], v24 offset:5120
    ds_read_b64_tr_b16 v[60:61], v25 offset:4096
    ds_read_b64_tr_b16 v[62:63], v25 offset:5120
    s_waitcnt vmcnt(46) lgkmcnt(10)
    v_mfma_f32_16x16x32_bf16 v[32:35], v[40:43], a[0:3], 0
    ds_read_b64_tr_b16 v[64:65], v24 offset:6144
    ds_read_b64_tr_b16 v[66:67], v24 offset:7168
    s_waitcnt lgkmcnt(10)
    v_mfma_f32_16x16x32_bf16 v[36:39], v[44:47], a[0:3], 0
    ds_read_b64_tr_b16 v[68:69], v25 offset:6144
    ds_read_b64_tr_b16 v[70:71], v25 offset:7168
    s_waitcnt vmcnt(45) lgkmcnt(10)
    v_mfma_f32_16x16x32_bf16 v[32:35], v[48:51], a[4:7], v[32:35]
    ds_read_b64_tr_b16 v[40:41], v24 offset:8192
    ds_read_b64_tr_b16 v[42:43], v24 offset:9216
    s_waitcnt lgkmcnt(10)
    v_mfma_f32_16x16x32_bf16 v[36:39], v[52:55], a[4:7], v[36:39]
    ds_read_b64_tr_b16 v[44:45], v25 offset:8192
    ds_read_b64_tr_b16 v[46:47], v25 offset:9216
    s_waitcnt vmcnt(44) lgkmcnt(10)
    v_mfma_f32_16x16x32_bf16 v[32:35], v[56:59], a[8:11], v[32:35]
    ds_read_b64_tr_b16 v[48:49], v24 offset:10240
    ds_read_b64_tr_b16 v[50:51], v24 offset:11264
    s_waitcnt lgkmcnt(10)
    v_mfma_f32_16x16x32_bf16 v[36:39], v[60:63], a[8:11], v[36:39]
    ds_read_b64_tr_b16 v[52:53], v25 offset:10240
    ds_read_b64_tr_b16 v[54:55], v25 offset:11264
    s_waitcnt vmcnt(43) lgkmcnt(10)
    v_mfma_f32_16x16x32_bf16 v[32:35], v[64:67], a[12:15], v[32:35]
    ds_read_b64_tr_b16 v[56:57], v24 offset:12288
    ds_read_b64_tr_b16 v[58:59], v24 offset:13312
    s_waitcnt lgkmcnt(10)
    v_mfma_f32_16x16x32_bf16 v[36:39], v[68:71], a[12:15], v[36:39]
    ds_read_b64_tr_b16 v[60:61], v25 offset:12288
    ds_read_b64_tr_b16 v[62:63], v25 offset:13312
    s_waitcnt vmcnt(42) lgkmcnt(10)
    v_mfma_f32_16x16x32_bf16 v[32:35], v[40:43], a[16:19], v[32:35]
    ds_read_b64_tr_b16 v[64:65], v24 offset:14336
    ds_read_b64_tr_b16 v[66:67], v24 offset:15360
    s_waitcnt lgkmcnt(10)
    v_mfma_f32_16x16x32_bf16 v[36:39], v[44:47], a[16:19], v[36:39]
    ds_read_b64_tr_b16 v[68:69], v25 offset:14336
    ds_read_b64_tr_b16 v[70:71], v25 offset:15360
    s_waitcnt vmcnt(41) lgkmcnt(10)
    v_mfma_f32_16x16x32_bf16 v[32:35], v[48:51], a[20:23], v[32:35]
    ds_read_b64_tr_b16 v[40:41], v24 offset:16384
    ds_read_b64_tr_b16 v[42:43], v24 offset:17408
    s_waitcnt lgkmcnt(10)
    v_mfma_f32_16x16x32_bf16 v[36:39], v[52:55], a[20:23], v[36:39]
    ds_read_b64_tr_b16 v[44:45], v25 offset:16384
    ds_read_b64_tr_b16 v[46:47], v25 offset:17408
    s_waitcnt vmcnt(40) lgkmcnt(10)
    v_mfma_f32_16x16x32_bf16 v[32:35], v[56:59], a[24:27], v[32:35]
    ds_read_b64_tr_b16 v[48:49], v24 offset:18432
    ds_read_b64_tr_b16 v[50:51], v24 offset:19456
    s_waitcnt lgkmcnt(10)
    v_mfma_f32_16x16x32_bf16 v[36:39], v[60:63], a[24:27], v[36:39]
    ds_read_b64_tr_b16 v[52:53], v25 offset:18432
    ds_read_b64_tr_b16 v[54:55], v25 offset:19456
    s_waitcnt vmcnt(39) lgkmcnt(10)
    v_mfma_f32_16x16x32_bf16 v[32:35], v[64:67], a[28:31], v[32:35]
    ds_read_b64_tr_b16 v[56:57], v24 offset:20480
    ds_read_b64_tr_b16 v[58:59], v24 offset:21504
    s_waitcnt lgkmcnt(10)
    v_mfma_f32_16x16x32_bf16 v[36:39], v[68:71], a[28:31], v[36:39]
    ds_read_b64_tr_b16 v[60:61], v25 offset:20480
    ds_read_b64_tr_b16 v[62:63], v25 offset:21504
    s_waitcnt vmcnt(38) lgkmcnt(10)
    v_mfma_f32_16x16x32_bf16 v[32:35], v[40:43], a[32:35], v[32:35]
    ds_read_b64_tr_b16 v[64:65], v24 offset:22528
    ds_read_b64_tr_b16 v[66:67], v24 offset:23552
    s_waitcnt lgkmcnt(10)
    v_mfma_f32_16x16x32_bf16 v[36:39], v[44:47], a[32:35], v[36:39]
    ds_read_b64_tr_b16 v[68:69], v25 offset:22528
    ds_read_b64_tr_b16 v[70:71], v25 offset:23552
    s_waitcnt vmcnt(37) lgkmcnt(10)
    v_mfma_f32_16x16x32_bf16 v[32:35], v[48:51], a[36:39], v[32:35]
    ds_read_b64_tr_b16 v[40:41], v24 offset:24576
    ds_read_b64_tr_b16 v[42:43], v24 offset:25600
    s_waitcnt lgkmcnt(10)
    v_mfma_f32_16x16x32_bf16 v[36:39], v[52:55], a[36:39], v[36:39]
    ds_read_b64_tr_b16 v[44:45], v25 offset:24576
    ds_read_b64_tr_b16 v[46:47], v25 offset:25600
    s_waitcnt vmcnt(36) lgkmcnt(10)
    v_mfma_f32_16x16x32_bf16 v[32:35], v[56:59], a[40:43], v[32:35]
    ds_read_b64_tr_b16 v[48:49], v24 offset:26624
    ds_read_b64_tr_b16 v[50:51], v24 offset:27648
    s_waitcnt lgkmcnt(10)
    v_mfma_f32_16x16x32_bf16 v[36:39], v[60:63], a[40:43], v[36:39]
    ds_read_b64_tr_b16 v[52:53], v25 offset:26624
    ds_read_b64_tr_b16 v[54:55], v25 offset:27648
    s_waitcnt vmcnt(35) lgkmcnt(10)
    v_mfma_f32_16x16x32_bf16 v[32:35], v[64:67], a[44:47], v[32:35]
    ds_read_b64_tr_b16 v[56:57], v24 offset:28672
    ds_read_b64_tr_b16 v[58:59], v24 offset:29696
    s_waitcnt lgkmcnt(10)
    v_mfma_f32_16x16x32_bf16 v[36:39], v[68:71], a[44:47], v[36:39]
    ds_read_b64_tr_b16 v[60:61], v25 offset:28672
    ds_read_b64_tr_b16 v[62:63], v25 offset:29696
    s_waitcnt vmcnt(34) lgkmcnt(10)
    v_mfma_f32_16x16x32_bf16 v[32:35], v[40:43], a[48:51], v[32:35]
    ds_read_b64_tr_b16 v[64:65], v24 offset:30720
    ds_read_b64_tr_b16 v[66:67], v24 offset:31744
    s_waitcnt lgkmcnt(10)
    v_mfma_f32_16x16x32_bf16 v[36:39], v[44:47], a[48:51], v[36:39]
    ds_read_b64_tr_b16 v[68:69], v25 offset:30720
    ds_read_b64_tr_b16 v[70:71], v25 offset:31744
    s_waitcnt vmcnt(33) lgkmcnt(10)
    v_mfma_f32_16x16x32_bf16 v[32:35], v[48:51], a[52:55], v[32:35]
    ds_read_b64_tr_b16 v[40:41], v24 offset:32768
    ds_read_b64_tr_b16 v[42:43], v24 offset:33792
    s_waitcnt lgkmcnt(10)
    v_mfma_f32_16x16x32_bf16 v[36:39], v[52:55], a[52:55], v[36:39]
    ds_read_b64_tr_b16 v[44:45], v25 offset:32768
    ds_read_b64_tr_b16 v[46:47], v25 offset:33792
    s_waitcnt vmcnt(32) lgkmcnt(10)
    v_mfma_f32_16x16x32_bf16 v[32:35], v[56:59], a[56:59], v[32:35]
    ds_read_b64_tr_b16 v[48:49], v24 offset:34816
    ds_read_b64_tr_b16 v[50:51], v24 offset:35840
    s_waitcnt lgkmcnt(10)
    v_mfma_f32_16x16x32_bf16 v[36:39], v[60:63], a[56:59], v[36:39]
    ds_read_b64_tr_b16 v[52:53], v25 offset:34816
    ds_read_b64_tr_b16 v[54:55], v25 offset:35840
    s_waitcnt vmcnt(31) lgkmcnt(10)
    v_mfma_f32_16x16x32_bf16 v[32:35], v[64:67], a[60:63], v[32:35]
    ds_read_b64_tr_b16 v[56:57], v24 offset:36864
    ds_read_b64_tr_b16 v[58:59], v24 offset:37888
    s_waitcnt lgkmcnt(10)
    v_mfma_f32_16x16x32_bf16 v[36:39], v[68:71], a[60:63], v[36:39]
    ds_read_b64_tr_b16 v[60:61], v25 offset:36864
    ds_read_b64_tr_b16 v[62:63], v25 offset:37888
    s_waitcnt vmcnt(30) lgkmcnt(10)
    v_mfma_f32_16x16x32_bf16 v[32:35], v[40:43], a[64:67], v[32:35]
    ds_read_b64_tr_b16 v[64:65], v24 offset:38912
    ds_read_b64_tr_b16 v[66:67], v24 offset:39936
    s_waitcnt lgkmcnt(10)
    v_mfma_f32_16x16x32_bf16 v[36:39], v[44:47], a[64:67], v[36:39]
    ds_read_b64_tr_b16 v[68:69], v25 offset:38912
    ds_read_b64_tr_b16 v[70:71], v25 offset:39936
    s_waitcnt vmcnt(29) lgkmcnt(10)
    v_mfma_f32_16x16x32_bf16 v[32:35], v[48:51], a[68:71], v[32:35]
    ds_read_b64_tr_b16 v[40:41], v24 offset:40960
    ds_read_b64_tr_b16 v[42:43], v24 offset:41984
    s_waitcnt lgkmcnt(10)
    v_mfma_f32_16x16x32_bf16 v[36:39], v[52:55], a[68:71], v[36:39]
    ds_read_b64_tr_b16 v[44:45], v25 offset:40960
    ds_read_b64_tr_b16 v[46:47], v25 offset:41984
    s_waitcnt vmcnt(28) lgkmcnt(10)
    v_mfma_f32_16x16x32_bf16 v[32:35], v[56:59], a[72:75], v[32:35]
    ds_read_b64_tr_b16 v[48:49], v24 offset:43008
    ds_read_b64_tr_b16 v[50:51], v24 offset:44032
    s_waitcnt lgkmcnt(10)
    v_mfma_f32_16x16x32_bf16 v[36:39], v[60:63], a[72:75], v[36:39]
    ds_read_b64_tr_b16 v[52:53], v25 offset:43008
    ds_read_b64_tr_b16 v[54:55], v25 offset:44032
    s_waitcnt vmcnt(27) lgkmcnt(10)
    v_mfma_f32_16x16x32_bf16 v[32:35], v[64:67], a[76:79], v[32:35]
    ds_read_b64_tr_b16 v[56:57], v24 offset:45056
    ds_read_b64_tr_b16 v[58:59], v24 offset:46080
    s_waitcnt lgkmcnt(10)
    v_mfma_f32_16x16x32_bf16 v[36:39], v[68:71], a[76:79], v[36:39]
    ds_read_b64_tr_b16 v[60:61], v25 offset:45056
    ds_read_b64_tr_b16 v[62:63], v25 offset:46080
    s_waitcnt vmcnt(26) lgkmcnt(10)
    v_mfma_f32_16x16x32_bf16 v[32:35], v[40:43], a[80:83], v[32:35]
    ds_read_b64_tr_b16 v[64:65], v24 offset:47104
    ds_read_b64_tr_b16 v[66:67], v24 offset:48128
    s_waitcnt lgkmcnt(10)
    v_mfma_f32_16x16x32_bf16 v[36:39], v[44:47], a[80:83], v[36:39]
    ds_read_b64_tr_b16 v[68:69], v25 offset:47104
    ds_read_b64_tr_b16 v[70:71], v25 offset:48128
    s_waitcnt vmcnt(25) lgkmcnt(10)
    v_mfma_f32_16x16x32_bf16 v[32:35], v[48:51], a[84:87], v[32:35]
    ds_read_b64_tr_b16 v[40:41], v24 offset:49152
    ds_read_b64_tr_b16 v[42:43], v24 offset:50176
    s_waitcnt lgkmcnt(10)
    v_mfma_f32_16x16x32_bf16 v[36:39], v[52:55], a[84:87], v[36:39]
    ds_read_b64_tr_b16 v[44:45], v25 offset:49152
    ds_read_b64_tr_b16 v[46:47], v25 offset:50176
    s_waitcnt vmcnt(24) lgkmcnt(10)
    v_mfma_f32_16x16x32_bf16 v[32:35], v[56:59], a[88:91], v[32:35]
    ds_read_b64_tr_b16 v[48:49], v24 offset:51200
    ds_read_b64_tr_b16 v[50:51], v24 offset:52224
    s_waitcnt lgkmcnt(10)
    v_mfma_f32_16x16x32_bf16 v[36:39], v[60:63], a[88:91], v[36:39]
    ds_read_b64_tr_b16 v[52:53], v25 offset:51200
    ds_read_b64_tr_b16 v[54:55], v25 offset:52224
    s_waitcnt vmcnt(23) lgkmcnt(10)
    v_mfma_f32_16x16x32_bf16 v[32:35], v[64:67], a[92:95], v[32:35]
    ds_read_b64_tr_b16 v[56:57], v24 offset:53248
    ds_read_b64_tr_b16 v[58:59], v24 offset:54272
    s_waitcnt lgkmcnt(10)
    v_mfma_f32_16x16x32_bf16 v[36:39], v[68:71], a[92:95], v[36:39]
    ds_read_b64_tr_b16 v[60:61], v25 offset:53248
    ds_read_b64_tr_b16 v[62:63], v25 offset:54272
    s_waitcnt vmcnt(22) lgkmcnt(10)
    v_mfma_f32_16x16x32_bf16 v[32:35], v[40:43], a[96:99], v[32:35]
    ds_read_b64_tr_b16 v[64:65], v24 offset:55296
    ds_read_b64_tr_b16 v[66:67], v24 offset:56320
    s_waitcnt lgkmcnt(10)
    v_mfma_f32_16x16x32_bf16 v[36:39], v[44:47], a[96:99], v[36:39]
    ds_read_b64_tr_b16 v[68:69], v25 offset:55296
    ds_read_b64_tr_b16 v[70:71], v25 offset:56320
    s_waitcnt vmcnt(21) lgkmcnt(10)
    v_mfma_f32_16x16x32_bf16 v[32:35], v[48:51], a[100:103], v[32:35]
    ds_read_b64_tr_b16 v[40:41], v24 offset:57344
    ds_read_b64_tr_b16 v[42:43], v24 offset:58368
    s_waitcnt lgkmcnt(10)
    v_mfma_f32_16x16x32_bf16 v[36:39], v[52:55], a[100:103], v[36:39]
    ds_read_b64_tr_b16 v[44:45], v25 offset:57344
    ds_read_b64_tr_b16 v[46:47], v25 offset:58368
    s_waitcnt vmcnt(20) lgkmcnt(10)
    v_mfma_f32_16x16x32_bf16 v[32:35], v[56:59], a[104:107], v[32:35]
    ds_read_b64_tr_b16 v[48:49], v24 offset:59392
    ds_read_b64_tr_b16 v[50:51], v24 offset:60416
    s_waitcnt lgkmcnt(10)
    v_mfma_f32_16x16x32_bf16 v[36:39], v[60:63], a[104:107], v[36:39]
    ds_read_b64_tr_b16 v[52:53], v25 offset:59392
    ds_read_b64_tr_b16 v[54:55], v25 offset:60416
    s_waitcnt vmcnt(19) lgkmcnt(10)
    v_mfma_f32_16x16x32_bf16 v[32:35], v[64:67], a[108:111], v[32:35]
    ds_read_b64_tr_b16 v[56:57], v24 offset:61440
    ds_read_b64_tr_b16 v[58:59], v24 offset:62464
    s_waitcnt lgkmcnt(10)
    v_mfma_f32_16x16x32_bf16 v[36:39], v[68:71], a[108:111], v[36:39]
    ds_read_b64_tr_b16 v[60:61], v25 offset:61440
    ds_read_b64_tr_b16 v[62:63], v25 offset:62464
    s_waitcnt vmcnt(18) lgkmcnt(10)
    v_mfma_f32_16x16x32_bf16 v[32:35], v[40:43], a[112:115], v[32:35]
    ds_read_b64_tr_b16 v[64:65], v24 offset:63488
    ds_read_b64_tr_b16 v[66:67], v24 offset:64512
    s_waitcnt lgkmcnt(10)
    v_mfma_f32_16x16x32_bf16 v[36:39], v[44:47], a[112:115], v[36:39]
    ds_read_b64_tr_b16 v[68:69], v25 offset:63488
    ds_read_b64_tr_b16 v[70:71], v25 offset:64512
    s_waitcnt vmcnt(17) lgkmcnt(10)
    v_mfma_f32_16x16x32_bf16 v[32:35], v[48:51], a[116:119], v[32:35]
    ds_read_b64_tr_b16 v[40:41], v28 offset:0
    ds_read_b64_tr_b16 v[42:43], v28 offset:1024
    s_waitcnt lgkmcnt(10)
    v_mfma_f32_16x16x32_bf16 v[36:39], v[52:55], a[116:119], v[36:39]
    ds_read_b64_tr_b16 v[44:45], v29 offset:0
    ds_read_b64_tr_b16 v[46:47], v29 offset:1024
    s_waitcnt vmcnt(16) lgkmcnt(10)
    v_mfma_f32_16x16x32_bf16 v[32:35], v[56:59], a[120:123], v[32:35]
    ds_read_b64_tr_b16 v[48:49], v28 offset:2048
    ds_read_b64_tr_b16 v[50:51], v28 offset:3072
    s_waitcnt lgkmcnt(10)
    v_mfma_f32_16x16x32_bf16 v[36:39], v[60:63], a[120:123], v[36:39]
    ds_read_b64_tr_b16 v[52:53], v29 offset:2048
    ds_read_b64_tr_b16 v[54:55], v29 offset:3072
    s_waitcnt vmcnt(15) lgkmcnt(10)
    v_mfma_f32_16x16x32_bf16 v[32:35], v[64:67], a[124:127], v[32:35]
    ds_read_b64_tr_b16 v[56:57], v28 offset:4096
    ds_read_b64_tr_b16 v[58:59], v28 offset:5120
    s_waitcnt lgkmcnt(10)
    v_mfma_f32_16x16x32_bf16 v[36:39], v[68:71], a[124:127], v[36:39]
    ds_read_b64_tr_b16 v[60:61], v29 offset:4096
    ds_read_b64_tr_b16 v[62:63], v29 offset:5120
    s_waitcnt vmcnt(14) lgkmcnt(10)
    v_mfma_f32_16x16x32_bf16 v[32:35], v[40:43], v[112:115], v[32:35]
    ds_read_b64_tr_b16 v[64:65], v28 offset:6144
    ds_read_b64_tr_b16 v[66:67], v28 offset:7168
    s_waitcnt lgkmcnt(10)
    v_mfma_f32_16x16x32_bf16 v[36:39], v[44:47], v[112:115], v[36:39]
    ds_read_b64_tr_b16 v[68:69], v29 offset:6144
    ds_read_b64_tr_b16 v[70:71], v29 offset:7168
    s_waitcnt vmcnt(13) lgkmcnt(10)
    v_mfma_f32_16x16x32_bf16 v[32:35], v[48:51], v[116:119], v[32:35]
    ds_read_b64_tr_b16 v[40:41], v28 offset:8192
    ds_read_b64_tr_b16 v[42:43], v28 offset:9216
    s_waitcnt lgkmcnt(10)
    v_mfma_f32_16x16x32_bf16 v[36:39], v[52:55], v[116:119], v[36:39]
    ds_read_b64_tr_b16 v[44:45], v29 offset:8192
    ds_read_b64_tr_b16 v[46:47], v29 offset:9216
    s_waitcnt vmcnt(12) lgkmcnt(10)
    v_mfma_f32_16x16x32_bf16 v[32:35], v[56:59], v[120:123], v[32:35]
    ds_read_b64_tr_b16 v[48:49], v28 offset:10240
    ds_read_b64_tr_b16 v[50:51], v28 offset:11264
    s_waitcnt lgkmcnt(10)
    v_mfma_f32_16x16x32_bf16 v[36:39], v[60:63], v[120:123], v[36:39]
    ds_read_b64_tr_b16 v[52:53], v29 offset:10240
    ds_read_b64_tr_b16 v[54:55], v29 offset:11264
    s_waitcnt vmcnt(11) lgkmcnt(10)
    v_mfma_f32_16x16x32_bf16 v[32:35], v[64:67], v[124:127], v[32:35]
    ds_read_b64_tr_b16 v[56:57], v28 offset:12288
    ds_read_b64_tr_b16 v[58:59], v28 offset:13312
    s_waitcnt lgkmcnt(10)
    v_mfma_f32_16x16x32_bf16 v[36:39], v[68:71], v[124:127], v[36:39]
    ds_read_b64_tr_b16 v[60:61], v29 offset:12288
    ds_read_b64_tr_b16 v[62:63], v29 offset:13312
    s_waitcnt vmcnt(10) lgkmcnt(10)
    v_mfma_f32_16x16x32_bf16 v[32:35], v[40:43], v[128:131], v[32:35]
    ds_read_b64_tr_b16 v[64:65], v28 offset:14336
    ds_read_b64_tr_b16 v[66:67], v28 offset:15360
    s_waitcnt lgkmcnt(10)
    v_mfma_f32_16x16x32_bf16 v[36:39], v[44:47], v[128:131], v[36:39]
    ds_read_b64_tr_b16 v[68:69], v29 offset:14336
    ds_read_b64_tr_b16 v[70:71], v29 offset:15360
    s_waitcnt vmcnt(9) lgkmcnt(10)
    v_mfma_f32_16x16x32_bf16 v[32:35], v[48:51], v[132:135], v[32:35]
    ds_read_b64_tr_b16 v[40:41], v28 offset:16384
    ds_read_b64_tr_b16 v[42:43], v28 offset:17408
    s_waitcnt lgkmcnt(10)
    v_mfma_f32_16x16x32_bf16 v[36:39], v[52:55], v[132:135], v[36:39]
    ds_read_b64_tr_b16 v[44:45], v29 offset:16384
    ds_read_b64_tr_b16 v[46:47], v29 offset:17408
    s_waitcnt vmcnt(8) lgkmcnt(10)
    v_mfma_f32_16x16x32_bf16 v[32:35], v[56:59], v[136:139], v[32:35]
    ds_read_b64_tr_b16 v[48:49], v28 offset:18432
    ds_read_b64_tr_b16 v[50:51], v28 offset:19456
    s_waitcnt lgkmcnt(10)
    v_mfma_f32_16x16x32_bf16 v[36:39], v[60:63], v[136:139], v[36:39]
    ds_read_b64_tr_b16 v[52:53], v29 offset:18432
    ds_read_b64_tr_b16 v[54:55], v29 offset:19456
    s_waitcnt vmcnt(7) lgkmcnt(10)
    v_mfma_f32_16x16x32_bf16 v[32:35], v[64:67], v[140:143], v[32:35]
    ds_read_b64_tr_b16 v[56:57], v28 offset:20480
    ds_read_b64_tr_b16 v[58:59], v28 offset:21504
    s_waitcnt lgkmcnt(10)
    v_mfma_f32_16x16x32_bf16 v[36:39], v[68:71], v[140:143], v[36:39]
    ds_read_b64_tr_b16 v[60:61], v29 offset:20480
    ds_read_b64_tr_b16 v[62:63], v29 offset:21504
    s_waitcnt vmcnt(6) lgkmcnt(10)
    v_mfma_f32_16x16x32_bf16 v[32:35], v[40:43], v[144:147], v[32:35]
    s_waitcnt lgkmcnt(8)
    v_mfma_f32_16x16x32_bf16 v[36:39], v[44:47], v[144:147], v[36:39]
    s_waitcnt vmcnt(5) lgkmcnt(6)
    v_mfma_f32_16x16x32_bf16 v[32:35], v[48:51], v[148:151], v[32:35]
    s_waitcnt lgkmcnt(4)
    v_mfma_f32_16x16x32_bf16 v[36:39], v[52:55], v[148:151], v[36:39]
    s_waitcnt vmcnt(4) lgkmcnt(2)
    v_mfma_f32_16x16x32_bf16 v[32:35], v[56:59], v[152:155], v[32:35]
    s_waitcnt lgkmcnt(0)
    v_mfma_f32_16x16x32_bf16 v[36:39], v[60:63], v[152:155], v[36:39]
    v_lshlrev_b32 v23, 10, v4
    v_lshl_add_u32 v23, v5, 3, v23
    s_lshl_b32 s57, s9, 14
    s_lshl_b32 s56, s10, 1
    s_add_u32 s57, s57, s56
    v_lshlrev_b32 v80, 16, v88
    v_add_f32 v32, v32, v80
    s_waitcnt vmcnt(2)
    v_fma_f32 v32, v32, v96, v104
    v_and_b32 v80, 0xffff0000, v88
    v_add_f32 v33, v33, v80
    v_fma_f32 v33, v33, v97, v105
    v_lshlrev_b32 v80, 16, v89
    v_add_f32 v34, v34, v80
    v_fma_f32 v34, v34, v98, v106
    v_and_b32 v80, 0xffff0000, v89
    v_add_f32 v35, v35, v80
    v_fma_f32 v35, v35, v99, v107
    v_cvt_pk_bf16_f32 v82, v32, v33
    v_cvt_pk_bf16_f32 v83, v34, v35
    buffer_store_dwordx2 v[82:83], v23, s[52:55], s57 offen offset:0 sc1
    v_lshlrev_b32 v80, 16, v90
    v_add_f32 v36, v36, v80
    s_waitcnt vmcnt(1)
    v_fma_f32 v36, v36, v100, v108
    v_and_b32 v80, 0xffff0000, v90
    v_add_f32 v37, v37, v80
    v_fma_f32 v37, v37, v101, v109
    v_lshlrev_b32 v80, 16, v91
    v_add_f32 v38, v38, v80
    v_fma_f32 v38, v38, v102, v110
    v_and_b32 v80, 0xffff0000, v91
    v_add_f32 v39, v39, v80
    v_fma_f32 v39, v39, v103, v111
    v_cvt_pk_bf16_f32 v82, v36, v37
    v_cvt_pk_bf16_f32 v83, v38, v39
    buffer_store_dwordx2 v[82:83], v23, s[52:55], s57 offen offset:32 sc1
L_adaLN_cond__memory_aug_recurrent_mem_tr__dense_activation_gelu__prompt_kernel_ps_f2_skip:
    s_waitcnt vmcnt(0) lgkmcnt(0)
    s_barrier
    s_add_u32 s81, s81, 7
    s_add_u32 s82, s82, 1
    s_branch L_adaLN_cond__memory_aug_recurrent_mem_tr__dense_activation_gelu__prompt_kernel_ps_loop
L_adaLN_cond__memory_aug_recurrent_mem_tr__dense_activation_gelu__prompt_kernel_ps_end:
    s_branch L_adaLN_cond__memory_aug_recurrent_mem_tr__dense_activation_gelu__prompt_kernel_exit
L_adaLN_cond__memory_aug_recurrent_mem_tr__dense_activation_gelu__prompt_kernel_postf:
    s_mov_b32 s83, s85
    s_mov_b32 s81, s84
    s_mov_b32 s82, 1
    s_cmp_lg_u32 s92, 0
    s_cbranch_scc1 L_w92_done
    v_mov_b32 v250, 224
    s_mov_b32 s94, 400000
L_w92_spin:
    global_load_dword v251, v250, s[90:91] sc1
    s_waitcnt vmcnt(0)
    v_readfirstlane_b32 s93, v251
    s_nop 3
    s_cmp_ge_u32 s93, 28
    s_cbranch_scc1 L_w92_done
    s_sleep 1
    s_sub_u32 s94, s94, 1
    s_cbranch_scc0 L_w92_spin
L_w92_done:
    s_barrier
    s_barrier
    s_cmp_ge_u32 s83, 22
    s_cbranch_scc1 L_adaLN_cond__memory_aug_recurrent_mem_tr__dense_activation_gelu__prompt_kernel_pf_i1
    s_load_dwordx2 s[60:61], s[0:1], 64
    s_lshl_b32 s10, s83, 6
    s_mov_b32 s11, 0
    v_and_b32 v2, 63, v0
    v_lshrrev_b32 v6, 3, v2
    v_and_b32 v7, 7, v2
    s_mov_b32 s20, 2752
    v_add_u32 v8, 0, v6
    v_bfe_u32 v20, v8, 1, 1
    v_bfe_u32 v21, v8, 3, 1
    v_lshl_or_b32 v20, v21, 1, v20
    v_lshrrev_b32 v21, 1, v7
    v_xor_b32 v21, v21, v20
    v_and_b32 v22, 1, v7
    v_lshl_or_b32 v21, v21, 1, v22
    v_mul_lo_u32 v8, v8, s20
    v_lshl_add_u32 v8, v21, 4, v8
    v_add_u32 v9, 8, v6
    v_bfe_u32 v20, v9, 1, 1
    v_bfe_u32 v21, v9, 3, 1
    v_lshl_or_b32 v20, v21, 1, v20
    v_lshrrev_b32 v21, 1, v7
    v_xor_b32 v21, v21, v20
    v_and_b32 v22, 1, v7
    v_lshl_or_b32 v21, v21, 1, v22
    v_mul_lo_u32 v9, v9, s20
    v_lshl_add_u32 v9, v21, 4, v9
    s_waitcnt lgkmcnt(0)
    s_mov_b32 s12, s60
    s_and_b32 s13, s61, 0xffff
    s_mov_b32 s14, 1409024
    s_mov_b32 s15, 0x00020000
    s_sub_u32 s18, s92, 0
    s_lshl_b32 s29, s10, 1
    s_mul_i32 s28, s11, 88064
    s_add_u32 s28, s28, s29
    s_mul_i32 s29, s18, 44032
    s_add_u32 s16, s28, s29
    s_mul_i32 s30, s18, 2048
    s_add_u32 s17, s30, 0
    s_add_u32 s31, s16, 0
    s_add_u32 m0, s17, 0
    s_nop 0
    buffer_load_dwordx4 v8, s[12:15], s31 offen lds
    s_add_u32 m0, m0, 1024
    s_nop 0
    buffer_load_dwordx4 v9, s[12:15], s31 offen lds
    s_add_u32 s31, s16, 176128
    s_add_u32 m0, s17, 8192
    s_nop 0
    buffer_load_dwordx4 v8, s[12:15], s31 offen lds
    s_add_u32 m0, m0, 1024
    s_nop 0
    buffer_load_dwordx4 v9, s[12:15], s31 offen lds
    s_add_u32 s31, s16, 352256
    s_add_u32 m0, s17, 16384
    s_nop 0
    buffer_load_dwordx4 v8, s[12:15], s31 offen lds
    s_add_u32 m0, m0, 1024
    s_nop 0
    buffer_load_dwordx4 v9, s[12:15], s31 offen lds
    s_add_u32 s31, s16, 528384
    s_add_u32 m0, s17, 24576
    s_nop 0
    buffer_load_dwordx4 v8, s[12:15], s31 offen lds
    s_add_u32 m0, m0, 1024
    s_nop 0
    buffer_load_dwordx4 v9, s[12:15], s31 offen lds
    s_add_u32 s31, s16, 704512
    s_add_u32 m0, s17, 32768
    s_nop 0
    buffer_load_dwordx4 v8, s[12:15], s31 offen lds
    s_add_u32 m0, m0, 1024
    s_nop 0
    buffer_load_dwordx4 v9, s[12:15], s31 offen lds
    s_add_u32 s31, s16, 880640
    s_add_u32 m0, s17, 40960
    s_nop 0
    buffer_load_dwordx4 v8, s[12:15], s31 offen lds
    s_add_u32 m0, m0, 1024
    s_nop 0
    buffer_load_dwordx4 v9, s[12:15], s31 offen lds
    s_add_u32 s31, s16, 1056768
    s_add_u32 m0, s17, 49152
    s_nop 0
    buffer_load_dwordx4 v8, s[12:15], s31 offen lds
    s_add_u32 m0, m0, 1024
    s_nop 0
    buffer_load_dwordx4 v9, s[12:15], s31 offen lds
    s_add_u32 s31, s16, 1232896
    s_add_u32 m0, s17, 57344
    s_nop 0
    buffer_load_dwordx4 v8, s[12:15], s31 offen lds
    s_add_u32 m0, m0, 1024
    s_nop 0
    buffer_load_dwordx4 v9, s[12:15], s31 offen lds
L_adaLN_cond__memory_aug_recurrent_mem_tr__dense_activation_gelu__prompt_kernel_pf_i1:
    s_load_dwordx2 s[60:61], s[0:1], 80
    s_lshr_b32 s17, s83, 1
    s_and_b32 s19, s83, 1
    s_lshl_b32 s10, s17, 5
    s_mov_b32 s11, 0
    v_and_b32 v2, 63, v0
    v_lshrrev_b32 v6, 2, v2
    v_and_b32 v7, 3, v2
    s_mov_b32 s20, 1024
    v_add_u32 v8, 0, v6
    v_bfe_u32 v20, v8, 2, 1
    v_lshrrev_b32 v21, 1, v7
    v_xor_b32 v21, v21, v20
    v_and_b32 v22, 1, v7
    v_lshl_or_b32 v21, v21, 1, v22
    v_mul_lo_u32 v8, v8, s20
    v_lshl_add_u32 v8, v21, 4, v8
    s_waitcnt lgkmcnt(0)
    s_mov_b32 s12, s60
    s_and_b32 s13, s61, 0xffff
    s_mov_b32 s14, 1409024
    s_mov_b32 s15, 0x00020000
    s_sub_u32 s18, s92, 0
    s_lshl_b32 s29, s10, 1
    s_mul_i32 s28, s11, 32768
    s_add_u32 s28, s28, s29
    s_mul_i32 s29, s18, 16384
    s_add_u32 s16, s28, s29
    s_mul_i32 s30, s18, 1024
    s_add_u32 s17, s30, 65536
    s_add_u32 s31, s16, 0
    s_add_u32 m0, s17, 0
    s_nop 0
    buffer_load_dwordx4 v8, s[12:15], s31 offen lds
    s_add_u32 s31, s16, 65536
    s_add_u32 m0, s17, 4096
    s_nop 0
    buffer_load_dwordx4 v8, s[12:15], s31 offen lds
    s_add_u32 s31, s16, 131072
    s_add_u32 m0, s17, 8192
    s_nop 0
    buffer_load_dwordx4 v8, s[12:15], s31 offen lds
    s_add_u32 s31, s16, 196608
    s_add_u32 m0, s17, 12288
    s_nop 0
    buffer_load_dwordx4 v8, s[12:15], s31 offen lds
    s_add_u32 s31, s16, 262144
    s_add_u32 m0, s17, 16384
    s_nop 0
    buffer_load_dwordx4 v8, s[12:15], s31 offen lds
    s_add_u32 s31, s16, 327680
    s_add_u32 m0, s17, 20480
    s_nop 0
    buffer_load_dwordx4 v8, s[12:15], s31 offen lds
    s_add_u32 s31, s16, 393216
    s_add_u32 m0, s17, 24576
    s_nop 0
    buffer_load_dwordx4 v8, s[12:15], s31 offen lds
    s_add_u32 s31, s16, 458752
    s_add_u32 m0, s17, 28672
    s_nop 0
    buffer_load_dwordx4 v8, s[12:15], s31 offen lds
    s_add_u32 s31, s16, 524288
    s_add_u32 m0, s17, 32768
    s_nop 0
    buffer_load_dwordx4 v8, s[12:15], s31 offen lds
    s_add_u32 s31, s16, 589824
    s_add_u32 m0, s17, 36864
    s_nop 0
    buffer_load_dwordx4 v8, s[12:15], s31 offen lds
    s_add_u32 s31, s16, 655360
    s_add_u32 m0, s17, 40960
    s_nop 0
    buffer_load_dwordx4 v8, s[12:15], s31 offen lds
    s_add_u32 s31, s16, 720896
    s_add_u32 m0, s17, 45056
    s_nop 0
    buffer_load_dwordx4 v8, s[12:15], s31 offen lds
    s_add_u32 s31, s16, 786432
    s_add_u32 m0, s17, 49152
    s_nop 0
    buffer_load_dwordx4 v8, s[12:15], s31 offen lds
    s_add_u32 s31, s16, 851968
    s_add_u32 m0, s17, 53248
    s_nop 0
    buffer_load_dwordx4 v8, s[12:15], s31 offen lds
    s_add_u32 s31, s16, 917504
    s_add_u32 m0, s17, 57344
    s_nop 0
    buffer_load_dwordx4 v8, s[12:15], s31 offen lds
    s_add_u32 s31, s16, 983040
    s_add_u32 m0, s17, 61440
    s_nop 0
    buffer_load_dwordx4 v8, s[12:15], s31 offen lds
    s_add_u32 s31, s16, 1048576
    s_add_u32 m0, s17, 65536
    s_nop 0
    buffer_load_dwordx4 v8, s[12:15], s31 offen lds
    s_add_u32 s31, s16, 1114112
    s_add_u32 m0, s17, 69632
    s_nop 0
    buffer_load_dwordx4 v8, s[12:15], s31 offen lds
    s_add_u32 s31, s16, 1179648
    s_add_u32 m0, s17, 73728
    s_nop 0
    buffer_load_dwordx4 v8, s[12:15], s31 offen lds
    s_add_u32 s31, s16, 1245184
    s_add_u32 m0, s17, 77824
    s_nop 0
    buffer_load_dwordx4 v8, s[12:15], s31 offen lds
    s_add_u32 s31, s16, 1310720
    s_add_u32 m0, s17, 81920
    s_nop 0
    buffer_load_dwordx4 v8, s[12:15], s31 offen lds
    s_add_u32 s31, s16, 1376256
    s_add_u32 m0, s17, 86016
    s_nop 0
    buffer_load_dwordx4 v8, s[12:15], s31 offen lds
    s_waitcnt vmcnt(0)
    s_barrier
    v_and_b32 v7, 63, v0
    v_lshlrev_b32 v7, 4, v7
    s_lshl_b32 s9, s92, 14
    v_add_u32 v6, s9, v7
    s_mul_i32 s9, s92, 22528
    s_add_u32 s9, s9, 65536
    v_add_u32 v7, s9, v7
    ds_read_b128 a[128:131], v6 offset:0
    ds_read_b128 a[132:135], v6 offset:1024
    ds_read_b128 a[136:139], v6 offset:2048
    ds_read_b128 a[140:143], v6 offset:3072
    ds_read_b128 a[144:147], v6 offset:4096
    ds_read_b128 a[148:151], v6 offset:5120
    ds_read_b128 a[152:155], v6 offset:6144
    ds_read_b128 a[156:159], v6 offset:7168
    ds_read_b128 a[160:163], v6 offset:8192
    ds_read_b128 a[164:167], v6 offset:9216
    ds_read_b128 a[168:171], v6 offset:10240
    ds_read_b128 a[172:175], v6 offset:11264
    ds_read_b128 a[176:179], v6 offset:12288
    ds_read_b128 a[180:183], v6 offset:13312
    ds_read_b128 a[184:187], v6 offset:14336
    ds_read_b128 a[188:191], v6 offset:15360
    ds_read_b128 a[192:195], v7 offset:0
    ds_read_b128 a[196:199], v7 offset:1024
    ds_read_b128 a[200:203], v7 offset:2048
    ds_read_b128 a[204:207], v7 offset:3072
    ds_read_b128 a[208:211], v7 offset:4096
    ds_read_b128 a[212:215], v7 offset:5120
    ds_read_b128 a[216:219], v7 offset:6144
    ds_read_b128 a[220:223], v7 offset:7168
    ds_read_b128 a[224:227], v7 offset:8192
    ds_read_b128 a[228:231], v7 offset:9216
    ds_read_b128 a[232:235], v7 offset:10240
    ds_read_b128 a[236:239], v7 offset:11264
    ds_read_b128 a[240:243], v7 offset:12288
    ds_read_b128 a[244:247], v7 offset:13312
    ds_read_b128 a[248:251], v7 offset:14336
    ds_read_b128 v[200:203], v7 offset:15360
    ds_read_b128 v[204:207], v7 offset:16384
    ds_read_b128 v[208:211], v7 offset:17408
    ds_read_b128 v[212:215], v7 offset:18432
    ds_read_b128 v[216:219], v7 offset:19456
    ds_read_b128 v[220:223], v7 offset:20480
    ds_read_b128 v[224:227], v7 offset:21504
    s_waitcnt lgkmcnt(0)
    s_barrier
L_adaLN_cond__memory_aug_recurrent_mem_tr__dense_activation_gelu__prompt_kernel_pf_loop:
    s_cmp_ge_u32 s81, 32
    s_cbranch_scc1 L_adaLN_cond__memory_aug_recurrent_mem_tr__dense_activation_gelu__prompt_kernel_pf_end
    s_load_dwordx2 s[60:61], s[0:1], 40
    s_lshr_b32 s17, s83, 3
    s_and_b32 s22, s83, 7
    s_lshl_b32 s10, s17, 7
    s_lshl_b32 s11, s22, 4
    v_and_b32 v2, 63, v0
    v_lshrrev_b32 v6, 4, v2
    v_and_b32 v7, 15, v2
    s_mov_b32 s20, 1024
    v_add_u32 v8, 0, v6
    v_and_b32 v20, 3, v8
    v_bfe_u32 v21, v8, 3, 1
    v_lshl_or_b32 v20, v21, 2, v20
    v_lshrrev_b32 v21, 1, v7
    v_xor_b32 v21, v21, v20
    v_and_b32 v22, 1, v7
    v_lshl_or_b32 v21, v21, 1, v22
    v_mul_lo_u32 v8, v8, s20
    v_lshl_add_u32 v8, v21, 4, v8
    v_add_u32 v9, 4, v6
    v_and_b32 v20, 3, v9
    v_bfe_u32 v21, v9, 3, 1
    v_lshl_or_b32 v20, v21, 2, v20
    v_lshrrev_b32 v21, 1, v7
    v_xor_b32 v21, v21, v20
    v_and_b32 v22, 1, v7
    v_lshl_or_b32 v21, v21, 1, v22
    v_mul_lo_u32 v9, v9, s20
    v_lshl_add_u32 v9, v21, 4, v9
    v_add_u32 v10, 8, v6
    v_and_b32 v20, 3, v10
    v_bfe_u32 v21, v10, 3, 1
    v_lshl_or_b32 v20, v21, 2, v20
    v_lshrrev_b32 v21, 1, v7
    v_xor_b32 v21, v21, v20
    v_and_b32 v22, 1, v7
    v_lshl_or_b32 v21, v21, 1, v22
    v_mul_lo_u32 v10, v10, s20
    v_lshl_add_u32 v10, v21, 4, v10
    v_add_u32 v11, 12, v6
    v_and_b32 v20, 3, v11
    v_bfe_u32 v21, v11, 3, 1
    v_lshl_or_b32 v20, v21, 2, v20
    v_lshrrev_b32 v21, 1, v7
    v_xor_b32 v21, v21, v20
    v_and_b32 v22, 1, v7
    v_lshl_or_b32 v21, v21, 1, v22
    v_mul_lo_u32 v11, v11, s20
    v_lshl_add_u32 v11, v21, 4, v11
    s_waitcnt lgkmcnt(0)
    s_mov_b32 s12, s60
    s_and_b32 s13, s61, 0xffff
    s_mov_b32 s14, 4194304
    s_mov_b32 s15, 0x00020000
    s_sub_u32 s18, s92, 0
    s_lshl_b32 s29, s10, 1
    s_mul_i32 s28, s11, 32768
    s_add_u32 s28, s28, s29
    s_mul_i32 s29, s18, 16384
    s_add_u32 s16, s28, s29
    s_mul_i32 s30, s18, 4096
    s_add_u32 s17, s30, 0
    s_add_u32 s31, s16, 0
    s_add_u32 m0, s17, 0
    s_nop 0
    buffer_load_dwordx4 v8, s[12:15], s31 offen lds
    s_add_u32 m0, m0, 1024
    s_nop 0
    buffer_load_dwordx4 v9, s[12:15], s31 offen lds
    s_add_u32 m0, m0, 1024
    s_nop 0
    buffer_load_dwordx4 v10, s[12:15], s31 offen lds
    s_add_u32 m0, m0, 1024
    s_nop 0
    buffer_load_dwordx4 v11, s[12:15], s31 offen lds
    s_add_u32 s31, s16, 65536
    s_add_u32 m0, s17, 16384
    s_nop 0
    buffer_load_dwordx4 v8, s[12:15], s31 offen lds
    s_add_u32 m0, m0, 1024
    s_nop 0
    buffer_load_dwordx4 v9, s[12:15], s31 offen lds
    s_add_u32 m0, m0, 1024
    s_nop 0
    buffer_load_dwordx4 v10, s[12:15], s31 offen lds
    s_add_u32 m0, m0, 1024
    s_nop 0
    buffer_load_dwordx4 v11, s[12:15], s31 offen lds
    s_add_u32 s31, s16, 131072
    s_add_u32 m0, s17, 32768
    s_nop 0
    buffer_load_dwordx4 v8, s[12:15], s31 offen lds
    s_add_u32 m0, m0, 1024
    s_nop 0
    buffer_load_dwordx4 v9, s[12:15], s31 offen lds
    s_add_u32 m0, m0, 1024
    s_nop 0
    buffer_load_dwordx4 v10, s[12:15], s31 offen lds
    s_add_u32 m0, m0, 1024
    s_nop 0
    buffer_load_dwordx4 v11, s[12:15], s31 offen lds
    s_add_u32 s31, s16, 196608
    s_add_u32 m0, s17, 49152
    s_nop 0
    buffer_load_dwordx4 v8, s[12:15], s31 offen lds
    s_add_u32 m0, m0, 1024
    s_nop 0
    buffer_load_dwordx4 v9, s[12:15], s31 offen lds
    s_add_u32 m0, m0, 1024
    s_nop 0
    buffer_load_dwordx4 v10, s[12:15], s31 offen lds
    s_add_u32 m0, m0, 1024
    s_nop 0
    buffer_load_dwordx4 v11, s[12:15], s31 offen lds
    s_add_u32 s31, s16, 262144
    s_add_u32 m0, s17, 65536
    s_nop 0
    buffer_load_dwordx4 v8, s[12:15], s31 offen lds
    s_add_u32 m0, m0, 1024
    s_nop 0
    buffer_load_dwordx4 v9, s[12:15], s31 offen lds
    s_add_u32 m0, m0, 1024
    s_nop 0
    buffer_load_dwordx4 v10, s[12:15], s31 offen lds
    s_add_u32 m0, m0, 1024
    s_nop 0
    buffer_load_dwordx4 v11, s[12:15], s31 offen lds
    s_add_u32 s31, s16, 327680
    s_add_u32 m0, s17, 81920
    s_nop 0
    buffer_load_dwordx4 v8, s[12:15], s31 offen lds
    s_add_u32 m0, m0, 1024
    s_nop 0
    buffer_load_dwordx4 v9, s[12:15], s31 offen lds
    s_add_u32 m0, m0, 1024
    s_nop 0
    buffer_load_dwordx4 v10, s[12:15], s31 offen lds
    s_add_u32 m0, m0, 1024
    s_nop 0
    buffer_load_dwordx4 v11, s[12:15], s31 offen lds
    s_add_u32 s31, s16, 393216
    s_add_u32 m0, s17, 98304
    s_nop 0
    buffer_load_dwordx4 v8, s[12:15], s31 offen lds
    s_add_u32 m0, m0, 1024
    s_nop 0
    buffer_load_dwordx4 v9, s[12:15], s31 offen lds
    s_add_u32 m0, m0, 1024
    s_nop 0
    buffer_load_dwordx4 v10, s[12:15], s31 offen lds
    s_add_u32 m0, m0, 1024
    s_nop 0
    buffer_load_dwordx4 v11, s[12:15], s31 offen lds
    s_add_u32 s31, s16, 458752
    s_add_u32 m0, s17, 114688
    s_nop 0
    buffer_load_dwordx4 v8, s[12:15], s31 offen lds
    s_add_u32 m0, m0, 1024
    s_nop 0
    buffer_load_dwordx4 v9, s[12:15], s31 offen lds
    s_add_u32 m0, m0, 1024
    s_nop 0
    buffer_load_dwordx4 v10, s[12:15], s31 offen lds
    s_add_u32 m0, m0, 1024
    s_nop 0
    buffer_load_dwordx4 v11, s[12:15], s31 offen lds
    s_cmp_ge_u32 s83, 16
    s_cbranch_scc1 L_adaLN_cond__memory_aug_recurrent_mem_tr__dense_activation_gelu__prompt_kernel_pf_noatt
    s_lshl_b32 s2, s81, 4
    s_add_u32 s2, s2, s83
    v_and_b32 v2, 63, v0
    s_lshr_b32 s22, s2, 5
    s_lshr_b32 s23, s2, 3
    s_and_b32 s24, s2, 7
    s_lshl_b32 s24, s24, 2
    s_add_u32 s24, s24, s92
    s_lshl_b32 s9, s23, 5
    s_add_u32 s9, s9, s24
    v_lshlrev_b32 v3, 4, v2
    v_and_b32 v4, 15, v2
    v_lshrrev_b32 v5, 4, v2
    s_lshl_b32 s10, s9, 13
    s_add_u32 s11, s10, 50331648
    s_add_u32 s12, s10, 16777216
    s_add_u32 s13, s10, 33554432
    s_lshl_b32 s14, s9, 11
    s_add_u32 s14, s14, 4194304
    s_lshl_b32 s15, s9, 12
    s_add_u32 s15, s15, 8388608
    s_cmp_lg_u32 s92, 0
    s_cbranch_scc1 L_w93_done
    s_lshl_b32 s79, s22, 7
    s_add_u32 s79, s79, 3936256
    v_mov_b32 v250, 0
    s_mov_b32 s94, 400000
L_w93_spin:
    buffer_load_dword v251, v250, s[4:7], s79 offen sc1
    s_waitcnt vmcnt(0)
    v_readfirstlane_b32 s93, v251
    s_nop 3
    s_cmp_ge_u32 s93, 32
    s_cbranch_scc1 L_w93_done
    s_sleep 1
    s_sub_u32 s94, s94, 1
    s_cbranch_scc0 L_w93_spin
L_w93_done:
    s_barrier
    buffer_load_dwordx4 v[8:11], v3, s[4:7], s11 offen offset:0 sc1
    buffer_load_dwordx4 v[12:15], v3, s[4:7], s11 offen offset:1024 sc1
    buffer_load_dwordx4 v[16:19], v3, s[4:7], s11 offen offset:2048 sc1
    buffer_load_dwordx4 v[20:23], v3, s[4:7], s11 offen offset:3072 sc1
    s_add_u32 s11, s11, 4096
    buffer_load_dwordx4 v[24:27], v3, s[4:7], s11 offen offset:0 sc1
    buffer_load_dwordx4 v[28:31], v3, s[4:7], s11 offen offset:1024 sc1
    buffer_load_dwordx4 v[32:35], v3, s[4:7], s11 offen offset:2048 sc1
    buffer_load_dwordx4 v[36:39], v3, s[4:7], s11 offen offset:3072 sc1
    buffer_load_dwordx4 v[40:43], v3, s[4:7], s12 offen offset:0 sc1
    buffer_load_dwordx4 v[44:47], v3, s[4:7], s12 offen offset:1024 sc1
    buffer_load_dwordx4 v[48:51], v3, s[4:7], s12 offen offset:2048 sc1
    buffer_load_dwordx4 v[52:55], v3, s[4:7], s12 offen offset:3072 sc1
    s_add_u32 s12, s12, 4096
    buffer_load_dwordx4 v[56:59], v3, s[4:7], s12 offen offset:0 sc1
    buffer_load_dwordx4 v[60:63], v3, s[4:7], s12 offen offset:1024 sc1
    buffer_load_dwordx4 v[64:67], v3, s[4:7], s12 offen offset:2048 sc1
    buffer_load_dwordx4 v[68:71], v3, s[4:7], s12 offen offset:3072 sc1
    buffer_load_dwordx4 v[72:75], v3, s[4:7], s13 offen offset:0 sc1
    buffer_load_dwordx4 v[76:79], v3, s[4:7], s13 offen offset:1024 sc1
    buffer_load_dwordx4 v[80:83], v3, s[4:7], s13 offen offset:2048 sc1
    buffer_load_dwordx4 v[84:87], v3, s[4:7], s13 offen offset:3072 sc1
    s_add_u32 s13, s13, 4096
    buffer_load_dwordx4 v[88:91], v3, s[4:7], s13 offen offset:0 sc1
    buffer_load_dwordx4 v[92:95], v3, s[4:7], s13 offen offset:1024 sc1
    buffer_load_dwordx4 v[96:99], v3, s[4:7], s13 offen offset:2048 sc1
    buffer_load_dwordx4 v[100:103], v3, s[4:7], s13 offen offset:3072 sc1
    v_lshlrev_b32 v104, 2, v5
    v_sub_u32 v104, v4, v104
    v_mov_b32 v108, 0x3f803f80
    v_mov_b32 v109, 0x3f803f80
    v_mov_b32 v110, 0x3f803f80
    v_mov_b32 v111, 0x3f803f80
    v_mov_b32 v106, 0x3f003f00
    v_mov_b32 v107, 0x3f003f00
    s_mov_b32 s20, 0x3e0293ee
    s_mov_b32 s21, 0xff800000
    s_lshl_b32 s17, s23, 18
    s_lshl_b32 s18, s24, 12
    s_add_u32 s17, s17, s18
    s_add_u32 s17, s17, 67108864
    s_waitcnt vmcnt(15)
    v_mfma_f32_16x16x32_bf16 v[112:115], v[40:43], v[8:11], 0
    s_waitcnt vmcnt(14)
    v_mfma_f32_16x16x32_bf16 v[112:115], v[44:47], v[12:15], v[112:115]
    s_waitcnt vmcnt(13)
    v_mfma_f32_16x16x32_bf16 v[112:115], v[48:51], v[16:19], v[112:115]
    s_waitcnt vmcnt(12)
    v_mfma_f32_16x16x32_bf16 v[112:115], v[52:55], v[20:23], v[112:115]
    v_mov_b32 v105, s21
    v_cmp_le_i32 vcc, 0, v104
    s_nop 5
    v_cndmask_b32 v112, v105, v112, vcc
    v_cmp_le_i32 vcc, 1, v104
    s_nop 1
    v_cndmask_b32 v113, v105, v113, vcc
    v_cmp_le_i32 vcc, 2, v104
    s_nop 1
    v_cndmask_b32 v114, v105, v114, vcc
    v_cmp_le_i32 vcc, 3, v104
    s_nop 1
    v_cndmask_b32 v115, v105, v115, vcc
    v_mfma_f32_16x16x32_bf16 v[116:119], v[40:43], v[24:27], 0
    s_waitcnt vmcnt(11)
    v_mfma_f32_16x16x32_bf16 v[40:43], v[56:59], v[24:27], 0
    v_mfma_f32_16x16x32_bf16 v[116:119], v[44:47], v[28:31], v[116:119]
    s_waitcnt vmcnt(10)
    v_mfma_f32_16x16x32_bf16 v[40:43], v[60:63], v[28:31], v[40:43]
    v_mfma_f32_16x16x32_bf16 v[116:119], v[48:51], v[32:35], v[116:119]
    s_waitcnt vmcnt(9)
    v_mfma_f32_16x16x32_bf16 v[40:43], v[64:67], v[32:35], v[40:43]
    v_mfma_f32_16x16x32_bf16 v[116:119], v[52:55], v[36:39], v[116:119]
    s_waitcnt vmcnt(8)
    v_mfma_f32_16x16x32_bf16 v[40:43], v[68:71], v[36:39], v[40:43]
    v_mov_b32 v44, s21
    v_cmp_le_i32 vcc, 0, v104
    s_nop 5
    v_cndmask_b32 v40, v44, v40, vcc
    v_cmp_le_i32 vcc, 1, v104
    s_nop 1
    v_cndmask_b32 v41, v44, v41, vcc
    v_cmp_le_i32 vcc, 2, v104
    s_nop 1
    v_cndmask_b32 v42, v44, v42, vcc
    v_cmp_le_i32 vcc, 3, v104
    s_nop 1
    v_cndmask_b32 v43, v44, v43, vcc
    s_add_u32 s26, s23, 1
    s_cmp_ge_u32 s23, 62
    s_cselect_b32 s27, 1, 0
    s_cselect_b32 s26, 32, s26
    s_cmp_lg_u32 s92, 0
    s_cbranch_scc1 L_w94_done
    s_lshl_b32 s79, s27, 7
    s_add_u32 s79, s79, 3946496
    v_mov_b32 v250, 0
    s_mov_b32 s94, 400000
L_w94_spin:
    buffer_load_dword v251, v250, s[4:7], s79 offen sc1
    s_waitcnt vmcnt(0)
    v_readfirstlane_b32 s93, v251
    s_nop 3
    s_cmp_ge_u32 s93, s26
    s_cbranch_scc1 L_w94_done
    s_cmp_eq_u32 s27, 1
    s_cbranch_scc1 L_w94_fast
    s_sleep 16
L_w94_fast:
    s_sleep 1
    s_sub_u32 s94, s94, 1
    s_cbranch_scc0 L_w94_spin
L_w94_done:
    s_barrier
    v_lshrrev_b32 v44, 1, v3
    buffer_load_dwordx2 v[46:47], v44, s[4:7], s14 offen offset:0 sc1
    buffer_load_dwordx2 v[48:49], v44, s[4:7], s14 offen offset:512 sc1
    buffer_load_dwordx2 v[50:51], v44, s[4:7], s14 offen offset:1024 sc1
    buffer_load_dwordx2 v[52:53], v44, s[4:7], s14 offen offset:1536 sc1
    buffer_load_dwordx4 v[56:59], v3, s[4:7], s15 offen offset:0 sc1
    buffer_load_dwordx4 v[60:63], v3, s[4:7], s15 offen offset:1024 sc1
    buffer_load_dwordx4 v[64:67], v3, s[4:7], s15 offen offset:2048 sc1
    buffer_load_dwordx4 v[68:71], v3, s[4:7], s15 offen offset:3072 sc1
    s_mul_i32 s16, s92, 2176
    s_add_u32 s16, s16, 131072
    v_and_b32 v44, 1, v5
    v_mul_u32_u24 v44, 1088, v44
    v_lshrrev_b32 v45, 1, v5
    v_lshl_add_u32 v45, v4, 1, v45
    v_lshl_add_u32 v44, v45, 3, v44
    v_add_u32 v44, s16, v44
    s_waitcnt vmcnt(7)
    ds_write_b64 v44, v[46:47] offset:0
    s_waitcnt vmcnt(6)
    ds_write_b64 v44, v[48:49] offset:256
    s_waitcnt vmcnt(5)
    ds_write_b64 v44, v[50:51] offset:512
    s_waitcnt vmcnt(4)
    ds_write_b64 v44, v[52:53] offset:768
    v_and_b32 v44, 1, v2
    v_mul_u32_u24 v44, 1088, v44
    v_lshrrev_b32 v45, 2, v4
    v_lshl_add_u32 v45, v5, 2, v45
    v_lshl_add_u32 v44, v45, 3, v44
    v_add_u32 v44, s16, v44
    s_waitcnt lgkmcnt(0)
    ds_read_b64_tr_b16 v[48:49], v44 offset:0
    ds_read_b64_tr_b16 v[50:51], v44 offset:128
    ds_read_b64_tr_b16 v[52:53], v44 offset:256
    ds_read_b64_tr_b16 v[54:55], v44 offset:384
    ds_read_b64_tr_b16 v[120:121], v44 offset:512
    ds_read_b64_tr_b16 v[122:123], v44 offset:640
    ds_read_b64_tr_b16 v[124:125], v44 offset:768
    ds_read_b64_tr_b16 v[126:127], v44 offset:896
    s_waitcnt lgkmcnt(6)
    v_mfma_f32_16x16x32_bf16 v[44:47], v[48:51], v[8:11], 0
    s_waitcnt lgkmcnt(4)
    v_mfma_f32_16x16x32_bf16 v[44:47], v[52:55], v[12:15], v[44:47]
    s_waitcnt lgkmcnt(2)
    v_mfma_f32_16x16x32_bf16 v[44:47], v[120:123], v[16:19], v[44:47]
    s_waitcnt lgkmcnt(0)
    v_mfma_f32_16x16x32_bf16 v[44:47], v[124:127], v[20:23], v[44:47]
    v_max3_f32 v8, v112, v113, v114
    s_nop 6
    v_max3_f32 v8, v8, v115, v44
    v_max3_f32 v8, v8, v45, v46
    v_max_f32 v8, v8, v47
    v_mov_b32 v9, v8
    s_nop 1
    v_permlane32_swap_b32 v8, v9
    v_max_f32 v8, v8, v9
    v_mov_b32 v9, v8
    s_nop 1
    v_permlane16_swap_b32 v8, v9
    v_max_f32 v8, v8, v9
    v_mul_f32 v8, s20, v8
    v_fma_f32 v112, v112, s20, -v8
    v_fma_f32 v113, v113, s20, -v8
    v_fma_f32 v114, v114, s20, -v8
    v_fma_f32 v115, v115, s20, -v8
    v_fma_f32 v44, v44, s20, -v8
    v_fma_f32 v45, v45, s20, -v8
    v_fma_f32 v46, v46, s20, -v8
    v_fma_f32 v47, v47, s20, -v8
    v_exp_f32 v112, v112
    v_exp_f32 v113, v113
    v_exp_f32 v114, v114
    v_exp_f32 v115, v115
    v_exp_f32 v44, v44
    v_exp_f32 v45, v45
    v_exp_f32 v46, v46
    v_exp_f32 v47, v47
    v_cvt_pk_bf16_f32 v8, v112, v113
    v_cvt_pk_bf16_f32 v9, v114, v115
    v_mov_b32 v10, 0
    v_mov_b32 v11, 0
    v_cvt_pk_bf16_f32 v12, v44, v45
    v_cvt_pk_bf16_f32 v13, v46, v47
    v_mfma_f32_16x16x32_bf16 v[16:19], v[108:111], v[8:11], 0
    v_mfma_f32_16x16x32_bf16 v[20:23], v[72:75], v[8:11], 0
    v_mfma_f32_16x16x32_bf16 v[44:47], v[76:79], v[8:11], 0
    v_mfma_f32_16x16x32_bf16 v[112:115], v[80:83], v[8:11], 0
    v_mfma_f32_16x16x32_bf16 v[128:131], v[84:87], v[8:11], 0
    v_mfma_f32_16x16x32_bf16 v[132:135], v[88:91], v[8:11], 0
    v_mfma_f32_16x16x32_bf16 v[136:139], v[92:95], v[8:11], 0
    v_mfma_f32_16x16x32_bf16 v[140:143], v[96:99], v[8:11], 0
    v_mfma_f32_16x16x32_bf16 v[144:147], v[100:103], v[8:11], 0
    v_mfma_f32_16x16x16_bf16 v[16:19], v[106:107], v[12:13], v[16:19]
    s_waitcnt vmcnt(3)
    v_mfma_f32_16x16x16_bf16 v[20:23], v[56:57], v[12:13], v[20:23]
    v_mfma_f32_16x16x16_bf16 v[44:47], v[58:59], v[12:13], v[44:47]
    s_waitcnt vmcnt(2)
    v_mfma_f32_16x16x16_bf16 v[112:115], v[60:61], v[12:13], v[112:115]
    v_mfma_f32_16x16x16_bf16 v[128:131], v[62:63], v[12:13], v[128:131]
    s_waitcnt vmcnt(1)
    v_mfma_f32_16x16x16_bf16 v[132:135], v[64:65], v[12:13], v[132:135]
    v_mfma_f32_16x16x16_bf16 v[136:139], v[66:67], v[12:13], v[136:139]
    s_waitcnt vmcnt(0)
    v_mfma_f32_16x16x16_bf16 v[140:143], v[68:69], v[12:13], v[140:143]
    v_mfma_f32_16x16x16_bf16 v[144:147], v[70:71], v[12:13], v[144:147]
    v_rcp_f32 v8, v16
    s_nop 0
    v_mul_f32 v20, v20, v8
    v_mul_f32 v44, v44, v8
    v_cvt_pk_bf16_f32 v12, v20, v44
    v_mul_f32 v21, v21, v8
    v_mul_f32 v45, v45, v8
    v_cvt_pk_bf16_f32 v13, v21, v45
    v_mul_f32 v22, v22, v8
    v_mul_f32 v46, v46, v8
    v_cvt_pk_bf16_f32 v14, v22, v46
    v_mul_f32 v23, v23, v8
    v_mul_f32 v47, v47, v8
    v_cvt_pk_bf16_f32 v15, v23, v47
    buffer_store_dwordx4 v[12:15], v3, s[4:7], s17 offen offset:0 sc1
    v_mul_f32 v112, v112, v8
    v_mul_f32 v128, v128, v8
    v_cvt_pk_bf16_f32 v12, v112, v128
    v_mul_f32 v113, v113, v8
    v_mul_f32 v129, v129, v8
    v_cvt_pk_bf16_f32 v13, v113, v129
    v_mul_f32 v114, v114, v8
    v_mul_f32 v130, v130, v8
    v_cvt_pk_bf16_f32 v14, v114, v130
    v_mul_f32 v115, v115, v8
    v_mul_f32 v131, v131, v8
    v_cvt_pk_bf16_f32 v15, v115, v131
    buffer_store_dwordx4 v[12:15], v3, s[4:7], s17 offen offset:1024 sc1
    v_mul_f32 v132, v132, v8
    v_mul_f32 v136, v136, v8
    v_cvt_pk_bf16_f32 v12, v132, v136
    v_mul_f32 v133, v133, v8
    v_mul_f32 v137, v137, v8
    v_cvt_pk_bf16_f32 v13, v133, v137
    v_mul_f32 v134, v134, v8
    v_mul_f32 v138, v138, v8
    v_cvt_pk_bf16_f32 v14, v134, v138
    v_mul_f32 v135, v135, v8
    v_mul_f32 v139, v139, v8
    v_cvt_pk_bf16_f32 v15, v135, v139
    buffer_store_dwordx4 v[12:15], v3, s[4:7], s17 offen offset:2048 sc1
    v_mul_f32 v140, v140, v8
    v_mul_f32 v144, v144, v8
    v_cvt_pk_bf16_f32 v12, v140, v144
    v_mul_f32 v141, v141, v8
    v_mul_f32 v145, v145, v8
    v_cvt_pk_bf16_f32 v13, v141, v145
    v_mul_f32 v142, v142, v8
    v_mul_f32 v146, v146, v8
    v_cvt_pk_bf16_f32 v14, v142, v146
    v_mul_f32 v143, v143, v8
    v_mul_f32 v147, v147, v8
    v_cvt_pk_bf16_f32 v15, v143, v147
    buffer_store_dwordx4 v[12:15], v3, s[4:7], s17 offen offset:3072 sc1
    s_add_u32 s17, s17, 131072
    v_mfma_f32_16x16x32_bf16 v[8:11], v[48:51], v[24:27], 0
    v_mfma_f32_16x16x32_bf16 v[8:11], v[52:55], v[28:31], v[8:11]
    v_mfma_f32_16x16x32_bf16 v[8:11], v[120:123], v[32:35], v[8:11]
    v_mfma_f32_16x16x32_bf16 v[8:11], v[124:127], v[36:39], v[8:11]
    v_max3_f32 v12, v116, v117, v118
    v_max3_f32 v12, v12, v119, v40
    v_max3_f32 v12, v12, v41, v42
    s_nop 4
    v_max3_f32 v12, v12, v43, v8
    v_max3_f32 v12, v12, v9, v10
    v_max_f32 v12, v12, v11
    v_mov_b32 v13, v12
    s_nop 1
    v_permlane32_swap_b32 v12, v13
    v_max_f32 v12, v12, v13
    v_mov_b32 v13, v12
    s_nop 1
    v_permlane16_swap_b32 v12, v13
    v_max_f32 v12, v12, v13
    v_mul_f32 v12, s20, v12
    v_fma_f32 v116, v116, s20, -v12
    v_fma_f32 v117, v117, s20, -v12
    v_fma_f32 v118, v118, s20, -v12
    v_fma_f32 v119, v119, s20, -v12
    v_fma_f32 v40, v40, s20, -v12
    v_fma_f32 v41, v41, s20, -v12
    v_fma_f32 v42, v42, s20, -v12
    v_fma_f32 v43, v43, s20, -v12
    v_fma_f32 v8, v8, s20, -v12
    v_fma_f32 v9, v9, s20, -v12
    v_fma_f32 v10, v10, s20, -v12
    v_fma_f32 v11, v11, s20, -v12
    v_exp_f32 v116, v116
    v_exp_f32 v117, v117
    v_exp_f32 v118, v118
    v_exp_f32 v119, v119
    v_exp_f32 v40, v40
    v_exp_f32 v41, v41
    v_exp_f32 v42, v42
    v_exp_f32 v43, v43
    v_exp_f32 v8, v8
    v_exp_f32 v9, v9
    v_exp_f32 v10, v10
    v_exp_f32 v11, v11
    v_cvt_pk_bf16_f32 v12, v116, v117
    v_cvt_pk_bf16_f32 v13, v118, v119
    v_cvt_pk_bf16_f32 v14, v40, v41
    v_cvt_pk_bf16_f32 v15, v42, v43
    v_cvt_pk_bf16_f32 v16, v8, v9
    v_cvt_pk_bf16_f32 v17, v10, v11
    v_mfma_f32_16x16x32_bf16 v[8:11], v[108:111], v[12:15], 0
    v_mfma_f32_16x16x32_bf16 v[20:23], v[72:75], v[12:15], 0
    v_mfma_f32_16x16x32_bf16 v[24:27], v[76:79], v[12:15], 0
    v_mfma_f32_16x16x32_bf16 v[28:31], v[80:83], v[12:15], 0
    v_mfma_f32_16x16x32_bf16 v[32:35], v[84:87], v[12:15], 0
    v_mfma_f32_16x16x32_bf16 v[36:39], v[88:91], v[12:15], 0
    v_mfma_f32_16x16x32_bf16 v[40:43], v[92:95], v[12:15], 0
    v_mfma_f32_16x16x32_bf16 v[44:47], v[96:99], v[12:15], 0
    v_mfma_f32_16x16x32_bf16 v[48:51], v[100:103], v[12:15], 0
    v_mfma_f32_16x16x16_bf16 v[8:11], v[106:107], v[16:17], v[8:11]
    v_mfma_f32_16x16x16_bf16 v[20:23], v[56:57], v[16:17], v[20:23]
    v_mfma_f32_16x16x16_bf16 v[24:27], v[58:59], v[16:17], v[24:27]
    v_mfma_f32_16x16x16_bf16 v[28:31], v[60:61], v[16:17], v[28:31]
    v_mfma_f32_16x16x16_bf16 v[32:35], v[62:63], v[16:17], v[32:35]
    v_mfma_f32_16x16x16_bf16 v[36:39], v[64:65], v[16:17], v[36:39]
    v_mfma_f32_16x16x16_bf16 v[40:43], v[66:67], v[16:17], v[40:43]
    v_mfma_f32_16x16x16_bf16 v[44:47], v[68:69], v[16:17], v[44:47]
    v_mfma_f32_16x16x16_bf16 v[48:51], v[70:71], v[16:17], v[48:51]
    v_rcp_f32 v12, v8
    s_nop 0
    v_mul_f32 v20, v20, v12
    v_mul_f32 v24, v24, v12
    v_cvt_pk_bf16_f32 v8, v20, v24
    v_mul_f32 v21, v21, v12
    v_mul_f32 v25, v25, v12
    v_cvt_pk_bf16_f32 v9, v21, v25
    v_mul_f32 v22, v22, v12
    v_mul_f32 v26, v26, v12
    v_cvt_pk_bf16_f32 v10, v22, v26
    v_mul_f32 v23, v23, v12
    v_mul_f32 v27, v27, v12
    v_cvt_pk_bf16_f32 v11, v23, v27
    buffer_store_dwordx4 v[8:11], v3, s[4:7], s17 offen offset:0 sc1
    v_mul_f32 v28, v28, v12
    v_mul_f32 v32, v32, v12
    v_cvt_pk_bf16_f32 v8, v28, v32
    v_mul_f32 v29, v29, v12
    v_mul_f32 v33, v33, v12
    v_cvt_pk_bf16_f32 v9, v29, v33
    v_mul_f32 v30, v30, v12
    v_mul_f32 v34, v34, v12
    v_cvt_pk_bf16_f32 v10, v30, v34
    v_mul_f32 v31, v31, v12
    v_mul_f32 v35, v35, v12
    v_cvt_pk_bf16_f32 v11, v31, v35
    buffer_store_dwordx4 v[8:11], v3, s[4:7], s17 offen offset:1024 sc1
    v_mul_f32 v36, v36, v12
    v_mul_f32 v40, v40, v12
    v_cvt_pk_bf16_f32 v8, v36, v40
    v_mul_f32 v37, v37, v12
    v_mul_f32 v41, v41, v12
    v_cvt_pk_bf16_f32 v9, v37, v41
    v_mul_f32 v38, v38, v12
    v_mul_f32 v42, v42, v12
    v_cvt_pk_bf16_f32 v10, v38, v42
    v_mul_f32 v39, v39, v12
    v_mul_f32 v43, v43, v12
    v_cvt_pk_bf16_f32 v11, v39, v43
    buffer_store_dwordx4 v[8:11], v3, s[4:7], s17 offen offset:2048 sc1
    v_mul_f32 v44, v44, v12
    v_mul_f32 v48, v48, v12
    v_cvt_pk_bf16_f32 v8, v44, v48
    v_mul_f32 v45, v45, v12
    v_mul_f32 v49, v49, v12
    v_cvt_pk_bf16_f32 v9, v45, v49
    v_mul_f32 v46, v46, v12
    v_mul_f32 v50, v50, v12
    v_cvt_pk_bf16_f32 v10, v46, v50
    v_mul_f32 v47, v47, v12
    v_mul_f32 v51, v51, v12
    v_cvt_pk_bf16_f32 v11, v47, v51
    buffer_store_dwordx4 v[8:11], v3, s[4:7], s17 offen offset:3072 sc1
    s_waitcnt vmcnt(0)
    s_barrier
    s_cmp_lg_u32 s92, 0
    s_cbranch_scc1 L_g95_done
    s_lshl_b32 s79, s84, 9
    s_lshl_b32 s93, s83, 2
    s_add_u32 s79, s79, s93
    s_add_u32 s79, s79, 3948544
    v_mov_b32 v250, 0
    v_mov_b32 v251, s82
    s_mov_b64 exec, 1
    buffer_store_dword v251, v250, s[4:7], s79 offen
    s_mov_b64 exec, -1
L_g95_done:
L_adaLN_cond__memory_aug_recurrent_mem_tr__dense_activation_gelu__prompt_kernel_pf_noatt:
    s_mov_b32 s16, s81
    s_lshr_b32 s17, s83, 3
    s_and_b32 s22, s83, 7
    s_lshl_b32 s10, s17, 7
    s_lshl_b32 s11, s22, 4
    v_and_b32 v2, 63, v0
    v_lshlrev_b32 v3, 4, v2
    v_and_b32 v4, 15, v2
    v_lshrrev_b32 v5, 4, v2
    v_lshrrev_b32 v20, 2, v4
    v_lshl_add_u32 v23, v5, 3, v20
    v_and_b32 v22, 3, v23
    v_bfe_u32 v21, v23, 3, 1
    v_lshl_or_b32 v22, v21, 2, v22
    v_mul_u32_u24 v21, 256, v23
    v_and_b32 v23, 3, v2
    v_lshl_add_u32 v21, v23, 3, v21
    v_xor_b32 v23, 0, v22
    v_lshl_add_u32 v12, v23, 5, v21
    v_add_u32 v24, 0x10000, v12
    v_xor_b32 v23, 1, v22
    v_lshl_add_u32 v13, v23, 5, v21
    v_add_u32 v25, 0x10000, v13
    v_xor_b32 v23, 2, v22
    v_lshl_add_u32 v14, v23, 5, v21
    v_add_u32 v26, 0x10000, v14
    v_xor_b32 v23, 3, v22
    v_lshl_add_u32 v15, v23, 5, v21
    v_add_u32 v27, 0x10000, v15
    v_xor_b32 v23, 4, v22
    v_lshl_add_u32 v16, v23, 5, v21
    v_add_u32 v28, 0x10000, v16
    v_xor_b32 v23, 5, v22
    v_lshl_add_u32 v17, v23, 5, v21
    v_add_u32 v29, 0x10000, v17
    v_xor_b32 v23, 6, v22
    v_lshl_add_u32 v18, v23, 5, v21
    v_add_u32 v30, 0x10000, v18
    v_xor_b32 v23, 7, v22
    v_lshl_add_u32 v19, v23, 5, v21
    v_add_u32 v31, 0x10000, v19
    s_waitcnt lgkmcnt(0)
    s_waitcnt vmcnt(0)
    s_cmp_lg_u32 s92, 0
    s_cbranch_scc1 L_g96_done
    s_lshl_b32 s79, s84, 9
    s_add_u32 s79, s79, 3948544
    v_mbcnt_lo_u32_b32 v250, -1, 0
    v_mbcnt_hi_u32_b32 v250, -1, v250
    v_min_u32 v250, 15, v250
    v_lshlrev_b32 v250, 2, v250
    s_mov_b32 s94, 400000
L_g96_spin:
    buffer_load_dword v251, v250, s[4:7], s79 offen sc1
    s_waitcnt vmcnt(0)
    v_cmp_gt_u32 vcc, s82, v251
    s_cbranch_vccz L_g96_done
    s_sub_u32 s94, s94, 1
    s_cbranch_scc0 L_g96_spin
L_g96_done:
    s_barrier
    s_lshl_b32 s9, s16, 2
    s_add_u32 s9, s9, s92
    s_and_b32 s8, s9, 3
    s_lshl_b32 s18, s84, 3
    s_add_u32 s8, s8, s18
    s_mul_i32 s23, s9, 131072
    s_lshl_b32 s24, s11, 10
    s_add_u32 s23, s23, s24
    s_add_u32 s23, s23, 67108864
    s_add_u32 s24, s23, 131072
    buffer_load_dwordx4 a[0:3], v3, s[4:7], s23 offen offset:0 sc1
    buffer_load_dwordx4 a[4:7], v3, s[4:7], s23 offen offset:1024 sc1
    buffer_load_dwordx4 a[8:11], v3, s[4:7], s23 offen offset:2048 sc1
    buffer_load_dwordx4 a[12:15], v3, s[4:7], s23 offen offset:3072 sc1
    s_add_u32 s23, s23, 4096
    buffer_load_dwordx4 a[16:19], v3, s[4:7], s23 offen offset:0 sc1
    buffer_load_dwordx4 a[20:23], v3, s[4:7], s23 offen offset:1024 sc1
    buffer_load_dwordx4 a[24:27], v3, s[4:7], s23 offen offset:2048 sc1
    buffer_load_dwordx4 a[28:31], v3, s[4:7], s23 offen offset:3072 sc1
    s_add_u32 s23, s23, 4096
    buffer_load_dwordx4 a[32:35], v3, s[4:7], s23 offen offset:0 sc1
    buffer_load_dwordx4 a[36:39], v3, s[4:7], s23 offen offset:1024 sc1
    buffer_load_dwordx4 a[40:43], v3, s[4:7], s23 offen offset:2048 sc1
    buffer_load_dwordx4 a[44:47], v3, s[4:7], s23 offen offset:3072 sc1
    s_add_u32 s23, s23, 4096
    buffer_load_dwordx4 a[48:51], v3, s[4:7], s23 offen offset:0 sc1
    buffer_load_dwordx4 a[52:55], v3, s[4:7], s23 offen offset:1024 sc1
    buffer_load_dwordx4 a[56:59], v3, s[4:7], s23 offen offset:2048 sc1
    buffer_load_dwordx4 a[60:63], v3, s[4:7], s23 offen offset:3072 sc1
    s_lshl_b32 s36, s22, 22
    s_lshl_b32 s37, s9, 15
    s_add_u32 s36, s36, s37
    s_lshl_b32 s37, s10, 2
    s_add_u32 s36, s36, s37
    s_add_u32 s36, s36, 134217728
    s_add_u32 s37, s36, 32768
    v_lshlrev_b32 v20, 11, v4
    v_lshl_add_u32 v20, v5, 4, v20
    ds_read_b64_tr_b16 v[64:65], v12 offset:0
    ds_read_b64_tr_b16 v[66:67], v12 offset:1024
    ds_read_b64_tr_b16 v[68:69], v12 offset:8192
    ds_read_b64_tr_b16 v[70:71], v12 offset:9216
    ds_read_b64_tr_b16 v[72:73], v12 offset:16384
    ds_read_b64_tr_b16 v[74:75], v12 offset:17408
    ds_read_b64_tr_b16 v[76:77], v12 offset:24576
    ds_read_b64_tr_b16 v[78:79], v12 offset:25600
    ds_read_b64_tr_b16 v[80:81], v12 offset:32768
    ds_read_b64_tr_b16 v[82:83], v12 offset:33792
    ds_read_b64_tr_b16 v[84:85], v12 offset:40960
    ds_read_b64_tr_b16 v[86:87], v12 offset:41984
    s_waitcnt vmcnt(15) lgkmcnt(10)
    v_mfma_f32_16x16x32_bf16 v[32:35], v[64:67], a[0:3], 0
    ds_read_b64_tr_b16 v[88:89], v12 offset:49152
    ds_read_b64_tr_b16 v[90:91], v12 offset:50176
    s_waitcnt vmcnt(14) lgkmcnt(10)
    v_mfma_f32_16x16x32_bf16 v[32:35], v[68:71], a[4:7], v[32:35]
    ds_read_b64_tr_b16 v[92:93], v12 offset:57344
    ds_read_b64_tr_b16 v[94:95], v12 offset:58368
    s_waitcnt vmcnt(13) lgkmcnt(10)
    v_mfma_f32_16x16x32_bf16 v[32:35], v[72:75], a[8:11], v[32:35]
    ds_read_b64_tr_b16 v[64:65], v24 offset:0
    ds_read_b64_tr_b16 v[66:67], v24 offset:1024
    s_waitcnt vmcnt(12) lgkmcnt(10)
    v_mfma_f32_16x16x32_bf16 v[32:35], v[76:79], a[12:15], v[32:35]
    ds_read_b64_tr_b16 v[68:69], v24 offset:8192
    ds_read_b64_tr_b16 v[70:71], v24 offset:9216
    s_waitcnt vmcnt(11) lgkmcnt(10)
    v_mfma_f32_16x16x32_bf16 v[32:35], v[80:83], a[16:19], v[32:35]
    ds_read_b64_tr_b16 v[72:73], v24 offset:16384
    ds_read_b64_tr_b16 v[74:75], v24 offset:17408
    s_waitcnt vmcnt(10) lgkmcnt(10)
    v_mfma_f32_16x16x32_bf16 v[32:35], v[84:87], a[20:23], v[32:35]
    ds_read_b64_tr_b16 v[76:77], v24 offset:24576
    ds_read_b64_tr_b16 v[78:79], v24 offset:25600
    s_waitcnt vmcnt(9) lgkmcnt(10)
    v_mfma_f32_16x16x32_bf16 v[32:35], v[88:91], a[24:27], v[32:35]
    ds_read_b64_tr_b16 v[80:81], v24 offset:32768
    ds_read_b64_tr_b16 v[82:83], v24 offset:33792
    s_waitcnt vmcnt(8) lgkmcnt(10)
    v_mfma_f32_16x16x32_bf16 v[32:35], v[92:95], a[28:31], v[32:35]
    ds_read_b64_tr_b16 v[84:85], v24 offset:40960
    ds_read_b64_tr_b16 v[86:87], v24 offset:41984
    s_waitcnt vmcnt(7) lgkmcnt(10)
    v_mfma_f32_16x16x32_bf16 v[32:35], v[64:67], a[32:35], v[32:35]
    ds_read_b64_tr_b16 v[88:89], v24 offset:49152
    ds_read_b64_tr_b16 v[90:91], v24 offset:50176
    s_waitcnt vmcnt(6) lgkmcnt(10)
    v_mfma_f32_16x16x32_bf16 v[32:35], v[68:71], a[36:39], v[32:35]
    ds_read_b64_tr_b16 v[92:93], v24 offset:57344
    ds_read_b64_tr_b16 v[94:95], v24 offset:58368
    s_waitcnt vmcnt(5) lgkmcnt(10)
    v_mfma_f32_16x16x32_bf16 v[32:35], v[72:75], a[40:43], v[32:35]
    ds_read_b64_tr_b16 v[64:65], v13 offset:0
    ds_read_b64_tr_b16 v[66:67], v13 offset:1024
    s_waitcnt vmcnt(4) lgkmcnt(10)
    v_mfma_f32_16x16x32_bf16 v[32:35], v[76:79], a[44:47], v[32:35]
    ds_read_b64_tr_b16 v[68:69], v13 offset:8192
    ds_read_b64_tr_b16 v[70:71], v13 offset:9216
    s_waitcnt vmcnt(3) lgkmcnt(10)
    v_mfma_f32_16x16x32_bf16 v[32:35], v[80:83], a[48:51], v[32:35]
    ds_read_b64_tr_b16 v[72:73], v13 offset:16384
    ds_read_b64_tr_b16 v[74:75], v13 offset:17408
    s_waitcnt vmcnt(2) lgkmcnt(10)
    v_mfma_f32_16x16x32_bf16 v[32:35], v[84:87], a[52:55], v[32:35]
    ds_read_b64_tr_b16 v[76:77], v13 offset:24576
    ds_read_b64_tr_b16 v[78:79], v13 offset:25600
    s_waitcnt vmcnt(1) lgkmcnt(10)
    v_mfma_f32_16x16x32_bf16 v[32:35], v[88:91], a[56:59], v[32:35]
    ds_read_b64_tr_b16 v[80:81], v13 offset:32768
    ds_read_b64_tr_b16 v[82:83], v13 offset:33792
    s_waitcnt vmcnt(0) lgkmcnt(10)
    v_mfma_f32_16x16x32_bf16 v[32:35], v[92:95], a[60:63], v[32:35]
    ds_read_b64_tr_b16 v[84:85], v13 offset:40960
    ds_read_b64_tr_b16 v[86:87], v13 offset:41984
    s_waitcnt lgkmcnt(10)
    v_mfma_f32_16x16x32_bf16 v[36:39], v[64:67], a[0:3], 0
    ds_read_b64_tr_b16 v[88:89], v13 offset:49152
    ds_read_b64_tr_b16 v[90:91], v13 offset:50176
    s_waitcnt lgkmcnt(10)
    v_mfma_f32_16x16x32_bf16 v[36:39], v[68:71], a[4:7], v[36:39]
    ds_read_b64_tr_b16 v[92:93], v13 offset:57344
    ds_read_b64_tr_b16 v[94:95], v13 offset:58368
    s_waitcnt lgkmcnt(10)
    v_mfma_f32_16x16x32_bf16 v[36:39], v[72:75], a[8:11], v[36:39]
    ds_read_b64_tr_b16 v[64:65], v25 offset:0
    ds_read_b64_tr_b16 v[66:67], v25 offset:1024
    s_waitcnt lgkmcnt(10)
    v_mfma_f32_16x16x32_bf16 v[36:39], v[76:79], a[12:15], v[36:39]
    ds_read_b64_tr_b16 v[68:69], v25 offset:8192
    ds_read_b64_tr_b16 v[70:71], v25 offset:9216
    buffer_store_dwordx4 v[32:35], v20, s[4:7], s36 offen offset:0 sc1
    s_waitcnt lgkmcnt(10)
    v_mfma_f32_16x16x32_bf16 v[36:39], v[80:83], a[16:19], v[36:39]
    ds_read_b64_tr_b16 v[72:73], v25 offset:16384
    ds_read_b64_tr_b16 v[74:75], v25 offset:17408
    s_waitcnt lgkmcnt(10)
    v_mfma_f32_16x16x32_bf16 v[36:39], v[84:87], a[20:23], v[36:39]
    ds_read_b64_tr_b16 v[76:77], v25 offset:24576
    ds_read_b64_tr_b16 v[78:79], v25 offset:25600
    s_waitcnt lgkmcnt(10)
    v_mfma_f32_16x16x32_bf16 v[36:39], v[88:91], a[24:27], v[36:39]
    ds_read_b64_tr_b16 v[80:81], v25 offset:32768
    ds_read_b64_tr_b16 v[82:83], v25 offset:33792
    s_waitcnt lgkmcnt(10)
    v_mfma_f32_16x16x32_bf16 v[36:39], v[92:95], a[28:31], v[36:39]
    ds_read_b64_tr_b16 v[84:85], v25 offset:40960
    ds_read_b64_tr_b16 v[86:87], v25 offset:41984
    s_waitcnt lgkmcnt(10)
    v_mfma_f32_16x16x32_bf16 v[36:39], v[64:67], a[32:35], v[36:39]
    ds_read_b64_tr_b16 v[88:89], v25 offset:49152
    ds_read_b64_tr_b16 v[90:91], v25 offset:50176
    s_waitcnt lgkmcnt(10)
    v_mfma_f32_16x16x32_bf16 v[36:39], v[68:71], a[36:39], v[36:39]
    ds_read_b64_tr_b16 v[92:93], v25 offset:57344
    ds_read_b64_tr_b16 v[94:95], v25 offset:58368
    s_waitcnt lgkmcnt(10)
    v_mfma_f32_16x16x32_bf16 v[36:39], v[72:75], a[40:43], v[36:39]
    ds_read_b64_tr_b16 v[64:65], v14 offset:0
    ds_read_b64_tr_b16 v[66:67], v14 offset:1024
    s_waitcnt lgkmcnt(10)
    v_mfma_f32_16x16x32_bf16 v[36:39], v[76:79], a[44:47], v[36:39]
    ds_read_b64_tr_b16 v[68:69], v14 offset:8192
    ds_read_b64_tr_b16 v[70:71], v14 offset:9216
    s_waitcnt lgkmcnt(10)
    v_mfma_f32_16x16x32_bf16 v[36:39], v[80:83], a[48:51], v[36:39]
    ds_read_b64_tr_b16 v[72:73], v14 offset:16384
    ds_read_b64_tr_b16 v[74:75], v14 offset:17408
    s_waitcnt lgkmcnt(10)
    v_mfma_f32_16x16x32_bf16 v[36:39], v[84:87], a[52:55], v[36:39]
    ds_read_b64_tr_b16 v[76:77], v14 offset:24576
    ds_read_b64_tr_b16 v[78:79], v14 offset:25600
    s_waitcnt lgkmcnt(10)
    v_mfma_f32_16x16x32_bf16 v[36:39], v[88:91], a[56:59], v[36:39]
    ds_read_b64_tr_b16 v[80:81], v14 offset:32768
    ds_read_b64_tr_b16 v[82:83], v14 offset:33792
    s_waitcnt lgkmcnt(10)
    v_mfma_f32_16x16x32_bf16 v[36:39], v[92:95], a[60:63], v[36:39]
    ds_read_b64_tr_b16 v[84:85], v14 offset:40960
    ds_read_b64_tr_b16 v[86:87], v14 offset:41984
    s_waitcnt lgkmcnt(10)
    v_mfma_f32_16x16x32_bf16 v[40:43], v[64:67], a[0:3], 0
    ds_read_b64_tr_b16 v[88:89], v14 offset:49152
    ds_read_b64_tr_b16 v[90:91], v14 offset:50176
    s_waitcnt lgkmcnt(10)
    v_mfma_f32_16x16x32_bf16 v[40:43], v[68:71], a[4:7], v[40:43]
    ds_read_b64_tr_b16 v[92:93], v14 offset:57344
    ds_read_b64_tr_b16 v[94:95], v14 offset:58368
    s_waitcnt lgkmcnt(10)
    v_mfma_f32_16x16x32_bf16 v[40:43], v[72:75], a[8:11], v[40:43]
    ds_read_b64_tr_b16 v[64:65], v26 offset:0
    ds_read_b64_tr_b16 v[66:67], v26 offset:1024
    s_waitcnt lgkmcnt(10)
    v_mfma_f32_16x16x32_bf16 v[40:43], v[76:79], a[12:15], v[40:43]
    ds_read_b64_tr_b16 v[68:69], v26 offset:8192
    ds_read_b64_tr_b16 v[70:71], v26 offset:9216
    buffer_store_dwordx4 v[36:39], v20, s[4:7], s36 offen offset:64 sc1
    s_waitcnt lgkmcnt(10)
    v_mfma_f32_16x16x32_bf16 v[40:43], v[80:83], a[16:19], v[40:43]
    ds_read_b64_tr_b16 v[72:73], v26 offset:16384
    ds_read_b64_tr_b16 v[74:75], v26 offset:17408
    s_waitcnt lgkmcnt(10)
    v_mfma_f32_16x16x32_bf16 v[40:43], v[84:87], a[20:23], v[40:43]
    ds_read_b64_tr_b16 v[76:77], v26 offset:24576
    ds_read_b64_tr_b16 v[78:79], v26 offset:25600
    s_waitcnt lgkmcnt(10)
    v_mfma_f32_16x16x32_bf16 v[40:43], v[88:91], a[24:27], v[40:43]
    ds_read_b64_tr_b16 v[80:81], v26 offset:32768
    ds_read_b64_tr_b16 v[82:83], v26 offset:33792
    s_waitcnt lgkmcnt(10)
    v_mfma_f32_16x16x32_bf16 v[40:43], v[92:95], a[28:31], v[40:43]
    ds_read_b64_tr_b16 v[84:85], v26 offset:40960
    ds_read_b64_tr_b16 v[86:87], v26 offset:41984
    s_waitcnt lgkmcnt(10)
    v_mfma_f32_16x16x32_bf16 v[40:43], v[64:67], a[32:35], v[40:43]
    ds_read_b64_tr_b16 v[88:89], v26 offset:49152
    ds_read_b64_tr_b16 v[90:91], v26 offset:50176
    s_waitcnt lgkmcnt(10)
    v_mfma_f32_16x16x32_bf16 v[40:43], v[68:71], a[36:39], v[40:43]
    ds_read_b64_tr_b16 v[92:93], v26 offset:57344
    ds_read_b64_tr_b16 v[94:95], v26 offset:58368
    s_waitcnt lgkmcnt(10)
    v_mfma_f32_16x16x32_bf16 v[40:43], v[72:75], a[40:43], v[40:43]
    ds_read_b64_tr_b16 v[64:65], v15 offset:0
    ds_read_b64_tr_b16 v[66:67], v15 offset:1024
    s_waitcnt lgkmcnt(10)
    v_mfma_f32_16x16x32_bf16 v[40:43], v[76:79], a[44:47], v[40:43]
    ds_read_b64_tr_b16 v[68:69], v15 offset:8192
    ds_read_b64_tr_b16 v[70:71], v15 offset:9216
    s_waitcnt lgkmcnt(10)
    v_mfma_f32_16x16x32_bf16 v[40:43], v[80:83], a[48:51], v[40:43]
    ds_read_b64_tr_b16 v[72:73], v15 offset:16384
    ds_read_b64_tr_b16 v[74:75], v15 offset:17408
    s_waitcnt lgkmcnt(10)
    v_mfma_f32_16x16x32_bf16 v[40:43], v[84:87], a[52:55], v[40:43]
    ds_read_b64_tr_b16 v[76:77], v15 offset:24576
    ds_read_b64_tr_b16 v[78:79], v15 offset:25600
    s_waitcnt lgkmcnt(10)
    v_mfma_f32_16x16x32_bf16 v[40:43], v[88:91], a[56:59], v[40:43]
    ds_read_b64_tr_b16 v[80:81], v15 offset:32768
    ds_read_b64_tr_b16 v[82:83], v15 offset:33792
    s_waitcnt lgkmcnt(10)
    v_mfma_f32_16x16x32_bf16 v[40:43], v[92:95], a[60:63], v[40:43]
    ds_read_b64_tr_b16 v[84:85], v15 offset:40960
    ds_read_b64_tr_b16 v[86:87], v15 offset:41984
    s_waitcnt lgkmcnt(10)
    v_mfma_f32_16x16x32_bf16 v[44:47], v[64:67], a[0:3], 0
    ds_read_b64_tr_b16 v[88:89], v15 offset:49152
    ds_read_b64_tr_b16 v[90:91], v15 offset:50176
    s_waitcnt lgkmcnt(10)
    v_mfma_f32_16x16x32_bf16 v[44:47], v[68:71], a[4:7], v[44:47]
    ds_read_b64_tr_b16 v[92:93], v15 offset:57344
    ds_read_b64_tr_b16 v[94:95], v15 offset:58368
    s_waitcnt lgkmcnt(10)
    v_mfma_f32_16x16x32_bf16 v[44:47], v[72:75], a[8:11], v[44:47]
    ds_read_b64_tr_b16 v[64:65], v27 offset:0
    ds_read_b64_tr_b16 v[66:67], v27 offset:1024
    s_waitcnt lgkmcnt(10)
    v_mfma_f32_16x16x32_bf16 v[44:47], v[76:79], a[12:15], v[44:47]
    ds_read_b64_tr_b16 v[68:69], v27 offset:8192
    ds_read_b64_tr_b16 v[70:71], v27 offset:9216
    buffer_store_dwordx4 v[40:43], v20, s[4:7], s36 offen offset:128 sc1
    s_waitcnt lgkmcnt(10)
    v_mfma_f32_16x16x32_bf16 v[44:47], v[80:83], a[16:19], v[44:47]
    ds_read_b64_tr_b16 v[72:73], v27 offset:16384
    ds_read_b64_tr_b16 v[74:75], v27 offset:17408
    s_waitcnt lgkmcnt(10)
    v_mfma_f32_16x16x32_bf16 v[44:47], v[84:87], a[20:23], v[44:47]
    ds_read_b64_tr_b16 v[76:77], v27 offset:24576
    ds_read_b64_tr_b16 v[78:79], v27 offset:25600
    s_waitcnt lgkmcnt(10)
    v_mfma_f32_16x16x32_bf16 v[44:47], v[88:91], a[24:27], v[44:47]
    ds_read_b64_tr_b16 v[80:81], v27 offset:32768
    ds_read_b64_tr_b16 v[82:83], v27 offset:33792
    s_waitcnt lgkmcnt(10)
    v_mfma_f32_16x16x32_bf16 v[44:47], v[92:95], a[28:31], v[44:47]
    ds_read_b64_tr_b16 v[84:85], v27 offset:40960
    ds_read_b64_tr_b16 v[86:87], v27 offset:41984
    s_waitcnt lgkmcnt(10)
    v_mfma_f32_16x16x32_bf16 v[44:47], v[64:67], a[32:35], v[44:47]
    ds_read_b64_tr_b16 v[88:89], v27 offset:49152
    ds_read_b64_tr_b16 v[90:91], v27 offset:50176
    s_waitcnt lgkmcnt(10)
    v_mfma_f32_16x16x32_bf16 v[44:47], v[68:71], a[36:39], v[44:47]
    ds_read_b64_tr_b16 v[92:93], v27 offset:57344
    ds_read_b64_tr_b16 v[94:95], v27 offset:58368
    s_waitcnt lgkmcnt(10)
    v_mfma_f32_16x16x32_bf16 v[44:47], v[72:75], a[40:43], v[44:47]
    ds_read_b64_tr_b16 v[64:65], v16 offset:0
    ds_read_b64_tr_b16 v[66:67], v16 offset:1024
    s_waitcnt lgkmcnt(10)
    v_mfma_f32_16x16x32_bf16 v[44:47], v[76:79], a[44:47], v[44:47]
    ds_read_b64_tr_b16 v[68:69], v16 offset:8192
    ds_read_b64_tr_b16 v[70:71], v16 offset:9216
    s_waitcnt lgkmcnt(10)
    v_mfma_f32_16x16x32_bf16 v[44:47], v[80:83], a[48:51], v[44:47]
    ds_read_b64_tr_b16 v[72:73], v16 offset:16384
    ds_read_b64_tr_b16 v[74:75], v16 offset:17408
    s_waitcnt lgkmcnt(10)
    v_mfma_f32_16x16x32_bf16 v[44:47], v[84:87], a[52:55], v[44:47]
    ds_read_b64_tr_b16 v[76:77], v16 offset:24576
    ds_read_b64_tr_b16 v[78:79], v16 offset:25600
    s_waitcnt lgkmcnt(10)
    v_mfma_f32_16x16x32_bf16 v[44:47], v[88:91], a[56:59], v[44:47]
    ds_read_b64_tr_b16 v[80:81], v16 offset:32768
    ds_read_b64_tr_b16 v[82:83], v16 offset:33792
    s_waitcnt lgkmcnt(10)
    v_mfma_f32_16x16x32_bf16 v[44:47], v[92:95], a[60:63], v[44:47]
    ds_read_b64_tr_b16 v[84:85], v16 offset:40960
    ds_read_b64_tr_b16 v[86:87], v16 offset:41984
    s_waitcnt lgkmcnt(10)
    v_mfma_f32_16x16x32_bf16 v[48:51], v[64:67], a[0:3], 0
    ds_read_b64_tr_b16 v[88:89], v16 offset:49152
    ds_read_b64_tr_b16 v[90:91], v16 offset:50176
    s_waitcnt lgkmcnt(10)
    v_mfma_f32_16x16x32_bf16 v[48:51], v[68:71], a[4:7], v[48:51]
    ds_read_b64_tr_b16 v[92:93], v16 offset:57344
    ds_read_b64_tr_b16 v[94:95], v16 offset:58368
    s_waitcnt lgkmcnt(10)
    v_mfma_f32_16x16x32_bf16 v[48:51], v[72:75], a[8:11], v[48:51]
    ds_read_b64_tr_b16 v[64:65], v28 offset:0
    ds_read_b64_tr_b16 v[66:67], v28 offset:1024
    s_waitcnt lgkmcnt(10)
    v_mfma_f32_16x16x32_bf16 v[48:51], v[76:79], a[12:15], v[48:51]
    ds_read_b64_tr_b16 v[68:69], v28 offset:8192
    ds_read_b64_tr_b16 v[70:71], v28 offset:9216
    buffer_store_dwordx4 v[44:47], v20, s[4:7], s36 offen offset:192 sc1
    s_waitcnt lgkmcnt(10)
    v_mfma_f32_16x16x32_bf16 v[48:51], v[80:83], a[16:19], v[48:51]
    ds_read_b64_tr_b16 v[72:73], v28 offset:16384
    ds_read_b64_tr_b16 v[74:75], v28 offset:17408
    s_waitcnt lgkmcnt(10)
    v_mfma_f32_16x16x32_bf16 v[48:51], v[84:87], a[20:23], v[48:51]
    ds_read_b64_tr_b16 v[76:77], v28 offset:24576
    ds_read_b64_tr_b16 v[78:79], v28 offset:25600
    s_waitcnt lgkmcnt(10)
    v_mfma_f32_16x16x32_bf16 v[48:51], v[88:91], a[24:27], v[48:51]
    ds_read_b64_tr_b16 v[80:81], v28 offset:32768
    ds_read_b64_tr_b16 v[82:83], v28 offset:33792
    s_waitcnt lgkmcnt(10)
    v_mfma_f32_16x16x32_bf16 v[48:51], v[92:95], a[28:31], v[48:51]
    ds_read_b64_tr_b16 v[84:85], v28 offset:40960
    ds_read_b64_tr_b16 v[86:87], v28 offset:41984
    s_waitcnt lgkmcnt(10)
    v_mfma_f32_16x16x32_bf16 v[48:51], v[64:67], a[32:35], v[48:51]
    ds_read_b64_tr_b16 v[88:89], v28 offset:49152
    ds_read_b64_tr_b16 v[90:91], v28 offset:50176
    s_waitcnt lgkmcnt(10)
    v_mfma_f32_16x16x32_bf16 v[48:51], v[68:71], a[36:39], v[48:51]
    ds_read_b64_tr_b16 v[92:93], v28 offset:57344
    ds_read_b64_tr_b16 v[94:95], v28 offset:58368
    s_waitcnt lgkmcnt(10)
    v_mfma_f32_16x16x32_bf16 v[48:51], v[72:75], a[40:43], v[48:51]
    ds_read_b64_tr_b16 v[64:65], v17 offset:0
    ds_read_b64_tr_b16 v[66:67], v17 offset:1024
    s_waitcnt lgkmcnt(10)
    v_mfma_f32_16x16x32_bf16 v[48:51], v[76:79], a[44:47], v[48:51]
    ds_read_b64_tr_b16 v[68:69], v17 offset:8192
    ds_read_b64_tr_b16 v[70:71], v17 offset:9216
    s_waitcnt lgkmcnt(10)
    v_mfma_f32_16x16x32_bf16 v[48:51], v[80:83], a[48:51], v[48:51]
    ds_read_b64_tr_b16 v[72:73], v17 offset:16384
    ds_read_b64_tr_b16 v[74:75], v17 offset:17408
    s_waitcnt lgkmcnt(10)
    v_mfma_f32_16x16x32_bf16 v[48:51], v[84:87], a[52:55], v[48:51]
    ds_read_b64_tr_b16 v[76:77], v17 offset:24576
    ds_read_b64_tr_b16 v[78:79], v17 offset:25600
    s_waitcnt lgkmcnt(10)
    v_mfma_f32_16x16x32_bf16 v[48:51], v[88:91], a[56:59], v[48:51]
    ds_read_b64_tr_b16 v[80:81], v17 offset:32768
    ds_read_b64_tr_b16 v[82:83], v17 offset:33792
    s_waitcnt lgkmcnt(10)
    v_mfma_f32_16x16x32_bf16 v[48:51], v[92:95], a[60:63], v[48:51]
    ds_read_b64_tr_b16 v[84:85], v17 offset:40960
    ds_read_b64_tr_b16 v[86:87], v17 offset:41984
    s_waitcnt lgkmcnt(10)
    v_mfma_f32_16x16x32_bf16 v[52:55], v[64:67], a[0:3], 0
    ds_read_b64_tr_b16 v[88:89], v17 offset:49152
    ds_read_b64_tr_b16 v[90:91], v17 offset:50176
    s_waitcnt lgkmcnt(10)
    v_mfma_f32_16x16x32_bf16 v[52:55], v[68:71], a[4:7], v[52:55]
    ds_read_b64_tr_b16 v[92:93], v17 offset:57344
    ds_read_b64_tr_b16 v[94:95], v17 offset:58368
    s_waitcnt lgkmcnt(10)
    v_mfma_f32_16x16x32_bf16 v[52:55], v[72:75], a[8:11], v[52:55]
    ds_read_b64_tr_b16 v[64:65], v29 offset:0
    ds_read_b64_tr_b16 v[66:67], v29 offset:1024
    s_waitcnt lgkmcnt(10)
    v_mfma_f32_16x16x32_bf16 v[52:55], v[76:79], a[12:15], v[52:55]
    ds_read_b64_tr_b16 v[68:69], v29 offset:8192
    ds_read_b64_tr_b16 v[70:71], v29 offset:9216
    buffer_store_dwordx4 v[48:51], v20, s[4:7], s36 offen offset:256 sc1
    s_waitcnt lgkmcnt(10)
    v_mfma_f32_16x16x32_bf16 v[52:55], v[80:83], a[16:19], v[52:55]
    ds_read_b64_tr_b16 v[72:73], v29 offset:16384
    ds_read_b64_tr_b16 v[74:75], v29 offset:17408
    s_waitcnt lgkmcnt(10)
    v_mfma_f32_16x16x32_bf16 v[52:55], v[84:87], a[20:23], v[52:55]
    ds_read_b64_tr_b16 v[76:77], v29 offset:24576
    ds_read_b64_tr_b16 v[78:79], v29 offset:25600
    s_waitcnt lgkmcnt(10)
    v_mfma_f32_16x16x32_bf16 v[52:55], v[88:91], a[24:27], v[52:55]
    ds_read_b64_tr_b16 v[80:81], v29 offset:32768
    ds_read_b64_tr_b16 v[82:83], v29 offset:33792
    s_waitcnt lgkmcnt(10)
    v_mfma_f32_16x16x32_bf16 v[52:55], v[92:95], a[28:31], v[52:55]
    ds_read_b64_tr_b16 v[84:85], v29 offset:40960
    ds_read_b64_tr_b16 v[86:87], v29 offset:41984
    s_waitcnt lgkmcnt(10)
    v_mfma_f32_16x16x32_bf16 v[52:55], v[64:67], a[32:35], v[52:55]
    ds_read_b64_tr_b16 v[88:89], v29 offset:49152
    ds_read_b64_tr_b16 v[90:91], v29 offset:50176
    s_waitcnt lgkmcnt(10)
    v_mfma_f32_16x16x32_bf16 v[52:55], v[68:71], a[36:39], v[52:55]
    ds_read_b64_tr_b16 v[92:93], v29 offset:57344
    ds_read_b64_tr_b16 v[94:95], v29 offset:58368
    s_waitcnt lgkmcnt(10)
    v_mfma_f32_16x16x32_bf16 v[52:55], v[72:75], a[40:43], v[52:55]
    ds_read_b64_tr_b16 v[64:65], v18 offset:0
    ds_read_b64_tr_b16 v[66:67], v18 offset:1024
    s_waitcnt lgkmcnt(10)
    v_mfma_f32_16x16x32_bf16 v[52:55], v[76:79], a[44:47], v[52:55]
    ds_read_b64_tr_b16 v[68:69], v18 offset:8192
    ds_read_b64_tr_b16 v[70:71], v18 offset:9216
    s_waitcnt lgkmcnt(10)
    v_mfma_f32_16x16x32_bf16 v[52:55], v[80:83], a[48:51], v[52:55]
    ds_read_b64_tr_b16 v[72:73], v18 offset:16384
    ds_read_b64_tr_b16 v[74:75], v18 offset:17408
    s_waitcnt lgkmcnt(10)
    v_mfma_f32_16x16x32_bf16 v[52:55], v[84:87], a[52:55], v[52:55]
    ds_read_b64_tr_b16 v[76:77], v18 offset:24576
    ds_read_b64_tr_b16 v[78:79], v18 offset:25600
    s_waitcnt lgkmcnt(10)
    v_mfma_f32_16x16x32_bf16 v[52:55], v[88:91], a[56:59], v[52:55]
    ds_read_b64_tr_b16 v[80:81], v18 offset:32768
    ds_read_b64_tr_b16 v[82:83], v18 offset:33792
    s_waitcnt lgkmcnt(10)
    v_mfma_f32_16x16x32_bf16 v[52:55], v[92:95], a[60:63], v[52:55]
    ds_read_b64_tr_b16 v[84:85], v18 offset:40960
    ds_read_b64_tr_b16 v[86:87], v18 offset:41984
    s_waitcnt lgkmcnt(10)
    v_mfma_f32_16x16x32_bf16 v[56:59], v[64:67], a[0:3], 0
    ds_read_b64_tr_b16 v[88:89], v18 offset:49152
    ds_read_b64_tr_b16 v[90:91], v18 offset:50176
    s_waitcnt lgkmcnt(10)
    v_mfma_f32_16x16x32_bf16 v[56:59], v[68:71], a[4:7], v[56:59]
    ds_read_b64_tr_b16 v[92:93], v18 offset:57344
    ds_read_b64_tr_b16 v[94:95], v18 offset:58368
    s_waitcnt lgkmcnt(10)
    v_mfma_f32_16x16x32_bf16 v[56:59], v[72:75], a[8:11], v[56:59]
    ds_read_b64_tr_b16 v[64:65], v30 offset:0
    ds_read_b64_tr_b16 v[66:67], v30 offset:1024
    s_waitcnt lgkmcnt(10)
    v_mfma_f32_16x16x32_bf16 v[56:59], v[76:79], a[12:15], v[56:59]
    ds_read_b64_tr_b16 v[68:69], v30 offset:8192
    ds_read_b64_tr_b16 v[70:71], v30 offset:9216
    buffer_store_dwordx4 v[52:55], v20, s[4:7], s36 offen offset:320 sc1
    s_waitcnt lgkmcnt(10)
    v_mfma_f32_16x16x32_bf16 v[56:59], v[80:83], a[16:19], v[56:59]
    ds_read_b64_tr_b16 v[72:73], v30 offset:16384
    ds_read_b64_tr_b16 v[74:75], v30 offset:17408
    s_waitcnt lgkmcnt(10)
    v_mfma_f32_16x16x32_bf16 v[56:59], v[84:87], a[20:23], v[56:59]
    ds_read_b64_tr_b16 v[76:77], v30 offset:24576
    ds_read_b64_tr_b16 v[78:79], v30 offset:25600
    s_waitcnt lgkmcnt(10)
    v_mfma_f32_16x16x32_bf16 v[56:59], v[88:91], a[24:27], v[56:59]
    ds_read_b64_tr_b16 v[80:81], v30 offset:32768
    ds_read_b64_tr_b16 v[82:83], v30 offset:33792
    s_waitcnt lgkmcnt(10)
    v_mfma_f32_16x16x32_bf16 v[56:59], v[92:95], a[28:31], v[56:59]
    ds_read_b64_tr_b16 v[84:85], v30 offset:40960
    ds_read_b64_tr_b16 v[86:87], v30 offset:41984
    s_waitcnt lgkmcnt(10)
    v_mfma_f32_16x16x32_bf16 v[56:59], v[64:67], a[32:35], v[56:59]
    ds_read_b64_tr_b16 v[88:89], v30 offset:49152
    ds_read_b64_tr_b16 v[90:91], v30 offset:50176
    s_waitcnt lgkmcnt(10)
    v_mfma_f32_16x16x32_bf16 v[56:59], v[68:71], a[36:39], v[56:59]
    ds_read_b64_tr_b16 v[92:93], v30 offset:57344
    ds_read_b64_tr_b16 v[94:95], v30 offset:58368
    s_waitcnt lgkmcnt(10)
    v_mfma_f32_16x16x32_bf16 v[56:59], v[72:75], a[40:43], v[56:59]
    ds_read_b64_tr_b16 v[64:65], v19 offset:0
    ds_read_b64_tr_b16 v[66:67], v19 offset:1024
    s_waitcnt lgkmcnt(10)
    v_mfma_f32_16x16x32_bf16 v[56:59], v[76:79], a[44:47], v[56:59]
    ds_read_b64_tr_b16 v[68:69], v19 offset:8192
    ds_read_b64_tr_b16 v[70:71], v19 offset:9216
    s_waitcnt lgkmcnt(10)
    v_mfma_f32_16x16x32_bf16 v[56:59], v[80:83], a[48:51], v[56:59]
    ds_read_b64_tr_b16 v[72:73], v19 offset:16384
    ds_read_b64_tr_b16 v[74:75], v19 offset:17408
    s_waitcnt lgkmcnt(10)
    v_mfma_f32_16x16x32_bf16 v[56:59], v[84:87], a[52:55], v[56:59]
    ds_read_b64_tr_b16 v[76:77], v19 offset:24576
    ds_read_b64_tr_b16 v[78:79], v19 offset:25600
    s_waitcnt lgkmcnt(10)
    v_mfma_f32_16x16x32_bf16 v[56:59], v[88:91], a[56:59], v[56:59]
    ds_read_b64_tr_b16 v[80:81], v19 offset:32768
    ds_read_b64_tr_b16 v[82:83], v19 offset:33792
    s_waitcnt lgkmcnt(10)
    v_mfma_f32_16x16x32_bf16 v[56:59], v[92:95], a[60:63], v[56:59]
    ds_read_b64_tr_b16 v[84:85], v19 offset:40960
    ds_read_b64_tr_b16 v[86:87], v19 offset:41984
    s_waitcnt lgkmcnt(10)
    v_mfma_f32_16x16x32_bf16 v[60:63], v[64:67], a[0:3], 0
    ds_read_b64_tr_b16 v[88:89], v19 offset:49152
    ds_read_b64_tr_b16 v[90:91], v19 offset:50176
    s_waitcnt lgkmcnt(10)
    v_mfma_f32_16x16x32_bf16 v[60:63], v[68:71], a[4:7], v[60:63]
    ds_read_b64_tr_b16 v[92:93], v19 offset:57344
    ds_read_b64_tr_b16 v[94:95], v19 offset:58368
    s_waitcnt lgkmcnt(10)
    v_mfma_f32_16x16x32_bf16 v[60:63], v[72:75], a[8:11], v[60:63]
    ds_read_b64_tr_b16 v[64:65], v31 offset:0
    ds_read_b64_tr_b16 v[66:67], v31 offset:1024
    s_waitcnt lgkmcnt(10)
    v_mfma_f32_16x16x32_bf16 v[60:63], v[76:79], a[12:15], v[60:63]
    ds_read_b64_tr_b16 v[68:69], v31 offset:8192
    ds_read_b64_tr_b16 v[70:71], v31 offset:9216
    buffer_store_dwordx4 v[56:59], v20, s[4:7], s36 offen offset:384 sc1
    s_waitcnt lgkmcnt(10)
    v_mfma_f32_16x16x32_bf16 v[60:63], v[80:83], a[16:19], v[60:63]
    ds_read_b64_tr_b16 v[72:73], v31 offset:16384
    ds_read_b64_tr_b16 v[74:75], v31 offset:17408
    s_waitcnt lgkmcnt(10)
    v_mfma_f32_16x16x32_bf16 v[60:63], v[84:87], a[20:23], v[60:63]
    ds_read_b64_tr_b16 v[76:77], v31 offset:24576
    ds_read_b64_tr_b16 v[78:79], v31 offset:25600
    s_waitcnt lgkmcnt(10)
    v_mfma_f32_16x16x32_bf16 v[60:63], v[88:91], a[24:27], v[60:63]
    ds_read_b64_tr_b16 v[80:81], v31 offset:32768
    ds_read_b64_tr_b16 v[82:83], v31 offset:33792
    s_waitcnt lgkmcnt(10)
    v_mfma_f32_16x16x32_bf16 v[60:63], v[92:95], a[28:31], v[60:63]
    ds_read_b64_tr_b16 v[84:85], v31 offset:40960
    ds_read_b64_tr_b16 v[86:87], v31 offset:41984
    s_waitcnt lgkmcnt(10)
    v_mfma_f32_16x16x32_bf16 v[60:63], v[64:67], a[32:35], v[60:63]
    ds_read_b64_tr_b16 v[88:89], v31 offset:49152
    ds_read_b64_tr_b16 v[90:91], v31 offset:50176
    s_waitcnt lgkmcnt(10)
    v_mfma_f32_16x16x32_bf16 v[60:63], v[68:71], a[36:39], v[60:63]
    ds_read_b64_tr_b16 v[92:93], v31 offset:57344
    ds_read_b64_tr_b16 v[94:95], v31 offset:58368
    s_waitcnt lgkmcnt(10)
    v_mfma_f32_16x16x32_bf16 v[60:63], v[72:75], a[40:43], v[60:63]
    s_waitcnt lgkmcnt(8)
    v_mfma_f32_16x16x32_bf16 v[60:63], v[76:79], a[44:47], v[60:63]
    s_waitcnt lgkmcnt(6)
    v_mfma_f32_16x16x32_bf16 v[60:63], v[80:83], a[48:51], v[60:63]
    s_waitcnt lgkmcnt(4)
    v_mfma_f32_16x16x32_bf16 v[60:63], v[84:87], a[52:55], v[60:63]
    s_waitcnt lgkmcnt(2)
    v_mfma_f32_16x16x32_bf16 v[60:63], v[88:91], a[56:59], v[60:63]
    s_waitcnt lgkmcnt(0)
    v_mfma_f32_16x16x32_bf16 v[60:63], v[92:95], a[60:63], v[60:63]
    s_nop 7
    buffer_store_dwordx4 v[60:63], v20, s[4:7], s36 offen offset:448 sc1
    s_waitcnt vmcnt(0)
    s_barrier
    s_cmp_lg_u32 s92, 0
    s_cbranch_scc1 L_g97_done
    s_lshl_b32 s79, s84, 9
    s_lshl_b32 s93, s83, 2
    s_add_u32 s79, s79, s93
    s_add_u32 s79, s79, 3948672
    v_mov_b32 v250, 0
    v_mov_b32 v251, s82
    s_mov_b64 exec, 1
    buffer_store_dword v251, v250, s[4:7], s79 offen
    s_mov_b64 exec, -1
L_g97_done:
    s_mov_b32 s16, s81
    s_load_dwordx2 s[12:13], s[0:1], 0
    v_and_b32 v2, 63, v0
    s_waitcnt lgkmcnt(0)
    s_mov_b32 s40, s12
    s_and_b32 s41, s13, 0xffff
    s_mov_b32 s42, 2097152
    s_mov_b32 s43, 0x00020000
    v_lshlrev_b32 v5, 4, v2
    v_lshlrev_b32 v6, 5, v2
    s_mov_b32 s20, 2101248
    buffer_load_dwordx4 v[16:19], v6, s[4:7], s20 offen offset:0 sc1
    buffer_load_dwordx4 v[20:23], v6, s[4:7], s20 offen offset:16 sc1
    s_mov_b32 s20, 2103296
    buffer_load_dwordx4 v[24:27], v6, s[4:7], s20 offen offset:0 sc1
    buffer_load_dwordx4 v[28:31], v6, s[4:7], s20 offen offset:16 sc1
    s_mov_b32 s20, 2105344
    buffer_load_dwordx4 v[32:35], v6, s[4:7], s20 offen offset:0 sc1
    buffer_load_dwordx4 v[36:39], v6, s[4:7], s20 offen offset:16 sc1
    v_lshrrev_b32 v7, 2, v2
    v_lshlrev_b32 v7, 10, v7
    v_and_b32 v8, 3, v2
    v_lshl_add_u32 v7, v8, 8, v7
    s_lshl_b32 s9, s16, 6
    s_lshl_b32 s10, s83, 1
    s_add_u32 s9, s9, s10
    s_and_b32 s10, s92, 1
    s_add_u32 s9, s9, s10
    s_lshl_b32 s10, s9, 10
    buffer_load_dwordx4 v[8:11], v5, s[40:43], s10 offen
    s_waitcnt vmcnt(0)
    v_lshlrev_b32 v40, 16, v8
    v_and_b32 v41, 0xffff0000, v8
    v_lshlrev_b32 v42, 16, v9
    v_and_b32 v43, 0xffff0000, v9
    v_lshlrev_b32 v44, 16, v10
    v_and_b32 v45, 0xffff0000, v10
    v_lshlrev_b32 v46, 16, v11
    v_and_b32 v47, 0xffff0000, v11
    s_lshl_b32 s11, s9, 11
    s_and_b32 s8, s9, 63
    s_lshl_b32 s18, s84, 7
    s_add_u32 s8, s8, s18
    s_lshl_b32 s15, s8, 11
    s_lshr_b32 s12, s8, 4
    s_lshl_b32 s12, s12, 14
    s_and_b32 s13, s8, 15
    s_lshl_b32 s13, s13, 4
    s_add_u32 s12, s12, s13
    s_add_u32 s12, s12, 104857600
    s_cmp_lg_u32 s92, 0
    s_cbranch_scc1 L_g98_done
    s_lshl_b32 s79, s84, 9
    s_add_u32 s79, s79, 3948672
    v_mbcnt_lo_u32_b32 v250, -1, 0
    v_mbcnt_hi_u32_b32 v250, -1, v250
    v_min_u32 v250, 31, v250
    v_lshlrev_b32 v250, 2, v250
    s_mov_b32 s94, 400000
L_g98_spin:
    buffer_load_dword v251, v250, s[4:7], s79 offen sc1
    s_waitcnt vmcnt(0)
    v_cmp_gt_u32 vcc, s82, v251
    s_cbranch_vccz L_g98_done
    s_sub_u32 s94, s94, 1
    s_cbranch_scc0 L_g98_spin
L_g98_done:
    s_barrier
    s_cmp_ge_u32 s92, 2
    s_cbranch_scc1 L_adaLN_cond__memory_aug_recurrent_mem_tr__dense_activation_gelu__prompt_kernel_pf_ln2_oth
    s_add_u32 s23, s11, 134217728
    buffer_load_dwordx4 v[64:67], v6, s[4:7], s23 offen offset:0 sc1
    buffer_load_dwordx4 v[68:71], v6, s[4:7], s23 offen offset:16 sc1
    s_add_u32 s23, s11, 138412032
    buffer_load_dwordx4 v[72:75], v6, s[4:7], s23 offen offset:0 sc1
    buffer_load_dwordx4 v[76:79], v6, s[4:7], s23 offen offset:16 sc1
    s_add_u32 s23, s11, 142606336
    buffer_load_dwordx4 v[80:83], v6, s[4:7], s23 offen offset:0 sc1
    buffer_load_dwordx4 v[84:87], v6, s[4:7], s23 offen offset:16 sc1
    s_add_u32 s23, s11, 146800640
    buffer_load_dwordx4 v[88:91], v6, s[4:7], s23 offen offset:0 sc1
    buffer_load_dwordx4 v[92:95], v6, s[4:7], s23 offen offset:16 sc1
    s_add_u32 s23, s11, 150994944
    buffer_load_dwordx4 v[96:99], v6, s[4:7], s23 offen offset:0 sc1
    buffer_load_dwordx4 v[100:103], v6, s[4:7], s23 offen offset:16 sc1
    s_add_u32 s23, s11, 155189248
    buffer_load_dwordx4 v[104:107], v6, s[4:7], s23 offen offset:0 sc1
    buffer_load_dwordx4 v[108:111], v6, s[4:7], s23 offen offset:16 sc1
    s_add_u32 s23, s11, 159383552
    buffer_load_dwordx4 v[112:115], v6, s[4:7], s23 offen offset:0 sc1
    buffer_load_dwordx4 v[116:119], v6, s[4:7], s23 offen offset:16 sc1
    s_add_u32 s23, s11, 163577856
    buffer_load_dwordx4 v[120:123], v6, s[4:7], s23 offen offset:0 sc1
    buffer_load_dwordx4 v[124:127], v6, s[4:7], s23 offen offset:16 sc1
    v_and_b32 v53, 63, v0
    v_lshlrev_b32 v53, 4, v53
    s_lshl_b32 s14, s92, 14
    v_add_u32 v52, s14, v53
    ds_write_b128 v52, a[128:131] offset:0
    ds_write_b128 v52, a[132:135] offset:1024
    ds_write_b128 v52, a[136:139] offset:2048
    ds_write_b128 v52, a[140:143] offset:3072
    ds_write_b128 v52, a[144:147] offset:4096
    ds_write_b128 v52, a[148:151] offset:5120
    ds_write_b128 v52, a[152:155] offset:6144
    ds_write_b128 v52, a[156:159] offset:7168
    ds_write_b128 v52, a[160:163] offset:8192
    ds_write_b128 v52, a[164:167] offset:9216
    ds_write_b128 v52, a[168:171] offset:10240
    ds_write_b128 v52, a[172:175] offset:11264
    ds_write_b128 v52, a[176:179] offset:12288
    ds_write_b128 v52, a[180:183] offset:13312
    ds_write_b128 v52, a[184:187] offset:14336
    ds_write_b128 v52, a[188:191] offset:15360
    s_waitcnt vmcnt(13)
    v_pk_add_f32 v[64:65], v[64:65], v[72:73]
    v_pk_add_f32 v[66:67], v[66:67], v[74:75]
    s_waitcnt vmcnt(12)
    v_pk_add_f32 v[68:69], v[68:69], v[76:77]
    v_pk_add_f32 v[70:71], v[70:71], v[78:79]
    s_waitcnt vmcnt(11)
    v_pk_add_f32 v[64:65], v[64:65], v[80:81]
    v_pk_add_f32 v[66:67], v[66:67], v[82:83]
    s_waitcnt vmcnt(10)
    v_pk_add_f32 v[68:69], v[68:69], v[84:85]
    v_pk_add_f32 v[70:71], v[70:71], v[86:87]
    s_waitcnt vmcnt(9)
    v_pk_add_f32 v[64:65], v[64:65], v[88:89]
    v_pk_add_f32 v[66:67], v[66:67], v[90:91]
    s_waitcnt vmcnt(8)
    v_pk_add_f32 v[68:69], v[68:69], v[92:93]
    v_pk_add_f32 v[70:71], v[70:71], v[94:95]
    s_waitcnt vmcnt(7)
    v_pk_add_f32 v[64:65], v[64:65], v[96:97]
    v_pk_add_f32 v[66:67], v[66:67], v[98:99]
    s_waitcnt vmcnt(6)
    v_pk_add_f32 v[68:69], v[68:69], v[100:101]
    v_pk_add_f32 v[70:71], v[70:71], v[102:103]
    s_waitcnt vmcnt(5)
    v_pk_add_f32 v[64:65], v[64:65], v[104:105]
    v_pk_add_f32 v[66:67], v[66:67], v[106:107]
    s_waitcnt vmcnt(4)
    v_pk_add_f32 v[68:69], v[68:69], v[108:109]
    v_pk_add_f32 v[70:71], v[70:71], v[110:111]
    s_waitcnt vmcnt(3)
    v_pk_add_f32 v[64:65], v[64:65], v[112:113]
    v_pk_add_f32 v[66:67], v[66:67], v[114:115]
    s_waitcnt vmcnt(2)
    v_pk_add_f32 v[68:69], v[68:69], v[116:117]
    v_pk_add_f32 v[70:71], v[70:71], v[118:119]
    s_waitcnt vmcnt(1)
    v_pk_add_f32 v[64:65], v[64:65], v[120:121]
    v_pk_add_f32 v[66:67], v[66:67], v[122:123]
    s_waitcnt vmcnt(0)
    v_pk_add_f32 v[68:69], v[68:69], v[124:125]
    v_pk_add_f32 v[70:71], v[70:71], v[126:127]
    v_fmac_f32 v40, v16, v64
    v_fmac_f32 v41, v17, v65
    v_fmac_f32 v42, v18, v66
    v_fmac_f32 v43, v19, v67
    v_fmac_f32 v44, v20, v68
    v_fmac_f32 v45, v21, v69
    v_fmac_f32 v46, v22, v70
    v_fmac_f32 v47, v23, v71
    s_add_u32 s23, s15, 100663296
    buffer_store_dwordx4 v[40:43], v6, s[4:7], s23 offen offset:0
    buffer_store_dwordx4 v[44:47], v6, s[4:7], s23 offen offset:16
    v_add_f32 v13, v40, v41
    v_add_f32 v13, v13, v42
    v_add_f32 v13, v13, v43
    v_add_f32 v13, v13, v44
    v_add_f32 v13, v13, v45
    v_add_f32 v13, v13, v46
    v_add_f32 v13, v13, v47
    s_nop 1
    v_add_f32_dpp v13, v13, v13 row_ror:1 row_mask:0xf bank_mask:0xf
    s_nop 1
    v_add_f32_dpp v13, v13, v13 row_ror:2 row_mask:0xf bank_mask:0xf
    s_nop 1
    v_add_f32_dpp v13, v13, v13 row_ror:4 row_mask:0xf bank_mask:0xf
    s_nop 1
    v_add_f32_dpp v13, v13, v13 row_ror:8 row_mask:0xf bank_mask:0xf
    v_mov_b32 v12, v13
    s_nop 1
    v_permlane16_swap_b32 v13, v12
    v_add_f32 v13, v13, v12
    v_mov_b32 v12, v13
    s_nop 1
    v_permlane32_swap_b32 v13, v12
    v_add_f32 v13, v13, v12
    v_mul_f32 v13, 0x3b000000, v13
    v_sub_f32 v56, v40, v13
    v_sub_f32 v57, v41, v13
    v_sub_f32 v58, v42, v13
    v_sub_f32 v59, v43, v13
    v_sub_f32 v60, v44, v13
    v_sub_f32 v61, v45, v13
    v_sub_f32 v62, v46, v13
    v_sub_f32 v63, v47, v13
    v_mul_f32 v14, v56, v56
    v_fmac_f32 v14, v57, v57
    v_fmac_f32 v14, v58, v58
    v_fmac_f32 v14, v59, v59
    v_fmac_f32 v14, v60, v60
    v_fmac_f32 v14, v61, v61
    v_fmac_f32 v14, v62, v62
    v_fmac_f32 v14, v63, v63
    s_nop 1
    v_add_f32_dpp v14, v14, v14 row_ror:1 row_mask:0xf bank_mask:0xf
    s_nop 1
    v_add_f32_dpp v14, v14, v14 row_ror:2 row_mask:0xf bank_mask:0xf
    s_nop 1
    v_add_f32_dpp v14, v14, v14 row_ror:4 row_mask:0xf bank_mask:0xf
    s_nop 1
    v_add_f32_dpp v14, v14, v14 row_ror:8 row_mask:0xf bank_mask:0xf
    v_mov_b32 v12, v14
    s_nop 1
    v_permlane16_swap_b32 v14, v12
    v_add_f32 v14, v14, v12
    v_mov_b32 v12, v14
    s_nop 1
    v_permlane32_swap_b32 v14, v12
    v_add_f32 v14, v14, v12
    v_mov_b32 v15, 0x3727c5ac
    v_fmac_f32 v15, 0x3b000000, v14
    v_rsq_f32 v15, v15
    s_nop 0
    v_mul_f32 v56, v56, v15
    v_fma_f32 v56, v56, v32, v24
    v_mul_f32 v57, v57, v15
    v_fma_f32 v57, v57, v33, v25
    v_mul_f32 v58, v58, v15
    v_fma_f32 v58, v58, v34, v26
    v_mul_f32 v59, v59, v15
    v_fma_f32 v59, v59, v35, v27
    v_mul_f32 v60, v60, v15
    v_fma_f32 v60, v60, v36, v28
    v_mul_f32 v61, v61, v15
    v_fma_f32 v61, v61, v37, v29
    v_mul_f32 v62, v62, v15
    v_fma_f32 v62, v62, v38, v30
    v_mul_f32 v63, v63, v15
    v_fma_f32 v63, v63, v39, v31
    v_cvt_pk_bf16_f32 v48, v56, v57
    v_cvt_pk_bf16_f32 v49, v58, v59
    v_cvt_pk_bf16_f32 v50, v60, v61
    v_cvt_pk_bf16_f32 v51, v62, v63
    buffer_store_dwordx4 v[48:51], v7, s[4:7], s12 offen
    s_branch L_adaLN_cond__memory_aug_recurrent_mem_tr__dense_activation_gelu__prompt_kernel_pf_ln2_end
L_adaLN_cond__memory_aug_recurrent_mem_tr__dense_activation_gelu__prompt_kernel_pf_ln2_oth:
    v_and_b32 v53, 63, v0
    v_lshlrev_b32 v53, 4, v53
    s_lshl_b32 s14, s92, 14
    v_add_u32 v52, s14, v53
    ds_write_b128 v52, a[128:131] offset:0
    ds_write_b128 v52, a[132:135] offset:1024
    ds_write_b128 v52, a[136:139] offset:2048
    ds_write_b128 v52, a[140:143] offset:3072
    ds_write_b128 v52, a[144:147] offset:4096
    ds_write_b128 v52, a[148:151] offset:5120
    ds_write_b128 v52, a[152:155] offset:6144
    ds_write_b128 v52, a[156:159] offset:7168
    ds_write_b128 v52, a[160:163] offset:8192
    ds_write_b128 v52, a[164:167] offset:9216
    ds_write_b128 v52, a[168:171] offset:10240
    ds_write_b128 v52, a[172:175] offset:11264
    ds_write_b128 v52, a[176:179] offset:12288
    ds_write_b128 v52, a[180:183] offset:13312
    ds_write_b128 v52, a[184:187] offset:14336
    ds_write_b128 v52, a[188:191] offset:15360
L_adaLN_cond__memory_aug_recurrent_mem_tr__dense_activation_gelu__prompt_kernel_pf_ln2_end:
    s_waitcnt lgkmcnt(0)
    s_waitcnt vmcnt(0)
    s_barrier
    s_cmp_lg_u32 s92, 0
    s_cbranch_scc1 L_g99_done
    s_lshl_b32 s79, s84, 9
    s_lshl_b32 s93, s83, 2
    s_add_u32 s79, s79, s93
    s_add_u32 s79, s79, 3948800
    v_mov_b32 v250, 0
    v_mov_b32 v251, s82
    s_mov_b64 exec, 1
    buffer_store_dword v251, v250, s[4:7], s79 offen
    s_mov_b64 exec, -1
L_g99_done:
    s_cmp_ge_u32 s83, 22
    s_cbranch_scc1 L_adaLN_cond__memory_aug_recurrent_mem_tr__dense_activation_gelu__prompt_kernel_pf_nof1b
    s_mov_b32 s16, s81
    s_lshl_b32 s10, s83, 6
    s_mov_b32 s11, 0
    s_load_dwordx2 s[66:67], s[0:1], 72
    v_and_b32 v2, 63, v0
    v_lshlrev_b32 v3, 4, v2
    v_and_b32 v4, 15, v2
    v_lshrrev_b32 v5, 4, v2
    v_lshrrev_b32 v20, 2, v4
    v_lshl_add_u32 v23, v5, 3, v20
    v_bfe_u32 v22, v23, 1, 1
    v_bfe_u32 v21, v23, 3, 1
    v_lshl_or_b32 v22, v21, 1, v22
    v_mul_u32_u24 v21, 128, v23
    v_and_b32 v23, 3, v2
    v_lshl_add_u32 v21, v23, 3, v21
    v_xor_b32 v23, 0, v22
    v_lshl_add_u32 v12, v23, 5, v21
    v_add_u32 v24, 0x10000, v12
    v_xor_b32 v23, 1, v22
    v_lshl_add_u32 v13, v23, 5, v21
    v_add_u32 v25, 0x10000, v13
    v_xor_b32 v23, 2, v22
    v_lshl_add_u32 v14, v23, 5, v21
    v_add_u32 v26, 0x10000, v14
    v_xor_b32 v23, 3, v22
    v_lshl_add_u32 v15, v23, 5, v21
    v_add_u32 v27, 0x10000, v15
    s_waitcnt lgkmcnt(0)
    s_mov_b32 s48, s66
    s_and_b32 s49, s67, 0xffff
    s_mov_b32 s50, 2752
    s_mov_b32 s51, 0x00020000
    v_lshlrev_b32 v20, 3, v5
    s_lshl_b32 s37, s10, 1
    buffer_load_dwordx2 v[96:97], v20, s[48:51], s37 offen offset:0
    buffer_load_dwordx2 v[98:99], v20, s[48:51], s37 offen offset:32
    buffer_load_dwordx2 v[100:101], v20, s[48:51], s37 offen offset:64
    buffer_load_dwordx2 v[102:103], v20, s[48:51], s37 offen offset:96
    s_cmp_lg_u32 s92, 0
    s_cbranch_scc1 L_g100_done
    s_lshl_b32 s79, s84, 9
    s_add_u32 s79, s79, 3948800
    v_mbcnt_lo_u32_b32 v250, -1, 0
    v_mbcnt_hi_u32_b32 v250, -1, v250
    v_min_u32 v250, 31, v250
    v_lshlrev_b32 v250, 2, v250
    s_mov_b32 s94, 400000
L_g100_spin:
    buffer_load_dword v251, v250, s[4:7], s79 offen sc1
    s_waitcnt vmcnt(0)
    v_cmp_gt_u32 vcc, s82, v251
    s_cbranch_vccz L_g100_done
    s_sub_u32 s94, s94, 1
    s_cbranch_scc0 L_g100_spin
L_g100_done:
    s_barrier
    s_lshl_b32 s9, s16, 2
    s_add_u32 s9, s9, s92
    s_and_b32 s8, s9, 3
    s_lshl_b32 s18, s84, 3
    s_add_u32 s8, s8, s18
    s_mul_i32 s23, s8, 16384
    s_lshl_b32 s24, s11, 10
    s_add_u32 s23, s23, s24
    s_add_u32 s23, s23, 104857600
    s_add_u32 s24, s23, 16384
    buffer_load_dwordx4 a[0:3], v3, s[4:7], s23 offen offset:0 sc1
    buffer_load_dwordx4 a[4:7], v3, s[4:7], s23 offen offset:1024 sc1
    buffer_load_dwordx4 a[8:11], v3, s[4:7], s23 offen offset:2048 sc1
    buffer_load_dwordx4 a[12:15], v3, s[4:7], s23 offen offset:3072 sc1
    s_add_u32 s23, s23, 4096
    buffer_load_dwordx4 a[16:19], v3, s[4:7], s23 offen offset:0 sc1
    buffer_load_dwordx4 a[20:23], v3, s[4:7], s23 offen offset:1024 sc1
    buffer_load_dwordx4 a[24:27], v3, s[4:7], s23 offen offset:2048 sc1
    buffer_load_dwordx4 a[28:31], v3, s[4:7], s23 offen offset:3072 sc1
    s_add_u32 s23, s23, 4096
    buffer_load_dwordx4 a[32:35], v3, s[4:7], s23 offen offset:0 sc1
    buffer_load_dwordx4 a[36:39], v3, s[4:7], s23 offen offset:1024 sc1
    buffer_load_dwordx4 a[40:43], v3, s[4:7], s23 offen offset:2048 sc1
    buffer_load_dwordx4 a[44:47], v3, s[4:7], s23 offen offset:3072 sc1
    s_add_u32 s23, s23, 4096
    buffer_load_dwordx4 a[48:51], v3, s[4:7], s23 offen offset:0 sc1
    buffer_load_dwordx4 a[52:55], v3, s[4:7], s23 offen offset:1024 sc1
    buffer_load_dwordx4 a[56:59], v3, s[4:7], s23 offen offset:2048 sc1
    buffer_load_dwordx4 a[60:63], v3, s[4:7], s23 offen offset:3072 sc1
    ds_read_b64_tr_b16 v[48:49], v12 offset:0
    ds_read_b64_tr_b16 v[50:51], v12 offset:512
    ds_read_b64_tr_b16 v[52:53], v13 offset:0
    ds_read_b64_tr_b16 v[54:55], v13 offset:512
    ds_read_b64_tr_b16 v[56:57], v14 offset:0
    ds_read_b64_tr_b16 v[58:59], v14 offset:512
    ds_read_b64_tr_b16 v[60:61], v15 offset:0
    ds_read_b64_tr_b16 v[62:63], v15 offset:512
    ds_read_b64_tr_b16 v[64:65], v12 offset:4096
    ds_read_b64_tr_b16 v[66:67], v12 offset:4608
    ds_read_b64_tr_b16 v[68:69], v13 offset:4096
    ds_read_b64_tr_b16 v[70:71], v13 offset:4608
    s_waitcnt vmcnt(15) lgkmcnt(10)
    v_mfma_f32_16x16x32_bf16 v[32:35], v[48:51], a[0:3], 0
    ds_read_b64_tr_b16 v[72:73], v14 offset:4096
    ds_read_b64_tr_b16 v[74:75], v14 offset:4608
    s_waitcnt lgkmcnt(10)
    v_mfma_f32_16x16x32_bf16 v[36:39], v[52:55], a[0:3], 0
    ds_read_b64_tr_b16 v[76:77], v15 offset:4096
    ds_read_b64_tr_b16 v[78:79], v15 offset:4608
    s_waitcnt lgkmcnt(10)
    v_mfma_f32_16x16x32_bf16 v[40:43], v[56:59], a[0:3], 0
    ds_read_b64_tr_b16 v[48:49], v12 offset:8192
    ds_read_b64_tr_b16 v[50:51], v12 offset:8704
    s_waitcnt lgkmcnt(10)
    v_mfma_f32_16x16x32_bf16 v[44:47], v[60:63], a[0:3], 0
    ds_read_b64_tr_b16 v[52:53], v13 offset:8192
    ds_read_b64_tr_b16 v[54:55], v13 offset:8704
    s_waitcnt vmcnt(14) lgkmcnt(10)
    v_mfma_f32_16x16x32_bf16 v[32:35], v[64:67], a[4:7], v[32:35]
    ds_read_b64_tr_b16 v[56:57], v14 offset:8192
    ds_read_b64_tr_b16 v[58:59], v14 offset:8704
    s_waitcnt lgkmcnt(10)
    v_mfma_f32_16x16x32_bf16 v[36:39], v[68:71], a[4:7], v[36:39]
    ds_read_b64_tr_b16 v[60:61], v15 offset:8192
    ds_read_b64_tr_b16 v[62:63], v15 offset:8704
    s_waitcnt lgkmcnt(10)
    v_mfma_f32_16x16x32_bf16 v[40:43], v[72:75], a[4:7], v[40:43]
    ds_read_b64_tr_b16 v[64:65], v12 offset:12288
    ds_read_b64_tr_b16 v[66:67], v12 offset:12800
    s_waitcnt lgkmcnt(10)
    v_mfma_f32_16x16x32_bf16 v[44:47], v[76:79], a[4:7], v[44:47]
    ds_read_b64_tr_b16 v[68:69], v13 offset:12288
    ds_read_b64_tr_b16 v[70:71], v13 offset:12800
    s_waitcnt vmcnt(13) lgkmcnt(10)
    v_mfma_f32_16x16x32_bf16 v[32:35], v[48:51], a[8:11], v[32:35]
    ds_read_b64_tr_b16 v[72:73], v14 offset:12288
    ds_read_b64_tr_b16 v[74:75], v14 offset:12800
    s_waitcnt lgkmcnt(10)
    v_mfma_f32_16x16x32_bf16 v[36:39], v[52:55], a[8:11], v[36:39]
    ds_read_b64_tr_b16 v[76:77], v15 offset:12288
    ds_read_b64_tr_b16 v[78:79], v15 offset:12800
    s_waitcnt lgkmcnt(10)
    v_mfma_f32_16x16x32_bf16 v[40:43], v[56:59], a[8:11], v[40:43]
    ds_read_b64_tr_b16 v[48:49], v12 offset:16384
    ds_read_b64_tr_b16 v[50:51], v12 offset:16896
    s_waitcnt lgkmcnt(10)
    v_mfma_f32_16x16x32_bf16 v[44:47], v[60:63], a[8:11], v[44:47]
    ds_read_b64_tr_b16 v[52:53], v13 offset:16384
    ds_read_b64_tr_b16 v[54:55], v13 offset:16896
    s_waitcnt vmcnt(12) lgkmcnt(10)
    v_mfma_f32_16x16x32_bf16 v[32:35], v[64:67], a[12:15], v[32:35]
    ds_read_b64_tr_b16 v[56:57], v14 offset:16384
    ds_read_b64_tr_b16 v[58:59], v14 offset:16896
    s_waitcnt lgkmcnt(10)
    v_mfma_f32_16x16x32_bf16 v[36:39], v[68:71], a[12:15], v[36:39]
    ds_read_b64_tr_b16 v[60:61], v15 offset:16384
    ds_read_b64_tr_b16 v[62:63], v15 offset:16896
    s_waitcnt lgkmcnt(10)
    v_mfma_f32_16x16x32_bf16 v[40:43], v[72:75], a[12:15], v[40:43]
    ds_read_b64_tr_b16 v[64:65], v12 offset:20480
    ds_read_b64_tr_b16 v[66:67], v12 offset:20992
    s_waitcnt lgkmcnt(10)
    v_mfma_f32_16x16x32_bf16 v[44:47], v[76:79], a[12:15], v[44:47]
    ds_read_b64_tr_b16 v[68:69], v13 offset:20480
    ds_read_b64_tr_b16 v[70:71], v13 offset:20992
    s_waitcnt vmcnt(11) lgkmcnt(10)
    v_mfma_f32_16x16x32_bf16 v[32:35], v[48:51], a[16:19], v[32:35]
    ds_read_b64_tr_b16 v[72:73], v14 offset:20480
    ds_read_b64_tr_b16 v[74:75], v14 offset:20992
    s_waitcnt lgkmcnt(10)
    v_mfma_f32_16x16x32_bf16 v[36:39], v[52:55], a[16:19], v[36:39]
    ds_read_b64_tr_b16 v[76:77], v15 offset:20480
    ds_read_b64_tr_b16 v[78:79], v15 offset:20992
    s_waitcnt lgkmcnt(10)
    v_mfma_f32_16x16x32_bf16 v[40:43], v[56:59], a[16:19], v[40:43]
    ds_read_b64_tr_b16 v[48:49], v12 offset:24576
    ds_read_b64_tr_b16 v[50:51], v12 offset:25088
    s_waitcnt lgkmcnt(10)
    v_mfma_f32_16x16x32_bf16 v[44:47], v[60:63], a[16:19], v[44:47]
    ds_read_b64_tr_b16 v[52:53], v13 offset:24576
    ds_read_b64_tr_b16 v[54:55], v13 offset:25088
    s_waitcnt vmcnt(10) lgkmcnt(10)
    v_mfma_f32_16x16x32_bf16 v[32:35], v[64:67], a[20:23], v[32:35]
    ds_read_b64_tr_b16 v[56:57], v14 offset:24576
    ds_read_b64_tr_b16 v[58:59], v14 offset:25088
    s_waitcnt lgkmcnt(10)
    v_mfma_f32_16x16x32_bf16 v[36:39], v[68:71], a[20:23], v[36:39]
    ds_read_b64_tr_b16 v[60:61], v15 offset:24576
    ds_read_b64_tr_b16 v[62:63], v15 offset:25088
    s_waitcnt lgkmcnt(10)
    v_mfma_f32_16x16x32_bf16 v[40:43], v[72:75], a[20:23], v[40:43]
    ds_read_b64_tr_b16 v[64:65], v12 offset:28672
    ds_read_b64_tr_b16 v[66:67], v12 offset:29184
    s_waitcnt lgkmcnt(10)
    v_mfma_f32_16x16x32_bf16 v[44:47], v[76:79], a[20:23], v[44:47]
    ds_read_b64_tr_b16 v[68:69], v13 offset:28672
    ds_read_b64_tr_b16 v[70:71], v13 offset:29184
    s_waitcnt vmcnt(9) lgkmcnt(10)
    v_mfma_f32_16x16x32_bf16 v[32:35], v[48:51], a[24:27], v[32:35]
    ds_read_b64_tr_b16 v[72:73], v14 offset:28672
    ds_read_b64_tr_b16 v[74:75], v14 offset:29184
    s_waitcnt lgkmcnt(10)
    v_mfma_f32_16x16x32_bf16 v[36:39], v[52:55], a[24:27], v[36:39]
    ds_read_b64_tr_b16 v[76:77], v15 offset:28672
    ds_read_b64_tr_b16 v[78:79], v15 offset:29184
    s_waitcnt lgkmcnt(10)
    v_mfma_f32_16x16x32_bf16 v[40:43], v[56:59], a[24:27], v[40:43]
    ds_read_b64_tr_b16 v[48:49], v12 offset:32768
    ds_read_b64_tr_b16 v[50:51], v12 offset:33280
    s_waitcnt lgkmcnt(10)
    v_mfma_f32_16x16x32_bf16 v[44:47], v[60:63], a[24:27], v[44:47]
    ds_read_b64_tr_b16 v[52:53], v13 offset:32768
    ds_read_b64_tr_b16 v[54:55], v13 offset:33280
    s_waitcnt vmcnt(8) lgkmcnt(10)
    v_mfma_f32_16x16x32_bf16 v[32:35], v[64:67], a[28:31], v[32:35]
    ds_read_b64_tr_b16 v[56:57], v14 offset:32768
    ds_read_b64_tr_b16 v[58:59], v14 offset:33280
    s_waitcnt lgkmcnt(10)
    v_mfma_f32_16x16x32_bf16 v[36:39], v[68:71], a[28:31], v[36:39]
    ds_read_b64_tr_b16 v[60:61], v15 offset:32768
    ds_read_b64_tr_b16 v[62:63], v15 offset:33280
    s_waitcnt lgkmcnt(10)
    v_mfma_f32_16x16x32_bf16 v[40:43], v[72:75], a[28:31], v[40:43]
    ds_read_b64_tr_b16 v[64:65], v12 offset:36864
    ds_read_b64_tr_b16 v[66:67], v12 offset:37376
    s_waitcnt lgkmcnt(10)
    v_mfma_f32_16x16x32_bf16 v[44:47], v[76:79], a[28:31], v[44:47]
    ds_read_b64_tr_b16 v[68:69], v13 offset:36864
    ds_read_b64_tr_b16 v[70:71], v13 offset:37376
    s_waitcnt vmcnt(7) lgkmcnt(10)
    v_mfma_f32_16x16x32_bf16 v[32:35], v[48:51], a[32:35], v[32:35]
    ds_read_b64_tr_b16 v[72:73], v14 offset:36864
    ds_read_b64_tr_b16 v[74:75], v14 offset:37376
    s_waitcnt lgkmcnt(10)
    v_mfma_f32_16x16x32_bf16 v[36:39], v[52:55], a[32:35], v[36:39]
    ds_read_b64_tr_b16 v[76:77], v15 offset:36864
    ds_read_b64_tr_b16 v[78:79], v15 offset:37376
    s_waitcnt lgkmcnt(10)
    v_mfma_f32_16x16x32_bf16 v[40:43], v[56:59], a[32:35], v[40:43]
    ds_read_b64_tr_b16 v[48:49], v12 offset:40960
    ds_read_b64_tr_b16 v[50:51], v12 offset:41472
    s_waitcnt lgkmcnt(10)
    v_mfma_f32_16x16x32_bf16 v[44:47], v[60:63], a[32:35], v[44:47]
    ds_read_b64_tr_b16 v[52:53], v13 offset:40960
    ds_read_b64_tr_b16 v[54:55], v13 offset:41472
    s_waitcnt vmcnt(6) lgkmcnt(10)
    v_mfma_f32_16x16x32_bf16 v[32:35], v[64:67], a[36:39], v[32:35]
    ds_read_b64_tr_b16 v[56:57], v14 offset:40960
    ds_read_b64_tr_b16 v[58:59], v14 offset:41472
    s_waitcnt lgkmcnt(10)
    v_mfma_f32_16x16x32_bf16 v[36:39], v[68:71], a[36:39], v[36:39]
    ds_read_b64_tr_b16 v[60:61], v15 offset:40960
    ds_read_b64_tr_b16 v[62:63], v15 offset:41472
    s_waitcnt lgkmcnt(10)
    v_mfma_f32_16x16x32_bf16 v[40:43], v[72:75], a[36:39], v[40:43]
    ds_read_b64_tr_b16 v[64:65], v12 offset:45056
    ds_read_b64_tr_b16 v[66:67], v12 offset:45568
    s_waitcnt lgkmcnt(10)
    v_mfma_f32_16x16x32_bf16 v[44:47], v[76:79], a[36:39], v[44:47]
    ds_read_b64_tr_b16 v[68:69], v13 offset:45056
    ds_read_b64_tr_b16 v[70:71], v13 offset:45568
    s_waitcnt vmcnt(5) lgkmcnt(10)
    v_mfma_f32_16x16x32_bf16 v[32:35], v[48:51], a[40:43], v[32:35]
    ds_read_b64_tr_b16 v[72:73], v14 offset:45056
    ds_read_b64_tr_b16 v[74:75], v14 offset:45568
    s_waitcnt lgkmcnt(10)
    v_mfma_f32_16x16x32_bf16 v[36:39], v[52:55], a[40:43], v[36:39]
    ds_read_b64_tr_b16 v[76:77], v15 offset:45056
    ds_read_b64_tr_b16 v[78:79], v15 offset:45568
    s_waitcnt lgkmcnt(10)
    v_mfma_f32_16x16x32_bf16 v[40:43], v[56:59], a[40:43], v[40:43]
    ds_read_b64_tr_b16 v[48:49], v12 offset:49152
    ds_read_b64_tr_b16 v[50:51], v12 offset:49664
    s_waitcnt lgkmcnt(10)
    v_mfma_f32_16x16x32_bf16 v[44:47], v[60:63], a[40:43], v[44:47]
    ds_read_b64_tr_b16 v[52:53], v13 offset:49152
    ds_read_b64_tr_b16 v[54:55], v13 offset:49664
    s_waitcnt vmcnt(4) lgkmcnt(10)
    v_mfma_f32_16x16x32_bf16 v[32:35], v[64:67], a[44:47], v[32:35]
    ds_read_b64_tr_b16 v[56:57], v14 offset:49152
    ds_read_b64_tr_b16 v[58:59], v14 offset:49664
    s_waitcnt lgkmcnt(10)
    v_mfma_f32_16x16x32_bf16 v[36:39], v[68:71], a[44:47], v[36:39]
    ds_read_b64_tr_b16 v[60:61], v15 offset:49152
    ds_read_b64_tr_b16 v[62:63], v15 offset:49664
    s_waitcnt lgkmcnt(10)
    v_mfma_f32_16x16x32_bf16 v[40:43], v[72:75], a[44:47], v[40:43]
    ds_read_b64_tr_b16 v[64:65], v12 offset:53248
    ds_read_b64_tr_b16 v[66:67], v12 offset:53760
    s_waitcnt lgkmcnt(10)
    v_mfma_f32_16x16x32_bf16 v[44:47], v[76:79], a[44:47], v[44:47]
    ds_read_b64_tr_b16 v[68:69], v13 offset:53248
    ds_read_b64_tr_b16 v[70:71], v13 offset:53760
    s_waitcnt vmcnt(3) lgkmcnt(10)
    v_mfma_f32_16x16x32_bf16 v[32:35], v[48:51], a[48:51], v[32:35]
    ds_read_b64_tr_b16 v[72:73], v14 offset:53248
    ds_read_b64_tr_b16 v[74:75], v14 offset:53760
    s_waitcnt lgkmcnt(10)
    v_mfma_f32_16x16x32_bf16 v[36:39], v[52:55], a[48:51], v[36:39]
    ds_read_b64_tr_b16 v[76:77], v15 offset:53248
    ds_read_b64_tr_b16 v[78:79], v15 offset:53760
    s_waitcnt lgkmcnt(10)
    v_mfma_f32_16x16x32_bf16 v[40:43], v[56:59], a[48:51], v[40:43]
    ds_read_b64_tr_b16 v[48:49], v12 offset:57344
    ds_read_b64_tr_b16 v[50:51], v12 offset:57856
    s_waitcnt lgkmcnt(10)
    v_mfma_f32_16x16x32_bf16 v[44:47], v[60:63], a[48:51], v[44:47]
    ds_read_b64_tr_b16 v[52:53], v13 offset:57344
    ds_read_b64_tr_b16 v[54:55], v13 offset:57856
    s_waitcnt vmcnt(2) lgkmcnt(10)
    v_mfma_f32_16x16x32_bf16 v[32:35], v[64:67], a[52:55], v[32:35]
    ds_read_b64_tr_b16 v[56:57], v14 offset:57344
    ds_read_b64_tr_b16 v[58:59], v14 offset:57856
    s_waitcnt lgkmcnt(10)
    v_mfma_f32_16x16x32_bf16 v[36:39], v[68:71], a[52:55], v[36:39]
    ds_read_b64_tr_b16 v[60:61], v15 offset:57344
    ds_read_b64_tr_b16 v[62:63], v15 offset:57856
    s_waitcnt lgkmcnt(10)
    v_mfma_f32_16x16x32_bf16 v[40:43], v[72:75], a[52:55], v[40:43]
    ds_read_b64_tr_b16 v[64:65], v12 offset:61440
    ds_read_b64_tr_b16 v[66:67], v12 offset:61952
    s_waitcnt lgkmcnt(10)
    v_mfma_f32_16x16x32_bf16 v[44:47], v[76:79], a[52:55], v[44:47]
    ds_read_b64_tr_b16 v[68:69], v13 offset:61440
    ds_read_b64_tr_b16 v[70:71], v13 offset:61952
    s_waitcnt vmcnt(1) lgkmcnt(10)
    v_mfma_f32_16x16x32_bf16 v[32:35], v[48:51], a[56:59], v[32:35]
    ds_read_b64_tr_b16 v[72:73], v14 offset:61440
    ds_read_b64_tr_b16 v[74:75], v14 offset:61952
    s_waitcnt lgkmcnt(10)
    v_mfma_f32_16x16x32_bf16 v[36:39], v[52:55], a[56:59], v[36:39]
    ds_read_b64_tr_b16 v[76:77], v15 offset:61440
    ds_read_b64_tr_b16 v[78:79], v15 offset:61952
    s_waitcnt lgkmcnt(10)
    v_mfma_f32_16x16x32_bf16 v[40:43], v[56:59], a[56:59], v[40:43]
    s_waitcnt lgkmcnt(8)
    v_mfma_f32_16x16x32_bf16 v[44:47], v[60:63], a[56:59], v[44:47]
    s_waitcnt vmcnt(0) lgkmcnt(6)
    v_mfma_f32_16x16x32_bf16 v[32:35], v[64:67], a[60:63], v[32:35]
    s_waitcnt lgkmcnt(4)
    v_mfma_f32_16x16x32_bf16 v[36:39], v[68:71], a[60:63], v[36:39]
    s_waitcnt lgkmcnt(2)
    v_mfma_f32_16x16x32_bf16 v[40:43], v[72:75], a[60:63], v[40:43]
    s_waitcnt lgkmcnt(0)
    v_mfma_f32_16x16x32_bf16 v[44:47], v[76:79], a[60:63], v[44:47]
    v_and_b32 v197, 63, v0
    v_lshlrev_b32 v197, 4, v197
    s_mul_i32 s40, s92, 22528
    s_add_u32 s40, s40, 65536
    v_add_u32 v197, s40, v197
    ds_write_b128 v197, a[192:195] offset:0
    ds_write_b128 v197, a[196:199] offset:1024
    ds_write_b128 v197, a[200:203] offset:2048
    ds_write_b128 v197, a[204:207] offset:3072
    ds_write_b128 v197, a[208:211] offset:4096
    ds_write_b128 v197, a[212:215] offset:5120
    ds_write_b128 v197, a[216:219] offset:6144
    ds_write_b128 v197, a[220:223] offset:7168
    ds_write_b128 v197, a[224:227] offset:8192
    ds_write_b128 v197, a[228:231] offset:9216
    ds_write_b128 v197, a[232:235] offset:10240
    ds_write_b128 v197, a[236:239] offset:11264
    ds_write_b128 v197, a[240:243] offset:12288
    ds_write_b128 v197, a[244:247] offset:13312
    ds_write_b128 v197, a[248:251] offset:14336
    ds_write_b128 v197, v[200:203] offset:15360
    ds_write_b128 v197, v[204:207] offset:16384
    ds_write_b128 v197, v[208:211] offset:17408
    ds_write_b128 v197, v[212:215] offset:18432
    ds_write_b128 v197, v[216:219] offset:19456
    ds_write_b128 v197, v[220:223] offset:20480
    ds_write_b128 v197, v[224:227] offset:21504
    s_mul_i32 s36, s8, 44032
    s_lshr_b32 s38, s10, 5
    s_lshl_b32 s39, s38, 10
    s_add_u32 s36, s36, s39
    s_add_u32 s36, s36, 109051904
    s_mov_b32 s52, 0x3d372713
    s_mov_b32 s54, 0x40135761
    s_mov_b32 s55, 0x40135761
    s_mov_b32 s56, 1.0
    s_mov_b32 s57, 1.0
    v_lshlrev_b32 v88, 16, v96
    v_and_b32 v89, 0xffff0000, v96
    v_lshlrev_b32 v90, 16, v97
    v_and_b32 v91, 0xffff0000, v97
    v_pk_add_f32 v[32:33], v[32:33], v[88:89]
    v_pk_add_f32 v[34:35], v[34:35], v[90:91]
    v_pk_mul_f32 v[88:89], v[32:33], v[32:33]
    v_pk_mul_f32 v[90:91], v[34:35], v[34:35]
    v_fma_f32 v88, v88, s52, 1.0
    v_fma_f32 v89, v89, s52, 1.0
    v_fma_f32 v90, v90, s52, 1.0
    v_fma_f32 v91, v91, s52, 1.0
    v_pk_mul_f32 v[88:89], v[88:89], v[32:33]
    v_pk_mul_f32 v[90:91], v[90:91], v[34:35]
    v_pk_mul_f32 v[88:89], v[88:89], s[54:55]
    v_pk_mul_f32 v[90:91], v[90:91], s[54:55]
    v_exp_f32 v88, -v88
    v_exp_f32 v89, -v89
    v_exp_f32 v90, -v90
    v_exp_f32 v91, -v91
    v_pk_add_f32 v[88:89], v[88:89], s[56:57]
    v_pk_add_f32 v[90:91], v[90:91], s[56:57]
    v_rcp_f32 v88, v88
    v_rcp_f32 v89, v89
    v_rcp_f32 v90, v90
    v_rcp_f32 v91, v91
    v_pk_mul_f32 v[32:33], v[32:33], v[88:89]
    v_pk_mul_f32 v[34:35], v[34:35], v[90:91]
    v_cvt_pk_bf16_f32 v80, v32, v33
    v_cvt_pk_bf16_f32 v81, v34, v35
    v_lshlrev_b32 v88, 16, v98
    v_and_b32 v89, 0xffff0000, v98
    v_lshlrev_b32 v90, 16, v99
    v_and_b32 v91, 0xffff0000, v99
    v_pk_add_f32 v[36:37], v[36:37], v[88:89]
    v_pk_add_f32 v[38:39], v[38:39], v[90:91]
    v_pk_mul_f32 v[88:89], v[36:37], v[36:37]
    v_pk_mul_f32 v[90:91], v[38:39], v[38:39]
    v_fma_f32 v88, v88, s52, 1.0
    v_fma_f32 v89, v89, s52, 1.0
    v_fma_f32 v90, v90, s52, 1.0
    v_fma_f32 v91, v91, s52, 1.0
    v_pk_mul_f32 v[88:89], v[88:89], v[36:37]
    v_pk_mul_f32 v[90:91], v[90:91], v[38:39]
    v_pk_mul_f32 v[88:89], v[88:89], s[54:55]
    v_pk_mul_f32 v[90:91], v[90:91], s[54:55]
    v_exp_f32 v88, -v88
    v_exp_f32 v89, -v89
    v_exp_f32 v90, -v90
    v_exp_f32 v91, -v91
    v_pk_add_f32 v[88:89], v[88:89], s[56:57]
    v_pk_add_f32 v[90:91], v[90:91], s[56:57]
    v_rcp_f32 v88, v88
    v_rcp_f32 v89, v89
    v_rcp_f32 v90, v90
    v_rcp_f32 v91, v91
    v_pk_mul_f32 v[36:37], v[36:37], v[88:89]
    v_pk_mul_f32 v[38:39], v[38:39], v[90:91]
    v_cvt_pk_bf16_f32 v82, v36, v37
    v_cvt_pk_bf16_f32 v83, v38, v39
    s_add_u32 s39, s38, 0
    s_cmp_ge_u32 s39, 43
    s_cbranch_scc1 L_adaLN_cond__memory_aug_recurrent_mem_tr__dense_activation_gelu__prompt_kernel_pf_f1_sk00
    buffer_store_dwordx4 v[80:83], v3, s[4:7], s36 offen offset:0
L_adaLN_cond__memory_aug_recurrent_mem_tr__dense_activation_gelu__prompt_kernel_pf_f1_sk00:
    v_lshlrev_b32 v88, 16, v100
    v_and_b32 v89, 0xffff0000, v100
    v_lshlrev_b32 v90, 16, v101
    v_and_b32 v91, 0xffff0000, v101
    v_pk_add_f32 v[40:41], v[40:41], v[88:89]
    v_pk_add_f32 v[42:43], v[42:43], v[90:91]
    v_pk_mul_f32 v[88:89], v[40:41], v[40:41]
    v_pk_mul_f32 v[90:91], v[42:43], v[42:43]
    v_fma_f32 v88, v88, s52, 1.0
    v_fma_f32 v89, v89, s52, 1.0
    v_fma_f32 v90, v90, s52, 1.0
    v_fma_f32 v91, v91, s52, 1.0
    v_pk_mul_f32 v[88:89], v[88:89], v[40:41]
    v_pk_mul_f32 v[90:91], v[90:91], v[42:43]
    v_pk_mul_f32 v[88:89], v[88:89], s[54:55]
    v_pk_mul_f32 v[90:91], v[90:91], s[54:55]
    v_exp_f32 v88, -v88
    v_exp_f32 v89, -v89
    v_exp_f32 v90, -v90
    v_exp_f32 v91, -v91
    v_pk_add_f32 v[88:89], v[88:89], s[56:57]
    v_pk_add_f32 v[90:91], v[90:91], s[56:57]
    v_rcp_f32 v88, v88
    v_rcp_f32 v89, v89
    v_rcp_f32 v90, v90
    v_rcp_f32 v91, v91
    v_pk_mul_f32 v[40:41], v[40:41], v[88:89]
    v_pk_mul_f32 v[42:43], v[42:43], v[90:91]
    v_cvt_pk_bf16_f32 v84, v40, v41
    v_cvt_pk_bf16_f32 v85, v42, v43
    v_lshlrev_b32 v88, 16, v102
    v_and_b32 v89, 0xffff0000, v102
    v_lshlrev_b32 v90, 16, v103
    v_and_b32 v91, 0xffff0000, v103
    v_pk_add_f32 v[44:45], v[44:45], v[88:89]
    v_pk_add_f32 v[46:47], v[46:47], v[90:91]
    v_pk_mul_f32 v[88:89], v[44:45], v[44:45]
    v_pk_mul_f32 v[90:91], v[46:47], v[46:47]
    v_fma_f32 v88, v88, s52, 1.0
    v_fma_f32 v89, v89, s52, 1.0
    v_fma_f32 v90, v90, s52, 1.0
    v_fma_f32 v91, v91, s52, 1.0
    v_pk_mul_f32 v[88:89], v[88:89], v[44:45]
    v_pk_mul_f32 v[90:91], v[90:91], v[46:47]
    v_pk_mul_f32 v[88:89], v[88:89], s[54:55]
    v_pk_mul_f32 v[90:91], v[90:91], s[54:55]
    v_exp_f32 v88, -v88
    v_exp_f32 v89, -v89
    v_exp_f32 v90, -v90
    v_exp_f32 v91, -v91
    v_pk_add_f32 v[88:89], v[88:89], s[56:57]
    v_pk_add_f32 v[90:91], v[90:91], s[56:57]
    v_rcp_f32 v88, v88
    v_rcp_f32 v89, v89
    v_rcp_f32 v90, v90
    v_rcp_f32 v91, v91
    v_pk_mul_f32 v[44:45], v[44:45], v[88:89]
    v_pk_mul_f32 v[46:47], v[46:47], v[90:91]
    v_cvt_pk_bf16_f32 v86, v44, v45
    v_cvt_pk_bf16_f32 v87, v46, v47
    s_add_u32 s39, s38, 1
    s_cmp_ge_u32 s39, 43
    s_cbranch_scc1 L_adaLN_cond__memory_aug_recurrent_mem_tr__dense_activation_gelu__prompt_kernel_pf_f1_sk01
    buffer_store_dwordx4 v[84:87], v3, s[4:7], s36 offen offset:1024
L_adaLN_cond__memory_aug_recurrent_mem_tr__dense_activation_gelu__prompt_kernel_pf_f1_sk01:
    s_add_u32 s36, s36, 44032
    s_waitcnt lgkmcnt(0)
    s_waitcnt vmcnt(0)
    s_barrier
    s_cmp_lg_u32 s92, 0
    s_cbranch_scc1 L_g101_done
    s_lshl_b32 s79, s84, 9
    s_lshl_b32 s93, s83, 2
    s_add_u32 s79, s79, s93
    s_add_u32 s79, s79, 3948928
    v_mov_b32 v250, 0
    v_mov_b32 v251, s82
    s_mov_b64 exec, 1
    buffer_store_dword v251, v250, s[4:7], s79 offen
    s_mov_b64 exec, -1
L_g101_done:
    s_branch L_adaLN_cond__memory_aug_recurrent_mem_tr__dense_activation_gelu__prompt_kernel_pf_f1d
L_adaLN_cond__memory_aug_recurrent_mem_tr__dense_activation_gelu__prompt_kernel_pf_nof1b:
    v_and_b32 v197, 63, v0
    v_lshlrev_b32 v197, 4, v197
    s_mul_i32 s40, s92, 22528
    s_add_u32 s40, s40, 65536
    v_add_u32 v197, s40, v197
    ds_write_b128 v197, a[192:195] offset:0
    ds_write_b128 v197, a[196:199] offset:1024
    ds_write_b128 v197, a[200:203] offset:2048
    ds_write_b128 v197, a[204:207] offset:3072
    ds_write_b128 v197, a[208:211] offset:4096
    ds_write_b128 v197, a[212:215] offset:5120
    ds_write_b128 v197, a[216:219] offset:6144
    ds_write_b128 v197, a[220:223] offset:7168
    ds_write_b128 v197, a[224:227] offset:8192
    ds_write_b128 v197, a[228:231] offset:9216
    ds_write_b128 v197, a[232:235] offset:10240
    ds_write_b128 v197, a[236:239] offset:11264
    ds_write_b128 v197, a[240:243] offset:12288
    ds_write_b128 v197, a[244:247] offset:13312
    ds_write_b128 v197, a[248:251] offset:14336
    ds_write_b128 v197, v[200:203] offset:15360
    ds_write_b128 v197, v[204:207] offset:16384
    ds_write_b128 v197, v[208:211] offset:17408
    ds_write_b128 v197, v[212:215] offset:18432
    ds_write_b128 v197, v[216:219] offset:19456
    ds_write_b128 v197, v[220:223] offset:20480
    ds_write_b128 v197, v[224:227] offset:21504
    s_waitcnt lgkmcnt(0)
L_adaLN_cond__memory_aug_recurrent_mem_tr__dense_activation_gelu__prompt_kernel_pf_f1d:
    s_mov_b32 s16, s81
    s_lshr_b32 s17, s83, 1
    s_and_b32 s19, s83, 1
    s_lshl_b32 s10, s17, 5
    s_mov_b32 s11, 0
    s_load_dwordx2 s[66:67], s[0:1], 88
    s_load_dwordx2 s[68:69], s[0:1], 112
    v_and_b32 v2, 63, v0
    v_lshlrev_b32 v3, 4, v2
    v_and_b32 v4, 15, v2
    v_lshrrev_b32 v5, 4, v2
    v_lshrrev_b32 v20, 2, v4
    v_lshl_add_u32 v23, v5, 2, v20
    v_bfe_u32 v22, v23, 2, 1
    v_mul_u32_u24 v21, 64, v23
    v_and_b32 v23, 3, v2
    v_lshl_add_u32 v21, v23, 3, v21
    v_xor_b32 v23, 0, v22
    v_lshl_add_u32 v12, v23, 5, v21
    v_add_u32 v24, 0x10000, v12
    v_xor_b32 v23, 1, v22
    v_lshl_add_u32 v13, v23, 5, v21
    v_add_u32 v25, 0x10000, v13
    s_waitcnt lgkmcnt(0)
    s_mov_b32 s48, s66
    s_and_b32 s49, s67, 0xffff
    s_mov_b32 s50, 1024
    s_mov_b32 s51, 0x00020000
    v_lshlrev_b32 v20, 3, v5
    s_lshl_b32 s37, s10, 1
    buffer_load_dwordx2 v[88:89], v20, s[48:51], s37 offen offset:0
    buffer_load_dwordx2 v[90:91], v20, s[48:51], s37 offen offset:32
    s_mov_b32 s52, s68
    s_and_b32 s53, s69, 0xffff
    s_mov_b32 s54, 2097152
    s_mov_b32 s55, 0x00020000
    s_cmp_lg_u32 s92, 0
    s_cbranch_scc1 L_g102_done
    s_lshl_b32 s79, s84, 9
    s_add_u32 s79, s79, 3948928
    v_mbcnt_lo_u32_b32 v250, -1, 0
    v_mbcnt_hi_u32_b32 v250, -1, v250
    v_min_u32 v250, 21, v250
    v_lshlrev_b32 v250, 2, v250
    s_mov_b32 s94, 400000
L_g102_spin:
    buffer_load_dword v251, v250, s[4:7], s79 offen sc1
    s_waitcnt vmcnt(0)
    v_cmp_gt_u32 vcc, s82, v251
    s_cbranch_vccz L_g102_done
    s_sub_u32 s94, s94, 1
    s_cbranch_scc0 L_g102_spin
L_g102_done:
    s_barrier
    s_cmp_ge_u32 s92, 2
    s_cbranch_scc1 L_adaLN_cond__memory_aug_recurrent_mem_tr__dense_activation_gelu__prompt_kernel_pf_f2_skip
    s_lshl_b32 s9, s16, 2
    s_lshl_b32 s18, s19, 1
    s_add_u32 s9, s9, s18
    s_add_u32 s9, s9, s92
    s_and_b32 s8, s9, 3
    s_lshl_b32 s18, s84, 3
    s_add_u32 s8, s8, s18
    s_mul_i32 s23, s8, 44032
    s_lshl_b32 s24, s11, 10
    s_add_u32 s23, s23, s24
    s_add_u32 s23, s23, 109051904
    s_add_u32 s24, s23, 44032
    buffer_load_dwordx4 a[0:3], v3, s[4:7], s23 offen offset:0 sc1
    buffer_load_dwordx4 a[4:7], v3, s[4:7], s23 offen offset:1024 sc1
    buffer_load_dwordx4 a[8:11], v3, s[4:7], s23 offen offset:2048 sc1
    buffer_load_dwordx4 a[12:15], v3, s[4:7], s23 offen offset:3072 sc1
    s_add_u32 s23, s23, 4096
    buffer_load_dwordx4 a[16:19], v3, s[4:7], s23 offen offset:0 sc1
    buffer_load_dwordx4 a[20:23], v3, s[4:7], s23 offen offset:1024 sc1
    buffer_load_dwordx4 a[24:27], v3, s[4:7], s23 offen offset:2048 sc1
    buffer_load_dwordx4 a[28:31], v3, s[4:7], s23 offen offset:3072 sc1
    s_add_u32 s23, s23, 4096
    buffer_load_dwordx4 a[32:35], v3, s[4:7], s23 offen offset:0 sc1
    buffer_load_dwordx4 a[36:39], v3, s[4:7], s23 offen offset:1024 sc1
    buffer_load_dwordx4 a[40:43], v3, s[4:7], s23 offen offset:2048 sc1
    buffer_load_dwordx4 a[44:47], v3, s[4:7], s23 offen offset:3072 sc1
    s_add_u32 s23, s23, 4096
    buffer_load_dwordx4 a[48:51], v3, s[4:7], s23 offen offset:0 sc1
    buffer_load_dwordx4 a[52:55], v3, s[4:7], s23 offen offset:1024 sc1
    buffer_load_dwordx4 a[56:59], v3, s[4:7], s23 offen offset:2048 sc1
    buffer_load_dwordx4 a[60:63], v3, s[4:7], s23 offen offset:3072 sc1
    s_add_u32 s23, s23, 4096
    buffer_load_dwordx4 a[64:67], v3, s[4:7], s23 offen offset:0 sc1
    buffer_load_dwordx4 a[68:71], v3, s[4:7], s23 offen offset:1024 sc1
    buffer_load_dwordx4 a[72:75], v3, s[4:7], s23 offen offset:2048 sc1
    buffer_load_dwordx4 a[76:79], v3, s[4:7], s23 offen offset:3072 sc1
    s_add_u32 s23, s23, 4096
    buffer_load_dwordx4 a[80:83], v3, s[4:7], s23 offen offset:0 sc1
    buffer_load_dwordx4 a[84:87], v3, s[4:7], s23 offen offset:1024 sc1
    buffer_load_dwordx4 a[88:91], v3, s[4:7], s23 offen offset:2048 sc1
    buffer_load_dwordx4 a[92:95], v3, s[4:7], s23 offen offset:3072 sc1
    s_add_u32 s23, s23, 4096
    buffer_load_dwordx4 a[96:99], v3, s[4:7], s23 offen offset:0 sc1
    buffer_load_dwordx4 a[100:103], v3, s[4:7], s23 offen offset:1024 sc1
    buffer_load_dwordx4 a[104:107], v3, s[4:7], s23 offen offset:2048 sc1
    buffer_load_dwordx4 a[108:111], v3, s[4:7], s23 offen offset:3072 sc1
    s_add_u32 s23, s23, 4096
    buffer_load_dwordx4 a[112:115], v3, s[4:7], s23 offen offset:0 sc1
    buffer_load_dwordx4 a[116:119], v3, s[4:7], s23 offen offset:1024 sc1
    buffer_load_dwordx4 a[120:123], v3, s[4:7], s23 offen offset:2048 sc1
    buffer_load_dwordx4 a[124:127], v3, s[4:7], s23 offen offset:3072 sc1
    s_add_u32 s23, s23, 4096
    buffer_load_dwordx4 v[112:115], v3, s[4:7], s23 offen offset:0 sc1
    buffer_load_dwordx4 v[116:119], v3, s[4:7], s23 offen offset:1024 sc1
    buffer_load_dwordx4 v[120:123], v3, s[4:7], s23 offen offset:2048 sc1
    buffer_load_dwordx4 v[124:127], v3, s[4:7], s23 offen offset:3072 sc1
    s_add_u32 s23, s23, 4096
    buffer_load_dwordx4 v[128:131], v3, s[4:7], s23 offen offset:0 sc1
    buffer_load_dwordx4 v[132:135], v3, s[4:7], s23 offen offset:1024 sc1
    buffer_load_dwordx4 v[136:139], v3, s[4:7], s23 offen offset:2048 sc1
    buffer_load_dwordx4 v[140:143], v3, s[4:7], s23 offen offset:3072 sc1
    s_add_u32 s23, s23, 4096
    buffer_load_dwordx4 v[144:147], v3, s[4:7], s23 offen offset:0 sc1
    buffer_load_dwordx4 v[148:151], v3, s[4:7], s23 offen offset:1024 sc1
    buffer_load_dwordx4 v[152:155], v3, s[4:7], s23 offen offset:2048 sc1
    v_lshlrev_b32 v21, 4, v5
    s_lshl_b32 s38, s10, 2
    s_add_u32 s38, s38, 2107392
    v_lshlrev_b32 v22, 11, v4
    v_lshl_add_u32 v22, v5, 4, v22
    s_lshl_b32 s39, s8, 15
    s_lshl_b32 s56, s10, 2
    s_add_u32 s39, s39, s56
    s_add_u32 s39, s39, 100663296
    buffer_load_dwordx4 v[96:99], v21, s[4:7], s38 offen offset:0 sc1
    buffer_load_dwordx4 v[104:107], v22, s[4:7], s39 offen offset:0 sc1
    buffer_load_dwordx4 v[100:103], v21, s[4:7], s38 offen offset:64 sc1
    buffer_load_dwordx4 v[108:111], v22, s[4:7], s39 offen offset:64 sc1
    v_add_u32 v28, 0x20000, v12
    v_add_u32 v29, 0x20000, v13
    ds_read_b64_tr_b16 v[40:41], v24 offset:0
    ds_read_b64_tr_b16 v[42:43], v24 offset:1024
    ds_read_b64_tr_b16 v[44:45], v25 offset:0
    ds_read_b64_tr_b16 v[46:47], v25 offset:1024
    ds_read_b64_tr_b16 v[48:49], v24 offset:2048
    ds_read_b64_tr_b16 v[50:51], v24 offset:3072
    ds_read_b64_tr_b16 v[52:53], v25 offset:2048
    ds_read_b64_tr_b16 v[54:55], v25 offset:3072
    ds_read_b64_tr_b16 v[56:57], v24 offset:4096
    ds_read_b64_tr_b16 v[58:59], v24 offset:5120
    ds_read_b64_tr_b16 v[60:61], v25 offset:4096
    ds_read_b64_tr_b16 v[62:63], v25 offset:5120
    s_waitcnt vmcnt(46) lgkmcnt(10)
    v_mfma_f32_16x16x32_bf16 v[32:35], v[40:43], a[0:3], 0
    ds_read_b64_tr_b16 v[64:65], v24 offset:6144
    ds_read_b64_tr_b16 v[66:67], v24 offset:7168
    s_waitcnt lgkmcnt(10)
    v_mfma_f32_16x16x32_bf16 v[36:39], v[44:47], a[0:3], 0
    ds_read_b64_tr_b16 v[68:69], v25 offset:6144
    ds_read_b64_tr_b16 v[70:71], v25 offset:7168
    s_waitcnt vmcnt(45) lgkmcnt(10)
    v_mfma_f32_16x16x32_bf16 v[32:35], v[48:51], a[4:7], v[32:35]
    ds_read_b64_tr_b16 v[40:41], v24 offset:8192
    ds_read_b64_tr_b16 v[42:43], v24 offset:9216
    s_waitcnt lgkmcnt(10)
    v_mfma_f32_16x16x32_bf16 v[36:39], v[52:55], a[4:7], v[36:39]
    ds_read_b64_tr_b16 v[44:45], v25 offset:8192
    ds_read_b64_tr_b16 v[46:47], v25 offset:9216
    s_waitcnt vmcnt(44) lgkmcnt(10)
    v_mfma_f32_16x16x32_bf16 v[32:35], v[56:59], a[8:11], v[32:35]
    ds_read_b64_tr_b16 v[48:49], v24 offset:10240
    ds_read_b64_tr_b16 v[50:51], v24 offset:11264
    s_waitcnt lgkmcnt(10)
    v_mfma_f32_16x16x32_bf16 v[36:39], v[60:63], a[8:11], v[36:39]
    ds_read_b64_tr_b16 v[52:53], v25 offset:10240
    ds_read_b64_tr_b16 v[54:55], v25 offset:11264
    s_waitcnt vmcnt(43) lgkmcnt(10)
    v_mfma_f32_16x16x32_bf16 v[32:35], v[64:67], a[12:15], v[32:35]
    ds_read_b64_tr_b16 v[56:57], v24 offset:12288
    ds_read_b64_tr_b16 v[58:59], v24 offset:13312
    s_waitcnt lgkmcnt(10)
    v_mfma_f32_16x16x32_bf16 v[36:39], v[68:71], a[12:15], v[36:39]
    ds_read_b64_tr_b16 v[60:61], v25 offset:12288
    ds_read_b64_tr_b16 v[62:63], v25 offset:13312
    s_waitcnt vmcnt(42) lgkmcnt(10)
    v_mfma_f32_16x16x32_bf16 v[32:35], v[40:43], a[16:19], v[32:35]
    ds_read_b64_tr_b16 v[64:65], v24 offset:14336
    ds_read_b64_tr_b16 v[66:67], v24 offset:15360
    s_waitcnt lgkmcnt(10)
    v_mfma_f32_16x16x32_bf16 v[36:39], v[44:47], a[16:19], v[36:39]
    ds_read_b64_tr_b16 v[68:69], v25 offset:14336
    ds_read_b64_tr_b16 v[70:71], v25 offset:15360
    s_waitcnt vmcnt(41) lgkmcnt(10)
    v_mfma_f32_16x16x32_bf16 v[32:35], v[48:51], a[20:23], v[32:35]
    ds_read_b64_tr_b16 v[40:41], v24 offset:16384
    ds_read_b64_tr_b16 v[42:43], v24 offset:17408
    s_waitcnt lgkmcnt(10)
    v_mfma_f32_16x16x32_bf16 v[36:39], v[52:55], a[20:23], v[36:39]
    ds_read_b64_tr_b16 v[44:45], v25 offset:16384
    ds_read_b64_tr_b16 v[46:47], v25 offset:17408
    s_waitcnt vmcnt(40) lgkmcnt(10)
    v_mfma_f32_16x16x32_bf16 v[32:35], v[56:59], a[24:27], v[32:35]
    ds_read_b64_tr_b16 v[48:49], v24 offset:18432
    ds_read_b64_tr_b16 v[50:51], v24 offset:19456
    s_waitcnt lgkmcnt(10)
    v_mfma_f32_16x16x32_bf16 v[36:39], v[60:63], a[24:27], v[36:39]
    ds_read_b64_tr_b16 v[52:53], v25 offset:18432
    ds_read_b64_tr_b16 v[54:55], v25 offset:19456
    s_waitcnt vmcnt(39) lgkmcnt(10)
    v_mfma_f32_16x16x32_bf16 v[32:35], v[64:67], a[28:31], v[32:35]
    ds_read_b64_tr_b16 v[56:57], v24 offset:20480
    ds_read_b64_tr_b16 v[58:59], v24 offset:21504
    s_waitcnt lgkmcnt(10)
    v_mfma_f32_16x16x32_bf16 v[36:39], v[68:71], a[28:31], v[36:39]
    ds_read_b64_tr_b16 v[60:61], v25 offset:20480
    ds_read_b64_tr_b16 v[62:63], v25 offset:21504
    s_waitcnt vmcnt(38) lgkmcnt(10)
    v_mfma_f32_16x16x32_bf16 v[32:35], v[40:43], a[32:35], v[32:35]
    ds_read_b64_tr_b16 v[64:65], v24 offset:22528
    ds_read_b64_tr_b16 v[66:67], v24 offset:23552
    s_waitcnt lgkmcnt(10)
    v_mfma_f32_16x16x32_bf16 v[36:39], v[44:47], a[32:35], v[36:39]
    ds_read_b64_tr_b16 v[68:69], v25 offset:22528
    ds_read_b64_tr_b16 v[70:71], v25 offset:23552
    s_waitcnt vmcnt(37) lgkmcnt(10)
    v_mfma_f32_16x16x32_bf16 v[32:35], v[48:51], a[36:39], v[32:35]
    ds_read_b64_tr_b16 v[40:41], v24 offset:24576
    ds_read_b64_tr_b16 v[42:43], v24 offset:25600
    s_waitcnt lgkmcnt(10)
    v_mfma_f32_16x16x32_bf16 v[36:39], v[52:55], a[36:39], v[36:39]
    ds_read_b64_tr_b16 v[44:45], v25 offset:24576
    ds_read_b64_tr_b16 v[46:47], v25 offset:25600
    s_waitcnt vmcnt(36) lgkmcnt(10)
    v_mfma_f32_16x16x32_bf16 v[32:35], v[56:59], a[40:43], v[32:35]
    ds_read_b64_tr_b16 v[48:49], v24 offset:26624
    ds_read_b64_tr_b16 v[50:51], v24 offset:27648
    s_waitcnt lgkmcnt(10)
    v_mfma_f32_16x16x32_bf16 v[36:39], v[60:63], a[40:43], v[36:39]
    ds_read_b64_tr_b16 v[52:53], v25 offset:26624
    ds_read_b64_tr_b16 v[54:55], v25 offset:27648
    s_waitcnt vmcnt(35) lgkmcnt(10)
    v_mfma_f32_16x16x32_bf16 v[32:35], v[64:67], a[44:47], v[32:35]
    ds_read_b64_tr_b16 v[56:57], v24 offset:28672
    ds_read_b64_tr_b16 v[58:59], v24 offset:29696
    s_waitcnt lgkmcnt(10)
    v_mfma_f32_16x16x32_bf16 v[36:39], v[68:71], a[44:47], v[36:39]
    ds_read_b64_tr_b16 v[60:61], v25 offset:28672
    ds_read_b64_tr_b16 v[62:63], v25 offset:29696
    s_waitcnt vmcnt(34) lgkmcnt(10)
    v_mfma_f32_16x16x32_bf16 v[32:35], v[40:43], a[48:51], v[32:35]
    ds_read_b64_tr_b16 v[64:65], v24 offset:30720
    ds_read_b64_tr_b16 v[66:67], v24 offset:31744
    s_waitcnt lgkmcnt(10)
    v_mfma_f32_16x16x32_bf16 v[36:39], v[44:47], a[48:51], v[36:39]
    ds_read_b64_tr_b16 v[68:69], v25 offset:30720
    ds_read_b64_tr_b16 v[70:71], v25 offset:31744
    s_waitcnt vmcnt(33) lgkmcnt(10)
    v_mfma_f32_16x16x32_bf16 v[32:35], v[48:51], a[52:55], v[32:35]
    ds_read_b64_tr_b16 v[40:41], v24 offset:32768
    ds_read_b64_tr_b16 v[42:43], v24 offset:33792
    s_waitcnt lgkmcnt(10)
    v_mfma_f32_16x16x32_bf16 v[36:39], v[52:55], a[52:55], v[36:39]
    ds_read_b64_tr_b16 v[44:45], v25 offset:32768
    ds_read_b64_tr_b16 v[46:47], v25 offset:33792
    s_waitcnt vmcnt(32) lgkmcnt(10)
    v_mfma_f32_16x16x32_bf16 v[32:35], v[56:59], a[56:59], v[32:35]
    ds_read_b64_tr_b16 v[48:49], v24 offset:34816
    ds_read_b64_tr_b16 v[50:51], v24 offset:35840
    s_waitcnt lgkmcnt(10)
    v_mfma_f32_16x16x32_bf16 v[36:39], v[60:63], a[56:59], v[36:39]
    ds_read_b64_tr_b16 v[52:53], v25 offset:34816
    ds_read_b64_tr_b16 v[54:55], v25 offset:35840
    s_waitcnt vmcnt(31) lgkmcnt(10)
    v_mfma_f32_16x16x32_bf16 v[32:35], v[64:67], a[60:63], v[32:35]
    ds_read_b64_tr_b16 v[56:57], v24 offset:36864
    ds_read_b64_tr_b16 v[58:59], v24 offset:37888
    s_waitcnt lgkmcnt(10)
    v_mfma_f32_16x16x32_bf16 v[36:39], v[68:71], a[60:63], v[36:39]
    ds_read_b64_tr_b16 v[60:61], v25 offset:36864
    ds_read_b64_tr_b16 v[62:63], v25 offset:37888
    s_waitcnt vmcnt(30) lgkmcnt(10)
    v_mfma_f32_16x16x32_bf16 v[32:35], v[40:43], a[64:67], v[32:35]
    ds_read_b64_tr_b16 v[64:65], v24 offset:38912
    ds_read_b64_tr_b16 v[66:67], v24 offset:39936
    s_waitcnt lgkmcnt(10)
    v_mfma_f32_16x16x32_bf16 v[36:39], v[44:47], a[64:67], v[36:39]
    ds_read_b64_tr_b16 v[68:69], v25 offset:38912
    ds_read_b64_tr_b16 v[70:71], v25 offset:39936
    s_waitcnt vmcnt(29) lgkmcnt(10)
    v_mfma_f32_16x16x32_bf16 v[32:35], v[48:51], a[68:71], v[32:35]
    ds_read_b64_tr_b16 v[40:41], v24 offset:40960
    ds_read_b64_tr_b16 v[42:43], v24 offset:41984
    s_waitcnt lgkmcnt(10)
    v_mfma_f32_16x16x32_bf16 v[36:39], v[52:55], a[68:71], v[36:39]
    ds_read_b64_tr_b16 v[44:45], v25 offset:40960
    ds_read_b64_tr_b16 v[46:47], v25 offset:41984
    s_waitcnt vmcnt(28) lgkmcnt(10)
    v_mfma_f32_16x16x32_bf16 v[32:35], v[56:59], a[72:75], v[32:35]
    ds_read_b64_tr_b16 v[48:49], v24 offset:43008
    ds_read_b64_tr_b16 v[50:51], v24 offset:44032
    s_waitcnt lgkmcnt(10)
    v_mfma_f32_16x16x32_bf16 v[36:39], v[60:63], a[72:75], v[36:39]
    ds_read_b64_tr_b16 v[52:53], v25 offset:43008
    ds_read_b64_tr_b16 v[54:55], v25 offset:44032
    s_waitcnt vmcnt(27) lgkmcnt(10)
    v_mfma_f32_16x16x32_bf16 v[32:35], v[64:67], a[76:79], v[32:35]
    ds_read_b64_tr_b16 v[56:57], v24 offset:45056
    ds_read_b64_tr_b16 v[58:59], v24 offset:46080
    s_waitcnt lgkmcnt(10)
    v_mfma_f32_16x16x32_bf16 v[36:39], v[68:71], a[76:79], v[36:39]
    ds_read_b64_tr_b16 v[60:61], v25 offset:45056
    ds_read_b64_tr_b16 v[62:63], v25 offset:46080
    s_waitcnt vmcnt(26) lgkmcnt(10)
    v_mfma_f32_16x16x32_bf16 v[32:35], v[40:43], a[80:83], v[32:35]
    ds_read_b64_tr_b16 v[64:65], v24 offset:47104
    ds_read_b64_tr_b16 v[66:67], v24 offset:48128
    s_waitcnt lgkmcnt(10)
    v_mfma_f32_16x16x32_bf16 v[36:39], v[44:47], a[80:83], v[36:39]
    ds_read_b64_tr_b16 v[68:69], v25 offset:47104
    ds_read_b64_tr_b16 v[70:71], v25 offset:48128
    s_waitcnt vmcnt(25) lgkmcnt(10)
    v_mfma_f32_16x16x32_bf16 v[32:35], v[48:51], a[84:87], v[32:35]
    ds_read_b64_tr_b16 v[40:41], v24 offset:49152
    ds_read_b64_tr_b16 v[42:43], v24 offset:50176
    s_waitcnt lgkmcnt(10)
    v_mfma_f32_16x16x32_bf16 v[36:39], v[52:55], a[84:87], v[36:39]
    ds_read_b64_tr_b16 v[44:45], v25 offset:49152
    ds_read_b64_tr_b16 v[46:47], v25 offset:50176
    s_waitcnt vmcnt(24) lgkmcnt(10)
    v_mfma_f32_16x16x32_bf16 v[32:35], v[56:59], a[88:91], v[32:35]
    ds_read_b64_tr_b16 v[48:49], v24 offset:51200
    ds_read_b64_tr_b16 v[50:51], v24 offset:52224
    s_waitcnt lgkmcnt(10)
    v_mfma_f32_16x16x32_bf16 v[36:39], v[60:63], a[88:91], v[36:39]
    ds_read_b64_tr_b16 v[52:53], v25 offset:51200
    ds_read_b64_tr_b16 v[54:55], v25 offset:52224
    s_waitcnt vmcnt(23) lgkmcnt(10)
    v_mfma_f32_16x16x32_bf16 v[32:35], v[64:67], a[92:95], v[32:35]
    ds_read_b64_tr_b16 v[56:57], v24 offset:53248
    ds_read_b64_tr_b16 v[58:59], v24 offset:54272
    s_waitcnt lgkmcnt(10)
    v_mfma_f32_16x16x32_bf16 v[36:39], v[68:71], a[92:95], v[36:39]
    ds_read_b64_tr_b16 v[60:61], v25 offset:53248
    ds_read_b64_tr_b16 v[62:63], v25 offset:54272
    s_waitcnt vmcnt(22) lgkmcnt(10)
    v_mfma_f32_16x16x32_bf16 v[32:35], v[40:43], a[96:99], v[32:35]
    ds_read_b64_tr_b16 v[64:65], v24 offset:55296
    ds_read_b64_tr_b16 v[66:67], v24 offset:56320
    s_waitcnt lgkmcnt(10)
    v_mfma_f32_16x16x32_bf16 v[36:39], v[44:47], a[96:99], v[36:39]
    ds_read_b64_tr_b16 v[68:69], v25 offset:55296
    ds_read_b64_tr_b16 v[70:71], v25 offset:56320
    s_waitcnt vmcnt(21) lgkmcnt(10)
    v_mfma_f32_16x16x32_bf16 v[32:35], v[48:51], a[100:103], v[32:35]
    ds_read_b64_tr_b16 v[40:41], v24 offset:57344
    ds_read_b64_tr_b16 v[42:43], v24 offset:58368
    s_waitcnt lgkmcnt(10)
    v_mfma_f32_16x16x32_bf16 v[36:39], v[52:55], a[100:103], v[36:39]
    ds_read_b64_tr_b16 v[44:45], v25 offset:57344
    ds_read_b64_tr_b16 v[46:47], v25 offset:58368
    s_waitcnt vmcnt(20) lgkmcnt(10)
    v_mfma_f32_16x16x32_bf16 v[32:35], v[56:59], a[104:107], v[32:35]
    ds_read_b64_tr_b16 v[48:49], v24 offset:59392
    ds_read_b64_tr_b16 v[50:51], v24 offset:60416
    s_waitcnt lgkmcnt(10)
    v_mfma_f32_16x16x32_bf16 v[36:39], v[60:63], a[104:107], v[36:39]
    ds_read_b64_tr_b16 v[52:53], v25 offset:59392
    ds_read_b64_tr_b16 v[54:55], v25 offset:60416
    s_waitcnt vmcnt(19) lgkmcnt(10)
    v_mfma_f32_16x16x32_bf16 v[32:35], v[64:67], a[108:111], v[32:35]
    ds_read_b64_tr_b16 v[56:57], v24 offset:61440
    ds_read_b64_tr_b16 v[58:59], v24 offset:62464
    s_waitcnt lgkmcnt(10)
    v_mfma_f32_16x16x32_bf16 v[36:39], v[68:71], a[108:111], v[36:39]
    ds_read_b64_tr_b16 v[60:61], v25 offset:61440
    ds_read_b64_tr_b16 v[62:63], v25 offset:62464
    s_waitcnt vmcnt(18) lgkmcnt(10)
    v_mfma_f32_16x16x32_bf16 v[32:35], v[40:43], a[112:115], v[32:35]
    ds_read_b64_tr_b16 v[64:65], v24 offset:63488
    ds_read_b64_tr_b16 v[66:67], v24 offset:64512
    s_waitcnt lgkmcnt(10)
    v_mfma_f32_16x16x32_bf16 v[36:39], v[44:47], a[112:115], v[36:39]
    ds_read_b64_tr_b16 v[68:69], v25 offset:63488
    ds_read_b64_tr_b16 v[70:71], v25 offset:64512
    s_waitcnt vmcnt(17) lgkmcnt(10)
    v_mfma_f32_16x16x32_bf16 v[32:35], v[48:51], a[116:119], v[32:35]
    ds_read_b64_tr_b16 v[40:41], v28 offset:0
    ds_read_b64_tr_b16 v[42:43], v28 offset:1024
    s_waitcnt lgkmcnt(10)
    v_mfma_f32_16x16x32_bf16 v[36:39], v[52:55], a[116:119], v[36:39]
    ds_read_b64_tr_b16 v[44:45], v29 offset:0
    ds_read_b64_tr_b16 v[46:47], v29 offset:1024
    s_waitcnt vmcnt(16) lgkmcnt(10)
    v_mfma_f32_16x16x32_bf16 v[32:35], v[56:59], a[120:123], v[32:35]
    ds_read_b64_tr_b16 v[48:49], v28 offset:2048
    ds_read_b64_tr_b16 v[50:51], v28 offset:3072
    s_waitcnt lgkmcnt(10)
    v_mfma_f32_16x16x32_bf16 v[36:39], v[60:63], a[120:123], v[36:39]
    ds_read_b64_tr_b16 v[52:53], v29 offset:2048
    ds_read_b64_tr_b16 v[54:55], v29 offset:3072
    s_waitcnt vmcnt(15) lgkmcnt(10)
    v_mfma_f32_16x16x32_bf16 v[32:35], v[64:67], a[124:127], v[32:35]
    ds_read_b64_tr_b16 v[56:57], v28 offset:4096
    ds_read_b64_tr_b16 v[58:59], v28 offset:5120
    s_waitcnt lgkmcnt(10)
    v_mfma_f32_16x16x32_bf16 v[36:39], v[68:71], a[124:127], v[36:39]
    ds_read_b64_tr_b16 v[60:61], v29 offset:4096
    ds_read_b64_tr_b16 v[62:63], v29 offset:5120
    s_waitcnt vmcnt(14) lgkmcnt(10)
    v_mfma_f32_16x16x32_bf16 v[32:35], v[40:43], v[112:115], v[32:35]
    ds_read_b64_tr_b16 v[64:65], v28 offset:6144
    ds_read_b64_tr_b16 v[66:67], v28 offset:7168
    s_waitcnt lgkmcnt(10)
    v_mfma_f32_16x16x32_bf16 v[36:39], v[44:47], v[112:115], v[36:39]
    ds_read_b64_tr_b16 v[68:69], v29 offset:6144
    ds_read_b64_tr_b16 v[70:71], v29 offset:7168
    s_waitcnt vmcnt(13) lgkmcnt(10)
    v_mfma_f32_16x16x32_bf16 v[32:35], v[48:51], v[116:119], v[32:35]
    ds_read_b64_tr_b16 v[40:41], v28 offset:8192
    ds_read_b64_tr_b16 v[42:43], v28 offset:9216
    s_waitcnt lgkmcnt(10)
    v_mfma_f32_16x16x32_bf16 v[36:39], v[52:55], v[116:119], v[36:39]
    ds_read_b64_tr_b16 v[44:45], v29 offset:8192
    ds_read_b64_tr_b16 v[46:47], v29 offset:9216
    s_waitcnt vmcnt(12) lgkmcnt(10)
    v_mfma_f32_16x16x32_bf16 v[32:35], v[56:59], v[120:123], v[32:35]
    ds_read_b64_tr_b16 v[48:49], v28 offset:10240
    ds_read_b64_tr_b16 v[50:51], v28 offset:11264
    s_waitcnt lgkmcnt(10)
    v_mfma_f32_16x16x32_bf16 v[36:39], v[60:63], v[120:123], v[36:39]
    ds_read_b64_tr_b16 v[52:53], v29 offset:10240
    ds_read_b64_tr_b16 v[54:55], v29 offset:11264
    s_waitcnt vmcnt(11) lgkmcnt(10)
    v_mfma_f32_16x16x32_bf16 v[32:35], v[64:67], v[124:127], v[32:35]
    ds_read_b64_tr_b16 v[56:57], v28 offset:12288
    ds_read_b64_tr_b16 v[58:59], v28 offset:13312
    s_waitcnt lgkmcnt(10)
    v_mfma_f32_16x16x32_bf16 v[36:39], v[68:71], v[124:127], v[36:39]
    ds_read_b64_tr_b16 v[60:61], v29 offset:12288
    ds_read_b64_tr_b16 v[62:63], v29 offset:13312
    s_waitcnt vmcnt(10) lgkmcnt(10)
    v_mfma_f32_16x16x32_bf16 v[32:35], v[40:43], v[128:131], v[32:35]
    ds_read_b64_tr_b16 v[64:65], v28 offset:14336
    ds_read_b64_tr_b16 v[66:67], v28 offset:15360
    s_waitcnt lgkmcnt(10)
    v_mfma_f32_16x16x32_bf16 v[36:39], v[44:47], v[128:131], v[36:39]
    ds_read_b64_tr_b16 v[68:69], v29 offset:14336
    ds_read_b64_tr_b16 v[70:71], v29 offset:15360
    s_waitcnt vmcnt(9) lgkmcnt(10)
    v_mfma_f32_16x16x32_bf16 v[32:35], v[48:51], v[132:135], v[32:35]
    ds_read_b64_tr_b16 v[40:41], v28 offset:16384
    ds_read_b64_tr_b16 v[42:43], v28 offset:17408
    s_waitcnt lgkmcnt(10)
    v_mfma_f32_16x16x32_bf16 v[36:39], v[52:55], v[132:135], v[36:39]
    ds_read_b64_tr_b16 v[44:45], v29 offset:16384
    ds_read_b64_tr_b16 v[46:47], v29 offset:17408
    s_waitcnt vmcnt(8) lgkmcnt(10)
    v_mfma_f32_16x16x32_bf16 v[32:35], v[56:59], v[136:139], v[32:35]
    ds_read_b64_tr_b16 v[48:49], v28 offset:18432
    ds_read_b64_tr_b16 v[50:51], v28 offset:19456
    s_waitcnt lgkmcnt(10)
    v_mfma_f32_16x16x32_bf16 v[36:39], v[60:63], v[136:139], v[36:39]
    ds_read_b64_tr_b16 v[52:53], v29 offset:18432
    ds_read_b64_tr_b16 v[54:55], v29 offset:19456
    s_waitcnt vmcnt(7) lgkmcnt(10)
    v_mfma_f32_16x16x32_bf16 v[32:35], v[64:67], v[140:143], v[32:35]
    ds_read_b64_tr_b16 v[56:57], v28 offset:20480
    ds_read_b64_tr_b16 v[58:59], v28 offset:21504
    s_waitcnt lgkmcnt(10)
    v_mfma_f32_16x16x32_bf16 v[36:39], v[68:71], v[140:143], v[36:39]
    ds_read_b64_tr_b16 v[60:61], v29 offset:20480
    ds_read_b64_tr_b16 v[62:63], v29 offset:21504
    s_waitcnt vmcnt(6) lgkmcnt(10)
    v_mfma_f32_16x16x32_bf16 v[32:35], v[40:43], v[144:147], v[32:35]
    s_waitcnt lgkmcnt(8)
    v_mfma_f32_16x16x32_bf16 v[36:39], v[44:47], v[144:147], v[36:39]
    s_waitcnt vmcnt(5) lgkmcnt(6)
    v_mfma_f32_16x16x32_bf16 v[32:35], v[48:51], v[148:151], v[32:35]
    s_waitcnt lgkmcnt(4)
    v_mfma_f32_16x16x32_bf16 v[36:39], v[52:55], v[148:151], v[36:39]
    s_waitcnt vmcnt(4) lgkmcnt(2)
    v_mfma_f32_16x16x32_bf16 v[32:35], v[56:59], v[152:155], v[32:35]
    s_waitcnt lgkmcnt(0)
    v_mfma_f32_16x16x32_bf16 v[36:39], v[60:63], v[152:155], v[36:39]
    v_lshlrev_b32 v23, 10, v4
    v_lshl_add_u32 v23, v5, 3, v23
    s_lshl_b32 s57, s9, 14
    s_lshl_b32 s56, s10, 1
    s_add_u32 s57, s57, s56
    v_lshlrev_b32 v80, 16, v88
    v_add_f32 v32, v32, v80
    s_waitcnt vmcnt(2)
    v_fma_f32 v32, v32, v96, v104
    v_and_b32 v80, 0xffff0000, v88
    v_add_f32 v33, v33, v80
    v_fma_f32 v33, v33, v97, v105
    v_lshlrev_b32 v80, 16, v89
    v_add_f32 v34, v34, v80
    v_fma_f32 v34, v34, v98, v106
    v_and_b32 v80, 0xffff0000, v89
    v_add_f32 v35, v35, v80
    v_fma_f32 v35, v35, v99, v107
    v_cvt_pk_bf16_f32 v82, v32, v33
    v_cvt_pk_bf16_f32 v83, v34, v35
    buffer_store_dwordx2 v[82:83], v23, s[52:55], s57 offen offset:0 sc1
    v_lshlrev_b32 v80, 16, v90
    v_add_f32 v36, v36, v80
    s_waitcnt vmcnt(1)
    v_fma_f32 v36, v36, v100, v108
    v_and_b32 v80, 0xffff0000, v90
    v_add_f32 v37, v37, v80
    v_fma_f32 v37, v37, v101, v109
    v_lshlrev_b32 v80, 16, v91
    v_add_f32 v38, v38, v80
    v_fma_f32 v38, v38, v102, v110
    v_and_b32 v80, 0xffff0000, v91
    v_add_f32 v39, v39, v80
    v_fma_f32 v39, v39, v103, v111
    v_cvt_pk_bf16_f32 v82, v36, v37
    v_cvt_pk_bf16_f32 v83, v38, v39
    buffer_store_dwordx2 v[82:83], v23, s[52:55], s57 offen offset:32 sc1
L_adaLN_cond__memory_aug_recurrent_mem_tr__dense_activation_gelu__prompt_kernel_pf_f2_skip:
    s_waitcnt vmcnt(0) lgkmcnt(0)
    s_barrier
    s_add_u32 s81, s81, 7
    s_add_u32 s82, s82, 1
    s_branch L_adaLN_cond__memory_aug_recurrent_mem_tr__dense_activation_gelu__prompt_kernel_pf_loop
L_adaLN_cond__memory_aug_recurrent_mem_tr__dense_activation_gelu__prompt_kernel_pf_end:
L_adaLN_cond__memory_aug_recurrent_mem_tr__dense_activation_gelu__prompt_kernel_exit:
    s_endpgm
L_adaLN_cond__memory_aug_recurrent_mem_tr__dense_activation_gelu__prompt_kernel_rec:
    s_load_dwordx2 s[56:57], s[0:1], 120
    s_load_dwordx2 s[4:5], s[0:1], 128
    s_load_dwordx2 s[60:61], s[0:1], 16
    s_load_dwordx2 s[62:63], s[0:1], 24
    s_load_dwordx2 s[64:65], s[0:1], 32
    s_load_dwordx2 s[66:67], s[0:1], 40
    s_load_dwordx2 s[68:69], s[0:1], 8
    v_mov_b32 v11, v0
    v_lshrrev_b32 v12, 6, v0
    s_nop 0
    v_readfirstlane_b32 s9, v12
    v_and_b32 v13, 63, v0
    s_waitcnt lgkmcnt(0)
    s_mov_b32 s6, 268435456
    s_mov_b32 s7, 0x00020000
    v_and_b32 v14, 15, v13
    v_lshrrev_b32 v15, 4, v13
    v_lshlrev_b32 v0, 4, v13
    v_mov_b32 v16, 0x8888
    v_mov_b32 v17, 0xdddd
    v_cmp_gt_u32 vcc, 8, v14
    s_nop 1
    v_cndmask_b32 v1, v17, v16, vcc
    v_and_b32 v16, 7, v14
    v_lshlrev_b32 v16, 4, v16
    v_lshl_add_u32 v2, v15, 7, v16
    s_mul_i32 s31, s9, 24576
    s_add_u32 s31, s31, 53760
    v_and_b32 v16, 1, v15
    v_mul_u32_u24 v16, 1088, v16
    v_lshrrev_b32 v17, 1, v15
    v_lshl_add_u32 v17, v14, 1, v17
    s_lshl_b32 s44, s9, 5
    v_add_u32 v17, s44, v17
    v_lshl_add_u32 v16, v17, 3, v16
    v_add_u32 v3, 45056, v16
    v_and_b32 v16, 1, v13
    v_mul_u32_u24 v16, 1088, v16
    v_lshrrev_b32 v17, 2, v14
    v_lshl_add_u32 v17, v15, 2, v17
    v_lshl_add_u32 v16, v17, 3, v16
    v_add_u32 v4, 45056, v16
    v_lshrrev_b32 v16, 2, v14
    s_lshl_b32 s44, s9, 3
    v_add_u32 v16, s44, v16
    v_lshlrev_b32 v16, 13, v16
    v_lshl_add_u32 v16, v15, 11, v16
    v_and_b32 v17, 3, v14
    v_lshl_add_u32 v16, v17, 4, v16
    s_and_b32 s44, s8, 1
    s_lshl_b32 s44, s44, 10
    s_lshr_b32 s45, s8, 1
    s_lshl_b32 s45, s45, 6
    s_add_u32 s44, s44, s45
    v_add_u32 v5, s44, v16
    s_lshl_b32 s44, s8, 13
    s_lshl_b32 s45, s9, 11
    s_add_u32 s44, s44, s45
    v_add_u32 v6, s44, v0
    v_lshlrev_b32 v16, 4, v15
    v_and_b32 v17, 3, v13
    v_lshl_add_u32 v16, v17, 2, v16
    s_lshr_b32 s44, s8, 1
    s_lshl_b32 s44, s44, 9
    s_and_b32 s45, s8, 1
    s_lshl_b32 s45, s45, 8
    s_add_u32 s44, s44, s45
    s_lshr_b32 s45, s9, 1
    s_lshl_b32 s45, s45, 7
    s_add_u32 s44, s44, s45
    s_and_b32 s45, s9, 1
    s_lshl_b32 s45, s45, 6
    s_add_u32 s44, s44, s45
    v_add_u32 v7, s44, v16
    v_mov_b32 v8, v0
    v_and_b32 v16, 3, v14
    v_lshrrev_b32 v17, 2, v14
    v_lshrrev_b32 v19, 1, v17
    v_lshl_add_u32 v19, v16, 1, v19
    v_and_b32 v17, 1, v17
    v_lshlrev_b32 v17, 4, v17
    v_mov_b32 v20, 0x3f80
    v_lshlrev_b32 v20, v17, v20
    v_cmp_eq_u32 vcc, 0, v19
    s_nop 1
    v_cndmask_b32 v24, 0, v20, vcc
    v_cmp_eq_u32 vcc, 1, v19
    s_nop 1
    v_cndmask_b32 v25, 0, v20, vcc
    v_cmp_eq_u32 vcc, 2, v19
    s_nop 1
    v_cndmask_b32 v26, 0, v20, vcc
    v_cmp_eq_u32 vcc, 3, v19
    s_nop 1
    v_cndmask_b32 v27, 0, v20, vcc
    v_add_u32 v21, 49664, v0
    ds_write_b128 v21, v[24:27]
    v_mov_b32 v28, 0x3f803f80
    v_mov_b32 v29, 0x3f803f80
    v_mov_b32 v30, 0x3f803f80
    v_mov_b32 v31, 0x3f803f80
    ds_write_b128 v21, v[28:31] offset:1024
    v_mov_b32 v28, 0x3f003f00
    v_mov_b32 v29, 0x3f003f00
    v_mov_b32 v30, 0x3f003f00
    v_mov_b32 v31, 0x3f003f00
    ds_write_b128 v21, v[28:31] offset:2048
    v_mov_b32 v28, 0x0
    v_mov_b32 v29, 0x0
    v_mov_b32 v30, 0x0
    v_mov_b32 v31, 0x0
    ds_write_b128 v21, v[28:31] offset:3072
    s_lshr_b32 s45, s8, 2
    s_add_u32 s44, s8, 0
    s_and_b32 s44, s44, 1
    s_lshl_b32 s44, s44, 15
    s_add_u32 s16, s44, 3145728
    s_add_u32 s44, s45, 0
    s_and_b32 s44, s44, 1
    s_lshl_b32 s44, s44, 10
    s_add_u32 s18, s44, 3145728
    s_add_u32 s44, s8, 1
    s_and_b32 s44, s44, 1
    s_lshl_b32 s44, s44, 15
    s_add_u32 s17, s44, 3145728
    s_add_u32 s44, s45, 1
    s_and_b32 s44, s44, 1
    s_lshl_b32 s44, s44, 10
    s_add_u32 s19, s44, 3145728
    s_mov_b32 s38, 0x3e0293ee
    s_mov_b32 s39, 0x3e0293ee
    s_mov_b32 s32, 0x000f000f
    s_mov_b32 s33, 0x000f000f
    s_add_u32 s44, s9, 1
    s_and_b32 s44, s44, 3
    s_lshl_b32 s44, s44, 10
    s_add_u32 s34, s44, 40960
    s_add_u32 s44, s9, 2
    s_and_b32 s44, s44, 3
    s_lshl_b32 s44, s44, 10
    s_add_u32 s35, s44, 40960
    s_add_u32 s44, s9, 3
    s_and_b32 s44, s44, 3
    s_lshl_b32 s44, s44, 10
    s_add_u32 s36, s44, 40960
    s_lshl_b32 s44, s9, 10
    s_add_u32 s37, s44, 40960
    s_lshl_b32 s44, s8, 13
    s_lshl_b32 s50, s9, 11
    s_add_u32 s44, s44, s50
    s_add_u32 s24, s44, 16777216
    s_add_u32 s25, s44, 33554432
    s_add_u32 s28, s50, 0
    s_add_u32 s29, s50, 8192
    s_lshl_b32 s44, s8, 11
    s_lshl_b32 s45, s9, 9
    s_add_u32 s26, s44, s45
    s_lshl_b32 s27, s26, 1
    s_add_u32 s27, s27, 8388608
    s_add_u32 s26, s26, 4194304
    s_mov_b32 s13, 3678208
    s_mov_b32 s14, 3686400
    s_mov_b32 s10, 0
    s_mov_b32 s11, 0
    s_mov_b32 s80, s60
    s_and_b32 s81, s61, 0xffff
    s_mov_b32 s82, 4194304
    s_mov_b32 s83, 0x00020000
    s_mov_b32 s84, s62
    s_and_b32 s85, s63, 0xffff
    s_mov_b32 s86, 4194304
    s_mov_b32 s87, 0x00020000
    s_mov_b32 s88, s64
    s_and_b32 s89, s65, 0xffff
    s_mov_b32 s90, 4194304
    s_mov_b32 s91, 0x00020000
    s_mov_b32 s92, s66
    s_and_b32 s93, s67, 0xffff
    s_mov_b32 s94, 4194304
    s_mov_b32 s95, 0x00020000
    v_lshrrev_b32 v16, 3, v13
    s_and_b32 s44, s9, 1
    s_lshl_b32 s44, s44, 6
    v_add_u32 v16, s44, v16
    v_lshlrev_b32 v16, 13, v16
    v_and_b32 v17, 7, v13
    v_lshl_add_u32 v16, v17, 4, v16
    s_lshl_b32 s44, s8, 8
    s_lshr_b32 s45, s9, 1
    s_lshl_b32 s45, s45, 7
    s_add_u32 s44, s44, s45
    v_add_u32 v16, s44, v16
    v_lshlrev_b32 v17, 10, v15
    v_lshl_add_u32 v17, v14, 4, v17
    s_lshl_b32 s44, s8, 17
    s_lshl_b32 s45, s9, 8
    s_add_u32 s44, s44, s45
    v_add_u32 v17, s44, v17
    s_lshl_b32 s46, s9, 13
    s_add_u32 s46, s46, 0
    v_add_u32 v18, s46, v0
    v_add_u32 v19, s31, v0
    v_and_b32 v20, 1, v15
    v_lshlrev_b32 v20, 2, v20
    v_lshrrev_b32 v21, 1, v15
    v_add_u32 v20, v20, v21
    v_lshlrev_b32 v20, 7, v20
    v_lshl_add_u32 v20, v14, 2, v20
    s_lshr_b32 s44, s9, 1
    s_lshl_b32 s44, s44, 14
    s_and_b32 s45, s9, 1
    s_lshl_b32 s45, s45, 6
    s_add_u32 s44, s44, s45
    s_add_u32 s44, s44, 0
    v_add_u32 v20, s44, v20
    v_lshlrev_b32 v21, 10, v15
    v_lshl_add_u32 v21, v14, 2, v21
    v_add_u32 v21, s46, v21
    s_and_b32 s44, s8, 1
    s_lshl_b32 s44, s44, 7
    s_xor_b32 s45, s44, 128
    v_add_u32 v22, s45, v21
    v_add_u32 v21, s44, v21
    s_mov_b32 s20, 0x05040100
    s_mov_b32 s21, 0x07060302
    s_add_u32 s45, s9, 0
    s_and_b32 s45, s45, 3
    s_lshl_b32 s45, s45, 15
    s_add_u32 s44, s45, 0
    buffer_load_dwordx4 v[24:27], v17, s[92:95], s44 offen
    s_add_u32 s44, s45, 4096
    buffer_load_dwordx4 v[28:31], v17, s[92:95], s44 offen
    s_add_u32 s44, s45, 8192
    buffer_load_dwordx4 v[32:35], v17, s[92:95], s44 offen
    s_add_u32 s44, s45, 12288
    buffer_load_dwordx4 v[36:39], v17, s[92:95], s44 offen
    s_add_u32 s44, s45, 16384
    buffer_load_dwordx4 v[40:43], v17, s[92:95], s44 offen
    s_add_u32 s44, s45, 20480
    buffer_load_dwordx4 v[44:47], v17, s[92:95], s44 offen
    s_add_u32 s44, s45, 24576
    buffer_load_dwordx4 v[48:51], v17, s[92:95], s44 offen
    s_add_u32 s44, s45, 28672
    buffer_load_dwordx4 v[52:55], v17, s[92:95], s44 offen
    s_add_u32 s45, s9, 1
    s_and_b32 s45, s45, 3
    s_lshl_b32 s45, s45, 15
    s_add_u32 s44, s45, 0
    buffer_load_dwordx4 v[96:99], v17, s[92:95], s44 offen
    s_add_u32 s44, s45, 4096
    buffer_load_dwordx4 v[100:103], v17, s[92:95], s44 offen
    s_add_u32 s44, s45, 8192
    buffer_load_dwordx4 v[104:107], v17, s[92:95], s44 offen
    s_add_u32 s44, s45, 12288
    buffer_load_dwordx4 v[108:111], v17, s[92:95], s44 offen
    s_add_u32 s44, s45, 16384
    buffer_load_dwordx4 v[112:115], v17, s[92:95], s44 offen
    s_add_u32 s44, s45, 20480
    buffer_load_dwordx4 v[116:119], v17, s[92:95], s44 offen
    s_add_u32 s44, s45, 24576
    buffer_load_dwordx4 v[120:123], v17, s[92:95], s44 offen
    s_add_u32 s44, s45, 28672
    buffer_load_dwordx4 v[124:127], v17, s[92:95], s44 offen
    s_add_u32 s45, s9, 2
    s_and_b32 s45, s45, 3
    s_lshl_b32 s45, s45, 15
    s_add_u32 s44, s45, 0
    buffer_load_dwordx4 v[128:131], v17, s[92:95], s44 offen
    s_add_u32 s44, s45, 4096
    buffer_load_dwordx4 v[132:135], v17, s[92:95], s44 offen
    s_add_u32 s44, s45, 8192
    buffer_load_dwordx4 v[136:139], v17, s[92:95], s44 offen
    s_add_u32 s44, s45, 12288
    buffer_load_dwordx4 v[140:143], v17, s[92:95], s44 offen
    s_add_u32 s44, s45, 16384
    buffer_load_dwordx4 v[144:147], v17, s[92:95], s44 offen
    s_add_u32 s44, s45, 20480
    buffer_load_dwordx4 v[148:151], v17, s[92:95], s44 offen
    s_add_u32 s44, s45, 24576
    buffer_load_dwordx4 v[152:155], v17, s[92:95], s44 offen
    s_add_u32 s44, s45, 28672
    buffer_load_dwordx4 v[156:159], v17, s[92:95], s44 offen
    s_add_u32 s45, s9, 3
    s_and_b32 s45, s45, 3
    s_lshl_b32 s45, s45, 15
    s_add_u32 s44, s45, 0
    buffer_load_dwordx4 v[160:163], v17, s[92:95], s44 offen
    s_add_u32 s44, s45, 4096
    buffer_load_dwordx4 v[164:167], v17, s[92:95], s44 offen
    s_add_u32 s44, s45, 8192
    buffer_load_dwordx4 v[168:171], v17, s[92:95], s44 offen
    s_add_u32 s44, s45, 12288
    buffer_load_dwordx4 v[172:175], v17, s[92:95], s44 offen
    s_add_u32 s44, s45, 16384
    buffer_load_dwordx4 v[176:179], v17, s[92:95], s44 offen
    s_add_u32 s44, s45, 20480
    buffer_load_dwordx4 v[180:183], v17, s[92:95], s44 offen
    s_add_u32 s44, s45, 24576
    buffer_load_dwordx4 v[184:187], v17, s[92:95], s44 offen
    s_add_u32 s44, s45, 28672
    buffer_load_dwordx4 v[188:191], v17, s[92:95], s44 offen
    s_mov_b32 s44, 0
    buffer_load_dwordx4 v[192:195], v16, s[88:91], s44 offen
    s_mov_b32 s44, 65536
    buffer_load_dwordx4 v[196:199], v16, s[88:91], s44 offen
    s_mov_b32 s44, 131072
    buffer_load_dwordx4 v[200:203], v16, s[88:91], s44 offen
    s_mov_b32 s44, 196608
    buffer_load_dwordx4 v[204:207], v16, s[88:91], s44 offen
    s_mov_b32 s44, 262144
    buffer_load_dwordx4 v[208:211], v16, s[88:91], s44 offen
    s_mov_b32 s44, 327680
    buffer_load_dwordx4 v[212:215], v16, s[88:91], s44 offen
    s_mov_b32 s44, 393216
    buffer_load_dwordx4 v[216:219], v16, s[88:91], s44 offen
    s_mov_b32 s44, 458752
    buffer_load_dwordx4 v[220:223], v16, s[88:91], s44 offen
    s_mov_b32 s44, 1048576
    buffer_load_dwordx4 v[224:227], v16, s[88:91], s44 offen
    s_mov_b32 s44, 1114112
    buffer_load_dwordx4 v[228:231], v16, s[88:91], s44 offen
    s_mov_b32 s44, 1179648
    buffer_load_dwordx4 v[232:235], v16, s[88:91], s44 offen
    s_mov_b32 s44, 1245184
    buffer_load_dwordx4 v[236:239], v16, s[88:91], s44 offen
    s_mov_b32 s44, 1310720
    buffer_load_dwordx4 v[240:243], v16, s[88:91], s44 offen
    s_mov_b32 s44, 1376256
    buffer_load_dwordx4 v[244:247], v16, s[88:91], s44 offen
    s_mov_b32 s44, 1441792
    buffer_load_dwordx4 v[248:251], v16, s[88:91], s44 offen
    s_mov_b32 s44, 1507328
    buffer_load_dwordx4 v[252:255], v16, s[88:91], s44 offen
    v_mov_b32 v88, -1
    v_mov_b32 v89, -1
    v_mov_b32 v90, -1
    v_mov_b32 v91, -1
    s_mov_b32 s44, 3145728
    buffer_store_dwordx4 v[88:91], v6, s[4:7], s44 offen offset:0 sc1
    buffer_store_dwordx4 v[88:91], v6, s[4:7], s44 offen offset:1024 sc1
    s_mov_b32 s44, 3407872
    buffer_store_dwordx4 v[88:91], v6, s[4:7], s44 offen offset:0 sc1
    buffer_store_dwordx4 v[88:91], v6, s[4:7], s44 offen offset:1024 sc1
    s_mov_b64 exec, s[32:33]
    s_mov_b32 s44, 3670016
    buffer_store_dword v88, v7, s[4:7], s44 offen sc1
    s_mov_b32 s44, 3678208
    buffer_store_dword v88, v7, s[4:7], s44 offen sc1
    s_mov_b32 s44, 3686400
    buffer_store_dword v88, v7, s[4:7], s44 offen sc1
    s_mov_b64 exec, -1
    s_mov_b32 s40, s68
    s_mov_b32 s41, s69
    s_mov_b32 s42, 8192
    s_mov_b32 s43, 0x00020000
    v_add_u32 v60, 0, v11
    v_and_b32 v61, 7, v60
    v_lshrrev_b32 v62, 4, v60
    v_bfe_u32 v63, v60, 3, 1
    v_lshrrev_b32 v64, 3, v62
    v_lshlrev_b32 v64, 7, v64
    v_bfe_u32 v65, v62, 2, 1
    v_lshl_add_u32 v64, v65, 6, v64
    v_and_b32 v65, 3, v62
    v_lshl_add_u32 v64, v65, 3, v64
    v_add_u32 v64, v64, v63
    v_lshlrev_b32 v64, 1, v64
    v_lshl_add_u32 v64, v61, 10, v64
    buffer_load_ushort v68, v64, s[40:43], 0 offen offset:0
    buffer_load_ushort v72, v64, s[40:43], 0 offen offset:64
    buffer_load_ushort v69, v64, s[40:43], 0 offen offset:4
    buffer_load_ushort v73, v64, s[40:43], 0 offen offset:68
    buffer_load_ushort v70, v64, s[40:43], 0 offen offset:8
    buffer_load_ushort v74, v64, s[40:43], 0 offen offset:72
    buffer_load_ushort v71, v64, s[40:43], 0 offen offset:12
    buffer_load_ushort v75, v64, s[40:43], 0 offen offset:76
    s_waitcnt vmcnt(6)
    v_lshl_or_b32 v68, v72, 16, v68
    s_waitcnt vmcnt(4)
    v_lshl_or_b32 v69, v73, 16, v69
    s_waitcnt vmcnt(2)
    v_lshl_or_b32 v70, v74, 16, v70
    s_waitcnt vmcnt(0)
    v_lshl_or_b32 v71, v75, 16, v71
    v_lshlrev_b32 v60, 4, v60
    ds_write_b128 v60, v[68:71] offset:32768
    v_add_u32 v60, 256, v11
    v_and_b32 v61, 7, v60
    v_lshrrev_b32 v62, 4, v60
    v_bfe_u32 v63, v60, 3, 1
    v_lshrrev_b32 v64, 3, v62
    v_lshlrev_b32 v64, 7, v64
    v_bfe_u32 v65, v62, 2, 1
    v_lshl_add_u32 v64, v65, 6, v64
    v_and_b32 v65, 3, v62
    v_lshl_add_u32 v64, v65, 3, v64
    v_add_u32 v64, v64, v63
    v_lshlrev_b32 v64, 1, v64
    v_lshl_add_u32 v64, v61, 10, v64
    buffer_load_ushort v68, v64, s[40:43], 0 offen offset:0
    buffer_load_ushort v72, v64, s[40:43], 0 offen offset:64
    buffer_load_ushort v69, v64, s[40:43], 0 offen offset:4
    buffer_load_ushort v73, v64, s[40:43], 0 offen offset:68
    buffer_load_ushort v70, v64, s[40:43], 0 offen offset:8
    buffer_load_ushort v74, v64, s[40:43], 0 offen offset:72
    buffer_load_ushort v71, v64, s[40:43], 0 offen offset:12
    buffer_load_ushort v75, v64, s[40:43], 0 offen offset:76
    s_waitcnt vmcnt(6)
    v_lshl_or_b32 v68, v72, 16, v68
    s_waitcnt vmcnt(4)
    v_lshl_or_b32 v69, v73, 16, v69
    s_waitcnt vmcnt(2)
    v_lshl_or_b32 v70, v74, 16, v70
    s_waitcnt vmcnt(0)
    v_lshl_or_b32 v71, v75, 16, v71
    v_lshlrev_b32 v60, 4, v60
    ds_write_b128 v60, v[68:71] offset:32768
    s_waitcnt lgkmcnt(0)
    ds_write_b128 v18, v[24:27] offset:0
    ds_write_b128 v18, v[28:31] offset:1024
    ds_write_b128 v18, v[32:35] offset:2048
    ds_write_b128 v18, v[36:39] offset:3072
    ds_write_b128 v18, v[40:43] offset:4096
    ds_write_b128 v18, v[44:47] offset:5120
    ds_write_b128 v18, v[48:51] offset:6144
    ds_write_b128 v18, v[52:55] offset:7168
    s_waitcnt lgkmcnt(0)
    ds_read_b32 a128, v21 offset:0
    ds_read_b32 a129, v21 offset:256
    ds_read_b32 a130, v21 offset:512
    ds_read_b32 a131, v21 offset:768
    ds_read_b32 a132, v21 offset:4096
    ds_read_b32 a133, v21 offset:4352
    ds_read_b32 a134, v21 offset:4608
    ds_read_b32 a135, v21 offset:4864
    ds_read_b32 a136, v21 offset:64
    ds_read_b32 a137, v21 offset:320
    ds_read_b32 a138, v21 offset:576
    ds_read_b32 a139, v21 offset:832
    ds_read_b32 a140, v21 offset:4160
    ds_read_b32 a141, v21 offset:4416
    ds_read_b32 a142, v21 offset:4672
    ds_read_b32 a143, v21 offset:4928
    ds_read_b32 a144, v22 offset:0
    ds_read_b32 a145, v22 offset:256
    ds_read_b32 a146, v22 offset:512
    ds_read_b32 a147, v22 offset:768
    ds_read_b32 a148, v22 offset:4096
    ds_read_b32 a149, v22 offset:4352
    ds_read_b32 a150, v22 offset:4608
    ds_read_b32 a151, v22 offset:4864
    ds_read_b32 a152, v22 offset:64
    ds_read_b32 a153, v22 offset:320
    ds_read_b32 a154, v22 offset:576
    ds_read_b32 a155, v22 offset:832
    ds_read_b32 a156, v22 offset:4160
    ds_read_b32 a157, v22 offset:4416
    ds_read_b32 a158, v22 offset:4672
    ds_read_b32 a159, v22 offset:4928
    s_mov_b32 s44, 2097152
    buffer_load_dwordx4 v[24:27], v16, s[88:91], s44 offen
    s_mov_b32 s44, 2162688
    buffer_load_dwordx4 v[28:31], v16, s[88:91], s44 offen
    s_mov_b32 s44, 2228224
    buffer_load_dwordx4 v[32:35], v16, s[88:91], s44 offen
    s_mov_b32 s44, 2293760
    buffer_load_dwordx4 v[36:39], v16, s[88:91], s44 offen
    s_mov_b32 s44, 2359296
    buffer_load_dwordx4 v[40:43], v16, s[88:91], s44 offen
    s_mov_b32 s44, 2424832
    buffer_load_dwordx4 v[44:47], v16, s[88:91], s44 offen
    s_mov_b32 s44, 2490368
    buffer_load_dwordx4 v[48:51], v16, s[88:91], s44 offen
    s_mov_b32 s44, 2555904
    buffer_load_dwordx4 v[52:55], v16, s[88:91], s44 offen
    s_waitcnt lgkmcnt(0)
    ds_write_b128 v18, v[96:99] offset:0
    ds_write_b128 v18, v[100:103] offset:1024
    ds_write_b128 v18, v[104:107] offset:2048
    ds_write_b128 v18, v[108:111] offset:3072
    ds_write_b128 v18, v[112:115] offset:4096
    ds_write_b128 v18, v[116:119] offset:5120
    ds_write_b128 v18, v[120:123] offset:6144
    ds_write_b128 v18, v[124:127] offset:7168
    s_waitcnt lgkmcnt(0)
    ds_read_b32 a160, v21 offset:0
    ds_read_b32 a161, v21 offset:256
    ds_read_b32 a162, v21 offset:512
    ds_read_b32 a163, v21 offset:768
    ds_read_b32 a164, v21 offset:4096
    ds_read_b32 a165, v21 offset:4352
    ds_read_b32 a166, v21 offset:4608
    ds_read_b32 a167, v21 offset:4864
    ds_read_b32 a168, v21 offset:64
    ds_read_b32 a169, v21 offset:320
    ds_read_b32 a170, v21 offset:576
    ds_read_b32 a171, v21 offset:832
    ds_read_b32 a172, v21 offset:4160
    ds_read_b32 a173, v21 offset:4416
    ds_read_b32 a174, v21 offset:4672
    ds_read_b32 a175, v21 offset:4928
    ds_read_b32 a176, v22 offset:0
    ds_read_b32 a177, v22 offset:256
    ds_read_b32 a178, v22 offset:512
    ds_read_b32 a179, v22 offset:768
    ds_read_b32 a180, v22 offset:4096
    ds_read_b32 a181, v22 offset:4352
    ds_read_b32 a182, v22 offset:4608
    ds_read_b32 a183, v22 offset:4864
    ds_read_b32 a184, v22 offset:64
    ds_read_b32 a185, v22 offset:320
    ds_read_b32 a186, v22 offset:576
    ds_read_b32 a187, v22 offset:832
    ds_read_b32 a188, v22 offset:4160
    ds_read_b32 a189, v22 offset:4416
    ds_read_b32 a190, v22 offset:4672
    ds_read_b32 a191, v22 offset:4928
    s_mov_b32 s44, 3145728
    buffer_load_dwordx4 v[96:99], v16, s[88:91], s44 offen
    s_mov_b32 s44, 3211264
    buffer_load_dwordx4 v[100:103], v16, s[88:91], s44 offen
    s_mov_b32 s44, 3276800
    buffer_load_dwordx4 v[104:107], v16, s[88:91], s44 offen
    s_mov_b32 s44, 3342336
    buffer_load_dwordx4 v[108:111], v16, s[88:91], s44 offen
    s_mov_b32 s44, 3407872
    buffer_load_dwordx4 v[112:115], v16, s[88:91], s44 offen
    s_mov_b32 s44, 3473408
    buffer_load_dwordx4 v[116:119], v16, s[88:91], s44 offen
    s_mov_b32 s44, 3538944
    buffer_load_dwordx4 v[120:123], v16, s[88:91], s44 offen
    s_mov_b32 s44, 3604480
    buffer_load_dwordx4 v[124:127], v16, s[88:91], s44 offen
    s_waitcnt lgkmcnt(0)
    ds_write_b128 v18, v[128:131] offset:0
    ds_write_b128 v18, v[132:135] offset:1024
    ds_write_b128 v18, v[136:139] offset:2048
    ds_write_b128 v18, v[140:143] offset:3072
    ds_write_b128 v18, v[144:147] offset:4096
    ds_write_b128 v18, v[148:151] offset:5120
    ds_write_b128 v18, v[152:155] offset:6144
    ds_write_b128 v18, v[156:159] offset:7168
    s_waitcnt lgkmcnt(0)
    ds_read_b32 a192, v21 offset:0
    ds_read_b32 a193, v21 offset:256
    ds_read_b32 a194, v21 offset:512
    ds_read_b32 a195, v21 offset:768
    ds_read_b32 a196, v21 offset:4096
    ds_read_b32 a197, v21 offset:4352
    ds_read_b32 a198, v21 offset:4608
    ds_read_b32 a199, v21 offset:4864
    ds_read_b32 a200, v21 offset:64
    ds_read_b32 a201, v21 offset:320
    ds_read_b32 a202, v21 offset:576
    ds_read_b32 a203, v21 offset:832
    ds_read_b32 a204, v21 offset:4160
    ds_read_b32 a205, v21 offset:4416
    ds_read_b32 a206, v21 offset:4672
    ds_read_b32 a207, v21 offset:4928
    ds_read_b32 a208, v22 offset:0
    ds_read_b32 a209, v22 offset:256
    ds_read_b32 a210, v22 offset:512
    ds_read_b32 a211, v22 offset:768
    ds_read_b32 a212, v22 offset:4096
    ds_read_b32 a213, v22 offset:4352
    ds_read_b32 a214, v22 offset:4608
    ds_read_b32 a215, v22 offset:4864
    ds_read_b32 a216, v22 offset:64
    ds_read_b32 a217, v22 offset:320
    ds_read_b32 a218, v22 offset:576
    ds_read_b32 a219, v22 offset:832
    ds_read_b32 a220, v22 offset:4160
    ds_read_b32 a221, v22 offset:4416
    ds_read_b32 a222, v22 offset:4672
    ds_read_b32 a223, v22 offset:4928
    s_waitcnt vmcnt(32)
    s_barrier
    s_cmp_lg_u32 s9, 0
    s_cbranch_scc1 L_adaLN_cond__memory_aug_recurrent_mem_tr__dense_activation_gelu__prompt_kernel_r_ri
    v_mov_b32 v9, 84
    v_mov_b32 v10, 1
    s_mov_b64 exec, 1
    global_atomic_add v9, v10, s[56:57]
    s_mov_b64 exec, -1
L_adaLN_cond__memory_aug_recurrent_mem_tr__dense_activation_gelu__prompt_kernel_r_ri:
    s_mov_b32 s44, 3145728
    buffer_load_dwordx4 v[128:131], v16, s[80:83], s44 offen
    s_mov_b32 s44, 3211264
    buffer_load_dwordx4 v[132:135], v16, s[80:83], s44 offen
    s_mov_b32 s44, 3276800
    buffer_load_dwordx4 v[136:139], v16, s[80:83], s44 offen
    s_mov_b32 s44, 3342336
    buffer_load_dwordx4 v[140:143], v16, s[80:83], s44 offen
    s_mov_b32 s44, 3407872
    buffer_load_dwordx4 v[144:147], v16, s[80:83], s44 offen
    s_mov_b32 s44, 3473408
    buffer_load_dwordx4 v[148:151], v16, s[80:83], s44 offen
    s_mov_b32 s44, 3538944
    buffer_load_dwordx4 v[152:155], v16, s[80:83], s44 offen
    s_mov_b32 s44, 3604480
    buffer_load_dwordx4 v[156:159], v16, s[80:83], s44 offen
    s_waitcnt lgkmcnt(0)
    ds_write_b128 v18, v[160:163] offset:0
    ds_write_b128 v18, v[164:167] offset:1024
    ds_write_b128 v18, v[168:171] offset:2048
    ds_write_b128 v18, v[172:175] offset:3072
    ds_write_b128 v18, v[176:179] offset:4096
    ds_write_b128 v18, v[180:183] offset:5120
    ds_write_b128 v18, v[184:187] offset:6144
    ds_write_b128 v18, v[188:191] offset:7168
    s_waitcnt lgkmcnt(0)
    ds_read_b32 a224, v21 offset:0
    ds_read_b32 a225, v21 offset:256
    ds_read_b32 a226, v21 offset:512
    ds_read_b32 a227, v21 offset:768
    ds_read_b32 a228, v21 offset:4096
    ds_read_b32 a229, v21 offset:4352
    ds_read_b32 a230, v21 offset:4608
    ds_read_b32 a231, v21 offset:4864
    ds_read_b32 a232, v21 offset:64
    ds_read_b32 a233, v21 offset:320
    ds_read_b32 a234, v21 offset:576
    ds_read_b32 a235, v21 offset:832
    ds_read_b32 a236, v21 offset:4160
    ds_read_b32 a237, v21 offset:4416
    ds_read_b32 a238, v21 offset:4672
    ds_read_b32 a239, v21 offset:4928
    ds_read_b32 a240, v22 offset:0
    ds_read_b32 a241, v22 offset:256
    ds_read_b32 a242, v22 offset:512
    ds_read_b32 a243, v22 offset:768
    ds_read_b32 a244, v22 offset:4096
    ds_read_b32 a245, v22 offset:4352
    ds_read_b32 a246, v22 offset:4608
    ds_read_b32 a247, v22 offset:4864
    ds_read_b32 a248, v22 offset:64
    ds_read_b32 a249, v22 offset:320
    ds_read_b32 a250, v22 offset:576
    ds_read_b32 a251, v22 offset:832
    ds_read_b32 a252, v22 offset:4160
    ds_read_b32 a253, v22 offset:4416
    ds_read_b32 a254, v22 offset:4672
    ds_read_b32 a255, v22 offset:4928
    s_mov_b32 s44, 3145728
    buffer_load_dwordx4 v[160:163], v16, s[84:87], s44 offen
    s_mov_b32 s44, 3211264
    buffer_load_dwordx4 v[164:167], v16, s[84:87], s44 offen
    s_mov_b32 s44, 3276800
    buffer_load_dwordx4 v[168:171], v16, s[84:87], s44 offen
    s_mov_b32 s44, 3342336
    buffer_load_dwordx4 v[172:175], v16, s[84:87], s44 offen
    s_mov_b32 s44, 3407872
    buffer_load_dwordx4 v[176:179], v16, s[84:87], s44 offen
    s_mov_b32 s44, 3473408
    buffer_load_dwordx4 v[180:183], v16, s[84:87], s44 offen
    s_mov_b32 s44, 3538944
    buffer_load_dwordx4 v[184:187], v16, s[84:87], s44 offen
    s_mov_b32 s44, 3604480
    buffer_load_dwordx4 v[188:191], v16, s[84:87], s44 offen
    s_waitcnt lgkmcnt(0)
    s_barrier
    ds_write_b128 v18, v[192:195] offset:0
    ds_write_b128 v18, v[196:199] offset:1024
    ds_write_b128 v18, v[200:203] offset:2048
    ds_write_b128 v18, v[204:207] offset:3072
    ds_write_b128 v18, v[208:211] offset:4096
    ds_write_b128 v18, v[212:215] offset:5120
    ds_write_b128 v18, v[216:219] offset:6144
    ds_write_b128 v18, v[220:223] offset:7168
    s_waitcnt lgkmcnt(0)
    s_barrier
    ds_read_b32 v88, v20 offset:0
    ds_read_b32 v89, v20 offset:2048
    ds_read_b32 v90, v20 offset:4096
    ds_read_b32 v91, v20 offset:6144
    ds_read_b32 v92, v20 offset:256
    ds_read_b32 v93, v20 offset:2304
    ds_read_b32 v94, v20 offset:4352
    ds_read_b32 v95, v20 offset:6400
    s_waitcnt lgkmcnt(6)
    v_perm_b32 v23, v89, v88, s20
    v_accvgpr_write_b32 a0, v23
    s_waitcnt lgkmcnt(4)
    v_perm_b32 v23, v91, v90, s20
    v_accvgpr_write_b32 a1, v23
    s_waitcnt lgkmcnt(2)
    v_perm_b32 v23, v93, v92, s20
    v_accvgpr_write_b32 a2, v23
    s_waitcnt lgkmcnt(0)
    v_perm_b32 v23, v95, v94, s20
    v_accvgpr_write_b32 a3, v23
    v_perm_b32 v23, v89, v88, s21
    v_accvgpr_write_b32 a8, v23
    v_perm_b32 v23, v91, v90, s21
    v_accvgpr_write_b32 a9, v23
    v_perm_b32 v23, v93, v92, s21
    v_accvgpr_write_b32 a10, v23
    v_perm_b32 v23, v95, v94, s21
    v_accvgpr_write_b32 a11, v23
    ds_read_b32 v88, v20 offset:1024
    ds_read_b32 v89, v20 offset:3072
    ds_read_b32 v90, v20 offset:5120
    ds_read_b32 v91, v20 offset:7168
    ds_read_b32 v92, v20 offset:1280
    ds_read_b32 v93, v20 offset:3328
    ds_read_b32 v94, v20 offset:5376
    ds_read_b32 v95, v20 offset:7424
    s_waitcnt lgkmcnt(6)
    v_perm_b32 v23, v89, v88, s20
    v_accvgpr_write_b32 a4, v23
    s_waitcnt lgkmcnt(4)
    v_perm_b32 v23, v91, v90, s20
    v_accvgpr_write_b32 a5, v23
    s_waitcnt lgkmcnt(2)
    v_perm_b32 v23, v93, v92, s20
    v_accvgpr_write_b32 a6, v23
    s_waitcnt lgkmcnt(0)
    v_perm_b32 v23, v95, v94, s20
    v_accvgpr_write_b32 a7, v23
    v_perm_b32 v23, v89, v88, s21
    v_accvgpr_write_b32 a12, v23
    v_perm_b32 v23, v91, v90, s21
    v_accvgpr_write_b32 a13, v23
    v_perm_b32 v23, v93, v92, s21
    v_accvgpr_write_b32 a14, v23
    v_perm_b32 v23, v95, v94, s21
    v_accvgpr_write_b32 a15, v23
    ds_read_b32 v88, v20 offset:8192
    ds_read_b32 v89, v20 offset:10240
    ds_read_b32 v90, v20 offset:12288
    ds_read_b32 v91, v20 offset:14336
    ds_read_b32 v92, v20 offset:8448
    ds_read_b32 v93, v20 offset:10496
    ds_read_b32 v94, v20 offset:12544
    ds_read_b32 v95, v20 offset:14592
    s_waitcnt lgkmcnt(6)
    v_perm_b32 v23, v89, v88, s20
    v_accvgpr_write_b32 a16, v23
    s_waitcnt lgkmcnt(4)
    v_perm_b32 v23, v91, v90, s20
    v_accvgpr_write_b32 a17, v23
    s_waitcnt lgkmcnt(2)
    v_perm_b32 v23, v93, v92, s20
    v_accvgpr_write_b32 a18, v23
    s_waitcnt lgkmcnt(0)
    v_perm_b32 v23, v95, v94, s20
    v_accvgpr_write_b32 a19, v23
    v_perm_b32 v23, v89, v88, s21
    v_accvgpr_write_b32 a24, v23
    v_perm_b32 v23, v91, v90, s21
    v_accvgpr_write_b32 a25, v23
    v_perm_b32 v23, v93, v92, s21
    v_accvgpr_write_b32 a26, v23
    v_perm_b32 v23, v95, v94, s21
    v_accvgpr_write_b32 a27, v23
    ds_read_b32 v88, v20 offset:9216
    ds_read_b32 v89, v20 offset:11264
    ds_read_b32 v90, v20 offset:13312
    ds_read_b32 v91, v20 offset:15360
    ds_read_b32 v92, v20 offset:9472
    ds_read_b32 v93, v20 offset:11520
    ds_read_b32 v94, v20 offset:13568
    ds_read_b32 v95, v20 offset:15616
    s_waitcnt lgkmcnt(6)
    v_perm_b32 v23, v89, v88, s20
    v_accvgpr_write_b32 a20, v23
    s_waitcnt lgkmcnt(4)
    v_perm_b32 v23, v91, v90, s20
    v_accvgpr_write_b32 a21, v23
    s_waitcnt lgkmcnt(2)
    v_perm_b32 v23, v93, v92, s20
    v_accvgpr_write_b32 a22, v23
    s_waitcnt lgkmcnt(0)
    v_perm_b32 v23, v95, v94, s20
    v_accvgpr_write_b32 a23, v23
    v_perm_b32 v23, v89, v88, s21
    v_accvgpr_write_b32 a28, v23
    v_perm_b32 v23, v91, v90, s21
    v_accvgpr_write_b32 a29, v23
    v_perm_b32 v23, v93, v92, s21
    v_accvgpr_write_b32 a30, v23
    v_perm_b32 v23, v95, v94, s21
    v_accvgpr_write_b32 a31, v23
    s_mov_b32 s44, 2097152
    buffer_load_dwordx4 v[56:59], v16, s[80:83], s44 offen
    s_mov_b32 s44, 2162688
    buffer_load_dwordx4 v[60:63], v16, s[80:83], s44 offen
    s_mov_b32 s44, 2228224
    buffer_load_dwordx4 v[64:67], v16, s[80:83], s44 offen
    s_mov_b32 s44, 2293760
    buffer_load_dwordx4 v[68:71], v16, s[80:83], s44 offen
    s_mov_b32 s44, 2359296
    buffer_load_dwordx4 v[72:75], v16, s[80:83], s44 offen
    s_mov_b32 s44, 2424832
    buffer_load_dwordx4 v[76:79], v16, s[80:83], s44 offen
    s_mov_b32 s44, 2490368
    buffer_load_dwordx4 v[80:83], v16, s[80:83], s44 offen
    s_mov_b32 s44, 2555904
    buffer_load_dwordx4 v[84:87], v16, s[80:83], s44 offen
    s_waitcnt lgkmcnt(0)
    s_barrier
    ds_write_b128 v18, v[224:227] offset:0
    ds_write_b128 v18, v[228:231] offset:1024
    ds_write_b128 v18, v[232:235] offset:2048
    ds_write_b128 v18, v[236:239] offset:3072
    ds_write_b128 v18, v[240:243] offset:4096
    ds_write_b128 v18, v[244:247] offset:5120
    ds_write_b128 v18, v[248:251] offset:6144
    ds_write_b128 v18, v[252:255] offset:7168
    s_waitcnt lgkmcnt(0)
    s_barrier
    ds_read_b32 v88, v20 offset:0
    ds_read_b32 v89, v20 offset:2048
    ds_read_b32 v90, v20 offset:4096
    ds_read_b32 v91, v20 offset:6144
    ds_read_b32 v92, v20 offset:256
    ds_read_b32 v93, v20 offset:2304
    ds_read_b32 v94, v20 offset:4352
    ds_read_b32 v95, v20 offset:6400
    s_waitcnt lgkmcnt(6)
    v_perm_b32 v23, v89, v88, s20
    v_accvgpr_write_b32 a32, v23
    s_waitcnt lgkmcnt(4)
    v_perm_b32 v23, v91, v90, s20
    v_accvgpr_write_b32 a33, v23
    s_waitcnt lgkmcnt(2)
    v_perm_b32 v23, v93, v92, s20
    v_accvgpr_write_b32 a34, v23
    s_waitcnt lgkmcnt(0)
    v_perm_b32 v23, v95, v94, s20
    v_accvgpr_write_b32 a35, v23
    v_perm_b32 v23, v89, v88, s21
    v_accvgpr_write_b32 a40, v23
    v_perm_b32 v23, v91, v90, s21
    v_accvgpr_write_b32 a41, v23
    v_perm_b32 v23, v93, v92, s21
    v_accvgpr_write_b32 a42, v23
    v_perm_b32 v23, v95, v94, s21
    v_accvgpr_write_b32 a43, v23
    ds_read_b32 v88, v20 offset:1024
    ds_read_b32 v89, v20 offset:3072
    ds_read_b32 v90, v20 offset:5120
    ds_read_b32 v91, v20 offset:7168
    ds_read_b32 v92, v20 offset:1280
    ds_read_b32 v93, v20 offset:3328
    ds_read_b32 v94, v20 offset:5376
    ds_read_b32 v95, v20 offset:7424
    s_waitcnt lgkmcnt(6)
    v_perm_b32 v23, v89, v88, s20
    v_accvgpr_write_b32 a36, v23
    s_waitcnt lgkmcnt(4)
    v_perm_b32 v23, v91, v90, s20
    v_accvgpr_write_b32 a37, v23
    s_waitcnt lgkmcnt(2)
    v_perm_b32 v23, v93, v92, s20
    v_accvgpr_write_b32 a38, v23
    s_waitcnt lgkmcnt(0)
    v_perm_b32 v23, v95, v94, s20
    v_accvgpr_write_b32 a39, v23
    v_perm_b32 v23, v89, v88, s21
    v_accvgpr_write_b32 a44, v23
    v_perm_b32 v23, v91, v90, s21
    v_accvgpr_write_b32 a45, v23
    v_perm_b32 v23, v93, v92, s21
    v_accvgpr_write_b32 a46, v23
    v_perm_b32 v23, v95, v94, s21
    v_accvgpr_write_b32 a47, v23
    ds_read_b32 v88, v20 offset:8192
    ds_read_b32 v89, v20 offset:10240
    ds_read_b32 v90, v20 offset:12288
    ds_read_b32 v91, v20 offset:14336
    ds_read_b32 v92, v20 offset:8448
    ds_read_b32 v93, v20 offset:10496
    ds_read_b32 v94, v20 offset:12544
    ds_read_b32 v95, v20 offset:14592
    s_waitcnt lgkmcnt(6)
    v_perm_b32 v23, v89, v88, s20
    v_accvgpr_write_b32 a48, v23
    s_waitcnt lgkmcnt(4)
    v_perm_b32 v23, v91, v90, s20
    v_accvgpr_write_b32 a49, v23
    s_waitcnt lgkmcnt(2)
    v_perm_b32 v23, v93, v92, s20
    v_accvgpr_write_b32 a50, v23
    s_waitcnt lgkmcnt(0)
    v_perm_b32 v23, v95, v94, s20
    v_accvgpr_write_b32 a51, v23
    v_perm_b32 v23, v89, v88, s21
    v_accvgpr_write_b32 a56, v23
    v_perm_b32 v23, v91, v90, s21
    v_accvgpr_write_b32 a57, v23
    v_perm_b32 v23, v93, v92, s21
    v_accvgpr_write_b32 a58, v23
    v_perm_b32 v23, v95, v94, s21
    v_accvgpr_write_b32 a59, v23
    ds_read_b32 v88, v20 offset:9216
    ds_read_b32 v89, v20 offset:11264
    ds_read_b32 v90, v20 offset:13312
    ds_read_b32 v91, v20 offset:15360
    ds_read_b32 v92, v20 offset:9472
    ds_read_b32 v93, v20 offset:11520
    ds_read_b32 v94, v20 offset:13568
    ds_read_b32 v95, v20 offset:15616
    s_waitcnt lgkmcnt(6)
    v_perm_b32 v23, v89, v88, s20
    v_accvgpr_write_b32 a52, v23
    s_waitcnt lgkmcnt(4)
    v_perm_b32 v23, v91, v90, s20
    v_accvgpr_write_b32 a53, v23
    s_waitcnt lgkmcnt(2)
    v_perm_b32 v23, v93, v92, s20
    v_accvgpr_write_b32 a54, v23
    s_waitcnt lgkmcnt(0)
    v_perm_b32 v23, v95, v94, s20
    v_accvgpr_write_b32 a55, v23
    v_perm_b32 v23, v89, v88, s21
    v_accvgpr_write_b32 a60, v23
    v_perm_b32 v23, v91, v90, s21
    v_accvgpr_write_b32 a61, v23
    v_perm_b32 v23, v93, v92, s21
    v_accvgpr_write_b32 a62, v23
    v_perm_b32 v23, v95, v94, s21
    v_accvgpr_write_b32 a63, v23
    s_waitcnt lgkmcnt(0)
    s_barrier
    s_waitcnt vmcnt(39)
    ds_write_b128 v18, v[24:27] offset:0
    s_waitcnt vmcnt(38)
    ds_write_b128 v18, v[28:31] offset:1024
    s_waitcnt vmcnt(37)
    ds_write_b128 v18, v[32:35] offset:2048
    s_waitcnt vmcnt(36)
    ds_write_b128 v18, v[36:39] offset:3072
    s_waitcnt vmcnt(35)
    ds_write_b128 v18, v[40:43] offset:4096
    s_waitcnt vmcnt(34)
    ds_write_b128 v18, v[44:47] offset:5120
    s_waitcnt vmcnt(33)
    ds_write_b128 v18, v[48:51] offset:6144
    s_waitcnt vmcnt(32)
    ds_write_b128 v18, v[52:55] offset:7168
    s_waitcnt lgkmcnt(0)
    s_barrier
    ds_read_b32 v88, v20 offset:0
    ds_read_b32 v89, v20 offset:2048
    ds_read_b32 v90, v20 offset:4096
    ds_read_b32 v91, v20 offset:6144
    ds_read_b32 v92, v20 offset:256
    ds_read_b32 v93, v20 offset:2304
    ds_read_b32 v94, v20 offset:4352
    ds_read_b32 v95, v20 offset:6400
    s_waitcnt lgkmcnt(6)
    v_perm_b32 v23, v89, v88, s20
    v_accvgpr_write_b32 a64, v23
    s_waitcnt lgkmcnt(4)
    v_perm_b32 v23, v91, v90, s20
    v_accvgpr_write_b32 a65, v23
    s_waitcnt lgkmcnt(2)
    v_perm_b32 v23, v93, v92, s20
    v_accvgpr_write_b32 a66, v23
    s_waitcnt lgkmcnt(0)
    v_perm_b32 v23, v95, v94, s20
    v_accvgpr_write_b32 a67, v23
    v_perm_b32 v23, v89, v88, s21
    v_accvgpr_write_b32 a72, v23
    v_perm_b32 v23, v91, v90, s21
    v_accvgpr_write_b32 a73, v23
    v_perm_b32 v23, v93, v92, s21
    v_accvgpr_write_b32 a74, v23
    v_perm_b32 v23, v95, v94, s21
    v_accvgpr_write_b32 a75, v23
    ds_read_b32 v88, v20 offset:1024
    ds_read_b32 v89, v20 offset:3072
    ds_read_b32 v90, v20 offset:5120
    ds_read_b32 v91, v20 offset:7168
    ds_read_b32 v92, v20 offset:1280
    ds_read_b32 v93, v20 offset:3328
    ds_read_b32 v94, v20 offset:5376
    ds_read_b32 v95, v20 offset:7424
    s_waitcnt lgkmcnt(6)
    v_perm_b32 v23, v89, v88, s20
    v_accvgpr_write_b32 a68, v23
    s_waitcnt lgkmcnt(4)
    v_perm_b32 v23, v91, v90, s20
    v_accvgpr_write_b32 a69, v23
    s_waitcnt lgkmcnt(2)
    v_perm_b32 v23, v93, v92, s20
    v_accvgpr_write_b32 a70, v23
    s_waitcnt lgkmcnt(0)
    v_perm_b32 v23, v95, v94, s20
    v_accvgpr_write_b32 a71, v23
    v_perm_b32 v23, v89, v88, s21
    v_accvgpr_write_b32 a76, v23
    v_perm_b32 v23, v91, v90, s21
    v_accvgpr_write_b32 a77, v23
    v_perm_b32 v23, v93, v92, s21
    v_accvgpr_write_b32 a78, v23
    v_perm_b32 v23, v95, v94, s21
    v_accvgpr_write_b32 a79, v23
    ds_read_b32 v88, v20 offset:8192
    ds_read_b32 v89, v20 offset:10240
    ds_read_b32 v90, v20 offset:12288
    ds_read_b32 v91, v20 offset:14336
    ds_read_b32 v92, v20 offset:8448
    ds_read_b32 v93, v20 offset:10496
    ds_read_b32 v94, v20 offset:12544
    ds_read_b32 v95, v20 offset:14592
    s_waitcnt lgkmcnt(6)
    v_perm_b32 v23, v89, v88, s20
    v_accvgpr_write_b32 a80, v23
    s_waitcnt lgkmcnt(4)
    v_perm_b32 v23, v91, v90, s20
    v_accvgpr_write_b32 a81, v23
    s_waitcnt lgkmcnt(2)
    v_perm_b32 v23, v93, v92, s20
    v_accvgpr_write_b32 a82, v23
    s_waitcnt lgkmcnt(0)
    v_perm_b32 v23, v95, v94, s20
    v_accvgpr_write_b32 a83, v23
    v_perm_b32 v23, v89, v88, s21
    v_accvgpr_write_b32 a88, v23
    v_perm_b32 v23, v91, v90, s21
    v_accvgpr_write_b32 a89, v23
    v_perm_b32 v23, v93, v92, s21
    v_accvgpr_write_b32 a90, v23
    v_perm_b32 v23, v95, v94, s21
    v_accvgpr_write_b32 a91, v23
    ds_read_b32 v88, v20 offset:9216
    ds_read_b32 v89, v20 offset:11264
    ds_read_b32 v90, v20 offset:13312
    ds_read_b32 v91, v20 offset:15360
    ds_read_b32 v92, v20 offset:9472
    ds_read_b32 v93, v20 offset:11520
    ds_read_b32 v94, v20 offset:13568
    ds_read_b32 v95, v20 offset:15616
    s_waitcnt lgkmcnt(6)
    v_perm_b32 v23, v89, v88, s20
    v_accvgpr_write_b32 a84, v23
    s_waitcnt lgkmcnt(4)
    v_perm_b32 v23, v91, v90, s20
    v_accvgpr_write_b32 a85, v23
    s_waitcnt lgkmcnt(2)
    v_perm_b32 v23, v93, v92, s20
    v_accvgpr_write_b32 a86, v23
    s_waitcnt lgkmcnt(0)
    v_perm_b32 v23, v95, v94, s20
    v_accvgpr_write_b32 a87, v23
    v_perm_b32 v23, v89, v88, s21
    v_accvgpr_write_b32 a92, v23
    v_perm_b32 v23, v91, v90, s21
    v_accvgpr_write_b32 a93, v23
    v_perm_b32 v23, v93, v92, s21
    v_accvgpr_write_b32 a94, v23
    v_perm_b32 v23, v95, v94, s21
    v_accvgpr_write_b32 a95, v23
    s_mov_b32 s44, 2097152
    buffer_load_dwordx4 v[24:27], v16, s[84:87], s44 offen
    s_mov_b32 s44, 2162688
    buffer_load_dwordx4 v[28:31], v16, s[84:87], s44 offen
    s_mov_b32 s44, 2228224
    buffer_load_dwordx4 v[32:35], v16, s[84:87], s44 offen
    s_mov_b32 s44, 2293760
    buffer_load_dwordx4 v[36:39], v16, s[84:87], s44 offen
    s_mov_b32 s44, 2359296
    buffer_load_dwordx4 v[40:43], v16, s[84:87], s44 offen
    s_mov_b32 s44, 2424832
    buffer_load_dwordx4 v[44:47], v16, s[84:87], s44 offen
    s_mov_b32 s44, 2490368
    buffer_load_dwordx4 v[48:51], v16, s[84:87], s44 offen
    s_mov_b32 s44, 2555904
    buffer_load_dwordx4 v[52:55], v16, s[84:87], s44 offen
    s_waitcnt lgkmcnt(0)
    s_barrier
    s_waitcnt vmcnt(39)
    ds_write_b128 v18, v[96:99] offset:0
    s_waitcnt vmcnt(38)
    ds_write_b128 v18, v[100:103] offset:1024
    s_waitcnt vmcnt(37)
    ds_write_b128 v18, v[104:107] offset:2048
    s_waitcnt vmcnt(36)
    ds_write_b128 v18, v[108:111] offset:3072
    s_waitcnt vmcnt(35)
    ds_write_b128 v18, v[112:115] offset:4096
    s_waitcnt vmcnt(34)
    ds_write_b128 v18, v[116:119] offset:5120
    s_waitcnt vmcnt(33)
    ds_write_b128 v18, v[120:123] offset:6144
    s_waitcnt vmcnt(32)
    ds_write_b128 v18, v[124:127] offset:7168
    s_waitcnt lgkmcnt(0)
    s_barrier
    ds_read_b32 v88, v20 offset:0
    ds_read_b32 v89, v20 offset:2048
    ds_read_b32 v90, v20 offset:4096
    ds_read_b32 v91, v20 offset:6144
    ds_read_b32 v92, v20 offset:256
    ds_read_b32 v93, v20 offset:2304
    ds_read_b32 v94, v20 offset:4352
    ds_read_b32 v95, v20 offset:6400
    s_waitcnt lgkmcnt(6)
    v_perm_b32 v23, v89, v88, s20
    v_accvgpr_write_b32 a96, v23
    s_waitcnt lgkmcnt(4)
    v_perm_b32 v23, v91, v90, s20
    v_accvgpr_write_b32 a97, v23
    s_waitcnt lgkmcnt(2)
    v_perm_b32 v23, v93, v92, s20
    v_accvgpr_write_b32 a98, v23
    s_waitcnt lgkmcnt(0)
    v_perm_b32 v23, v95, v94, s20
    v_accvgpr_write_b32 a99, v23
    v_perm_b32 v23, v89, v88, s21
    v_accvgpr_write_b32 a104, v23
    v_perm_b32 v23, v91, v90, s21
    v_accvgpr_write_b32 a105, v23
    v_perm_b32 v23, v93, v92, s21
    v_accvgpr_write_b32 a106, v23
    v_perm_b32 v23, v95, v94, s21
    v_accvgpr_write_b32 a107, v23
    ds_read_b32 v88, v20 offset:1024
    ds_read_b32 v89, v20 offset:3072
    ds_read_b32 v90, v20 offset:5120
    ds_read_b32 v91, v20 offset:7168
    ds_read_b32 v92, v20 offset:1280
    ds_read_b32 v93, v20 offset:3328
    ds_read_b32 v94, v20 offset:5376
    ds_read_b32 v95, v20 offset:7424
    s_waitcnt lgkmcnt(6)
    v_perm_b32 v23, v89, v88, s20
    v_accvgpr_write_b32 a100, v23
    s_waitcnt lgkmcnt(4)
    v_perm_b32 v23, v91, v90, s20
    v_accvgpr_write_b32 a101, v23
    s_waitcnt lgkmcnt(2)
    v_perm_b32 v23, v93, v92, s20
    v_accvgpr_write_b32 a102, v23
    s_waitcnt lgkmcnt(0)
    v_perm_b32 v23, v95, v94, s20
    v_accvgpr_write_b32 a103, v23
    v_perm_b32 v23, v89, v88, s21
    v_accvgpr_write_b32 a108, v23
    v_perm_b32 v23, v91, v90, s21
    v_accvgpr_write_b32 a109, v23
    v_perm_b32 v23, v93, v92, s21
    v_accvgpr_write_b32 a110, v23
    v_perm_b32 v23, v95, v94, s21
    v_accvgpr_write_b32 a111, v23
    ds_read_b32 v88, v20 offset:8192
    ds_read_b32 v89, v20 offset:10240
    ds_read_b32 v90, v20 offset:12288
    ds_read_b32 v91, v20 offset:14336
    ds_read_b32 v92, v20 offset:8448
    ds_read_b32 v93, v20 offset:10496
    ds_read_b32 v94, v20 offset:12544
    ds_read_b32 v95, v20 offset:14592
    s_waitcnt lgkmcnt(6)
    v_perm_b32 v23, v89, v88, s20
    v_accvgpr_write_b32 a112, v23
    s_waitcnt lgkmcnt(4)
    v_perm_b32 v23, v91, v90, s20
    v_accvgpr_write_b32 a113, v23
    s_waitcnt lgkmcnt(2)
    v_perm_b32 v23, v93, v92, s20
    v_accvgpr_write_b32 a114, v23
    s_waitcnt lgkmcnt(0)
    v_perm_b32 v23, v95, v94, s20
    v_accvgpr_write_b32 a115, v23
    v_perm_b32 v23, v89, v88, s21
    v_accvgpr_write_b32 a120, v23
    v_perm_b32 v23, v91, v90, s21
    v_accvgpr_write_b32 a121, v23
    v_perm_b32 v23, v93, v92, s21
    v_accvgpr_write_b32 a122, v23
    v_perm_b32 v23, v95, v94, s21
    v_accvgpr_write_b32 a123, v23
    ds_read_b32 v88, v20 offset:9216
    ds_read_b32 v89, v20 offset:11264
    ds_read_b32 v90, v20 offset:13312
    ds_read_b32 v91, v20 offset:15360
    ds_read_b32 v92, v20 offset:9472
    ds_read_b32 v93, v20 offset:11520
    ds_read_b32 v94, v20 offset:13568
    ds_read_b32 v95, v20 offset:15616
    s_waitcnt lgkmcnt(6)
    v_perm_b32 v23, v89, v88, s20
    v_accvgpr_write_b32 a116, v23
    s_waitcnt lgkmcnt(4)
    v_perm_b32 v23, v91, v90, s20
    v_accvgpr_write_b32 a117, v23
    s_waitcnt lgkmcnt(2)
    v_perm_b32 v23, v93, v92, s20
    v_accvgpr_write_b32 a118, v23
    s_waitcnt lgkmcnt(0)
    v_perm_b32 v23, v95, v94, s20
    v_accvgpr_write_b32 a119, v23
    v_perm_b32 v23, v89, v88, s21
    v_accvgpr_write_b32 a124, v23
    v_perm_b32 v23, v91, v90, s21
    v_accvgpr_write_b32 a125, v23
    v_perm_b32 v23, v93, v92, s21
    v_accvgpr_write_b32 a126, v23
    v_perm_b32 v23, v95, v94, s21
    v_accvgpr_write_b32 a127, v23
    s_waitcnt lgkmcnt(0)
    s_barrier
    s_waitcnt vmcnt(31)
    ds_write_b128 v18, v[128:131] offset:0
    s_waitcnt vmcnt(30)
    ds_write_b128 v18, v[132:135] offset:1024
    s_waitcnt vmcnt(29)
    ds_write_b128 v18, v[136:139] offset:2048
    s_waitcnt vmcnt(28)
    ds_write_b128 v18, v[140:143] offset:3072
    s_waitcnt vmcnt(27)
    ds_write_b128 v18, v[144:147] offset:4096
    s_waitcnt vmcnt(26)
    ds_write_b128 v18, v[148:151] offset:5120
    s_waitcnt vmcnt(25)
    ds_write_b128 v18, v[152:155] offset:6144
    s_waitcnt vmcnt(24)
    ds_write_b128 v18, v[156:159] offset:7168
    s_waitcnt lgkmcnt(0)
    s_barrier
    ds_read_b32 v192, v20 offset:0
    ds_read_b32 v193, v20 offset:4096
    ds_read_b32 v194, v20 offset:256
    ds_read_b32 v195, v20 offset:4352
    ds_read_b32 v196, v20 offset:1024
    ds_read_b32 v197, v20 offset:5120
    ds_read_b32 v198, v20 offset:1280
    ds_read_b32 v199, v20 offset:5376
    ds_read_b32 v208, v20 offset:2048
    ds_read_b32 v209, v20 offset:6144
    ds_read_b32 v210, v20 offset:2304
    ds_read_b32 v211, v20 offset:6400
    ds_read_b32 v212, v20 offset:3072
    ds_read_b32 v213, v20 offset:7168
    ds_read_b32 v214, v20 offset:3328
    ds_read_b32 v215, v20 offset:7424
    ds_read_b32 v224, v20 offset:8192
    ds_read_b32 v225, v20 offset:12288
    ds_read_b32 v226, v20 offset:8448
    ds_read_b32 v227, v20 offset:12544
    ds_read_b32 v228, v20 offset:9216
    ds_read_b32 v229, v20 offset:13312
    ds_read_b32 v230, v20 offset:9472
    ds_read_b32 v231, v20 offset:13568
    ds_read_b32 v240, v20 offset:10240
    ds_read_b32 v241, v20 offset:14336
    ds_read_b32 v242, v20 offset:10496
    ds_read_b32 v243, v20 offset:14592
    ds_read_b32 v244, v20 offset:11264
    ds_read_b32 v245, v20 offset:15360
    ds_read_b32 v246, v20 offset:11520
    ds_read_b32 v247, v20 offset:15616
    s_waitcnt lgkmcnt(0)
    s_barrier
    s_waitcnt vmcnt(23)
    ds_write_b128 v18, v[160:163] offset:0
    s_waitcnt vmcnt(22)
    ds_write_b128 v18, v[164:167] offset:1024
    s_waitcnt vmcnt(21)
    ds_write_b128 v18, v[168:171] offset:2048
    s_waitcnt vmcnt(20)
    ds_write_b128 v18, v[172:175] offset:3072
    s_waitcnt vmcnt(19)
    ds_write_b128 v18, v[176:179] offset:4096
    s_waitcnt vmcnt(18)
    ds_write_b128 v18, v[180:183] offset:5120
    s_waitcnt vmcnt(17)
    ds_write_b128 v18, v[184:187] offset:6144
    s_waitcnt vmcnt(16)
    ds_write_b128 v18, v[188:191] offset:7168
    s_waitcnt lgkmcnt(0)
    s_barrier
    ds_read_b32 v200, v20 offset:0
    ds_read_b32 v201, v20 offset:4096
    ds_read_b32 v202, v20 offset:256
    ds_read_b32 v203, v20 offset:4352
    ds_read_b32 v204, v20 offset:1024
    ds_read_b32 v205, v20 offset:5120
    ds_read_b32 v206, v20 offset:1280
    ds_read_b32 v207, v20 offset:5376
    ds_read_b32 v216, v20 offset:2048
    ds_read_b32 v217, v20 offset:6144
    ds_read_b32 v218, v20 offset:2304
    ds_read_b32 v219, v20 offset:6400
    ds_read_b32 v220, v20 offset:3072
    ds_read_b32 v221, v20 offset:7168
    ds_read_b32 v222, v20 offset:3328
    ds_read_b32 v223, v20 offset:7424
    ds_read_b32 v232, v20 offset:8192
    ds_read_b32 v233, v20 offset:12288
    ds_read_b32 v234, v20 offset:8448
    ds_read_b32 v235, v20 offset:12544
    ds_read_b32 v236, v20 offset:9216
    ds_read_b32 v237, v20 offset:13312
    ds_read_b32 v238, v20 offset:9472
    ds_read_b32 v239, v20 offset:13568
    ds_read_b32 v248, v20 offset:10240
    ds_read_b32 v249, v20 offset:14336
    ds_read_b32 v250, v20 offset:10496
    ds_read_b32 v251, v20 offset:14592
    ds_read_b32 v252, v20 offset:11264
    ds_read_b32 v253, v20 offset:15360
    ds_read_b32 v254, v20 offset:11520
    ds_read_b32 v255, v20 offset:15616
    s_waitcnt lgkmcnt(0)
    s_barrier
    s_waitcnt vmcnt(15)
    ds_write_b128 v18, v[56:59] offset:0
    s_waitcnt vmcnt(14)
    ds_write_b128 v18, v[60:63] offset:1024
    s_waitcnt vmcnt(13)
    ds_write_b128 v18, v[64:67] offset:2048
    s_waitcnt vmcnt(12)
    ds_write_b128 v18, v[68:71] offset:3072
    s_waitcnt vmcnt(11)
    ds_write_b128 v18, v[72:75] offset:4096
    s_waitcnt vmcnt(10)
    ds_write_b128 v18, v[76:79] offset:5120
    s_waitcnt vmcnt(9)
    ds_write_b128 v18, v[80:83] offset:6144
    s_waitcnt vmcnt(8)
    ds_write_b128 v18, v[84:87] offset:7168
    s_waitcnt lgkmcnt(0)
    s_barrier
    ds_read_b32 v128, v20 offset:0
    ds_read_b32 v129, v20 offset:4096
    ds_read_b32 v130, v20 offset:256
    ds_read_b32 v131, v20 offset:4352
    ds_read_b32 v132, v20 offset:1024
    ds_read_b32 v133, v20 offset:5120
    ds_read_b32 v134, v20 offset:1280
    ds_read_b32 v135, v20 offset:5376
    ds_read_b32 v144, v20 offset:2048
    ds_read_b32 v145, v20 offset:6144
    ds_read_b32 v146, v20 offset:2304
    ds_read_b32 v147, v20 offset:6400
    ds_read_b32 v148, v20 offset:3072
    ds_read_b32 v149, v20 offset:7168
    ds_read_b32 v150, v20 offset:3328
    ds_read_b32 v151, v20 offset:7424
    ds_read_b32 v160, v20 offset:8192
    ds_read_b32 v161, v20 offset:12288
    ds_read_b32 v162, v20 offset:8448
    ds_read_b32 v163, v20 offset:12544
    ds_read_b32 v164, v20 offset:9216
    ds_read_b32 v165, v20 offset:13312
    ds_read_b32 v166, v20 offset:9472
    ds_read_b32 v167, v20 offset:13568
    ds_read_b32 v176, v20 offset:10240
    ds_read_b32 v177, v20 offset:14336
    ds_read_b32 v178, v20 offset:10496
    ds_read_b32 v179, v20 offset:14592
    ds_read_b32 v180, v20 offset:11264
    ds_read_b32 v181, v20 offset:15360
    ds_read_b32 v182, v20 offset:11520
    ds_read_b32 v183, v20 offset:15616
    s_mov_b32 s44, 1048576
    buffer_load_dwordx4 v[56:59], v16, s[80:83], s44 offen
    s_mov_b32 s44, 1114112
    buffer_load_dwordx4 v[60:63], v16, s[80:83], s44 offen
    s_mov_b32 s44, 1179648
    buffer_load_dwordx4 v[64:67], v16, s[80:83], s44 offen
    s_mov_b32 s44, 1245184
    buffer_load_dwordx4 v[68:71], v16, s[80:83], s44 offen
    s_mov_b32 s44, 1310720
    buffer_load_dwordx4 v[72:75], v16, s[80:83], s44 offen
    s_mov_b32 s44, 1376256
    buffer_load_dwordx4 v[76:79], v16, s[80:83], s44 offen
    s_mov_b32 s44, 1441792
    buffer_load_dwordx4 v[80:83], v16, s[80:83], s44 offen
    s_mov_b32 s44, 1507328
    buffer_load_dwordx4 v[84:87], v16, s[80:83], s44 offen
    s_waitcnt lgkmcnt(0)
    s_barrier
    s_waitcnt vmcnt(15)
    ds_write_b128 v18, v[24:27] offset:0
    s_waitcnt vmcnt(14)
    ds_write_b128 v18, v[28:31] offset:1024
    s_waitcnt vmcnt(13)
    ds_write_b128 v18, v[32:35] offset:2048
    s_waitcnt vmcnt(12)
    ds_write_b128 v18, v[36:39] offset:3072
    s_waitcnt vmcnt(11)
    ds_write_b128 v18, v[40:43] offset:4096
    s_waitcnt vmcnt(10)
    ds_write_b128 v18, v[44:47] offset:5120
    s_waitcnt vmcnt(9)
    ds_write_b128 v18, v[48:51] offset:6144
    s_waitcnt vmcnt(8)
    ds_write_b128 v18, v[52:55] offset:7168
    s_waitcnt lgkmcnt(0)
    s_barrier
    ds_read_b32 v136, v20 offset:0
    ds_read_b32 v137, v20 offset:4096
    ds_read_b32 v138, v20 offset:256
    ds_read_b32 v139, v20 offset:4352
    ds_read_b32 v140, v20 offset:1024
    ds_read_b32 v141, v20 offset:5120
    ds_read_b32 v142, v20 offset:1280
    ds_read_b32 v143, v20 offset:5376
    ds_read_b32 v152, v20 offset:2048
    ds_read_b32 v153, v20 offset:6144
    ds_read_b32 v154, v20 offset:2304
    ds_read_b32 v155, v20 offset:6400
    ds_read_b32 v156, v20 offset:3072
    ds_read_b32 v157, v20 offset:7168
    ds_read_b32 v158, v20 offset:3328
    ds_read_b32 v159, v20 offset:7424
    ds_read_b32 v168, v20 offset:8192
    ds_read_b32 v169, v20 offset:12288
    ds_read_b32 v170, v20 offset:8448
    ds_read_b32 v171, v20 offset:12544
    ds_read_b32 v172, v20 offset:9216
    ds_read_b32 v173, v20 offset:13312
    ds_read_b32 v174, v20 offset:9472
    ds_read_b32 v175, v20 offset:13568
    ds_read_b32 v184, v20 offset:10240
    ds_read_b32 v185, v20 offset:14336
    ds_read_b32 v186, v20 offset:10496
    ds_read_b32 v187, v20 offset:14592
    ds_read_b32 v188, v20 offset:11264
    ds_read_b32 v189, v20 offset:15360
    ds_read_b32 v190, v20 offset:11520
    ds_read_b32 v191, v20 offset:15616
    s_mov_b32 s44, 1048576
    buffer_load_dwordx4 v[24:27], v16, s[84:87], s44 offen
    s_mov_b32 s44, 1114112
    buffer_load_dwordx4 v[28:31], v16, s[84:87], s44 offen
    s_mov_b32 s44, 1179648
    buffer_load_dwordx4 v[32:35], v16, s[84:87], s44 offen
    s_mov_b32 s44, 1245184
    buffer_load_dwordx4 v[36:39], v16, s[84:87], s44 offen
    s_mov_b32 s44, 1310720
    buffer_load_dwordx4 v[40:43], v16, s[84:87], s44 offen
    s_mov_b32 s44, 1376256
    buffer_load_dwordx4 v[44:47], v16, s[84:87], s44 offen
    s_mov_b32 s44, 1441792
    buffer_load_dwordx4 v[48:51], v16, s[84:87], s44 offen
    s_mov_b32 s44, 1507328
    buffer_load_dwordx4 v[52:55], v16, s[84:87], s44 offen
    s_waitcnt lgkmcnt(0)
    s_barrier
    s_waitcnt vmcnt(15)
    ds_write_b128 v18, v[56:59] offset:0
    s_waitcnt vmcnt(14)
    ds_write_b128 v18, v[60:63] offset:1024
    s_waitcnt vmcnt(13)
    ds_write_b128 v18, v[64:67] offset:2048
    s_waitcnt vmcnt(12)
    ds_write_b128 v18, v[68:71] offset:3072
    s_waitcnt vmcnt(11)
    ds_write_b128 v18, v[72:75] offset:4096
    s_waitcnt vmcnt(10)
    ds_write_b128 v18, v[76:79] offset:5120
    s_waitcnt vmcnt(9)
    ds_write_b128 v18, v[80:83] offset:6144
    s_waitcnt vmcnt(8)
    ds_write_b128 v18, v[84:87] offset:7168
    s_waitcnt lgkmcnt(0)
    s_barrier
    ds_read_b32 v88, v20 offset:0
    ds_read_b32 v89, v20 offset:4096
    ds_read_b32 v90, v20 offset:256
    ds_read_b32 v91, v20 offset:4352
    ds_read_b32 v92, v20 offset:1024
    ds_read_b32 v93, v20 offset:5120
    ds_read_b32 v94, v20 offset:1280
    ds_read_b32 v95, v20 offset:5376
    s_waitcnt lgkmcnt(4)
    ds_write_b128 v19, v[88:91] offset:16384
    s_waitcnt lgkmcnt(1)
    ds_write_b128 v19, v[92:95] offset:17408
    ds_read_b32 v88, v20 offset:2048
    ds_read_b32 v89, v20 offset:6144
    ds_read_b32 v90, v20 offset:2304
    ds_read_b32 v91, v20 offset:6400
    ds_read_b32 v92, v20 offset:3072
    ds_read_b32 v93, v20 offset:7168
    ds_read_b32 v94, v20 offset:3328
    ds_read_b32 v95, v20 offset:7424
    s_waitcnt lgkmcnt(4)
    ds_write_b128 v19, v[88:91] offset:20480
    s_waitcnt lgkmcnt(1)
    ds_write_b128 v19, v[92:95] offset:21504
    ds_read_b32 v96, v20 offset:8192
    ds_read_b32 v97, v20 offset:12288
    ds_read_b32 v98, v20 offset:8448
    ds_read_b32 v99, v20 offset:12544
    ds_read_b32 v100, v20 offset:9216
    ds_read_b32 v101, v20 offset:13312
    ds_read_b32 v102, v20 offset:9472
    ds_read_b32 v103, v20 offset:13568
    ds_read_b32 v112, v20 offset:10240
    ds_read_b32 v113, v20 offset:14336
    ds_read_b32 v114, v20 offset:10496
    ds_read_b32 v115, v20 offset:14592
    ds_read_b32 v116, v20 offset:11264
    ds_read_b32 v117, v20 offset:15360
    ds_read_b32 v118, v20 offset:11520
    ds_read_b32 v119, v20 offset:15616
    s_mov_b32 s44, 0
    buffer_load_dwordx4 v[56:59], v16, s[80:83], s44 offen
    s_mov_b32 s44, 65536
    buffer_load_dwordx4 v[60:63], v16, s[80:83], s44 offen
    s_mov_b32 s44, 131072
    buffer_load_dwordx4 v[64:67], v16, s[80:83], s44 offen
    s_mov_b32 s44, 196608
    buffer_load_dwordx4 v[68:71], v16, s[80:83], s44 offen
    s_mov_b32 s44, 262144
    buffer_load_dwordx4 v[72:75], v16, s[80:83], s44 offen
    s_mov_b32 s44, 327680
    buffer_load_dwordx4 v[76:79], v16, s[80:83], s44 offen
    s_mov_b32 s44, 393216
    buffer_load_dwordx4 v[80:83], v16, s[80:83], s44 offen
    s_mov_b32 s44, 458752
    buffer_load_dwordx4 v[84:87], v16, s[80:83], s44 offen
    s_waitcnt lgkmcnt(0)
    s_barrier
    s_waitcnt vmcnt(15)
    ds_write_b128 v18, v[24:27] offset:0
    s_waitcnt vmcnt(14)
    ds_write_b128 v18, v[28:31] offset:1024
    s_waitcnt vmcnt(13)
    ds_write_b128 v18, v[32:35] offset:2048
    s_waitcnt vmcnt(12)
    ds_write_b128 v18, v[36:39] offset:3072
    s_waitcnt vmcnt(11)
    ds_write_b128 v18, v[40:43] offset:4096
    s_waitcnt vmcnt(10)
    ds_write_b128 v18, v[44:47] offset:5120
    s_waitcnt vmcnt(9)
    ds_write_b128 v18, v[48:51] offset:6144
    s_waitcnt vmcnt(8)
    ds_write_b128 v18, v[52:55] offset:7168
    s_waitcnt lgkmcnt(0)
    s_barrier
    ds_read_b32 v88, v20 offset:0
    ds_read_b32 v89, v20 offset:4096
    ds_read_b32 v90, v20 offset:256
    ds_read_b32 v91, v20 offset:4352
    ds_read_b32 v92, v20 offset:1024
    ds_read_b32 v93, v20 offset:5120
    ds_read_b32 v94, v20 offset:1280
    ds_read_b32 v95, v20 offset:5376
    s_waitcnt lgkmcnt(4)
    ds_write_b128 v19, v[88:91] offset:18432
    s_waitcnt lgkmcnt(1)
    ds_write_b128 v19, v[92:95] offset:19456
    ds_read_b32 v88, v20 offset:2048
    ds_read_b32 v89, v20 offset:6144
    ds_read_b32 v90, v20 offset:2304
    ds_read_b32 v91, v20 offset:6400
    ds_read_b32 v92, v20 offset:3072
    ds_read_b32 v93, v20 offset:7168
    ds_read_b32 v94, v20 offset:3328
    ds_read_b32 v95, v20 offset:7424
    s_waitcnt lgkmcnt(4)
    ds_write_b128 v19, v[88:91] offset:22528
    s_waitcnt lgkmcnt(1)
    ds_write_b128 v19, v[92:95] offset:23552
    ds_read_b32 v104, v20 offset:8192
    ds_read_b32 v105, v20 offset:12288
    ds_read_b32 v106, v20 offset:8448
    ds_read_b32 v107, v20 offset:12544
    ds_read_b32 v108, v20 offset:9216
    ds_read_b32 v109, v20 offset:13312
    ds_read_b32 v110, v20 offset:9472
    ds_read_b32 v111, v20 offset:13568
    ds_read_b32 v120, v20 offset:10240
    ds_read_b32 v121, v20 offset:14336
    ds_read_b32 v122, v20 offset:10496
    ds_read_b32 v123, v20 offset:14592
    ds_read_b32 v124, v20 offset:11264
    ds_read_b32 v125, v20 offset:15360
    ds_read_b32 v126, v20 offset:11520
    ds_read_b32 v127, v20 offset:15616
    s_mov_b32 s44, 0
    buffer_load_dwordx4 v[24:27], v16, s[84:87], s44 offen
    s_mov_b32 s44, 65536
    buffer_load_dwordx4 v[28:31], v16, s[84:87], s44 offen
    s_mov_b32 s44, 131072
    buffer_load_dwordx4 v[32:35], v16, s[84:87], s44 offen
    s_mov_b32 s44, 196608
    buffer_load_dwordx4 v[36:39], v16, s[84:87], s44 offen
    s_mov_b32 s44, 262144
    buffer_load_dwordx4 v[40:43], v16, s[84:87], s44 offen
    s_mov_b32 s44, 327680
    buffer_load_dwordx4 v[44:47], v16, s[84:87], s44 offen
    s_mov_b32 s44, 393216
    buffer_load_dwordx4 v[48:51], v16, s[84:87], s44 offen
    s_mov_b32 s44, 458752
    buffer_load_dwordx4 v[52:55], v16, s[84:87], s44 offen
    s_waitcnt lgkmcnt(0)
    s_barrier
    s_waitcnt vmcnt(15)
    ds_write_b128 v18, v[56:59] offset:0
    s_waitcnt vmcnt(14)
    ds_write_b128 v18, v[60:63] offset:1024
    s_waitcnt vmcnt(13)
    ds_write_b128 v18, v[64:67] offset:2048
    s_waitcnt vmcnt(12)
    ds_write_b128 v18, v[68:71] offset:3072
    s_waitcnt vmcnt(11)
    ds_write_b128 v18, v[72:75] offset:4096
    s_waitcnt vmcnt(10)
    ds_write_b128 v18, v[76:79] offset:5120
    s_waitcnt vmcnt(9)
    ds_write_b128 v18, v[80:83] offset:6144
    s_waitcnt vmcnt(8)
    ds_write_b128 v18, v[84:87] offset:7168
    s_waitcnt lgkmcnt(0)
    s_barrier
    ds_read_b32 v88, v20 offset:0
    ds_read_b32 v89, v20 offset:4096
    ds_read_b32 v90, v20 offset:256
    ds_read_b32 v91, v20 offset:4352
    ds_read_b32 v92, v20 offset:1024
    ds_read_b32 v93, v20 offset:5120
    ds_read_b32 v94, v20 offset:1280
    ds_read_b32 v95, v20 offset:5376
    s_waitcnt lgkmcnt(4)
    ds_write_b128 v19, v[88:91] offset:0
    s_waitcnt lgkmcnt(1)
    ds_write_b128 v19, v[92:95] offset:1024
    ds_read_b32 v88, v20 offset:2048
    ds_read_b32 v89, v20 offset:6144
    ds_read_b32 v90, v20 offset:2304
    ds_read_b32 v91, v20 offset:6400
    ds_read_b32 v92, v20 offset:3072
    ds_read_b32 v93, v20 offset:7168
    ds_read_b32 v94, v20 offset:3328
    ds_read_b32 v95, v20 offset:7424
    s_waitcnt lgkmcnt(4)
    ds_write_b128 v19, v[88:91] offset:4096
    s_waitcnt lgkmcnt(1)
    ds_write_b128 v19, v[92:95] offset:5120
    ds_read_b32 v88, v20 offset:8192
    ds_read_b32 v89, v20 offset:12288
    ds_read_b32 v90, v20 offset:8448
    ds_read_b32 v91, v20 offset:12544
    ds_read_b32 v92, v20 offset:9216
    ds_read_b32 v93, v20 offset:13312
    ds_read_b32 v94, v20 offset:9472
    ds_read_b32 v95, v20 offset:13568
    s_waitcnt lgkmcnt(4)
    ds_write_b128 v19, v[88:91] offset:8192
    s_waitcnt lgkmcnt(1)
    ds_write_b128 v19, v[92:95] offset:9216
    ds_read_b32 v88, v20 offset:10240
    ds_read_b32 v89, v20 offset:14336
    ds_read_b32 v90, v20 offset:10496
    ds_read_b32 v91, v20 offset:14592
    ds_read_b32 v92, v20 offset:11264
    ds_read_b32 v93, v20 offset:15360
    ds_read_b32 v94, v20 offset:11520
    ds_read_b32 v95, v20 offset:15616
    s_waitcnt lgkmcnt(4)
    ds_write_b128 v19, v[88:91] offset:12288
    s_waitcnt lgkmcnt(1)
    ds_write_b128 v19, v[92:95] offset:13312
    s_waitcnt lgkmcnt(0)
    s_barrier
    s_waitcnt vmcnt(7)
    ds_write_b128 v18, v[24:27] offset:0
    s_waitcnt vmcnt(6)
    ds_write_b128 v18, v[28:31] offset:1024
    s_waitcnt vmcnt(5)
    ds_write_b128 v18, v[32:35] offset:2048
    s_waitcnt vmcnt(4)
    ds_write_b128 v18, v[36:39] offset:3072
    s_waitcnt vmcnt(3)
    ds_write_b128 v18, v[40:43] offset:4096
    s_waitcnt vmcnt(2)
    ds_write_b128 v18, v[44:47] offset:5120
    s_waitcnt vmcnt(1)
    ds_write_b128 v18, v[48:51] offset:6144
    s_waitcnt vmcnt(0)
    ds_write_b128 v18, v[52:55] offset:7168
    s_waitcnt lgkmcnt(0)
    s_barrier
    ds_read_b32 v88, v20 offset:0
    ds_read_b32 v89, v20 offset:4096
    ds_read_b32 v90, v20 offset:256
    ds_read_b32 v91, v20 offset:4352
    ds_read_b32 v92, v20 offset:1024
    ds_read_b32 v93, v20 offset:5120
    ds_read_b32 v94, v20 offset:1280
    ds_read_b32 v95, v20 offset:5376
    s_waitcnt lgkmcnt(4)
    ds_write_b128 v19, v[88:91] offset:2048
    s_waitcnt lgkmcnt(1)
    ds_write_b128 v19, v[92:95] offset:3072
    ds_read_b32 v88, v20 offset:2048
    ds_read_b32 v89, v20 offset:6144
    ds_read_b32 v90, v20 offset:2304
    ds_read_b32 v91, v20 offset:6400
    ds_read_b32 v92, v20 offset:3072
    ds_read_b32 v93, v20 offset:7168
    ds_read_b32 v94, v20 offset:3328
    ds_read_b32 v95, v20 offset:7424
    s_waitcnt lgkmcnt(4)
    ds_write_b128 v19, v[88:91] offset:6144
    s_waitcnt lgkmcnt(1)
    ds_write_b128 v19, v[92:95] offset:7168
    ds_read_b32 v88, v20 offset:8192
    ds_read_b32 v89, v20 offset:12288
    ds_read_b32 v90, v20 offset:8448
    ds_read_b32 v91, v20 offset:12544
    ds_read_b32 v92, v20 offset:9216
    ds_read_b32 v93, v20 offset:13312
    ds_read_b32 v94, v20 offset:9472
    ds_read_b32 v95, v20 offset:13568
    s_waitcnt lgkmcnt(4)
    ds_write_b128 v19, v[88:91] offset:10240
    s_waitcnt lgkmcnt(1)
    ds_write_b128 v19, v[92:95] offset:11264
    ds_read_b32 v88, v20 offset:10240
    ds_read_b32 v89, v20 offset:14336
    ds_read_b32 v90, v20 offset:10496
    ds_read_b32 v91, v20 offset:14592
    ds_read_b32 v92, v20 offset:11264
    ds_read_b32 v93, v20 offset:15360
    ds_read_b32 v94, v20 offset:11520
    ds_read_b32 v95, v20 offset:15616
    s_waitcnt lgkmcnt(4)
    ds_write_b128 v19, v[88:91] offset:14336
    s_waitcnt lgkmcnt(1)
    ds_write_b128 v19, v[92:95] offset:15360
    s_waitcnt vmcnt(0) lgkmcnt(0)
    s_mov_b32 s30, 1
    s_barrier
    s_mov_b32 s15, 100000
L_adaLN_cond__memory_aug_recurrent_mem_tr__dense_activation_gelu__prompt_kernel_r_riw:
    v_mov_b32 v20, 84
    global_load_dword v21, v20, s[56:57] sc1
    s_waitcnt vmcnt(0)
    v_readfirstlane_b32 s44, v21
    s_nop 3
    s_cmp_ge_u32 s44, 32
    s_cbranch_scc1 L_adaLN_cond__memory_aug_recurrent_mem_tr__dense_activation_gelu__prompt_kernel_r_riok
    s_sub_u32 s15, s15, 1
    s_cbranch_scc0 L_adaLN_cond__memory_aug_recurrent_mem_tr__dense_activation_gelu__prompt_kernel_r_riw
    s_branch L_adaLN_cond__memory_aug_recurrent_mem_tr__dense_activation_gelu__prompt_kernel_r_abort
L_adaLN_cond__memory_aug_recurrent_mem_tr__dense_activation_gelu__prompt_kernel_r_riok:
    s_mov_b32 s15, 100000
L_adaLN_cond__memory_aug_recurrent_mem_tr__dense_activation_gelu__prompt_kernel_r_mw:
    v_lshrrev_b32 v20, 2, v0
    v_min_u32 v20, 76, v20
    global_load_dword v21, v20, s[56:57] offset:128 sc1
    s_waitcnt vmcnt(0)
    v_cmp_eq_u32 vcc, 0, v21
    s_cbranch_vccz L_adaLN_cond__memory_aug_recurrent_mem_tr__dense_activation_gelu__prompt_kernel_r_mok
    s_sub_u32 s15, s15, 1
    s_cbranch_scc0 L_adaLN_cond__memory_aug_recurrent_mem_tr__dense_activation_gelu__prompt_kernel_r_mw
    s_branch L_adaLN_cond__memory_aug_recurrent_mem_tr__dense_activation_gelu__prompt_kernel_r_abort
L_adaLN_cond__memory_aug_recurrent_mem_tr__dense_activation_gelu__prompt_kernel_r_mok:
    s_mov_b32 s45, 0
    s_mov_b32 s15, 100000
L_adaLN_cond__memory_aug_recurrent_mem_tr__dense_activation_gelu__prompt_kernel_r_kv0:
    v_lshlrev_b32 v9, 3, v0
    v_min_u32 v9, 1920, v9
    s_mov_b32 s46, 3934208
    buffer_load_dword v10, v9, s[4:7], s46 offen sc1
    s_waitcnt vmcnt(0)
    v_cmp_gt_u32 vcc, 64, v10
    s_nop 4
    s_ff1_i32_b64 s51, vcc
    s_min_u32 s51, s51, 16
    s_cmp_gt_u32 s51, s45
    s_cbranch_scc1 L_adaLN_cond__memory_aug_recurrent_mem_tr__dense_activation_gelu__prompt_kernel_r_kv0_ok
    s_sleep 2
    s_sub_u32 s15, s15, 1
    s_cbranch_scc0 L_adaLN_cond__memory_aug_recurrent_mem_tr__dense_activation_gelu__prompt_kernel_r_kv0
    s_branch L_adaLN_cond__memory_aug_recurrent_mem_tr__dense_activation_gelu__prompt_kernel_r_abort
L_adaLN_cond__memory_aug_recurrent_mem_tr__dense_activation_gelu__prompt_kernel_r_kv0_ok:
    s_mov_b32 m0, s28
    s_nop 0
    buffer_load_dwordx4 v0, s[4:7], s24 offen sc1 lds
    buffer_load_dwordx4 v0, s[4:7], s24 offen offset:1024 sc1 lds
    s_add_u32 s24, s24, 262144
    s_xor_b32 s28, s28, 16384
    s_mov_b32 m0, s29
    s_nop 0
    buffer_load_dwordx4 v0, s[4:7], s25 offen sc1 lds
    buffer_load_dwordx4 v0, s[4:7], s25 offen offset:1024 sc1 lds
    s_add_u32 s25, s25, 262144
    s_xor_b32 s29, s29, 16384
    s_waitcnt vmcnt(0)
    s_mov_b32 s15, 100000
L_adaLN_cond__memory_aug_recurrent_mem_tr__dense_activation_gelu__prompt_kernel_r_mode:
    v_mov_b32 v20, 64
    global_load_dword v22, v20, s[56:57] sc1
    s_waitcnt vmcnt(0)
    v_mov_b32 v20, 0
    global_load_dword v21, v20, s[56:57] sc1
    s_waitcnt vmcnt(0)
    v_readfirstlane_b32 s44, v21
    v_readfirstlane_b32 s45, v22
    s_nop 2
    s_cmp_ge_u32 s44, 32
    s_cbranch_scc1 L_adaLN_cond__memory_aug_recurrent_mem_tr__dense_activation_gelu__prompt_kernel_rf_preA
    s_cmp_ge_u32 s45, 256
    s_cbranch_scc1 L_adaLN_cond__memory_aug_recurrent_mem_tr__dense_activation_gelu__prompt_kernel_rs_preA
    s_sub_u32 s15, s15, 1
    s_cbranch_scc0 L_adaLN_cond__memory_aug_recurrent_mem_tr__dense_activation_gelu__prompt_kernel_r_mode
    s_branch L_adaLN_cond__memory_aug_recurrent_mem_tr__dense_activation_gelu__prompt_kernel_r_abort
L_adaLN_cond__memory_aug_recurrent_mem_tr__dense_activation_gelu__prompt_kernel_rf_top:
L_adaLN_cond__memory_aug_recurrent_mem_tr__dense_activation_gelu__prompt_kernel_rf_preA:
    v_add_u32 v9, s31, v0
    ds_read_b128 v[12:15], v0 offset:49664
    ds_read_b128 v[16:19], v9 offset:0
    ds_read_b128 v[20:23], v9 offset:1024
    ds_read_b128 v[24:27], v9 offset:2048
    ds_read_b128 v[28:31], v9 offset:3072
    ds_read_b128 v[32:35], v9 offset:4096
    ds_read_b128 v[36:39], v9 offset:5120
    s_cmp_eq_u32 s30, 1
    s_cbranch_scc1 L_adaLN_cond__memory_aug_recurrent_mem_tr__dense_activation_gelu__prompt_kernel_rf_pre
    s_nop 15
    s_nop 15
    s_nop 15
    s_nop 15
    s_mov_b32 s15, 100000
    s_waitcnt lgkmcnt(0)
    buffer_load_dwordx4 v[40:43], v6, s[4:7], s18 offen sc1
    buffer_load_dwordx4 v[44:47], v6, s[4:7], s19 offen sc1
L_adaLN_cond__memory_aug_recurrent_mem_tr__dense_activation_gelu__prompt_kernel_rf_h1p:
    s_waitcnt vmcnt(0)
    v_bitop3_b32 v48, v40, v41, s11 bitop3:0x7e
    v_bitop3_b32 v49, v42, v43, s11 bitop3:0x7e
    v_bitop3_b32 v50, v44, v45, s11 bitop3:0x7e
    v_bitop3_b32 v51, v46, v47, s11 bitop3:0x7e
    v_or3_b32 v48, v48, v49, v50
    v_bitop3_b32 v48, v48, v51, 1 bitop3:0xa8
    v_cmp_ne_u32 vcc, 0, v48
    s_cbranch_vccz L_adaLN_cond__memory_aug_recurrent_mem_tr__dense_activation_gelu__prompt_kernel_rf_h1u0
    buffer_load_dwordx4 v[40:43], v6, s[4:7], s18 offen sc1
    buffer_load_dwordx4 v[44:47], v6, s[4:7], s19 offen sc1
    s_nop 0
    s_sub_u32 s15, s15, 1
    s_cbranch_scc0 L_adaLN_cond__memory_aug_recurrent_mem_tr__dense_activation_gelu__prompt_kernel_rf_h1p
    s_branch L_adaLN_cond__memory_aug_recurrent_mem_tr__dense_activation_gelu__prompt_kernel_r_abort
L_adaLN_cond__memory_aug_recurrent_mem_tr__dense_activation_gelu__prompt_kernel_rf_h1u0:
    v_mfma_f32_16x16x32_bf16 v[48:51], v[12:15], v[40:43], 0
    v_mfma_f32_16x16x32_bf16 v[48:51], v[12:15], v[44:47], v[48:51]
L_adaLN_cond__memory_aug_recurrent_mem_tr__dense_activation_gelu__prompt_kernel_rf_h1ok:
    s_nop 3
    s_add_u32 s12, s13, s50
    s_xor_b32 s11, s11, 1
    s_add_u32 s10, s10, 1
    s_nop 0
    v_add_f32_dpp v48, v48, v48 row_ror:4 row_mask:0xf bank_mask:0xf
    v_add_f32_dpp v49, v49, v49 row_ror:4 row_mask:0xf bank_mask:0xf
    s_nop 0
    v_add_f32_dpp v48, v48, v48 row_ror:8 row_mask:0xf bank_mask:0xf
    v_add_f32_dpp v49, v49, v49 row_ror:8 row_mask:0xf bank_mask:0xf
    v_cvt_pk_bf16_f32 v48, v48, v49
    s_mov_b64 exec, s[32:33]
    buffer_store_dword v48, v7, s[4:7], s13 offen
    s_mov_b64 exec, -1
    s_mov_b32 s13, s14
    s_add_u32 s14, s14, 8192
    s_cmp_eq_u32 s14, 3694592
    s_cselect_b32 s14, 3670016, s14
    s_add_u32 s26, s26, 65536
    s_add_u32 s27, s27, 131072
    v_xor_b32 v8, 16384, v8
L_adaLN_cond__memory_aug_recurrent_mem_tr__dense_activation_gelu__prompt_kernel_rf_pre:
    ds_read_b128 v[40:43], v9 offset:6144
    ds_read_b128 v[44:47], v9 offset:7168
    ds_read_b128 v[48:51], v9 offset:8192
    ds_read_b128 v[52:55], v9 offset:9216
    ds_read_b128 v[56:59], v9 offset:10240
    ds_read_b128 v[60:63], v9 offset:11264
    ds_read_b128 v[64:67], v9 offset:12288
    ds_read_b128 v[68:71], v9 offset:13312
    ds_read_b128 v[12:15], v0 offset:52736
    ds_read_b128 v[72:75], v0 offset:52736
    v_add_u32 v10, s50, v0
    s_cmp_eq_u32 s30, 1
    s_mov_b32 s30, 0
    s_cbranch_scc1 L_adaLN_cond__memory_aug_recurrent_mem_tr__dense_activation_gelu__prompt_kernel_rf_e0
    s_nop 15
    s_nop 7
    s_mov_b32 s15, 100000
    buffer_load_dwordx4 v[76:79], v0, s[4:7], s12 offen sc1
    buffer_load_dwordx4 v[80:83], v0, s[4:7], s12 offen offset:1024 sc1
L_adaLN_cond__memory_aug_recurrent_mem_tr__dense_activation_gelu__prompt_kernel_rf_h2p:
    s_waitcnt vmcnt(0)
    v_max3_u32 v11, v76, v77, v78
    v_max3_u32 v84, v79, v80, v81
    v_max3_u32 v11, v11, v82, v83
    v_max_u32 v11, v11, v84
    v_cmp_eq_u32 vcc, -1, v11
    s_cbranch_vccz L_adaLN_cond__memory_aug_recurrent_mem_tr__dense_activation_gelu__prompt_kernel_rf_h2u0
    buffer_load_dwordx4 v[76:79], v0, s[4:7], s12 offen sc1
    buffer_load_dwordx4 v[80:83], v0, s[4:7], s12 offen offset:1024 sc1
    s_nop 0
    s_sub_u32 s15, s15, 1
    s_cbranch_scc0 L_adaLN_cond__memory_aug_recurrent_mem_tr__dense_activation_gelu__prompt_kernel_rf_h2p
    s_branch L_adaLN_cond__memory_aug_recurrent_mem_tr__dense_activation_gelu__prompt_kernel_r_abort
L_adaLN_cond__memory_aug_recurrent_mem_tr__dense_activation_gelu__prompt_kernel_rf_h2u0:
    ds_write_b128 v10, v[76:79] offset:32768
    ds_write_b128 v10, v[80:83] offset:33792
L_adaLN_cond__memory_aug_recurrent_mem_tr__dense_activation_gelu__prompt_kernel_rf_h2ok:
    s_mov_b64 exec, s[32:33]
    v_mov_b32 v10, -1
    buffer_store_dword v10, v7, s[4:7], s14 offen
    s_mov_b64 exec, -1
L_adaLN_cond__memory_aug_recurrent_mem_tr__dense_activation_gelu__prompt_kernel_rf_e0:
    s_add_u32 s45, s10, 1
    s_lshr_b32 s45, s45, 2
    s_min_u32 s45, s45, 15
    s_cmp_gt_u32 s51, s45
    s_cbranch_scc1 L_adaLN_cond__memory_aug_recurrent_mem_tr__dense_activation_gelu__prompt_kernel_rf_kvok
    s_mov_b32 s15, 100000
L_adaLN_cond__memory_aug_recurrent_mem_tr__dense_activation_gelu__prompt_kernel_rf_kvp:
    v_lshlrev_b32 v10, 3, v0
    v_min_u32 v10, 1920, v10
    s_mov_b32 s46, 3934208
    buffer_load_dword v11, v10, s[4:7], s46 offen sc1
    s_waitcnt vmcnt(0)
    v_cmp_gt_u32 vcc, 64, v11
    s_nop 4
    s_ff1_i32_b64 s51, vcc
    s_min_u32 s51, s51, 16
    s_cmp_gt_u32 s51, s45
    s_cbranch_scc1 L_adaLN_cond__memory_aug_recurrent_mem_tr__dense_activation_gelu__prompt_kernel_rf_kvok
    s_sleep 2
    s_sub_u32 s15, s15, 1
    s_cbranch_scc0 L_adaLN_cond__memory_aug_recurrent_mem_tr__dense_activation_gelu__prompt_kernel_rf_kvp
    s_branch L_adaLN_cond__memory_aug_recurrent_mem_tr__dense_activation_gelu__prompt_kernel_r_abort
L_adaLN_cond__memory_aug_recurrent_mem_tr__dense_activation_gelu__prompt_kernel_rf_kvok:
    s_waitcnt lgkmcnt(0)
    s_barrier
    ds_read_b128 v[76:79], v2 offset:32768
    ds_read_b128 v[80:83], v2 offset:33280
    ds_read_b128 v[84:87], v2 offset:33792
    ds_read_b128 v[88:91], v2 offset:34304
    s_waitcnt lgkmcnt(3)
    v_smfmac_f32_16x16x64_bf16 v[12:15], v[76:79], v[16:23], v1
    s_mov_b32 m0, s28
    s_nop 0
    buffer_load_dwordx4 v0, s[4:7], s24 offen sc1 lds
    v_smfmac_f32_16x16x64_bf16 v[72:75], v[76:79], v[24:31], v1
    ds_read_b128 v[16:19], v2 offset:35840
    s_waitcnt lgkmcnt(3)
    v_smfmac_f32_16x16x64_bf16 v[12:15], v[80:83], v[32:39], v1
    ds_read_b128 v[20:23], v9 offset:14336
    v_smfmac_f32_16x16x64_bf16 v[72:75], v[80:83], v[40:47], v1
    ds_read_b128 v[28:31], v2 offset:36352
    s_waitcnt lgkmcnt(4)
    v_smfmac_f32_16x16x64_bf16 v[12:15], v[84:87], v[48:55], v1
    ds_read_b128 v[24:27], v9 offset:15360
    v_smfmac_f32_16x16x64_bf16 v[72:75], v[84:87], v[56:63], v1
    ds_read_b128 v[32:35], v2 offset:36864
    s_waitcnt lgkmcnt(5)
    v_smfmac_f32_16x16x64_bf16 v[12:15], v[88:91], v[64:71], v1
    buffer_load_dwordx4 v0, s[4:7], s24 offen offset:1024 sc1 lds
    s_add_u32 s24, s24, 262144
    s_xor_b32 s28, s28, 16384
    s_waitcnt lgkmcnt(4)
    v_smfmac_f32_16x16x64_bf16 v[12:15], v[16:19], v[96:103], v1
    s_mov_b32 m0, s29
    s_nop 0
    buffer_load_dwordx4 v0, s[4:7], s25 offen sc1 lds
    v_smfmac_f32_16x16x64_bf16 v[72:75], v[16:19], v[104:111], v1
    ds_read_b128 v[16:19], v2 offset:37376
    s_waitcnt lgkmcnt(3)
    v_smfmac_f32_16x16x64_bf16 v[12:15], v[28:31], v[112:119], v1
    buffer_load_dwordx4 v0, s[4:7], s25 offen offset:1024 sc1 lds
    s_add_u32 s25, s25, 262144
    s_xor_b32 s29, s29, 16384
    v_smfmac_f32_16x16x64_bf16 v[72:75], v[28:31], v[120:127], v1
    ds_read_b128 v[28:31], v2 offset:37888
    s_waitcnt lgkmcnt(3)
    v_smfmac_f32_16x16x64_bf16 v[72:75], v[88:91], v[20:27], v1
    s_or_b32 s46, s8, s9
    s_cmp_lg_u32 s46, 0
    s_cbranch_scc1 L_adaLN_cond__memory_aug_recurrent_mem_tr__dense_activation_gelu__prompt_kernel_rf_nopg
    s_mov_b64 exec, 1
    s_mov_b32 s46, 3946496
    s_sub_u32 s47, s10, 0
    s_max_i32 s47, s47, 0
    v_mov_b32 v10, 0
    v_mov_b32 v11, s47
    buffer_store_dword v11, v10, s[4:7], s46 offen sc1
    s_mov_b64 exec, -1
L_adaLN_cond__memory_aug_recurrent_mem_tr__dense_activation_gelu__prompt_kernel_rf_nopg:
    s_nop 0
    s_waitcnt lgkmcnt(2)
    v_smfmac_f32_16x16x64_bf16 v[12:15], v[32:35], v[128:135], v1
    ds_read_b128 v[20:23], v9 offset:16384
    v_smfmac_f32_16x16x64_bf16 v[72:75], v[32:35], v[136:143], v1
    ds_read_b128 v[32:35], v2 offset:38400
    s_waitcnt lgkmcnt(3)
    v_smfmac_f32_16x16x64_bf16 v[12:15], v[16:19], v[144:151], v1
    ds_read_b128 v[24:27], v9 offset:17408
    v_and_b32 v10, 1, v1
    v_smfmac_f32_16x16x64_bf16 v[72:75], v[16:19], v[152:159], v1
    ds_read_b128 v[16:19], v2 offset:38912
    s_waitcnt lgkmcnt(4)
    v_smfmac_f32_16x16x64_bf16 v[12:15], v[28:31], v[160:167], v1
    ds_read_b128 v[36:39], v9 offset:20480
    v_lshl_add_u32 v10, v10, 9, v2
    v_smfmac_f32_16x16x64_bf16 v[72:75], v[28:31], v[168:175], v1
    ds_read_b128 v[28:31], v2 offset:39424
    s_waitcnt lgkmcnt(4)
    v_smfmac_f32_16x16x64_bf16 v[12:15], v[32:35], v[176:183], v1
    ds_read_b128 v[40:43], v9 offset:21504
    v_smfmac_f32_16x16x64_bf16 v[72:75], v[32:35], v[184:191], v1
    ds_read_b128 v[32:35], v2 offset:39936
    s_waitcnt lgkmcnt(4)
    v_smfmac_f32_16x16x64_bf16 v[12:15], v[16:19], v[192:199], v1
    ds_read_b128 v[44:47], v9 offset:18432
    v_smfmac_f32_16x16x64_bf16 v[72:75], v[16:19], v[200:207], v1
    ds_read_b128 v[16:19], v2 offset:40448
    s_waitcnt lgkmcnt(4)
    v_smfmac_f32_16x16x64_bf16 v[12:15], v[28:31], v[208:215], v1
    ds_read_b128 v[48:51], v9 offset:19456
    v_smfmac_f32_16x16x64_bf16 v[72:75], v[28:31], v[216:223], v1
    ds_read_b128 v[28:31], v2 offset:34816
    s_waitcnt lgkmcnt(4)
    v_smfmac_f32_16x16x64_bf16 v[12:15], v[32:35], v[224:231], v1
    ds_read_b128 v[52:55], v9 offset:22528
    v_smfmac_f32_16x16x64_bf16 v[72:75], v[32:35], v[232:239], v1
    ds_read_b128 v[32:35], v2 offset:35328
    s_waitcnt lgkmcnt(4)
    v_smfmac_f32_16x16x64_bf16 v[12:15], v[16:19], v[240:247], v1
    ds_read_b128 v[56:59], v9 offset:23552
    v_smfmac_f32_16x16x64_bf16 v[72:75], v[16:19], v[248:255], v1
    ds_read_b128 v[16:19], v0 offset:52736
    s_waitcnt lgkmcnt(4)
    v_smfmac_f32_16x16x64_bf16 v[12:15], v[28:31], v[20:27], v1
    ds_read_b128 v[20:23], v0 offset:52736
    ds_read_b128 v[24:27], v10 offset:32768
    s_waitcnt lgkmcnt(4)
    v_smfmac_f32_16x16x64_bf16 v[12:15], v[32:35], v[36:43], v1
    ds_read_b128 v[36:39], v10 offset:33792
    v_smfmac_f32_16x16x64_bf16 v[72:75], v[28:31], v[44:51], v1
    ds_read_b128 v[28:31], v10 offset:34816
    s_waitcnt lgkmcnt(5)
    v_smfmac_f32_16x16x64_bf16 v[72:75], v[32:35], v[52:59], v1
    ds_read_b128 v[32:35], v10 offset:35840
    v_pk_mul_f32 v[12:13], v[12:13], s[38:39]
    v_pk_mul_f32 v[14:15], v[14:15], s[38:39]
    s_waitcnt lgkmcnt(3)
    v_smfmac_f32_16x16x64_bf16 v[16:19], v[24:27], a[0:7], v1
    v_cvt_pk_bf16_f32 v40, v12, v13
    v_cvt_pk_bf16_f32 v41, v14, v15
    ds_write_b64 v3, v[40:41]
    v_smfmac_f32_16x16x64_bf16 v[20:23], v[24:27], a[8:15], v1
    v_cvt_pk_bf16_f32 v12, v72, v73
    v_cvt_pk_bf16_f32 v13, v74, v75
    ds_write_b64 v3, v[12:13] offset:2176
    s_waitcnt lgkmcnt(4)
    v_smfmac_f32_16x16x64_bf16 v[16:19], v[36:39], a[16:23], v1
    ds_read_b128 v[24:27], v8 offset:0
    v_smfmac_f32_16x16x64_bf16 v[20:23], v[36:39], a[24:31], v1
    ds_read_b128 v[36:39], v8 offset:4096
    s_waitcnt lgkmcnt(5)
    v_smfmac_f32_16x16x64_bf16 v[16:19], v[28:31], a[32:39], v1
    ds_read_b128 v[40:43], v10 offset:36864
    v_smfmac_f32_16x16x64_bf16 v[20:23], v[28:31], a[40:47], v1
    ds_read_b128 v[28:31], v10 offset:37888
    s_waitcnt lgkmcnt(4)
    s_barrier
    ds_read_b64_tr_b16 v[44:45], v4 offset:0
    ds_read_b64_tr_b16 v[46:47], v4 offset:128
    v_smfmac_f32_16x16x64_bf16 v[16:19], v[32:35], a[48:55], v1
    ds_read_b64_tr_b16 v[48:49], v4 offset:256
    v_smfmac_f32_16x16x64_bf16 v[20:23], v[32:35], a[56:63], v1
    ds_read_b64_tr_b16 v[50:51], v4 offset:384
    s_waitcnt lgkmcnt(5)
    v_smfmac_f32_16x16x64_bf16 v[16:19], v[40:43], a[64:71], v1
    ds_read_b128 v[32:35], v10 offset:38912
    v_smfmac_f32_16x16x64_bf16 v[20:23], v[40:43], a[72:79], v1
    ds_read_b128 v[40:43], v8 offset:1024
    s_waitcnt lgkmcnt(6)
    v_smfmac_f32_16x16x64_bf16 v[16:19], v[28:31], a[80:87], v1
    ds_read_b128 v[52:55], v8 offset:5120
    v_smfmac_f32_16x16x64_bf16 v[20:23], v[28:31], a[88:95], v1
    ds_read_b128 v[28:31], v10 offset:39936
    s_waitcnt lgkmcnt(6)
    v_mfma_f32_16x16x32_bf16 v[56:59], v[24:27], v[44:47], 0
    ds_read_b64_tr_b16 v[24:25], v4 offset:512
    ds_read_b64_tr_b16 v[26:27], v4 offset:640
    v_mfma_f32_16x16x32_bf16 v[60:63], v[36:39], v[44:47], 0
    ds_read_b128 v[36:39], v8 offset:2048
    ds_read_b128 v[64:67], v8 offset:6144
    s_waitcnt lgkmcnt(7)
    v_smfmac_f32_16x16x64_bf16 v[16:19], v[32:35], a[96:103], v1
    ds_read_b64_tr_b16 v[68:69], v4 offset:768
    s_waitcnt lgkmcnt(7)
    v_mfma_f32_16x16x32_bf16 v[56:59], v[40:43], v[48:51], v[56:59]
    ds_read_b64_tr_b16 v[70:71], v4 offset:896
    ds_read_b128 v[40:43], v8 offset:3072
    s_waitcnt lgkmcnt(8)
    v_mfma_f32_16x16x32_bf16 v[60:63], v[52:55], v[48:51], v[60:63]
    ds_read_b128 v[52:55], v8 offset:7168
    ds_read_b64_tr_b16 v[72:73], v4 offset:2176
    ds_read_b64_tr_b16 v[74:75], v4 offset:2304
    s_waitcnt lgkmcnt(7)
    v_mfma_f32_16x16x32_bf16 v[56:59], v[36:39], v[24:27], v[56:59]
    ds_read_b64_tr_b16 v[36:37], v4 offset:2432
    ds_read_b64_tr_b16 v[38:39], v4 offset:2560
    s_waitcnt lgkmcnt(8)
    v_mfma_f32_16x16x32_bf16 v[60:63], v[64:67], v[24:27], v[60:63]
    ds_read_b64_tr_b16 v[64:65], v4 offset:2688
    ds_read_b64_tr_b16 v[66:67], v4 offset:2816
    ds_read_b64_tr_b16 v[76:77], v4 offset:2944
    s_waitcnt lgkmcnt(8)
    v_mfma_f32_16x16x32_bf16 v[56:59], v[40:43], v[68:71], v[56:59]
    ds_read_b64_tr_b16 v[78:79], v4 offset:3072
    v_lshrrev_b32 v9, 1, v0
    s_waitcnt lgkmcnt(8)
    v_mfma_f32_16x16x32_bf16 v[60:63], v[52:55], v[68:71], v[60:63]
    buffer_store_dwordx2 v[12:13], v9, s[4:7], s26 offen sc1
    v_add_u32 v9, s50, v8
    s_waitcnt lgkmcnt(6)
    v_mfma_f32_16x16x32_bf16 v[12:15], v[72:75], v[44:47], 0
    ds_read_b128 v[40:43], v9 offset:8192
    v_max3_f32 v10, v56, v57, v58
    s_waitcnt lgkmcnt(5)
    v_mfma_f32_16x16x32_bf16 v[12:15], v[36:39], v[48:51], v[12:15]
    ds_read_b128 v[36:39], v9 offset:9216
    v_max3_f32 v9, v59, v60, v61
    s_waitcnt lgkmcnt(4)
    v_mfma_f32_16x16x32_bf16 v[12:15], v[64:67], v[24:27], v[12:15]
    ds_read_b128 v[24:27], v0 offset:50688
    v_max3_f32 v10, v10, v62, v63
    s_waitcnt lgkmcnt(3)
    v_mfma_f32_16x16x32_bf16 v[12:15], v[76:79], v[68:71], v[12:15]
    ds_read_b128 v[44:47], v0 offset:51712
    v_max_f32 v10, v10, v9
    v_smfmac_f32_16x16x64_bf16 v[20:23], v[32:35], a[104:111], v1
    s_nop 3
    v_max3_f32 v9, v12, v13, v14
    v_max3_f32 v10, v10, v9, v15
    v_mov_b32 v9, v10
    v_smfmac_f32_16x16x64_bf16 v[16:19], v[28:31], a[112:119], v1
    s_nop 0
    v_permlane32_swap_b32 v10, v9
    ds_read_b128 v[32:35], v0 offset:52736
    v_max_f32 v10, v10, v9
    v_mov_b32 v9, v10
    v_smfmac_f32_16x16x64_bf16 v[20:23], v[28:31], a[120:127], v1
    s_nop 0
    v_permlane16_swap_b32 v10, v9
    ds_read_b128 v[28:31], v0 offset:52736
    v_max_f32 v10, v10, v9
    v_pk_add_f32 v[56:57], v[56:57], v[10:11] op_sel_hi:[1,0] neg_lo:[0,1] neg_hi:[0,1]
    v_pk_add_f32 v[58:59], v[58:59], v[10:11] op_sel_hi:[1,0] neg_lo:[0,1] neg_hi:[0,1]
    v_pk_add_f32 v[60:61], v[60:61], v[10:11] op_sel_hi:[1,0] neg_lo:[0,1] neg_hi:[0,1]
    v_pk_add_f32 v[62:63], v[62:63], v[10:11] op_sel_hi:[1,0] neg_lo:[0,1] neg_hi:[0,1]
    v_exp_f32 v56, v56
    v_exp_f32 v57, v57
    v_exp_f32 v58, v58
    v_exp_f32 v59, v59
    v_pk_add_f32 v[12:13], v[12:13], v[10:11] op_sel_hi:[1,0] neg_lo:[0,1] neg_hi:[0,1]
    v_pk_add_f32 v[14:15], v[14:15], v[10:11] op_sel_hi:[1,0] neg_lo:[0,1] neg_hi:[0,1]
    v_exp_f32 v60, v60
    v_exp_f32 v61, v61
    v_exp_f32 v62, v62
    v_exp_f32 v63, v63
    v_cvt_pk_bf16_f32 v48, v56, v57
    v_cvt_pk_bf16_f32 v49, v58, v59
    v_cvt_pk_bf16_f32 v50, v60, v61
    v_cvt_pk_bf16_f32 v51, v62, v63
    v_cvt_pk_bf16_f32 v52, v16, v17
    v_cvt_pk_bf16_f32 v53, v18, v19
    v_cvt_pk_bf16_f32 v54, v20, v21
    v_cvt_pk_bf16_f32 v55, v22, v23
    v_exp_f32 v12, v12
    s_waitcnt lgkmcnt(3)
    v_mfma_f32_16x16x32_bf16 v[16:19], v[24:27], v[48:51], 0
    buffer_store_dwordx4 v[52:55], v0, s[4:7], s27 offen sc1
    s_cmp_eq_u32 s10, 63
    s_cbranch_scc1 L_adaLN_cond__memory_aug_recurrent_mem_tr__dense_activation_gelu__prompt_kernel_r_done
    v_exp_f32 v13, v13
    v_mfma_f32_16x16x32_bf16 v[20:23], v[40:43], v[48:51], 0
    v_exp_f32 v14, v14
    v_mfma_f32_16x16x32_bf16 v[24:27], v[36:39], v[48:51], 0
    v_exp_f32 v15, v15
    v_cvt_pk_bf16_f32 v10, v12, v13
    v_cvt_pk_bf16_f32 v11, v14, v15
    s_waitcnt lgkmcnt(2)
    s_nop 0
    v_mfma_f32_16x16x16_bf16 v[16:19], v[44:45], v[10:11], v[16:19]
    ds_read_b128 v[12:15], v0 offset:52736
    v_add_u32 v39, s37, v0
    v_mfma_f32_16x16x16_bf16 v[20:23], v[52:53], v[10:11], v[20:23]
    ds_read_b128 v[40:43], v0 offset:52736
    v_add_u32 v36, s34, v0
    v_mfma_f32_16x16x16_bf16 v[24:27], v[54:55], v[10:11], v[24:27]
    v_add_u32 v37, s35, v0
    v_add_u32 v38, s36, v0
    v_rcp_f32 v10, v16
    s_nop 0
    v_pk_mul_f32 v[20:21], v[20:21], v[10:11] op_sel_hi:[1,0]
    v_pk_mul_f32 v[22:23], v[22:23], v[10:11] op_sel_hi:[1,0]
    s_nop 1
    v_pk_mul_f32 v[24:25], v[24:25], v[10:11] op_sel_hi:[1,0]
    v_pk_mul_f32 v[26:27], v[26:27], v[10:11] op_sel_hi:[1,0]
    v_cvt_pk_bf16_f32 v16, v20, v24
    v_cvt_pk_bf16_f32 v17, v21, v25
    v_cvt_pk_bf16_f32 v18, v22, v26
    v_cvt_pk_bf16_f32 v19, v23, v27
    ds_write_b128 v39, v[16:19]
    s_waitcnt lgkmcnt(4)
    v_smfmac_f32_16x16x64_bf16 v[32:35], v[16:19], a[128:135], v1
    s_waitcnt lgkmcnt(3)
    v_smfmac_f32_16x16x64_bf16 v[28:31], v[16:19], a[136:143], v1
    s_waitcnt lgkmcnt(2)
    v_smfmac_f32_16x16x64_bf16 v[12:15], v[16:19], a[144:151], v1
    s_waitcnt lgkmcnt(0)
    s_barrier
    ds_read_b128 v[20:23], v36
    ds_read_b128 v[24:27], v37
    ds_read_b128 v[44:47], v38
    v_smfmac_f32_16x16x64_bf16 v[40:43], v[16:19], a[152:159], v1
    s_waitcnt lgkmcnt(2)
    v_smfmac_f32_16x16x64_bf16 v[32:35], v[20:23], a[160:167], v1
    s_waitcnt lgkmcnt(1)
    v_smfmac_f32_16x16x64_bf16 v[32:35], v[24:27], a[192:199], v1
    s_waitcnt lgkmcnt(0)
    v_smfmac_f32_16x16x64_bf16 v[32:35], v[44:47], a[224:231], v1
    v_smfmac_f32_16x16x64_bf16 v[28:31], v[20:23], a[168:175], v1
    v_smfmac_f32_16x16x64_bf16 v[28:31], v[24:27], a[200:207], v1
    v_smfmac_f32_16x16x64_bf16 v[28:31], v[44:47], a[232:239], v1
    v_cvt_pk_bf16_f32 v16, v32, v33
    v_smfmac_f32_16x16x64_bf16 v[12:15], v[20:23], a[176:183], v1
    v_cvt_pk_bf16_f32 v17, v34, v35
    v_and_or_b32 v16, v16, -2, s11
    v_smfmac_f32_16x16x64_bf16 v[12:15], v[24:27], a[208:215], v1
    v_and_or_b32 v17, v17, -2, s11
    v_cvt_pk_bf16_f32 v18, v28, v29
    v_smfmac_f32_16x16x64_bf16 v[12:15], v[44:47], a[240:247], v1
    v_cvt_pk_bf16_f32 v19, v30, v31
    v_and_or_b32 v18, v18, -2, s11
    v_smfmac_f32_16x16x64_bf16 v[40:43], v[20:23], a[184:191], v1
    v_and_or_b32 v19, v19, -2, s11
    buffer_store_dwordx4 v[16:19], v5, s[4:7], s16 offen
    v_smfmac_f32_16x16x64_bf16 v[40:43], v[24:27], a[216:223], v1
    v_cvt_pk_bf16_f32 v16, v12, v13
    v_cvt_pk_bf16_f32 v17, v14, v15
    v_smfmac_f32_16x16x64_bf16 v[40:43], v[44:47], a[248:255], v1
    v_and_or_b32 v16, v16, -2, s11
    v_and_or_b32 v17, v17, -2, s11
    s_nop 5
    v_cvt_pk_bf16_f32 v18, v40, v41
    v_cvt_pk_bf16_f32 v19, v42, v43
    v_and_or_b32 v18, v18, -2, s11
    v_and_or_b32 v19, v19, -2, s11
    buffer_store_dwordx4 v[16:19], v5, s[4:7], s17 offen
    s_branch L_adaLN_cond__memory_aug_recurrent_mem_tr__dense_activation_gelu__prompt_kernel_rf_top
L_adaLN_cond__memory_aug_recurrent_mem_tr__dense_activation_gelu__prompt_kernel_rs_top:
L_adaLN_cond__memory_aug_recurrent_mem_tr__dense_activation_gelu__prompt_kernel_rs_preA:
    v_add_u32 v9, s31, v0
    ds_read_b128 v[12:15], v0 offset:49664
    ds_read_b128 v[16:19], v9 offset:0
    ds_read_b128 v[20:23], v9 offset:1024
    ds_read_b128 v[24:27], v9 offset:2048
    ds_read_b128 v[28:31], v9 offset:3072
    ds_read_b128 v[32:35], v9 offset:4096
    ds_read_b128 v[36:39], v9 offset:5120
    s_cmp_eq_u32 s30, 1
    s_cbranch_scc1 L_adaLN_cond__memory_aug_recurrent_mem_tr__dense_activation_gelu__prompt_kernel_rs_pre
    s_nop 15
    s_nop 15
    s_nop 15
    s_nop 15
    s_mov_b32 s15, 100000
    s_waitcnt lgkmcnt(0)
    buffer_load_dwordx4 v[40:43], v6, s[4:7], s18 offen sc1
    buffer_load_dwordx4 v[44:47], v6, s[4:7], s19 offen sc1
L_adaLN_cond__memory_aug_recurrent_mem_tr__dense_activation_gelu__prompt_kernel_rs_h1p:
    s_waitcnt vmcnt(0)
    v_bitop3_b32 v48, v40, v41, s11 bitop3:0x7e
    v_bitop3_b32 v49, v42, v43, s11 bitop3:0x7e
    v_bitop3_b32 v50, v44, v45, s11 bitop3:0x7e
    v_bitop3_b32 v51, v46, v47, s11 bitop3:0x7e
    v_or3_b32 v48, v48, v49, v50
    v_bitop3_b32 v48, v48, v51, 1 bitop3:0xa8
    v_cmp_ne_u32 vcc, 0, v48
    s_cbranch_vccz L_adaLN_cond__memory_aug_recurrent_mem_tr__dense_activation_gelu__prompt_kernel_rs_h1u0
    buffer_load_dwordx4 v[40:43], v6, s[4:7], s18 offen sc1
    buffer_load_dwordx4 v[44:47], v6, s[4:7], s19 offen sc1
    s_nop 0
    s_sub_u32 s15, s15, 1
    s_cbranch_scc0 L_adaLN_cond__memory_aug_recurrent_mem_tr__dense_activation_gelu__prompt_kernel_rs_h1p
    s_branch L_adaLN_cond__memory_aug_recurrent_mem_tr__dense_activation_gelu__prompt_kernel_r_abort
L_adaLN_cond__memory_aug_recurrent_mem_tr__dense_activation_gelu__prompt_kernel_rs_h1u0:
    v_mfma_f32_16x16x32_bf16 v[48:51], v[12:15], v[40:43], 0
    v_mfma_f32_16x16x32_bf16 v[48:51], v[12:15], v[44:47], v[48:51]
L_adaLN_cond__memory_aug_recurrent_mem_tr__dense_activation_gelu__prompt_kernel_rs_h1ok:
    s_nop 3
    s_add_u32 s12, s13, s50
    s_xor_b32 s11, s11, 1
    s_add_u32 s10, s10, 1
    s_nop 0
    v_add_f32_dpp v48, v48, v48 row_ror:4 row_mask:0xf bank_mask:0xf
    v_add_f32_dpp v49, v49, v49 row_ror:4 row_mask:0xf bank_mask:0xf
    s_nop 0
    v_add_f32_dpp v48, v48, v48 row_ror:8 row_mask:0xf bank_mask:0xf
    v_add_f32_dpp v49, v49, v49 row_ror:8 row_mask:0xf bank_mask:0xf
    v_cvt_pk_bf16_f32 v48, v48, v49
    s_mov_b64 exec, s[32:33]
    buffer_store_dword v48, v7, s[4:7], s13 offen sc1
    s_mov_b64 exec, -1
    s_mov_b32 s13, s14
    s_add_u32 s14, s14, 8192
    s_cmp_eq_u32 s14, 3694592
    s_cselect_b32 s14, 3670016, s14
    s_add_u32 s26, s26, 65536
    s_add_u32 s27, s27, 131072
    v_xor_b32 v8, 16384, v8
L_adaLN_cond__memory_aug_recurrent_mem_tr__dense_activation_gelu__prompt_kernel_rs_pre:
    ds_read_b128 v[40:43], v9 offset:6144
    ds_read_b128 v[44:47], v9 offset:7168
    ds_read_b128 v[48:51], v9 offset:8192
    ds_read_b128 v[52:55], v9 offset:9216
    ds_read_b128 v[56:59], v9 offset:10240
    ds_read_b128 v[60:63], v9 offset:11264
    ds_read_b128 v[64:67], v9 offset:12288
    ds_read_b128 v[68:71], v9 offset:13312
    ds_read_b128 v[12:15], v0 offset:52736
    ds_read_b128 v[72:75], v0 offset:52736
    v_add_u32 v10, s50, v0
    s_cmp_eq_u32 s30, 1
    s_mov_b32 s30, 0
    s_cbranch_scc1 L_adaLN_cond__memory_aug_recurrent_mem_tr__dense_activation_gelu__prompt_kernel_rs_e0
    s_nop 15
    s_nop 7
    s_mov_b32 s15, 100000
    buffer_load_dwordx4 v[76:79], v0, s[4:7], s12 offen sc1
    buffer_load_dwordx4 v[80:83], v0, s[4:7], s12 offen offset:1024 sc1
L_adaLN_cond__memory_aug_recurrent_mem_tr__dense_activation_gelu__prompt_kernel_rs_h2p:
    s_waitcnt vmcnt(0)
    v_max3_u32 v11, v76, v77, v78
    v_max3_u32 v84, v79, v80, v81
    v_max3_u32 v11, v11, v82, v83
    v_max_u32 v11, v11, v84
    v_cmp_eq_u32 vcc, -1, v11
    s_cbranch_vccz L_adaLN_cond__memory_aug_recurrent_mem_tr__dense_activation_gelu__prompt_kernel_rs_h2u0
    buffer_load_dwordx4 v[76:79], v0, s[4:7], s12 offen sc1
    buffer_load_dwordx4 v[80:83], v0, s[4:7], s12 offen offset:1024 sc1
    s_nop 0
    s_sub_u32 s15, s15, 1
    s_cbranch_scc0 L_adaLN_cond__memory_aug_recurrent_mem_tr__dense_activation_gelu__prompt_kernel_rs_h2p
    s_branch L_adaLN_cond__memory_aug_recurrent_mem_tr__dense_activation_gelu__prompt_kernel_r_abort
L_adaLN_cond__memory_aug_recurrent_mem_tr__dense_activation_gelu__prompt_kernel_rs_h2u0:
    ds_write_b128 v10, v[76:79] offset:32768
    ds_write_b128 v10, v[80:83] offset:33792
L_adaLN_cond__memory_aug_recurrent_mem_tr__dense_activation_gelu__prompt_kernel_rs_h2ok:
    s_mov_b64 exec, s[32:33]
    v_mov_b32 v10, -1
    buffer_store_dword v10, v7, s[4:7], s14 offen sc1
    s_mov_b64 exec, -1
L_adaLN_cond__memory_aug_recurrent_mem_tr__dense_activation_gelu__prompt_kernel_rs_e0:
    s_add_u32 s45, s10, 1
    s_lshr_b32 s45, s45, 2
    s_min_u32 s45, s45, 15
    s_cmp_gt_u32 s51, s45
    s_cbranch_scc1 L_adaLN_cond__memory_aug_recurrent_mem_tr__dense_activation_gelu__prompt_kernel_rs_kvok
    s_mov_b32 s15, 100000
L_adaLN_cond__memory_aug_recurrent_mem_tr__dense_activation_gelu__prompt_kernel_rs_kvp:
    v_lshlrev_b32 v10, 3, v0
    v_min_u32 v10, 1920, v10
    s_mov_b32 s46, 3934208
    buffer_load_dword v11, v10, s[4:7], s46 offen sc1
    s_waitcnt vmcnt(0)
    v_cmp_gt_u32 vcc, 64, v11
    s_nop 4
    s_ff1_i32_b64 s51, vcc
    s_min_u32 s51, s51, 16
    s_cmp_gt_u32 s51, s45
    s_cbranch_scc1 L_adaLN_cond__memory_aug_recurrent_mem_tr__dense_activation_gelu__prompt_kernel_rs_kvok
    s_sleep 2
    s_sub_u32 s15, s15, 1
    s_cbranch_scc0 L_adaLN_cond__memory_aug_recurrent_mem_tr__dense_activation_gelu__prompt_kernel_rs_kvp
    s_branch L_adaLN_cond__memory_aug_recurrent_mem_tr__dense_activation_gelu__prompt_kernel_r_abort
L_adaLN_cond__memory_aug_recurrent_mem_tr__dense_activation_gelu__prompt_kernel_rs_kvok:
    s_waitcnt lgkmcnt(0)
    s_barrier
    ds_read_b128 v[76:79], v2 offset:32768
    ds_read_b128 v[80:83], v2 offset:33280
    ds_read_b128 v[84:87], v2 offset:33792
    ds_read_b128 v[88:91], v2 offset:34304
    s_waitcnt lgkmcnt(3)
    v_smfmac_f32_16x16x64_bf16 v[12:15], v[76:79], v[16:23], v1
    s_mov_b32 m0, s28
    s_nop 0
    buffer_load_dwordx4 v0, s[4:7], s24 offen sc1 lds
    v_smfmac_f32_16x16x64_bf16 v[72:75], v[76:79], v[24:31], v1
    ds_read_b128 v[16:19], v2 offset:35840
    s_waitcnt lgkmcnt(3)
    v_smfmac_f32_16x16x64_bf16 v[12:15], v[80:83], v[32:39], v1
    ds_read_b128 v[20:23], v9 offset:14336
    v_smfmac_f32_16x16x64_bf16 v[72:75], v[80:83], v[40:47], v1
    ds_read_b128 v[28:31], v2 offset:36352
    s_waitcnt lgkmcnt(4)
    v_smfmac_f32_16x16x64_bf16 v[12:15], v[84:87], v[48:55], v1
    ds_read_b128 v[24:27], v9 offset:15360
    v_smfmac_f32_16x16x64_bf16 v[72:75], v[84:87], v[56:63], v1
    ds_read_b128 v[32:35], v2 offset:36864
    s_waitcnt lgkmcnt(5)
    v_smfmac_f32_16x16x64_bf16 v[12:15], v[88:91], v[64:71], v1
    buffer_load_dwordx4 v0, s[4:7], s24 offen offset:1024 sc1 lds
    s_add_u32 s24, s24, 262144
    s_xor_b32 s28, s28, 16384
    s_waitcnt lgkmcnt(4)
    v_smfmac_f32_16x16x64_bf16 v[12:15], v[16:19], v[96:103], v1
    s_mov_b32 m0, s29
    s_nop 0
    buffer_load_dwordx4 v0, s[4:7], s25 offen sc1 lds
    v_smfmac_f32_16x16x64_bf16 v[72:75], v[16:19], v[104:111], v1
    ds_read_b128 v[16:19], v2 offset:37376
    s_waitcnt lgkmcnt(3)
    v_smfmac_f32_16x16x64_bf16 v[12:15], v[28:31], v[112:119], v1
    buffer_load_dwordx4 v0, s[4:7], s25 offen offset:1024 sc1 lds
    s_add_u32 s25, s25, 262144
    s_xor_b32 s29, s29, 16384
    v_smfmac_f32_16x16x64_bf16 v[72:75], v[28:31], v[120:127], v1
    ds_read_b128 v[28:31], v2 offset:37888
    s_waitcnt lgkmcnt(3)
    v_smfmac_f32_16x16x64_bf16 v[72:75], v[88:91], v[20:27], v1
    s_or_b32 s46, s8, s9
    s_cmp_lg_u32 s46, 0
    s_cbranch_scc1 L_adaLN_cond__memory_aug_recurrent_mem_tr__dense_activation_gelu__prompt_kernel_rs_nopg
    s_mov_b64 exec, 1
    s_mov_b32 s46, 3946496
    s_sub_u32 s47, s10, 0
    s_max_i32 s47, s47, 0
    v_mov_b32 v10, 0
    v_mov_b32 v11, s47
    buffer_store_dword v11, v10, s[4:7], s46 offen sc1
    s_mov_b64 exec, -1
L_adaLN_cond__memory_aug_recurrent_mem_tr__dense_activation_gelu__prompt_kernel_rs_nopg:
    s_nop 0
    s_waitcnt lgkmcnt(2)
    v_smfmac_f32_16x16x64_bf16 v[12:15], v[32:35], v[128:135], v1
    ds_read_b128 v[20:23], v9 offset:16384
    v_smfmac_f32_16x16x64_bf16 v[72:75], v[32:35], v[136:143], v1
    ds_read_b128 v[32:35], v2 offset:38400
    s_waitcnt lgkmcnt(3)
    v_smfmac_f32_16x16x64_bf16 v[12:15], v[16:19], v[144:151], v1
    ds_read_b128 v[24:27], v9 offset:17408
    v_and_b32 v10, 1, v1
    v_smfmac_f32_16x16x64_bf16 v[72:75], v[16:19], v[152:159], v1
    ds_read_b128 v[16:19], v2 offset:38912
    s_waitcnt lgkmcnt(4)
    v_smfmac_f32_16x16x64_bf16 v[12:15], v[28:31], v[160:167], v1
    ds_read_b128 v[36:39], v9 offset:20480
    v_lshl_add_u32 v10, v10, 9, v2
    v_smfmac_f32_16x16x64_bf16 v[72:75], v[28:31], v[168:175], v1
    ds_read_b128 v[28:31], v2 offset:39424
    s_waitcnt lgkmcnt(4)
    v_smfmac_f32_16x16x64_bf16 v[12:15], v[32:35], v[176:183], v1
    ds_read_b128 v[40:43], v9 offset:21504
    v_smfmac_f32_16x16x64_bf16 v[72:75], v[32:35], v[184:191], v1
    ds_read_b128 v[32:35], v2 offset:39936
    s_waitcnt lgkmcnt(4)
    v_smfmac_f32_16x16x64_bf16 v[12:15], v[16:19], v[192:199], v1
    ds_read_b128 v[44:47], v9 offset:18432
    v_smfmac_f32_16x16x64_bf16 v[72:75], v[16:19], v[200:207], v1
    ds_read_b128 v[16:19], v2 offset:40448
    s_waitcnt lgkmcnt(4)
    v_smfmac_f32_16x16x64_bf16 v[12:15], v[28:31], v[208:215], v1
    ds_read_b128 v[48:51], v9 offset:19456
    v_smfmac_f32_16x16x64_bf16 v[72:75], v[28:31], v[216:223], v1
    ds_read_b128 v[28:31], v2 offset:34816
    s_waitcnt lgkmcnt(4)
    v_smfmac_f32_16x16x64_bf16 v[12:15], v[32:35], v[224:231], v1
    ds_read_b128 v[52:55], v9 offset:22528
    v_smfmac_f32_16x16x64_bf16 v[72:75], v[32:35], v[232:239], v1
    ds_read_b128 v[32:35], v2 offset:35328
    s_waitcnt lgkmcnt(4)
    v_smfmac_f32_16x16x64_bf16 v[12:15], v[16:19], v[240:247], v1
    ds_read_b128 v[56:59], v9 offset:23552
    v_smfmac_f32_16x16x64_bf16 v[72:75], v[16:19], v[248:255], v1
    ds_read_b128 v[16:19], v0 offset:52736
    s_waitcnt lgkmcnt(4)
    v_smfmac_f32_16x16x64_bf16 v[12:15], v[28:31], v[20:27], v1
    ds_read_b128 v[20:23], v0 offset:52736
    ds_read_b128 v[24:27], v10 offset:32768
    s_waitcnt lgkmcnt(4)
    v_smfmac_f32_16x16x64_bf16 v[12:15], v[32:35], v[36:43], v1
    ds_read_b128 v[36:39], v10 offset:33792
    v_smfmac_f32_16x16x64_bf16 v[72:75], v[28:31], v[44:51], v1
    ds_read_b128 v[28:31], v10 offset:34816
    s_waitcnt lgkmcnt(5)
    v_smfmac_f32_16x16x64_bf16 v[72:75], v[32:35], v[52:59], v1
    ds_read_b128 v[32:35], v10 offset:35840
    v_pk_mul_f32 v[12:13], v[12:13], s[38:39]
    v_pk_mul_f32 v[14:15], v[14:15], s[38:39]
    s_waitcnt lgkmcnt(3)
    v_smfmac_f32_16x16x64_bf16 v[16:19], v[24:27], a[0:7], v1
    v_cvt_pk_bf16_f32 v40, v12, v13
    v_cvt_pk_bf16_f32 v41, v14, v15
    ds_write_b64 v3, v[40:41]
    v_smfmac_f32_16x16x64_bf16 v[20:23], v[24:27], a[8:15], v1
    v_cvt_pk_bf16_f32 v12, v72, v73
    v_cvt_pk_bf16_f32 v13, v74, v75
    ds_write_b64 v3, v[12:13] offset:2176
    s_waitcnt lgkmcnt(4)
    v_smfmac_f32_16x16x64_bf16 v[16:19], v[36:39], a[16:23], v1
    ds_read_b128 v[24:27], v8 offset:0
    v_smfmac_f32_16x16x64_bf16 v[20:23], v[36:39], a[24:31], v1
    ds_read_b128 v[36:39], v8 offset:4096
    s_waitcnt lgkmcnt(5)
    v_smfmac_f32_16x16x64_bf16 v[16:19], v[28:31], a[32:39], v1
    ds_read_b128 v[40:43], v10 offset:36864
    v_smfmac_f32_16x16x64_bf16 v[20:23], v[28:31], a[40:47], v1
    ds_read_b128 v[28:31], v10 offset:37888
    s_waitcnt lgkmcnt(4)
    s_barrier
    ds_read_b64_tr_b16 v[44:45], v4 offset:0
    ds_read_b64_tr_b16 v[46:47], v4 offset:128
    v_smfmac_f32_16x16x64_bf16 v[16:19], v[32:35], a[48:55], v1
    ds_read_b64_tr_b16 v[48:49], v4 offset:256
    v_smfmac_f32_16x16x64_bf16 v[20:23], v[32:35], a[56:63], v1
    ds_read_b64_tr_b16 v[50:51], v4 offset:384
    s_waitcnt lgkmcnt(5)
    v_smfmac_f32_16x16x64_bf16 v[16:19], v[40:43], a[64:71], v1
    ds_read_b128 v[32:35], v10 offset:38912
    v_smfmac_f32_16x16x64_bf16 v[20:23], v[40:43], a[72:79], v1
    ds_read_b128 v[40:43], v8 offset:1024
    s_waitcnt lgkmcnt(6)
    v_smfmac_f32_16x16x64_bf16 v[16:19], v[28:31], a[80:87], v1
    ds_read_b128 v[52:55], v8 offset:5120
    v_smfmac_f32_16x16x64_bf16 v[20:23], v[28:31], a[88:95], v1
    ds_read_b128 v[28:31], v10 offset:39936
    s_waitcnt lgkmcnt(6)
    v_mfma_f32_16x16x32_bf16 v[56:59], v[24:27], v[44:47], 0
    ds_read_b64_tr_b16 v[24:25], v4 offset:512
    ds_read_b64_tr_b16 v[26:27], v4 offset:640
    v_mfma_f32_16x16x32_bf16 v[60:63], v[36:39], v[44:47], 0
    ds_read_b128 v[36:39], v8 offset:2048
    ds_read_b128 v[64:67], v8 offset:6144
    s_waitcnt lgkmcnt(7)
    v_smfmac_f32_16x16x64_bf16 v[16:19], v[32:35], a[96:103], v1
    ds_read_b64_tr_b16 v[68:69], v4 offset:768
    s_waitcnt lgkmcnt(7)
    v_mfma_f32_16x16x32_bf16 v[56:59], v[40:43], v[48:51], v[56:59]
    ds_read_b64_tr_b16 v[70:71], v4 offset:896
    ds_read_b128 v[40:43], v8 offset:3072
    s_waitcnt lgkmcnt(8)
    v_mfma_f32_16x16x32_bf16 v[60:63], v[52:55], v[48:51], v[60:63]
    ds_read_b128 v[52:55], v8 offset:7168
    ds_read_b64_tr_b16 v[72:73], v4 offset:2176
    ds_read_b64_tr_b16 v[74:75], v4 offset:2304
    s_waitcnt lgkmcnt(7)
    v_mfma_f32_16x16x32_bf16 v[56:59], v[36:39], v[24:27], v[56:59]
    ds_read_b64_tr_b16 v[36:37], v4 offset:2432
    ds_read_b64_tr_b16 v[38:39], v4 offset:2560
    s_waitcnt lgkmcnt(8)
    v_mfma_f32_16x16x32_bf16 v[60:63], v[64:67], v[24:27], v[60:63]
    ds_read_b64_tr_b16 v[64:65], v4 offset:2688
    ds_read_b64_tr_b16 v[66:67], v4 offset:2816
    ds_read_b64_tr_b16 v[76:77], v4 offset:2944
    s_waitcnt lgkmcnt(8)
    v_mfma_f32_16x16x32_bf16 v[56:59], v[40:43], v[68:71], v[56:59]
    ds_read_b64_tr_b16 v[78:79], v4 offset:3072
    v_lshrrev_b32 v9, 1, v0
    s_waitcnt lgkmcnt(8)
    v_mfma_f32_16x16x32_bf16 v[60:63], v[52:55], v[68:71], v[60:63]
    buffer_store_dwordx2 v[12:13], v9, s[4:7], s26 offen sc1
    v_add_u32 v9, s50, v8
    s_waitcnt lgkmcnt(6)
    v_mfma_f32_16x16x32_bf16 v[12:15], v[72:75], v[44:47], 0
    ds_read_b128 v[40:43], v9 offset:8192
    v_max3_f32 v10, v56, v57, v58
    s_waitcnt lgkmcnt(5)
    v_mfma_f32_16x16x32_bf16 v[12:15], v[36:39], v[48:51], v[12:15]
    ds_read_b128 v[36:39], v9 offset:9216
    v_max3_f32 v9, v59, v60, v61
    s_waitcnt lgkmcnt(4)
    v_mfma_f32_16x16x32_bf16 v[12:15], v[64:67], v[24:27], v[12:15]
    ds_read_b128 v[24:27], v0 offset:50688
    v_max3_f32 v10, v10, v62, v63
    s_waitcnt lgkmcnt(3)
    v_mfma_f32_16x16x32_bf16 v[12:15], v[76:79], v[68:71], v[12:15]
    ds_read_b128 v[44:47], v0 offset:51712
    v_max_f32 v10, v10, v9
    v_smfmac_f32_16x16x64_bf16 v[20:23], v[32:35], a[104:111], v1
    s_nop 3
    v_max3_f32 v9, v12, v13, v14
    v_max3_f32 v10, v10, v9, v15
    v_mov_b32 v9, v10
    v_smfmac_f32_16x16x64_bf16 v[16:19], v[28:31], a[112:119], v1
    s_nop 0
    v_permlane32_swap_b32 v10, v9
    ds_read_b128 v[32:35], v0 offset:52736
    v_max_f32 v10, v10, v9
    v_mov_b32 v9, v10
    v_smfmac_f32_16x16x64_bf16 v[20:23], v[28:31], a[120:127], v1
    s_nop 0
    v_permlane16_swap_b32 v10, v9
    ds_read_b128 v[28:31], v0 offset:52736
    v_max_f32 v10, v10, v9
    v_pk_add_f32 v[56:57], v[56:57], v[10:11] op_sel_hi:[1,0] neg_lo:[0,1] neg_hi:[0,1]
    v_pk_add_f32 v[58:59], v[58:59], v[10:11] op_sel_hi:[1,0] neg_lo:[0,1] neg_hi:[0,1]
    v_pk_add_f32 v[60:61], v[60:61], v[10:11] op_sel_hi:[1,0] neg_lo:[0,1] neg_hi:[0,1]
    v_pk_add_f32 v[62:63], v[62:63], v[10:11] op_sel_hi:[1,0] neg_lo:[0,1] neg_hi:[0,1]
    v_exp_f32 v56, v56
    v_exp_f32 v57, v57
    v_exp_f32 v58, v58
    v_exp_f32 v59, v59
    v_pk_add_f32 v[12:13], v[12:13], v[10:11] op_sel_hi:[1,0] neg_lo:[0,1] neg_hi:[0,1]
    v_pk_add_f32 v[14:15], v[14:15], v[10:11] op_sel_hi:[1,0] neg_lo:[0,1] neg_hi:[0,1]
    v_exp_f32 v60, v60
    v_exp_f32 v61, v61
    v_exp_f32 v62, v62
    v_exp_f32 v63, v63
    v_cvt_pk_bf16_f32 v48, v56, v57
    v_cvt_pk_bf16_f32 v49, v58, v59
    v_cvt_pk_bf16_f32 v50, v60, v61
    v_cvt_pk_bf16_f32 v51, v62, v63
    v_cvt_pk_bf16_f32 v52, v16, v17
    v_cvt_pk_bf16_f32 v53, v18, v19
    v_cvt_pk_bf16_f32 v54, v20, v21
    v_cvt_pk_bf16_f32 v55, v22, v23
    v_exp_f32 v12, v12
    s_waitcnt lgkmcnt(3)
    v_mfma_f32_16x16x32_bf16 v[16:19], v[24:27], v[48:51], 0
    buffer_store_dwordx4 v[52:55], v0, s[4:7], s27 offen sc1
    s_cmp_eq_u32 s10, 63
    s_cbranch_scc1 L_adaLN_cond__memory_aug_recurrent_mem_tr__dense_activation_gelu__prompt_kernel_r_done
    v_exp_f32 v13, v13
    v_mfma_f32_16x16x32_bf16 v[20:23], v[40:43], v[48:51], 0
    v_exp_f32 v14, v14
    v_mfma_f32_16x16x32_bf16 v[24:27], v[36:39], v[48:51], 0
    v_exp_f32 v15, v15
    v_cvt_pk_bf16_f32 v10, v12, v13
    v_cvt_pk_bf16_f32 v11, v14, v15
    s_waitcnt lgkmcnt(2)
    s_nop 0
    v_mfma_f32_16x16x16_bf16 v[16:19], v[44:45], v[10:11], v[16:19]
    ds_read_b128 v[12:15], v0 offset:52736
    v_add_u32 v39, s37, v0
    v_mfma_f32_16x16x16_bf16 v[20:23], v[52:53], v[10:11], v[20:23]
    ds_read_b128 v[40:43], v0 offset:52736
    v_add_u32 v36, s34, v0
    v_mfma_f32_16x16x16_bf16 v[24:27], v[54:55], v[10:11], v[24:27]
    v_add_u32 v37, s35, v0
    v_add_u32 v38, s36, v0
    v_rcp_f32 v10, v16
    s_nop 0
    v_pk_mul_f32 v[20:21], v[20:21], v[10:11] op_sel_hi:[1,0]
    v_pk_mul_f32 v[22:23], v[22:23], v[10:11] op_sel_hi:[1,0]
    s_nop 1
    v_pk_mul_f32 v[24:25], v[24:25], v[10:11] op_sel_hi:[1,0]
    v_pk_mul_f32 v[26:27], v[26:27], v[10:11] op_sel_hi:[1,0]
    v_cvt_pk_bf16_f32 v16, v20, v24
    v_cvt_pk_bf16_f32 v17, v21, v25
    v_cvt_pk_bf16_f32 v18, v22, v26
    v_cvt_pk_bf16_f32 v19, v23, v27
    ds_write_b128 v39, v[16:19]
    s_waitcnt lgkmcnt(4)
    v_smfmac_f32_16x16x64_bf16 v[32:35], v[16:19], a[128:135], v1
    s_waitcnt lgkmcnt(3)
    v_smfmac_f32_16x16x64_bf16 v[28:31], v[16:19], a[136:143], v1
    s_waitcnt lgkmcnt(2)
    v_smfmac_f32_16x16x64_bf16 v[12:15], v[16:19], a[144:151], v1
    s_waitcnt lgkmcnt(0)
    s_barrier
    ds_read_b128 v[20:23], v36
    ds_read_b128 v[24:27], v37
    ds_read_b128 v[44:47], v38
    v_smfmac_f32_16x16x64_bf16 v[40:43], v[16:19], a[152:159], v1
    s_waitcnt lgkmcnt(2)
    v_smfmac_f32_16x16x64_bf16 v[32:35], v[20:23], a[160:167], v1
    s_waitcnt lgkmcnt(1)
    v_smfmac_f32_16x16x64_bf16 v[32:35], v[24:27], a[192:199], v1
    s_waitcnt lgkmcnt(0)
    v_smfmac_f32_16x16x64_bf16 v[32:35], v[44:47], a[224:231], v1
    v_smfmac_f32_16x16x64_bf16 v[28:31], v[20:23], a[168:175], v1
    v_smfmac_f32_16x16x64_bf16 v[28:31], v[24:27], a[200:207], v1
    v_smfmac_f32_16x16x64_bf16 v[28:31], v[44:47], a[232:239], v1
    v_cvt_pk_bf16_f32 v16, v32, v33
    v_smfmac_f32_16x16x64_bf16 v[12:15], v[20:23], a[176:183], v1
    v_cvt_pk_bf16_f32 v17, v34, v35
    v_and_or_b32 v16, v16, -2, s11
    v_smfmac_f32_16x16x64_bf16 v[12:15], v[24:27], a[208:215], v1
    v_and_or_b32 v17, v17, -2, s11
    v_cvt_pk_bf16_f32 v18, v28, v29
    v_smfmac_f32_16x16x64_bf16 v[12:15], v[44:47], a[240:247], v1
    v_cvt_pk_bf16_f32 v19, v30, v31
    v_and_or_b32 v18, v18, -2, s11
    v_smfmac_f32_16x16x64_bf16 v[40:43], v[20:23], a[184:191], v1
    v_and_or_b32 v19, v19, -2, s11
    buffer_store_dwordx4 v[16:19], v5, s[4:7], s16 offen sc1
    v_smfmac_f32_16x16x64_bf16 v[40:43], v[24:27], a[216:223], v1
    v_cvt_pk_bf16_f32 v16, v12, v13
    v_cvt_pk_bf16_f32 v17, v14, v15
    v_smfmac_f32_16x16x64_bf16 v[40:43], v[44:47], a[248:255], v1
    v_and_or_b32 v16, v16, -2, s11
    v_and_or_b32 v17, v17, -2, s11
    s_nop 5
    v_cvt_pk_bf16_f32 v18, v40, v41
    v_cvt_pk_bf16_f32 v19, v42, v43
    v_and_or_b32 v18, v18, -2, s11
    v_and_or_b32 v19, v19, -2, s11
    buffer_store_dwordx4 v[16:19], v5, s[4:7], s17 offen sc1
    s_branch L_adaLN_cond__memory_aug_recurrent_mem_tr__dense_activation_gelu__prompt_kernel_rs_top
L_adaLN_cond__memory_aug_recurrent_mem_tr__dense_activation_gelu__prompt_kernel_r_abort:
    v_mov_b32 v20, 0xdead
    v_mov_b32 v21, s10
    v_mov_b32 v22, 0
    global_store_dwordx2 v22, v[20:21], s[56:57] offset:88
L_adaLN_cond__memory_aug_recurrent_mem_tr__dense_activation_gelu__prompt_kernel_r_done:
    s_waitcnt vmcnt(0)
    s_barrier
    s_cmp_lg_u32 s9, 0
    s_cbranch_scc1 L_adaLN_cond__memory_aug_recurrent_mem_tr__dense_activation_gelu__prompt_kernel_r_fin
    s_mov_b64 exec, 1
    v_mov_b32 v20, 0
    v_mov_b32 v21, 1
    s_mov_b32 s46, 3946624
    buffer_atomic_add v21, v20, s[4:7], s46 offen
    s_mov_b64 exec, -1
L_adaLN_cond__memory_aug_recurrent_mem_tr__dense_activation_gelu__prompt_kernel_r_fin:
    s_waitcnt vmcnt(0)
L_adaLN_cond__memory_aug_recurrent_mem_tr__dense_activation_gelu__prompt_kernel_r_end:
    s_endpgm
.section .rodata,"a"
.p2align 6
.amdhsa_kernel adaLN_cond__memory_aug_recurrent_mem_tr__dense_activation_gelu__prompt_kernel
  .amdhsa_next_free_vgpr 512
  .amdhsa_next_free_sgpr 102
  .amdhsa_accum_offset 256
  .amdhsa_group_segment_fixed_size 0
  .amdhsa_kernarg_size 136
  .amdhsa_user_sgpr_count 2
  .amdhsa_user_sgpr_kernarg_segment_ptr 1
  .amdhsa_system_sgpr_workgroup_id_x 1
.end_amdhsa_kernel
```
